```python
import torch

def _softmax(x, axis=-1):
    return torch.softmax(x, dim=axis)

def _gelu(x):
    return torch.nn.functional.gelu(x, approximate='tanh')

def _silu(x):
    return torch.nn.functional.silu(x)

def _sigmoid(x):
    return torch.sigmoid(x)

def _layernorm(x, axis=-1, eps=1e-05):
    m = x.mean(dim=axis, keepdim=True)
    v = x.var(dim=axis, keepdim=True, unbiased=False)
    return (x - m) / torch.sqrt(v + eps)

def _scatter_add(tgt, idx, src, axis=0):
    return tgt.clone().index_add_(axis, idx, src)

def _segment_sum(src, seg, n):
    out = torch.zeros((n,) + src.shape[1:], dtype=src.dtype)
    return out.index_add_(0, seg, src)

def _pad(x, pw):
    flat = tuple((v for pair in reversed(pw) for v in pair))
    return torch.nn.functional.pad(x, flat)
kernel_name = 'recurrent_scan__sliding_block_cached__mixer_gmlp__prompt'

def setup_inputs():

    _w = lambda a: (lambda t: t.to(torch.bfloat16) if t.is_floating_point() else t)(torch.as_tensor(a))

    def _A_setup():
        B, Sq, D = (1, 2048, 512)
        Hq, Hkv, Sk, Dh = (32, 32, 2048, 128)
        assert Hq % Hkv == 0, (Hq, Hkv)
        return {'x': _w((lambda *s: torch.randn(*s, dtype=torch.bfloat16) * 0.05)(B, Sq, D)), 'k_cache': _w((lambda *s: torch.randn(*s, dtype=torch.bfloat16) * 0.8)(B, Hkv, Sk, Dh)), 'v_cache': _w((lambda *s: torch.randn(*s, dtype=torch.bfloat16) * 0.2)(B, Hkv, Sk, Dh)), 'wq': _w((lambda *s: torch.randn(*s, dtype=torch.bfloat16) * 0.8)(D, Hq * Dh) * D ** (-0.5)), 'wo': _w((lambda *s: torch.randn(*s, dtype=torch.bfloat16) * 0.2)(Hq * Dh, D) * (Hq * Dh) ** (-0.5))}
    _A_in = _A_setup()

    def _B_setup():
        B, S, D, F = (1, 2048, 512, 1376)
        Fh = F // 2
        return {'x': _w((lambda *s: torch.randn(*s, dtype=torch.bfloat16) * 0.05)(B, S, D)), 'w_in': _w((lambda *s: torch.randn(*s, dtype=torch.bfloat16) * 0.4)(D, 2 * Fh)), 'w_sp': _w(0.01 * (lambda *s: torch.randn(*s, dtype=torch.bfloat16) * 0.4)(S, S)), 'b_sp': _w(1.0 + 0.01 * (lambda *s: torch.randn(*s, dtype=torch.bfloat16) * 0.1)(S)), 'w_out': _w((lambda *s: torch.randn(*s, dtype=torch.bfloat16) * 0.1)(Fh, D))}
    _B_in = _B_setup()
    return {'A_x': _A_in['x'], 'A_k_cache': _A_in['k_cache'], 'A_v_cache': _A_in['v_cache'], 'A_wq': _A_in['wq'], 'A_wo': _A_in['wo'], 'B_x': _B_in['x'], 'B_w_in': _B_in['w_in'], 'B_w_sp': _B_in['w_sp'], 'B_b_sp': _B_in['b_sp'], 'B_w_out': _B_in['w_out']}

def reference(A_x, A_k_cache, A_v_cache, A_wq, A_wo, B_x, B_w_in, B_w_sp, B_b_sp, B_w_out):

    def _A_ref(x, k_cache, v_cache, wq, wo):
        B, Sq, D = x.shape
        Hq, Dh = (32, 128)
        Hkv, Sk = (k_cache.shape[1], k_cache.shape[2])
        W = min(4096, max(256, Sk // 4))
        rep = Hq // Hkv
        q = (lambda x, *d: x.permute(*d))((x @ wq).reshape(B, Sq, Hq, Dh), 0, 2, 1, 3)
        k = (lambda x, n, axis: torch.repeat_interleave(x, n, dim=axis))(k_cache[:, :, Sk - W:, :], rep, axis=1)
        v = (lambda x, n, axis: torch.repeat_interleave(x, n, dim=axis))(v_cache[:, :, Sk - W:, :], rep, axis=1)
        scores = torch.einsum('bhqd,bhkd->bhqk', q, k) * Dh ** (-0.5)
        p = _softmax(scores, axis=-1)
        o = torch.einsum('bhqk,bhkd->bhqd', p, v)
        return (lambda x, *d: x.permute(*d))(o, 0, 2, 1, 3).reshape(B, Sq, Hq * Dh) @ wo

    def _B_ref(x, w_in, w_sp, b_sp, w_out):
        B, S, D = x.shape
        F = w_in.shape[-1]
        Fh = F // 2
        z = _gelu(torch.einsum('bsd,df->bsf', x, w_in))
        z1 = z[..., :Fh].clone()
        z2 = _layernorm(z[..., Fh:], axis=-1)
        g = torch.einsum('ts,bsf->btf', w_sp, z2) + b_sp[None, :, None]
        return torch.einsum('bsf,fd->bsd', z1 * g, w_out)
    x = A_x
    xn = _layernorm(x, axis=-1)
    s = _A_ref(xn, A_k_cache, A_v_cache, A_wq, A_wo)
    g = _silu(_B_ref(xn, B_w_in, B_w_sp, B_b_sp, B_w_out))
    return x + s * g
```

```asm
; @launch grid=(256,1,1) block=(256,1,1) lds=163840
.amdgcn_target "amdgcn-amd-amdhsa--gfx950"
.text
.globl recurrent_scan__sliding_block_cached__mixer_gmlp__prompt_kernel
.p2align 8
.type recurrent_scan__sliding_block_cached__mixer_gmlp__prompt_kernel,@function
recurrent_scan__sliding_block_cached__mixer_gmlp__prompt_kernel:
s_cmp_ge_u32 s2, 0x100
s_cbranch_scc1 L_done
s_load_dwordx8 s[56:63], s[0:1], 0
s_load_dwordx8 s[68:75], s[0:1], 48
s_load_dwordx2 s[80:81], s[0:1], 0x60
s_load_dwordx4 s[76:79], s[0:1], 0x50
s_load_dwordx2 s[64:65], s[0:1], 32
v_lshrrev_b32 v2, 6, v0
v_and_b32 v1, 63, v0
v_readfirstlane_b32 s5, v2
s_mov_b32 s67, 0
s_mov_b32 s94, 0
s_getpc_b64 s[100:101]
L_pc_1:
s_sub_u32 s100, s100, L_pc_1-recurrent_scan__sliding_block_cached__mixer_gmlp__prompt_kernel
s_subb_u32 s101, s101, 0
s_lshr_b32 s82, s2, 3
s_mul_i32 s82, s82, 0x980
v_min_u32 v4, 18, v1
v_lshlrev_b32 v4, 7, v4
v_add_u32 v4, s82, v4
v_min_u32 v4, 0x12f90, v4
global_load_dword a255, v4, s[100:101]
s_mov_b32 s101, s2
s_waitcnt lgkmcnt(0)
s_mov_b32 s28, s80
s_and_b32 s29, s81, 0xffff
s_mov_b32 s30, 0x10000000
s_mov_b32 s31, 0x20000
s_or_b32 s82, s101, s5
s_cmp_eq_u32 s82, 0
s_cbranch_scc0 L_nonce_2
s_memrealtime s[98:99]
s_waitcnt lgkmcnt(0)
s_or_b32 s98, s98, 1
v_mov_b32 v2, s98
v_mov_b32 v3, 0
s_mov_b64 exec, 1
global_store_dword v3, v2, s[78:79] sc0 sc1
s_mov_b64 exec, -1
L_nonce_2:
L_restart:
s_and_b32 s6, s2, 7
s_lshl_b32 s6, s6, 2
s_lshr_b32 s7, s2, 3
s_and_b32 s3, s7, 3
s_add_u32 s3, s3, s6
s_lshr_b32 s4, s2, 5
s_lshl_b32 s82, s4, 8
s_lshl_b32 s83, s5, 6
s_add_u32 s82, s82, s83
s_lshl_b32 s82, s82, 10
s_add_u32 s8, s56, s82
s_addc_u32 s9, s57, 0
s_and_b32 s9, s9, 0xffff
s_mov_b32 s10, 0x10000
s_mov_b32 s11, 0x20000
s_lshl_b32 s82, s3, 8
s_add_u32 s12, s62, s82
s_addc_u32 s13, s63, 0
s_and_b32 s13, s13, 0xffff
s_mov_b32 s14, 0
s_mov_b32 s15, 0x20000
s_sub_u32 s14, 0x400000, s82
s_mov_b32 s16, s68
s_and_b32 s17, s69, 0xffff
s_mov_b32 s18, 0x158000
s_mov_b32 s19, 0x20000
s_mov_b32 s33, 0x1c00
s_mov_b32 s34, 0x3800
s_mov_b32 s35, 0x5400
s_mov_b32 s36, 0x8000
s_mov_b32 s37, 0x9c00
s_mov_b32 s38, 0xb800
s_mov_b32 s39, 0xd400
s_lshl_b32 s82, s5, 17
s_add_u32 s40, s82, 0
s_add_u32 s41, s82, 0x7c00
s_add_u32 s42, s82, 0xf800
s_add_u32 s43, s82, 0x17400
s_mov_b32 s95, s3
s_lshr_b32 s82, s3, 2
s_lshl_b32 s82, s82, 1
s_and_b32 s83, s3, 1
s_add_u32 s66, s82, s83
s_and_b32 s83, s3, 3
s_cmp_lt_u32 s83, 2
s_cselect_b32 s66, s66, 12
s_cmp_lt_u32 s3, 22
s_cselect_b32 s66, s66, 12
s_add_u32 s96, s66, 32
s_mul_i32 s82, s5, 0xac00
s_lshl_b32 s83, s95, 6
s_sub_u32 s84, s83, 32
s_cmp_lt_u32 s95, 22
s_cselect_b32 s83, s83, s84
s_add_u32 s44, s82, s83
s_lshl_b32 s83, s96, 6
s_sub_u32 s84, s83, 32
s_cmp_lt_u32 s96, 22
s_cselect_b32 s83, s83, s84
s_add_u32 s45, s82, s83
s_lshl_b32 s46, s5, 14
v_lshrrev_b32 v2, 3, v1
v_lshlrev_b32 v2, 10, v2
v_and_b32 v3, 7, v1
v_lshrrev_b32 v4, 4, v1
v_xor_b32 v3, v3, v4
v_lshl_add_u32 v10, v3, 4, v2
v_xor_b32 v3, 4, v3
v_lshl_add_u32 v11, v3, 4, v2
v_lshlrev_b32 v3, 2, v4
v_and_b32 v5, 15, v1
v_xor_b32 v5, v5, v3
v_lshlrev_b32 v4, 13, v4
v_lshl_add_u32 v12, v5, 4, v4
v_lshrrev_b32 v2, 2, v1
v_mul_u32_u24 v2, 0xac0, v2
v_and_b32 v3, 3, v1
v_lshl_add_u32 v13, v3, 4, v2
s_lshl_b32 s47, s5, 12
s_add_u32 s47, s47, 0x10000
s_lshl_b32 s48, s5, 10
s_add_u32 s48, s48, 0x14000
s_cmp_lt_u32 s66, 12
s_cbranch_scc1 L_heavy
s_lshl_b32 s86, s4, 8
s_lshl_b32 s87, s3, 3
s_add_u32 s86, s86, s87
s_lshl_b32 s87, s5, 1
s_add_u32 s97, s86, s87
s_lshl_b32 s87, s97, 10
s_mov_b32 s20, s56
s_and_b32 s21, s57, 0xffff
s_mov_b32 s22, 0x200000
s_mov_b32 s23, 0x20000
v_lshlrev_b32 v3, 4, v1
buffer_load_dwordx4 v[40:43], v3, s[20:23], s87 offen
buffer_load_dwordx4 v[44:47], v3, s[20:23], s87 offen offset:1024
s_add_u32 m0, s47, 0
s_nop 0
buffer_load_dwordx4 v12, s[12:15], s40 offen lds
buffer_load_dwordx4 v12, s[12:15], s41 offen offset:1024 lds
buffer_load_dwordx4 v12, s[12:15], s42 offen offset:2048 lds
buffer_load_dwordx4 v12, s[12:15], s43 offen offset:3072 lds
s_add_u32 m0, s48, 0
s_nop 0
buffer_load_dwordx4 v13, s[16:19], s44 offen lds
s_add_u32 m0, s46, 0
s_nop 0
buffer_load_dwordx4 v10, s[8:11], 0 offen lds
buffer_load_dwordx4 v11, s[8:11], s33 offen offset:1024 lds
buffer_load_dwordx4 v10, s[8:11], s34 offen offset:2048 lds
buffer_load_dwordx4 v11, s[8:11], s35 offen offset:3072 lds
s_add_u32 m0, s46, 0x1000
s_nop 0
buffer_load_dwordx4 v10, s[8:11], s36 offen lds
buffer_load_dwordx4 v11, s[8:11], s37 offen offset:1024 lds
buffer_load_dwordx4 v10, s[8:11], s38 offen offset:2048 lds
buffer_load_dwordx4 v11, s[8:11], s39 offen offset:3072 lds
v_add_u32 v10, 0x80, v10
v_add_u32 v11, 0x80, v11
v_add_u32 v12, 0x80000, v12
v_add_u32 v13, 0x2b000, v13
v_mov_b32 v3, 0
global_load_dword v33, v3, s[78:79] sc0 sc1
v_lshrrev_b32 v2, 5, v1
v_bfe_u32 v3, v1, 4, 1
v_bfe_u32 v4, v1, 2, 2
v_and_b32 v5, 3, v1
v_and_b32 v6, 1, v5
v_lshl_add_u32 v6, v3, 1, v6
v_lshrrev_b32 v7, 1, v5
v_lshlrev_b32 v7, 3, v7
v_lshl_add_u32 v8, v2, 3, v4
v_lshlrev_b32 v9, 6, v8
v_lshl_add_u32 v9, v6, 4, v9
v_add_u32 v9, v9, v7
v_add_u32 v18, 0x14000, v9
v_lshlrev_b32 v8, 8, v8
v_add_u32 v8, v8, v7
v_lshl_add_u32 v8, v6, 4, v8
v_add_u32 v8, 0x10000, v8
s_add_u32 s82, s5, 0
s_and_b32 s82, s82, 3
v_xor_b32 v9, s82, v4
v_lshl_add_u32 v14, v9, 6, v8
s_add_u32 s82, s5, 1
s_and_b32 s82, s82, 3
v_xor_b32 v9, s82, v4
v_lshl_add_u32 v15, v9, 6, v8
s_add_u32 s82, s5, 2
s_and_b32 s82, s82, 3
v_xor_b32 v9, s82, v4
v_lshl_add_u32 v16, v9, 6, v8
s_add_u32 s82, s5, 3
s_and_b32 s82, s82, 3
v_xor_b32 v9, s82, v4
v_lshl_add_u32 v17, v9, 6, v8
v_and_b32 v3, 31, v1
v_bfe_u32 v4, v1, 1, 3
v_lshlrev_b32 v3, 7, v3
v_add_u32 v3, s46, v3
v_xor_b32 v4, v4, v2
v_xor_b32 v5, 0, v4
v_lshl_add_u32 v19, v5, 4, v3
v_xor_b32 v5, 2, v4
v_lshl_add_u32 v20, v5, 4, v3
v_xor_b32 v5, 4, v4
v_lshl_add_u32 v21, v5, 4, v3
v_xor_b32 v5, 6, v4
v_lshl_add_u32 v22, v5, 4, v3
s_lshl_b32 s82, s4, 8
s_and_b32 s83, s3, 3
s_lshl_b32 s83, s83, 6
s_add_u32 s82, s82, s83
s_lshl_b32 s82, s82, 10
s_lshl_b32 s83, s4, 16
s_lshl_b32 s84, s3, 8
s_add_u32 s83, s83, s84
s_cmp_eq_u32 s5, 2
s_cselect_b32 s84, s44, s45
s_mul_i32 s85, s5, 0xac00
s_sub_u32 s84, s84, s85
s_min_u32 s84, s84, 0xa80
s_mul_i32 s85, s4, 0x5600
s_add_u32 s84, s84, s85
s_mov_b32 s49, 0x80000
s_cmp_eq_u32 s5, 0
s_cselect_b32 s50, s56, s62
s_cselect_b32 s51, s57, s63
s_cselect_b32 s82, s82, s83
s_cselect_b32 s49, 0x80, s49
s_cmp_lt_u32 s5, 2
s_cselect_b32 s50, s50, s68
s_cselect_b32 s51, s51, s69
s_cselect_b32 s82, s82, s84
s_mov_b32 s83, 0x2b000
s_cmp_lt_u32 s5, 2
s_cselect_b32 s49, s49, s83
s_add_u32 s50, s50, s82
s_addc_u32 s51, s51, 0
s_add_u32 s50, s50, s49
s_addc_u32 s51, s51, 0
s_mov_b32 s82, 0xac0
s_cmp_eq_u32 s5, 1
s_cselect_b32 s82, 0x2000, s82
s_cselect_b32 s83, 0x80, 60
v_bfe_u32 v2, v1, 1, 3
v_mul_lo_u32 v2, v2, s82
v_and_b32 v3, 1, v1
v_mul_lo_u32 v3, v3, s83
v_add_u32 v2, v2, v3
v_lshlrev_b32 v3, 10, v1
s_cmp_eq_u32 s5, 0
s_cselect_b64 s[98:99], -1, 0
v_cndmask_b32 v39, v2, v3, s[98:99]
global_load_dword a254, v39, s[50:51]
s_add_u32 s50, s50, s49
s_addc_u32 s51, s51, 0
global_load_dword a254, v39, s[50:51]
s_add_u32 s50, s50, s49
s_addc_u32 s51, s51, 0
global_load_dword a254, v39, s[50:51]
s_add_u32 s50, s50, s49
s_addc_u32 s51, s51, 0
global_load_dword a254, v39, s[50:51]
s_add_u32 s50, s50, s49
s_addc_u32 s51, s51, 0
s_lshl_b32 s82, s4, 8
s_lshl_b32 s83, s5, 6
s_add_u32 s82, s82, s83
s_lshl_b32 s82, s82, 4
s_add_u32 s7, s82, 0x1000000
v_mov_b32 v23, 0
v_mov_b32 v24, 0
v_and_b32 v2, 15, v1
v_bfe_u32 v3, v1, 4, 1
v_cmp_eq_u32 vcc, v2, v3
v_mov_b32 v4, 0x3f803f80
s_nop 0
v_cndmask_b32 v4, 0, v4, vcc
v_accvgpr_write_b32 a8, v4
v_accvgpr_write_b32 a9, v4
v_accvgpr_write_b32 a10, v4
v_accvgpr_write_b32 a11, v4
v_mov_b32 v38, 0xffff0000
s_waitcnt vmcnt(19)
v_lshlrev_b32 v48, 16, v40
v_and_b32 v49, v38, v40
v_lshlrev_b32 v50, 16, v41
v_and_b32 v51, v38, v41
v_lshlrev_b32 v52, 16, v42
v_and_b32 v53, v38, v42
v_lshlrev_b32 v54, 16, v43
v_and_b32 v55, v38, v43
v_add_f32 v4, v48, v49
v_add_f32 v4, v4, v50
v_add_f32 v4, v4, v51
v_add_f32 v4, v4, v52
v_add_f32 v4, v4, v53
v_add_f32 v4, v4, v54
v_add_f32 v4, v4, v55
s_waitcnt vmcnt(18)
v_lshlrev_b32 v56, 16, v44
v_and_b32 v57, v38, v44
v_lshlrev_b32 v58, 16, v45
v_and_b32 v59, v38, v45
v_lshlrev_b32 v60, 16, v46
v_and_b32 v61, v38, v46
v_lshlrev_b32 v62, 16, v47
v_and_b32 v63, v38, v47
v_add_f32 v5, v56, v57
v_add_f32 v5, v5, v58
v_add_f32 v5, v5, v59
v_add_f32 v5, v5, v60
v_add_f32 v5, v5, v61
v_add_f32 v5, v5, v62
v_add_f32 v5, v5, v63
v_add_f32_dpp v4, v4, v4 quad_perm:[1,0,3,2] row_mask:0xf bank_mask:0xf
s_nop 0
v_add_f32_dpp v5, v5, v5 quad_perm:[1,0,3,2] row_mask:0xf bank_mask:0xf
v_add_f32_dpp v4, v4, v4 quad_perm:[2,3,0,1] row_mask:0xf bank_mask:0xf
s_nop 0
v_add_f32_dpp v5, v5, v5 quad_perm:[2,3,0,1] row_mask:0xf bank_mask:0xf
v_add_f32_dpp v4, v4, v4 row_half_mirror row_mask:0xf bank_mask:0xf
s_nop 0
v_add_f32_dpp v5, v5, v5 row_half_mirror row_mask:0xf bank_mask:0xf
v_add_f32_dpp v4, v4, v4 row_mirror row_mask:0xf bank_mask:0xf
s_nop 0
v_add_f32_dpp v5, v5, v5 row_mirror row_mask:0xf bank_mask:0xf
v_mov_b32 v8, v4
v_mov_b32 v9, v5
s_nop 0
v_permlane16_swap_b32 v4, v8
v_permlane16_swap_b32 v5, v9
v_add_f32 v4, v4, v8
v_add_f32 v5, v5, v9
v_mov_b32 v8, v4
v_mov_b32 v9, v5
s_nop 0
v_permlane32_swap_b32 v4, v8
v_permlane32_swap_b32 v5, v9
v_add_f32 v4, v4, v8
v_add_f32 v5, v5, v9
v_mul_f32 v4, 0x3b000000, v4
v_sub_f32 v48, v48, v4
v_sub_f32 v49, v49, v4
v_sub_f32 v50, v50, v4
v_sub_f32 v51, v51, v4
v_sub_f32 v52, v52, v4
v_sub_f32 v53, v53, v4
v_sub_f32 v54, v54, v4
v_sub_f32 v55, v55, v4
v_mul_f32 v6, v48, v48
v_fmac_f32 v6, v49, v49
v_fmac_f32 v6, v50, v50
v_fmac_f32 v6, v51, v51
v_fmac_f32 v6, v52, v52
v_fmac_f32 v6, v53, v53
v_fmac_f32 v6, v54, v54
v_fmac_f32 v6, v55, v55
v_mul_f32 v5, 0x3b000000, v5
v_sub_f32 v56, v56, v5
v_sub_f32 v57, v57, v5
v_sub_f32 v58, v58, v5
v_sub_f32 v59, v59, v5
v_sub_f32 v60, v60, v5
v_sub_f32 v61, v61, v5
v_sub_f32 v62, v62, v5
v_sub_f32 v63, v63, v5
v_mul_f32 v7, v56, v56
v_fmac_f32 v7, v57, v57
v_fmac_f32 v7, v58, v58
v_fmac_f32 v7, v59, v59
v_fmac_f32 v7, v60, v60
v_fmac_f32 v7, v61, v61
v_fmac_f32 v7, v62, v62
v_fmac_f32 v7, v63, v63
v_add_f32_dpp v6, v6, v6 quad_perm:[1,0,3,2] row_mask:0xf bank_mask:0xf
s_nop 0
v_add_f32_dpp v7, v7, v7 quad_perm:[1,0,3,2] row_mask:0xf bank_mask:0xf
v_add_f32_dpp v6, v6, v6 quad_perm:[2,3,0,1] row_mask:0xf bank_mask:0xf
s_nop 0
v_add_f32_dpp v7, v7, v7 quad_perm:[2,3,0,1] row_mask:0xf bank_mask:0xf
v_add_f32_dpp v6, v6, v6 row_half_mirror row_mask:0xf bank_mask:0xf
s_nop 0
v_add_f32_dpp v7, v7, v7 row_half_mirror row_mask:0xf bank_mask:0xf
v_add_f32_dpp v6, v6, v6 row_mirror row_mask:0xf bank_mask:0xf
s_nop 0
v_add_f32_dpp v7, v7, v7 row_mirror row_mask:0xf bank_mask:0xf
v_mov_b32 v8, v6
v_mov_b32 v9, v7
s_nop 0
v_permlane16_swap_b32 v6, v8
v_permlane16_swap_b32 v7, v9
v_add_f32 v6, v6, v8
v_add_f32 v7, v7, v9
v_mov_b32 v8, v6
v_mov_b32 v9, v7
s_nop 0
v_permlane32_swap_b32 v6, v8
v_permlane32_swap_b32 v7, v9
v_add_f32 v6, v6, v8
v_add_f32 v7, v7, v9
v_mov_b32 v8, 0x3727c5ac
v_fmac_f32 v8, 0x3b000000, v6
v_rsq_f32 v35, v8
v_mov_b32 v34, v4
v_mov_b32 v9, 0x3727c5ac
v_fmac_f32 v9, 0x3b000000, v7
v_rsq_f32 v37, v9
v_mov_b32 v36, v5
s_waitcnt vmcnt(5)
s_barrier
ds_read_b128 a[160:163], v19 offset:0
ds_read_b128 a[164:167], v19 offset:4096
ds_read_b128 a[168:171], v20 offset:0
ds_read_b128 a[172:175], v20 offset:4096
ds_read_b128 a[176:179], v21 offset:0
ds_read_b128 a[180:183], v21 offset:4096
ds_read_b128 a[184:187], v22 offset:0
ds_read_b128 a[188:191], v22 offset:4096
ds_read_b64_tr_b16 v[48:49], v18 offset:0
ds_read_b64_tr_b16 v[50:51], v18 offset:256
ds_read_b64_tr_b16 v[40:41], v14 offset:0
ds_read_b64_tr_b16 v[42:43], v14 offset:1024
ds_read_b64_tr_b16 a[128:129], v15 offset:0
ds_read_b64_tr_b16 a[130:131], v15 offset:1024
ds_read_b64_tr_b16 a[132:133], v16 offset:0
ds_read_b64_tr_b16 a[134:135], v16 offset:1024
ds_read_b64_tr_b16 a[136:137], v17 offset:0
ds_read_b64_tr_b16 a[138:139], v17 offset:1024
s_waitcnt lgkmcnt(0)
v_mfma_f32_32x32x16_bf16 v[64:79], v[48:51], a[160:163], 0
s_add_u32 m0, s47, 0x6000
s_nop 0
buffer_load_dwordx4 v12, s[12:15], s40 offen lds
ds_read_b64_tr_b16 v[56:57], v18 offset:1024
ds_read_b64_tr_b16 v[58:59], v18 offset:1280
v_mfma_f32_32x32x16_bf16 v[80:95], v[48:51], a[164:167], 0
buffer_load_dwordx4 v12, s[12:15], s41 offen offset:1024 lds
ds_read_b64_tr_b16 v[44:45], v14 offset:4096
buffer_load_dwordx4 v12, s[12:15], s42 offen offset:2048 lds
v_lshlrev_b32 v29, 16, v40
v_mfma_f32_32x32x16_bf16 v[128:143], v[40:43], a[160:163], 0
buffer_load_dwordx4 v12, s[12:15], s43 offen offset:3072 lds
ds_read_b64_tr_b16 v[46:47], v14 offset:5120
s_add_u32 m0, s48, 0x6000
v_and_b32 v30, v38, v40
v_add_f32 v23, v23, v29
v_mfma_f32_16x16x32_bf16 a[0:3], v[48:51], a[8:11], 0
buffer_load_dwordx4 v13, s[16:19], s44 offen lds
ds_read_b64_tr_b16 a[140:141], v15 offset:4096
v_add_f32 v24, v24, v30
v_add_u32 v12, 0x80000, v12
v_lshlrev_b32 v31, 16, v41
v_mfma_f32_32x32x16_bf16 v[144:159], v[40:43], a[164:167], 0
ds_read_b64_tr_b16 a[142:143], v15 offset:5120
v_add_u32 v13, 0x2b000, v13
s_add_u32 m0, s46, 0x2000
v_and_b32 v32, v38, v41
buffer_load_dwordx4 v10, s[8:11], 0 offen lds
v_mfma_f32_32x32x16_bf16 v[160:175], a[128:131], a[160:163], 0
buffer_load_dwordx4 v11, s[8:11], s33 offen offset:1024 lds
ds_read_b64_tr_b16 a[144:145], v16 offset:4096
ds_read_b64_tr_b16 a[146:147], v16 offset:5120
v_add_f32 v23, v23, v31
v_add_f32 v24, v24, v32
v_mfma_f32_32x32x16_bf16 v[176:191], a[128:131], a[164:167], 0
buffer_load_dwordx4 v10, s[8:11], s34 offen offset:2048 lds
ds_read_b64_tr_b16 a[148:149], v17 offset:4096
v_lshlrev_b32 v29, 16, v42
v_and_b32 v30, v38, v42
v_mfma_f32_32x32x16_bf16 v[192:207], a[132:135], a[160:163], 0
buffer_load_dwordx4 v11, s[8:11], s35 offen offset:3072 lds
s_add_u32 m0, s46, 0x3000
ds_read_b64_tr_b16 a[150:151], v17 offset:5120
v_add_f32 v23, v23, v29
v_mfma_f32_32x32x16_bf16 v[208:223], a[132:135], a[164:167], 0
buffer_load_dwordx4 v10, s[8:11], s36 offen lds
buffer_load_dwordx4 v11, s[8:11], s37 offen offset:1024 lds
v_add_f32 v24, v24, v30
v_mfma_f32_32x32x16_bf16 v[224:239], a[136:139], a[160:163], 0
buffer_load_dwordx4 v10, s[8:11], s38 offen offset:2048 lds
v_lshlrev_b32 v31, 16, v43
v_and_b32 v32, v38, v43
v_mfma_f32_32x32x16_bf16 v[240:255], a[136:139], a[164:167], 0
buffer_load_dwordx4 v11, s[8:11], s39 offen offset:3072 lds
v_add_f32 v23, v23, v31
v_add_f32 v24, v24, v32
v_add_u32 v10, 0x80, v10
v_add_u32 v11, 0x80, v11
s_waitcnt lgkmcnt(0)
v_mfma_f32_32x32x16_bf16 v[64:79], v[56:59], a[168:171], v[64:79]
s_add_u32 m0, s46, 0
ds_read_b64_tr_b16 v[48:49], v18 offset:2048
buffer_load_dwordx4 v10, s[8:11], 0 offen lds
ds_read_b64_tr_b16 v[50:51], v18 offset:2304
v_mfma_f32_32x32x16_bf16 v[80:95], v[56:59], a[172:175], v[80:95]
buffer_load_dwordx4 v11, s[8:11], s33 offen offset:1024 lds
ds_read_b64_tr_b16 v[40:41], v14 offset:8192
v_lshlrev_b32 v29, 16, v44
v_and_b32 v30, v38, v44
v_mfma_f32_32x32x16_bf16 v[128:143], v[44:47], a[168:171], v[128:143]
buffer_load_dwordx4 v10, s[8:11], s34 offen offset:2048 lds
ds_read_b64_tr_b16 v[42:43], v14 offset:9216
v_add_f32 v23, v23, v29
v_mfma_f32_16x16x32_bf16 a[0:3], v[56:59], a[8:11], a[0:3]
buffer_load_dwordx4 v11, s[8:11], s35 offen offset:3072 lds
ds_read_b64_tr_b16 a[128:129], v15 offset:8192
v_add_f32 v24, v24, v30
v_mfma_f32_32x32x16_bf16 v[144:159], v[44:47], a[172:175], v[144:159]
s_add_u32 m0, s46, 0x1000
ds_read_b64_tr_b16 a[130:131], v15 offset:9216
v_lshlrev_b32 v31, 16, v45
v_and_b32 v32, v38, v45
v_mfma_f32_32x32x16_bf16 v[160:175], a[140:143], a[168:171], v[160:175]
buffer_load_dwordx4 v10, s[8:11], s36 offen lds
ds_read_b64_tr_b16 a[132:133], v16 offset:8192
v_add_f32 v23, v23, v31
v_mfma_f32_32x32x16_bf16 v[176:191], a[140:143], a[172:175], v[176:191]
buffer_load_dwordx4 v11, s[8:11], s37 offen offset:1024 lds
ds_read_b64_tr_b16 a[134:135], v16 offset:9216
v_add_f32 v24, v24, v32
v_mfma_f32_32x32x16_bf16 v[192:207], a[144:147], a[168:171], v[192:207]
buffer_load_dwordx4 v10, s[8:11], s38 offen offset:2048 lds
ds_read_b64_tr_b16 a[136:137], v17 offset:8192
v_lshlrev_b32 v29, 16, v46
v_mfma_f32_32x32x16_bf16 v[208:223], a[144:147], a[172:175], v[208:223]
ds_read_b64_tr_b16 a[138:139], v17 offset:9216
buffer_load_dwordx4 v11, s[8:11], s39 offen offset:3072 lds
v_and_b32 v30, v38, v46
v_mfma_f32_32x32x16_bf16 v[224:239], a[148:151], a[168:171], v[224:239]
v_add_f32 v23, v23, v29
v_add_f32 v24, v24, v30
v_add_u32 v10, 0x80, v10
v_lshlrev_b32 v31, 16, v47
v_mfma_f32_32x32x16_bf16 v[240:255], a[148:151], a[172:175], v[240:255]
v_and_b32 v32, v38, v47
v_add_f32 v23, v23, v31
v_add_u32 v11, 0x80, v11
v_add_f32 v24, v24, v32
s_waitcnt vmcnt(8)
s_barrier
s_waitcnt lgkmcnt(0)
v_mfma_f32_32x32x16_bf16 v[64:79], v[48:51], a[176:179], v[64:79]
ds_read_b64_tr_b16 v[56:57], v18 offset:3072
s_add_u32 m0, s47, 0xc000
ds_read_b128 a[192:195], v19 offset:8192
ds_read_b64_tr_b16 v[58:59], v18 offset:3328
ds_read_b128 a[196:199], v19 offset:12288
v_mfma_f32_32x32x16_bf16 v[80:95], v[48:51], a[180:183], v[80:95]
buffer_load_dwordx4 v12, s[12:15], s40 offen lds
ds_read_b64_tr_b16 v[44:45], v14 offset:12288
ds_read_b128 a[200:203], v20 offset:8192
v_lshlrev_b32 v29, 16, v40
v_mfma_f32_32x32x16_bf16 v[128:143], v[40:43], a[176:179], v[128:143]
ds_read_b64_tr_b16 v[46:47], v14 offset:13312
buffer_load_dwordx4 v12, s[12:15], s41 offen offset:1024 lds
v_and_b32 v30, v38, v40
v_mfma_f32_16x16x32_bf16 a[0:3], v[48:51], a[8:11], a[0:3]
ds_read_b64_tr_b16 a[140:141], v15 offset:12288
buffer_load_dwordx4 v12, s[12:15], s42 offen offset:2048 lds
v_add_f32 v23, v23, v29
v_mfma_f32_32x32x16_bf16 v[144:159], v[40:43], a[180:183], v[144:159]
ds_read_b64_tr_b16 a[142:143], v15 offset:13312
ds_read_b128 a[204:207], v20 offset:12288
v_add_f32 v24, v24, v30
v_lshlrev_b32 v31, 16, v41
v_mfma_f32_32x32x16_bf16 v[160:175], a[128:131], a[176:179], v[160:175]
ds_read_b64_tr_b16 a[144:145], v16 offset:12288
buffer_load_dwordx4 v12, s[12:15], s43 offen offset:3072 lds
v_and_b32 v32, v38, v41
v_mfma_f32_32x32x16_bf16 v[176:191], a[128:131], a[180:183], v[176:191]
ds_read_b64_tr_b16 a[146:147], v16 offset:13312
ds_read_b128 a[208:211], v21 offset:8192
v_add_f32 v23, v23, v31
v_add_f32 v24, v24, v32
v_mfma_f32_32x32x16_bf16 v[192:207], a[132:135], a[176:179], v[192:207]
ds_read_b64_tr_b16 a[148:149], v17 offset:12288
ds_read_b128 a[212:215], v21 offset:12288
v_lshlrev_b32 v29, 16, v42
v_and_b32 v30, v38, v42
v_mfma_f32_32x32x16_bf16 v[208:223], a[132:135], a[180:183], v[208:223]
ds_read_b64_tr_b16 a[150:151], v17 offset:13312
ds_read_b128 a[216:219], v22 offset:8192
s_add_u32 m0, s48, 0xc000
v_add_f32 v23, v23, v29
v_mfma_f32_32x32x16_bf16 v[224:239], a[136:139], a[176:179], v[224:239]
ds_read_b128 a[220:223], v22 offset:12288
v_add_f32 v24, v24, v30
v_lshlrev_b32 v31, 16, v43
v_and_b32 v32, v38, v43
v_mfma_f32_32x32x16_bf16 v[240:255], a[136:139], a[180:183], v[240:255]
buffer_load_dwordx4 v13, s[16:19], s44 offen lds
v_add_f32 v23, v23, v31
v_add_f32 v24, v24, v32
s_waitcnt lgkmcnt(0)
v_mfma_f32_32x32x16_bf16 v[64:79], v[56:59], a[184:187], v[64:79]
ds_read_b64_tr_b16 v[48:49], v18 offset:24576
ds_read_b64_tr_b16 v[50:51], v18 offset:24832
v_add_u32 v12, 0x80000, v12
v_mfma_f32_32x32x16_bf16 v[80:95], v[56:59], a[188:191], v[80:95]
ds_read_b64_tr_b16 v[40:41], v14 offset:24576
v_lshlrev_b32 v29, 16, v44
v_and_b32 v30, v38, v44
v_mfma_f32_32x32x16_bf16 v[128:143], v[44:47], a[184:187], v[128:143]
ds_read_b64_tr_b16 v[42:43], v14 offset:25600
v_add_f32 v23, v23, v29
v_add_u32 v13, 0x2b000, v13
v_mfma_f32_16x16x32_bf16 a[0:3], v[56:59], a[8:11], a[0:3]
ds_read_b64_tr_b16 a[128:129], v15 offset:24576
v_add_f32 v24, v24, v30
v_lshlrev_b32 v31, 16, v45
v_mfma_f32_32x32x16_bf16 v[144:159], v[44:47], a[188:191], v[144:159]
ds_read_b64_tr_b16 a[130:131], v15 offset:25600
v_and_b32 v32, v38, v45
v_add_f32 v23, v23, v31
v_mfma_f32_32x32x16_bf16 v[160:175], a[140:143], a[184:187], v[160:175]
ds_read_b64_tr_b16 a[132:133], v16 offset:24576
v_add_f32 v24, v24, v32
v_lshlrev_b32 v29, 16, v46
v_mfma_f32_32x32x16_bf16 v[176:191], a[140:143], a[188:191], v[176:191]
ds_read_b64_tr_b16 a[134:135], v16 offset:25600
v_and_b32 v30, v38, v46
v_add_f32 v23, v23, v29
v_mfma_f32_32x32x16_bf16 v[192:207], a[144:147], a[184:187], v[192:207]
ds_read_b64_tr_b16 a[136:137], v17 offset:24576
v_add_f32 v24, v24, v30
v_lshlrev_b32 v31, 16, v47
v_mfma_f32_32x32x16_bf16 v[208:223], a[144:147], a[188:191], v[208:223]
ds_read_b64_tr_b16 a[138:139], v17 offset:25600
global_load_dword a254, v39, s[50:51]
v_mfma_f32_32x32x16_bf16 v[224:239], a[148:151], a[184:187], v[224:239]
s_add_u32 s50, s50, s49
s_addc_u32 s51, s51, 0
v_and_b32 v32, v38, v47
v_mfma_f32_32x32x16_bf16 v[240:255], a[148:151], a[188:191], v[240:255]
v_add_f32 v23, v23, v31
v_add_f32 v24, v24, v32
s_waitcnt lgkmcnt(0)
v_mfma_f32_32x32x16_bf16 v[64:79], v[48:51], a[192:195], v[64:79]
ds_read_b64_tr_b16 v[56:57], v18 offset:25600
ds_read_b64_tr_b16 v[58:59], v18 offset:25856
v_mfma_f32_32x32x16_bf16 v[80:95], v[48:51], a[196:199], v[80:95]
ds_read_b64_tr_b16 v[44:45], v14 offset:28672
s_add_u32 m0, s46, 0x2000
v_lshlrev_b32 v29, 16, v40
v_and_b32 v30, v38, v40
v_mfma_f32_32x32x16_bf16 v[128:143], v[40:43], a[192:195], v[128:143]
ds_read_b64_tr_b16 v[46:47], v14 offset:29696
buffer_load_dwordx4 v10, s[8:11], 0 offen lds
v_add_f32 v23, v23, v29
v_mfma_f32_16x16x32_bf16 a[0:3], v[48:51], a[8:11], a[0:3]
ds_read_b64_tr_b16 a[140:141], v15 offset:28672
buffer_load_dwordx4 v11, s[8:11], s33 offen offset:1024 lds
v_add_f32 v24, v24, v30
v_mfma_f32_32x32x16_bf16 v[144:159], v[40:43], a[196:199], v[144:159]
ds_read_b64_tr_b16 a[142:143], v15 offset:29696
v_lshlrev_b32 v31, 16, v41
v_and_b32 v32, v38, v41
v_mfma_f32_32x32x16_bf16 v[160:175], a[128:131], a[192:195], v[160:175]
ds_read_b64_tr_b16 a[144:145], v16 offset:28672
v_add_f32 v23, v23, v31
v_add_f32 v24, v24, v32
v_mfma_f32_32x32x16_bf16 v[176:191], a[128:131], a[196:199], v[176:191]
ds_read_b64_tr_b16 a[146:147], v16 offset:29696
v_lshlrev_b32 v29, 16, v42
v_and_b32 v30, v38, v42
v_mfma_f32_32x32x16_bf16 v[192:207], a[132:135], a[192:195], v[192:207]
ds_read_b64_tr_b16 a[148:149], v17 offset:28672
v_add_f32 v23, v23, v29
v_add_f32 v24, v24, v30
v_mfma_f32_32x32x16_bf16 v[208:223], a[132:135], a[196:199], v[208:223]
ds_read_b64_tr_b16 a[150:151], v17 offset:29696
v_lshlrev_b32 v31, 16, v43
v_and_b32 v32, v38, v43
v_mfma_f32_32x32x16_bf16 v[224:239], a[136:139], a[192:195], v[224:239]
buffer_load_dwordx4 v10, s[8:11], s34 offen offset:2048 lds
v_add_f32 v23, v23, v31
v_mfma_f32_32x32x16_bf16 v[240:255], a[136:139], a[196:199], v[240:255]
buffer_load_dwordx4 v11, s[8:11], s35 offen offset:3072 lds
v_add_f32 v24, v24, v32
s_waitcnt lgkmcnt(0)
v_mfma_f32_32x32x16_bf16 v[64:79], v[56:59], a[200:203], v[64:79]
ds_read_b64_tr_b16 v[48:49], v18 offset:26624
s_add_u32 m0, s46, 0x3000
ds_read_b64_tr_b16 v[50:51], v18 offset:26880
v_mfma_f32_32x32x16_bf16 v[80:95], v[56:59], a[204:207], v[80:95]
ds_read_b64_tr_b16 v[40:41], v14 offset:32768
buffer_load_dwordx4 v10, s[8:11], s36 offen lds
v_lshlrev_b32 v29, 16, v44
v_mfma_f32_32x32x16_bf16 v[128:143], v[44:47], a[200:203], v[128:143]
ds_read_b64_tr_b16 v[42:43], v14 offset:33792
buffer_load_dwordx4 v11, s[8:11], s37 offen offset:1024 lds
v_and_b32 v30, v38, v44
v_mfma_f32_16x16x32_bf16 a[0:3], v[56:59], a[8:11], a[0:3]
ds_read_b64_tr_b16 a[128:129], v15 offset:32768
buffer_load_dwordx4 v10, s[8:11], s38 offen offset:2048 lds
v_add_f32 v23, v23, v29
v_mfma_f32_32x32x16_bf16 v[144:159], v[44:47], a[204:207], v[144:159]
ds_read_b64_tr_b16 a[130:131], v15 offset:33792
ds_read_b64_tr_b16 a[132:133], v16 offset:32768
v_add_f32 v24, v24, v30
v_lshlrev_b32 v31, 16, v45
v_mfma_f32_32x32x16_bf16 v[160:175], a[140:143], a[200:203], v[160:175]
ds_read_b64_tr_b16 a[134:135], v16 offset:33792
v_and_b32 v32, v38, v45
v_add_f32 v23, v23, v31
v_mfma_f32_32x32x16_bf16 v[176:191], a[140:143], a[204:207], v[176:191]
buffer_load_dwordx4 v11, s[8:11], s39 offen offset:3072 lds
v_add_f32 v24, v24, v32
v_mfma_f32_32x32x16_bf16 v[192:207], a[144:147], a[200:203], v[192:207]
ds_read_b64_tr_b16 a[136:137], v17 offset:32768
v_lshlrev_b32 v29, 16, v46
v_and_b32 v30, v38, v46
v_mfma_f32_32x32x16_bf16 v[208:223], a[144:147], a[204:207], v[208:223]
ds_read_b64_tr_b16 a[138:139], v17 offset:33792
v_add_f32 v23, v23, v29
v_add_f32 v24, v24, v30
v_mfma_f32_32x32x16_bf16 v[224:239], a[148:151], a[200:203], v[224:239]
v_lshlrev_b32 v31, 16, v47
v_add_u32 v10, 0x80, v10
v_and_b32 v32, v38, v47
v_mfma_f32_32x32x16_bf16 v[240:255], a[148:151], a[204:207], v[240:255]
v_add_f32 v23, v23, v31
v_add_u32 v11, 0x80, v11
v_add_f32 v24, v24, v32
s_waitcnt vmcnt(9)
s_barrier
s_waitcnt lgkmcnt(0)
v_mfma_f32_32x32x16_bf16 v[64:79], v[48:51], a[208:211], v[64:79]
ds_read_b64_tr_b16 v[56:57], v18 offset:27648
s_add_u32 m0, s47, 0
ds_read_b128 a[160:163], v19 offset:0
ds_read_b64_tr_b16 v[58:59], v18 offset:27904
ds_read_b128 a[164:167], v19 offset:4096
v_mfma_f32_32x32x16_bf16 v[80:95], v[48:51], a[212:215], v[80:95]
buffer_load_dwordx4 v12, s[12:15], s40 offen lds
ds_read_b64_tr_b16 v[44:45], v14 offset:36864
ds_read_b128 a[168:171], v20 offset:0
v_lshlrev_b32 v29, 16, v40
v_mfma_f32_32x32x16_bf16 v[128:143], v[40:43], a[208:211], v[128:143]
ds_read_b64_tr_b16 v[46:47], v14 offset:37888
buffer_load_dwordx4 v12, s[12:15], s41 offen offset:1024 lds
v_and_b32 v30, v38, v40
v_mfma_f32_16x16x32_bf16 a[0:3], v[48:51], a[8:11], a[0:3]
ds_read_b64_tr_b16 a[140:141], v15 offset:36864
buffer_load_dwordx4 v12, s[12:15], s42 offen offset:2048 lds
v_add_f32 v23, v23, v29
v_mfma_f32_32x32x16_bf16 v[144:159], v[40:43], a[212:215], v[144:159]
ds_read_b64_tr_b16 a[142:143], v15 offset:37888
ds_read_b128 a[172:175], v20 offset:4096
v_add_f32 v24, v24, v30
v_lshlrev_b32 v31, 16, v41
v_mfma_f32_32x32x16_bf16 v[160:175], a[128:131], a[208:211], v[160:175]
ds_read_b64_tr_b16 a[144:145], v16 offset:36864
buffer_load_dwordx4 v12, s[12:15], s43 offen offset:3072 lds
v_and_b32 v32, v38, v41
v_mfma_f32_32x32x16_bf16 v[176:191], a[128:131], a[212:215], v[176:191]
ds_read_b64_tr_b16 a[146:147], v16 offset:37888
ds_read_b128 a[176:179], v21 offset:0
v_add_f32 v23, v23, v31
v_add_f32 v24, v24, v32
v_mfma_f32_32x32x16_bf16 v[192:207], a[132:135], a[208:211], v[192:207]
ds_read_b64_tr_b16 a[148:149], v17 offset:36864
ds_read_b128 a[180:183], v21 offset:4096
v_lshlrev_b32 v29, 16, v42
v_and_b32 v30, v38, v42
v_mfma_f32_32x32x16_bf16 v[208:223], a[132:135], a[212:215], v[208:223]
ds_read_b64_tr_b16 a[150:151], v17 offset:37888
ds_read_b128 a[184:187], v22 offset:0
s_add_u32 m0, s48, 0
v_add_f32 v23, v23, v29
v_mfma_f32_32x32x16_bf16 v[224:239], a[136:139], a[208:211], v[224:239]
ds_read_b128 a[188:191], v22 offset:4096
v_add_f32 v24, v24, v30
v_lshlrev_b32 v31, 16, v43
v_and_b32 v32, v38, v43
v_mfma_f32_32x32x16_bf16 v[240:255], a[136:139], a[212:215], v[240:255]
buffer_load_dwordx4 v13, s[16:19], s44 offen lds
v_add_f32 v23, v23, v31
v_add_f32 v24, v24, v32
s_waitcnt lgkmcnt(0)
v_mfma_f32_32x32x16_bf16 v[64:79], v[56:59], a[216:219], v[64:79]
ds_read_b64_tr_b16 v[48:49], v18 offset:49152
ds_read_b64_tr_b16 v[50:51], v18 offset:49408
v_add_u32 v12, 0x80000, v12
v_mfma_f32_32x32x16_bf16 v[80:95], v[56:59], a[220:223], v[80:95]
ds_read_b64_tr_b16 v[40:41], v14 offset:49152
v_lshlrev_b32 v29, 16, v44
v_and_b32 v30, v38, v44
v_mfma_f32_32x32x16_bf16 v[128:143], v[44:47], a[216:219], v[128:143]
ds_read_b64_tr_b16 v[42:43], v14 offset:50176
v_add_f32 v23, v23, v29
v_add_u32 v13, 0x2b000, v13
v_mfma_f32_16x16x32_bf16 a[0:3], v[56:59], a[8:11], a[0:3]
ds_read_b64_tr_b16 a[128:129], v15 offset:49152
v_add_f32 v24, v24, v30
v_lshlrev_b32 v31, 16, v45
v_mfma_f32_32x32x16_bf16 v[144:159], v[44:47], a[220:223], v[144:159]
ds_read_b64_tr_b16 a[130:131], v15 offset:50176
v_and_b32 v32, v38, v45
v_add_f32 v23, v23, v31
v_mfma_f32_32x32x16_bf16 v[160:175], a[140:143], a[216:219], v[160:175]
ds_read_b64_tr_b16 a[132:133], v16 offset:49152
v_add_f32 v24, v24, v32
v_lshlrev_b32 v29, 16, v46
v_mfma_f32_32x32x16_bf16 v[176:191], a[140:143], a[220:223], v[176:191]
ds_read_b64_tr_b16 a[134:135], v16 offset:50176
v_and_b32 v30, v38, v46
v_add_f32 v23, v23, v29
v_mfma_f32_32x32x16_bf16 v[192:207], a[144:147], a[216:219], v[192:207]
ds_read_b64_tr_b16 a[136:137], v17 offset:49152
v_add_f32 v24, v24, v30
v_lshlrev_b32 v31, 16, v47
v_mfma_f32_32x32x16_bf16 v[208:223], a[144:147], a[220:223], v[208:223]
ds_read_b64_tr_b16 a[138:139], v17 offset:50176
global_load_dword a254, v39, s[50:51]
v_mfma_f32_32x32x16_bf16 v[224:239], a[148:151], a[216:219], v[224:239]
s_add_u32 s50, s50, s49
s_addc_u32 s51, s51, 0
v_and_b32 v32, v38, v47
v_mfma_f32_32x32x16_bf16 v[240:255], a[148:151], a[220:223], v[240:255]
v_add_f32 v23, v23, v31
v_add_f32 v24, v24, v32
s_waitcnt lgkmcnt(0)
v_mfma_f32_32x32x16_bf16 v[64:79], v[48:51], a[160:163], v[64:79]
ds_read_b64_tr_b16 v[56:57], v18 offset:50176
ds_read_b64_tr_b16 v[58:59], v18 offset:50432
v_mfma_f32_32x32x16_bf16 v[80:95], v[48:51], a[164:167], v[80:95]
ds_read_b64_tr_b16 v[44:45], v14 offset:53248
s_add_u32 m0, s46, 0
v_lshlrev_b32 v29, 16, v40
v_and_b32 v30, v38, v40
v_mfma_f32_32x32x16_bf16 v[128:143], v[40:43], a[160:163], v[128:143]
ds_read_b64_tr_b16 v[46:47], v14 offset:54272
buffer_load_dwordx4 v10, s[8:11], 0 offen lds
v_add_f32 v23, v23, v29
v_mfma_f32_16x16x32_bf16 a[0:3], v[48:51], a[8:11], a[0:3]
ds_read_b64_tr_b16 a[140:141], v15 offset:53248
buffer_load_dwordx4 v11, s[8:11], s33 offen offset:1024 lds
v_add_f32 v24, v24, v30
v_mfma_f32_32x32x16_bf16 v[144:159], v[40:43], a[164:167], v[144:159]
ds_read_b64_tr_b16 a[142:143], v15 offset:54272
v_lshlrev_b32 v31, 16, v41
v_and_b32 v32, v38, v41
v_mfma_f32_32x32x16_bf16 v[160:175], a[128:131], a[160:163], v[160:175]
ds_read_b64_tr_b16 a[144:145], v16 offset:53248
v_add_f32 v23, v23, v31
v_add_f32 v24, v24, v32
v_mfma_f32_32x32x16_bf16 v[176:191], a[128:131], a[164:167], v[176:191]
ds_read_b64_tr_b16 a[146:147], v16 offset:54272
v_lshlrev_b32 v29, 16, v42
v_and_b32 v30, v38, v42
v_mfma_f32_32x32x16_bf16 v[192:207], a[132:135], a[160:163], v[192:207]
ds_read_b64_tr_b16 a[148:149], v17 offset:53248
v_add_f32 v23, v23, v29
v_add_f32 v24, v24, v30
v_mfma_f32_32x32x16_bf16 v[208:223], a[132:135], a[164:167], v[208:223]
ds_read_b64_tr_b16 a[150:151], v17 offset:54272
v_lshlrev_b32 v31, 16, v43
v_and_b32 v32, v38, v43
v_mfma_f32_32x32x16_bf16 v[224:239], a[136:139], a[160:163], v[224:239]
buffer_load_dwordx4 v10, s[8:11], s34 offen offset:2048 lds
v_add_f32 v23, v23, v31
v_mfma_f32_32x32x16_bf16 v[240:255], a[136:139], a[164:167], v[240:255]
buffer_load_dwordx4 v11, s[8:11], s35 offen offset:3072 lds
v_add_f32 v24, v24, v32
s_waitcnt lgkmcnt(0)
v_mfma_f32_32x32x16_bf16 v[64:79], v[56:59], a[168:171], v[64:79]
s_lshl_b32 s82, s3, 19
ds_read_b64_tr_b16 v[48:49], v18 offset:51200
s_add_u32 m0, s46, 0x1000
s_add_u32 s82, s82, 0x60000
ds_read_b64_tr_b16 v[50:51], v18 offset:51456
v_mfma_f32_32x32x16_bf16 v[80:95], v[56:59], a[172:175], v[80:95]
s_lshl_b32 s83, s4, 14
ds_read_b64_tr_b16 v[40:41], v14 offset:57344
buffer_load_dwordx4 v10, s[8:11], s36 offen lds
v_lshlrev_b32 v29, 16, v44
v_mfma_f32_32x32x16_bf16 v[128:143], v[44:47], a[168:171], v[128:143]
s_add_u32 s82, s82, s83
ds_read_b64_tr_b16 v[42:43], v14 offset:58368
buffer_load_dwordx4 v11, s[8:11], s37 offen offset:1024 lds
v_and_b32 v30, v38, v44
v_mfma_f32_16x16x32_bf16 a[0:3], v[56:59], a[8:11], a[0:3]
s_add_u32 s24, s58, s82
s_addc_u32 s25, s59, 0
ds_read_b64_tr_b16 a[128:129], v15 offset:57344
v_add_f32 v23, v23, v29
v_add_f32 v24, v24, v30
v_mfma_f32_32x32x16_bf16 v[144:159], v[44:47], a[172:175], v[144:159]
ds_read_b64_tr_b16 a[130:131], v15 offset:58368
s_and_b32 s25, s25, 0xffff
buffer_load_dwordx4 v10, s[8:11], s38 offen offset:2048 lds
v_lshlrev_b32 v31, 16, v45
v_mfma_f32_32x32x16_bf16 v[160:175], a[140:143], a[168:171], v[160:175]
ds_read_b64_tr_b16 a[132:133], v16 offset:57344
s_cmp_eq_u32 s5, 0
s_cselect_b32 s26, 0x2000, 0
v_and_b32 v32, v38, v45
v_add_f32 v23, v23, v31
v_mfma_f32_32x32x16_bf16 v[176:191], a[140:143], a[172:175], v[176:191]
ds_read_b64_tr_b16 a[134:135], v16 offset:58368
buffer_load_dwordx4 v11, s[8:11], s39 offen offset:3072 lds
v_add_f32 v24, v24, v32
v_mfma_f32_32x32x16_bf16 v[192:207], a[144:147], a[168:171], v[192:207]
ds_read_b64_tr_b16 a[136:137], v17 offset:57344
s_mov_b32 s27, 0x20000
v_lshlrev_b32 v29, 16, v46
v_and_b32 v30, v38, v46
v_mfma_f32_32x32x16_bf16 v[208:223], a[144:147], a[172:175], v[208:223]
ds_read_b64_tr_b16 a[138:139], v17 offset:58368
v_add_f32 v23, v23, v29
v_lshlrev_b32 v4, 7, v1
v_add_f32 v24, v24, v30
v_mfma_f32_32x32x16_bf16 v[224:239], a[148:151], a[168:171], v[224:239]
buffer_load_dword a254, v4, s[24:27], 0 offen
v_lshlrev_b32 v31, 16, v47
v_add_u32 v10, 0x80, v10
v_mfma_f32_32x32x16_bf16 v[240:255], a[148:151], a[172:175], v[240:255]
v_and_b32 v32, v38, v47
v_add_f32 v23, v23, v31
v_add_u32 v11, 0x80, v11
v_add_f32 v24, v24, v32
s_waitcnt vmcnt(10)
s_barrier
s_waitcnt lgkmcnt(0)
v_mfma_f32_32x32x16_bf16 v[64:79], v[48:51], a[176:179], v[64:79]
ds_read_b64_tr_b16 v[56:57], v18 offset:52224
s_add_u32 m0, s47, 0x6000
ds_read_b128 a[192:195], v19 offset:8192
ds_read_b64_tr_b16 v[58:59], v18 offset:52480
ds_read_b128 a[196:199], v19 offset:12288
v_mfma_f32_32x32x16_bf16 v[80:95], v[48:51], a[180:183], v[80:95]
buffer_load_dwordx4 v12, s[12:15], s40 offen lds
ds_read_b64_tr_b16 v[44:45], v14 offset:61440
ds_read_b128 a[200:203], v20 offset:8192
v_lshlrev_b32 v29, 16, v40
v_mfma_f32_32x32x16_bf16 v[128:143], v[40:43], a[176:179], v[128:143]
ds_read_b64_tr_b16 v[46:47], v14 offset:62464
buffer_load_dwordx4 v12, s[12:15], s41 offen offset:1024 lds
v_and_b32 v30, v38, v40
v_mfma_f32_16x16x32_bf16 a[0:3], v[48:51], a[8:11], a[0:3]
ds_read_b64_tr_b16 a[140:141], v15 offset:61440
buffer_load_dwordx4 v12, s[12:15], s42 offen offset:2048 lds
v_add_f32 v23, v23, v29
v_mfma_f32_32x32x16_bf16 v[144:159], v[40:43], a[180:183], v[144:159]
ds_read_b64_tr_b16 a[142:143], v15 offset:62464
ds_read_b128 a[204:207], v20 offset:12288
v_add_f32 v24, v24, v30
v_lshlrev_b32 v31, 16, v41
v_mfma_f32_32x32x16_bf16 v[160:175], a[128:131], a[176:179], v[160:175]
ds_read_b64_tr_b16 a[144:145], v16 offset:61440
buffer_load_dwordx4 v12, s[12:15], s43 offen offset:3072 lds
v_and_b32 v32, v38, v41
v_mfma_f32_32x32x16_bf16 v[176:191], a[128:131], a[180:183], v[176:191]
ds_read_b64_tr_b16 a[146:147], v16 offset:62464
ds_read_b128 a[208:211], v21 offset:8192
v_add_f32 v23, v23, v31
v_add_f32 v24, v24, v32
v_mfma_f32_32x32x16_bf16 v[192:207], a[132:135], a[176:179], v[192:207]
ds_read_b64_tr_b16 a[148:149], v17 offset:61440
ds_read_b128 a[212:215], v21 offset:12288
v_lshlrev_b32 v29, 16, v42
v_and_b32 v30, v38, v42
v_mfma_f32_32x32x16_bf16 v[208:223], a[132:135], a[180:183], v[208:223]
ds_read_b64_tr_b16 a[150:151], v17 offset:62464
ds_read_b128 a[216:219], v22 offset:8192
s_add_u32 m0, s48, 0x6000
v_add_f32 v23, v23, v29
v_mfma_f32_32x32x16_bf16 v[224:239], a[136:139], a[176:179], v[224:239]
ds_read_b128 a[220:223], v22 offset:12288
v_add_f32 v24, v24, v30
v_lshlrev_b32 v31, 16, v43
v_and_b32 v32, v38, v43
v_mfma_f32_32x32x16_bf16 v[240:255], a[136:139], a[180:183], v[240:255]
buffer_load_dwordx4 v13, s[16:19], s44 offen lds
v_add_f32 v23, v23, v31
v_add_f32 v24, v24, v32
s_waitcnt lgkmcnt(0)
v_mfma_f32_32x32x16_bf16 v[64:79], v[56:59], a[184:187], v[64:79]
v_readfirstlane_b32 s32, v33
s_cmp_lg_u32 s32, 0
s_cbranch_scc0 L_slow_3
L_slow_3_r:
ds_read_b64_tr_b16 v[48:49], v18 offset:0
v_add_u32 v12, 0x80000, v12
v_mfma_f32_32x32x16_bf16 v[80:95], v[56:59], a[188:191], v[80:95]
ds_read_b64_tr_b16 v[50:51], v18 offset:256
v_mov_b32 v2, v34
v_lshlrev_b32 v29, 16, v44
v_mov_b32 v3, v35
v_and_b32 v30, v38, v44
v_mfma_f32_32x32x16_bf16 v[128:143], v[44:47], a[184:187], v[128:143]
ds_read_b64_tr_b16 v[40:41], v14 offset:0
v_mov_b32 v4, s32
v_add_f32 v23, v23, v29
v_add_u32 v13, 0x2b000, v13
v_mov_b32 v5, 0
v_mfma_f32_16x16x32_bf16 a[0:3], v[56:59], a[8:11], a[0:3]
ds_read_b64_tr_b16 v[42:43], v14 offset:1024
v_add_f32 v24, v24, v30
v_mov_b32 v6, v36
v_lshlrev_b32 v31, 16, v45
v_mov_b32 v7, v37
v_mfma_f32_32x32x16_bf16 v[144:159], v[44:47], a[188:191], v[144:159]
ds_read_b64_tr_b16 a[128:129], v15 offset:0
global_load_dword a254, v39, s[50:51]
v_and_b32 v32, v38, v45
v_mov_b32 v8, s32
v_mfma_f32_32x32x16_bf16 v[160:175], a[140:143], a[184:187], v[160:175]
ds_read_b64_tr_b16 a[130:131], v15 offset:1024
ds_read_b64_tr_b16 a[132:133], v16 offset:0
v_add_f32 v23, v23, v31
v_mov_b32 v9, 0
v_add_f32 v24, v24, v32
v_mfma_f32_32x32x16_bf16 v[176:191], a[140:143], a[188:191], v[176:191]
s_lshl_b32 s87, s97, 4
s_add_u32 s87, s87, 0x1000000
ds_read_b64_tr_b16 a[134:135], v16 offset:1024
v_lshlrev_b32 v29, 16, v46
v_and_b32 v30, v38, v46
v_mfma_f32_32x32x16_bf16 v[192:207], a[144:147], a[184:187], v[192:207]
ds_read_b64_tr_b16 a[136:137], v17 offset:0
s_add_u32 s50, s50, s49
s_addc_u32 s51, s51, 0
v_mov_b32 v33, 0
v_add_f32 v23, v23, v29
v_mfma_f32_32x32x16_bf16 v[208:223], a[144:147], a[188:191], v[208:223]
ds_read_b64_tr_b16 a[138:139], v17 offset:1024
v_add_f32 v24, v24, v30
v_lshlrev_b32 v31, 16, v47
v_mfma_f32_32x32x16_bf16 v[224:239], a[148:151], a[184:187], v[224:239]
v_and_b32 v32, v38, v47
v_add_f32 v23, v23, v31
v_mfma_f32_32x32x16_bf16 v[240:255], a[148:151], a[188:191], v[240:255]
s_mov_b64 exec, 1
buffer_store_dwordx4 v[2:5], v33, s[28:31], s87 offen sc0 sc1
buffer_store_dwordx4 v[6:9], v33, s[28:31], s87 offen offset:16 sc0 sc1
s_mov_b64 exec, -1
v_add_f32 v24, v24, v32
s_waitcnt lgkmcnt(0)
v_mfma_f32_32x32x16_bf16 v[64:79], v[48:51], a[192:195], v[64:79]
ds_read_b64_tr_b16 v[56:57], v18 offset:1024
ds_read_b64_tr_b16 v[58:59], v18 offset:1280
v_mfma_f32_32x32x16_bf16 v[80:95], v[48:51], a[196:199], v[80:95]
ds_read_b64_tr_b16 v[44:45], v14 offset:4096
s_add_u32 m0, s46, 0x2000
v_lshlrev_b32 v29, 16, v40
v_and_b32 v30, v38, v40
v_mfma_f32_32x32x16_bf16 v[128:143], v[40:43], a[192:195], v[128:143]
ds_read_b64_tr_b16 v[46:47], v14 offset:5120
buffer_load_dwordx4 v10, s[8:11], 0 offen lds
v_add_f32 v23, v23, v29
v_mfma_f32_16x16x32_bf16 a[0:3], v[48:51], a[8:11], a[0:3]
ds_read_b64_tr_b16 a[140:141], v15 offset:4096
buffer_load_dwordx4 v11, s[8:11], s33 offen offset:1024 lds
v_add_f32 v24, v24, v30
v_mfma_f32_32x32x16_bf16 v[144:159], v[40:43], a[196:199], v[144:159]
ds_read_b64_tr_b16 a[142:143], v15 offset:5120
v_lshlrev_b32 v31, 16, v41
v_and_b32 v32, v38, v41
v_mfma_f32_32x32x16_bf16 v[160:175], a[128:131], a[192:195], v[160:175]
ds_read_b64_tr_b16 a[144:145], v16 offset:4096
v_add_f32 v23, v23, v31
v_add_f32 v24, v24, v32
v_mfma_f32_32x32x16_bf16 v[176:191], a[128:131], a[196:199], v[176:191]
ds_read_b64_tr_b16 a[146:147], v16 offset:5120
v_lshlrev_b32 v29, 16, v42
v_and_b32 v30, v38, v42
v_mfma_f32_32x32x16_bf16 v[192:207], a[132:135], a[192:195], v[192:207]
ds_read_b64_tr_b16 a[148:149], v17 offset:4096
v_add_f32 v23, v23, v29
v_add_f32 v24, v24, v30
v_mfma_f32_32x32x16_bf16 v[208:223], a[132:135], a[196:199], v[208:223]
ds_read_b64_tr_b16 a[150:151], v17 offset:5120
v_lshlrev_b32 v31, 16, v43
v_and_b32 v32, v38, v43
v_mfma_f32_32x32x16_bf16 v[224:239], a[136:139], a[192:195], v[224:239]
buffer_load_dwordx4 v10, s[8:11], s34 offen offset:2048 lds
v_add_f32 v23, v23, v31
v_mfma_f32_32x32x16_bf16 v[240:255], a[136:139], a[196:199], v[240:255]
buffer_load_dwordx4 v11, s[8:11], s35 offen offset:3072 lds
v_add_f32 v24, v24, v32
s_waitcnt lgkmcnt(0)
v_mfma_f32_32x32x16_bf16 v[64:79], v[56:59], a[200:203], v[64:79]
s_lshl_b32 s82, s3, 19
ds_read_b64_tr_b16 v[48:49], v18 offset:2048
s_add_u32 m0, s46, 0x3000
s_add_u32 s82, s82, 0x62000
ds_read_b64_tr_b16 v[50:51], v18 offset:2304
v_mfma_f32_32x32x16_bf16 v[80:95], v[56:59], a[204:207], v[80:95]
s_lshl_b32 s83, s4, 14
ds_read_b64_tr_b16 v[40:41], v14 offset:8192
buffer_load_dwordx4 v10, s[8:11], s36 offen lds
v_lshlrev_b32 v29, 16, v44
v_mfma_f32_32x32x16_bf16 v[128:143], v[44:47], a[200:203], v[128:143]
s_add_u32 s82, s82, s83
ds_read_b64_tr_b16 v[42:43], v14 offset:9216
buffer_load_dwordx4 v11, s[8:11], s37 offen offset:1024 lds
v_and_b32 v30, v38, v44
v_mfma_f32_16x16x32_bf16 a[0:3], v[56:59], a[8:11], a[0:3]
s_add_u32 s24, s58, s82
s_addc_u32 s25, s59, 0
ds_read_b64_tr_b16 a[128:129], v15 offset:8192
v_add_f32 v23, v23, v29
v_add_f32 v24, v24, v30
v_mfma_f32_32x32x16_bf16 v[144:159], v[44:47], a[204:207], v[144:159]
ds_read_b64_tr_b16 a[130:131], v15 offset:9216
s_and_b32 s25, s25, 0xffff
buffer_load_dwordx4 v10, s[8:11], s38 offen offset:2048 lds
v_lshlrev_b32 v31, 16, v45
v_mfma_f32_32x32x16_bf16 v[160:175], a[140:143], a[200:203], v[160:175]
ds_read_b64_tr_b16 a[132:133], v16 offset:8192
s_cmp_eq_u32 s5, 1
s_cselect_b32 s26, 0x2000, 0
v_and_b32 v32, v38, v45
v_add_f32 v23, v23, v31
v_mfma_f32_32x32x16_bf16 v[176:191], a[140:143], a[204:207], v[176:191]
ds_read_b64_tr_b16 a[134:135], v16 offset:9216
buffer_load_dwordx4 v11, s[8:11], s39 offen offset:3072 lds
v_add_f32 v24, v24, v32
v_mfma_f32_32x32x16_bf16 v[192:207], a[144:147], a[200:203], v[192:207]
ds_read_b64_tr_b16 a[136:137], v17 offset:8192
s_mov_b32 s27, 0x20000
v_lshlrev_b32 v29, 16, v46
v_and_b32 v30, v38, v46
v_mfma_f32_32x32x16_bf16 v[208:223], a[144:147], a[204:207], v[208:223]
ds_read_b64_tr_b16 a[138:139], v17 offset:9216
v_add_f32 v23, v23, v29
v_lshlrev_b32 v4, 7, v1
v_add_f32 v24, v24, v30
v_mfma_f32_32x32x16_bf16 v[224:239], a[148:151], a[200:203], v[224:239]
buffer_load_dword a254, v4, s[24:27], 0 offen
v_lshlrev_b32 v31, 16, v47
v_add_u32 v10, 0x80, v10
v_mfma_f32_32x32x16_bf16 v[240:255], a[148:151], a[204:207], v[240:255]
v_and_b32 v32, v38, v47
v_add_f32 v23, v23, v31
v_add_u32 v11, 0x80, v11
v_add_f32 v24, v24, v32
s_waitcnt vmcnt(12)
s_barrier
s_waitcnt lgkmcnt(0)
v_mfma_f32_32x32x16_bf16 v[64:79], v[48:51], a[208:211], v[64:79]
ds_read_b64_tr_b16 v[56:57], v18 offset:3072
s_add_u32 m0, s47, 0xc000
ds_read_b128 a[160:163], v19 offset:0
ds_read_b64_tr_b16 v[58:59], v18 offset:3328
ds_read_b128 a[164:167], v19 offset:4096
v_mfma_f32_32x32x16_bf16 v[80:95], v[48:51], a[212:215], v[80:95]
buffer_load_dwordx4 v12, s[12:15], s40 offen lds
ds_read_b64_tr_b16 v[44:45], v14 offset:12288
ds_read_b128 a[168:171], v20 offset:0
v_lshlrev_b32 v29, 16, v40
v_mfma_f32_32x32x16_bf16 v[128:143], v[40:43], a[208:211], v[128:143]
ds_read_b64_tr_b16 v[46:47], v14 offset:13312
buffer_load_dwordx4 v12, s[12:15], s41 offen offset:1024 lds
v_and_b32 v30, v38, v40
v_mfma_f32_16x16x32_bf16 a[0:3], v[48:51], a[8:11], a[0:3]
ds_read_b64_tr_b16 a[140:141], v15 offset:12288
buffer_load_dwordx4 v12, s[12:15], s42 offen offset:2048 lds
v_add_f32 v23, v23, v29
v_mfma_f32_32x32x16_bf16 v[144:159], v[40:43], a[212:215], v[144:159]
ds_read_b64_tr_b16 a[142:143], v15 offset:13312
ds_read_b128 a[172:175], v20 offset:4096
v_add_f32 v24, v24, v30
v_lshlrev_b32 v31, 16, v41
v_mfma_f32_32x32x16_bf16 v[160:175], a[128:131], a[208:211], v[160:175]
ds_read_b64_tr_b16 a[144:145], v16 offset:12288
buffer_load_dwordx4 v12, s[12:15], s43 offen offset:3072 lds
v_and_b32 v32, v38, v41
v_mfma_f32_32x32x16_bf16 v[176:191], a[128:131], a[212:215], v[176:191]
ds_read_b64_tr_b16 a[146:147], v16 offset:13312
ds_read_b128 a[176:179], v21 offset:0
v_add_f32 v23, v23, v31
v_add_f32 v24, v24, v32
v_mfma_f32_32x32x16_bf16 v[192:207], a[132:135], a[208:211], v[192:207]
ds_read_b64_tr_b16 a[148:149], v17 offset:12288
ds_read_b128 a[180:183], v21 offset:4096
v_lshlrev_b32 v29, 16, v42
v_and_b32 v30, v38, v42
v_mfma_f32_32x32x16_bf16 v[208:223], a[132:135], a[212:215], v[208:223]
ds_read_b64_tr_b16 a[150:151], v17 offset:13312
ds_read_b128 a[184:187], v22 offset:0
s_add_u32 m0, s48, 0xc000
v_add_f32 v23, v23, v29
v_mfma_f32_32x32x16_bf16 v[224:239], a[136:139], a[208:211], v[224:239]
ds_read_b128 a[188:191], v22 offset:4096
v_add_f32 v24, v24, v30
v_lshlrev_b32 v31, 16, v43
v_and_b32 v32, v38, v43
v_mfma_f32_32x32x16_bf16 v[240:255], a[136:139], a[212:215], v[240:255]
buffer_load_dwordx4 v13, s[16:19], s44 offen lds
v_add_f32 v23, v23, v31
v_add_f32 v24, v24, v32
s_waitcnt lgkmcnt(0)
v_mfma_f32_32x32x16_bf16 v[64:79], v[56:59], a[216:219], v[64:79]
ds_read_b64_tr_b16 v[48:49], v18 offset:24576
ds_read_b64_tr_b16 v[50:51], v18 offset:24832
v_add_u32 v12, 0x80000, v12
v_mfma_f32_32x32x16_bf16 v[80:95], v[56:59], a[220:223], v[80:95]
ds_read_b64_tr_b16 v[40:41], v14 offset:24576
v_lshlrev_b32 v29, 16, v44
v_and_b32 v30, v38, v44
v_mfma_f32_32x32x16_bf16 v[128:143], v[44:47], a[216:219], v[128:143]
ds_read_b64_tr_b16 v[42:43], v14 offset:25600
v_add_f32 v23, v23, v29
v_add_f32 v24, v24, v30
v_mfma_f32_16x16x32_bf16 a[0:3], v[56:59], a[8:11], a[0:3]
ds_read_b64_tr_b16 a[128:129], v15 offset:24576
v_lshlrev_b32 v31, 16, v45
v_and_b32 v32, v38, v45
v_mfma_f32_32x32x16_bf16 v[144:159], v[44:47], a[220:223], v[144:159]
ds_read_b64_tr_b16 a[130:131], v15 offset:25600
v_add_f32 v23, v23, v31
v_add_f32 v24, v24, v32
v_mfma_f32_32x32x16_bf16 v[160:175], a[140:143], a[216:219], v[160:175]
ds_read_b64_tr_b16 a[132:133], v16 offset:24576
v_lshlrev_b32 v29, 16, v46
v_and_b32 v30, v38, v46
v_mfma_f32_32x32x16_bf16 v[176:191], a[140:143], a[220:223], v[176:191]
ds_read_b64_tr_b16 a[134:135], v16 offset:25600
v_add_f32 v23, v23, v29
v_mfma_f32_32x32x16_bf16 v[192:207], a[144:147], a[216:219], v[192:207]
ds_read_b64_tr_b16 a[136:137], v17 offset:24576
v_add_f32 v24, v24, v30
v_mfma_f32_32x32x16_bf16 v[208:223], a[144:147], a[220:223], v[208:223]
ds_read_b64_tr_b16 a[138:139], v17 offset:25600
v_lshlrev_b32 v31, 16, v47
v_mfma_f32_32x32x16_bf16 v[224:239], a[148:151], a[216:219], v[224:239]
v_and_b32 v32, v38, v47
v_add_u32 v13, 0x2b000, v13
v_mfma_f32_32x32x16_bf16 v[240:255], a[148:151], a[220:223], v[240:255]
v_add_f32 v23, v23, v31
v_add_f32 v24, v24, v32
s_waitcnt lgkmcnt(0)
v_mfma_f32_32x32x16_bf16 v[64:79], v[48:51], a[160:163], v[64:79]
ds_read_b64_tr_b16 v[56:57], v18 offset:25600
ds_read_b64_tr_b16 v[58:59], v18 offset:25856
v_mfma_f32_32x32x16_bf16 v[80:95], v[48:51], a[164:167], v[80:95]
ds_read_b64_tr_b16 v[44:45], v14 offset:28672
s_add_u32 m0, s46, 0
v_lshlrev_b32 v29, 16, v40
v_and_b32 v30, v38, v40
v_mfma_f32_32x32x16_bf16 v[128:143], v[40:43], a[160:163], v[128:143]
ds_read_b64_tr_b16 v[46:47], v14 offset:29696
buffer_load_dwordx4 v10, s[8:11], 0 offen lds
v_add_f32 v23, v23, v29
v_mfma_f32_16x16x32_bf16 a[0:3], v[48:51], a[8:11], a[0:3]
ds_read_b64_tr_b16 a[140:141], v15 offset:28672
buffer_load_dwordx4 v11, s[8:11], s33 offen offset:1024 lds
v_add_f32 v24, v24, v30
v_mfma_f32_32x32x16_bf16 v[144:159], v[40:43], a[164:167], v[144:159]
ds_read_b64_tr_b16 a[142:143], v15 offset:29696
v_lshlrev_b32 v31, 16, v41
v_and_b32 v32, v38, v41
v_mfma_f32_32x32x16_bf16 v[160:175], a[128:131], a[160:163], v[160:175]
ds_read_b64_tr_b16 a[144:145], v16 offset:28672
v_add_f32 v23, v23, v31
v_add_f32 v24, v24, v32
v_mfma_f32_32x32x16_bf16 v[176:191], a[128:131], a[164:167], v[176:191]
ds_read_b64_tr_b16 a[146:147], v16 offset:29696
v_lshlrev_b32 v29, 16, v42
v_and_b32 v30, v38, v42
v_mfma_f32_32x32x16_bf16 v[192:207], a[132:135], a[160:163], v[192:207]
ds_read_b64_tr_b16 a[148:149], v17 offset:28672
v_add_f32 v23, v23, v29
v_add_f32 v24, v24, v30
v_mfma_f32_32x32x16_bf16 v[208:223], a[132:135], a[164:167], v[208:223]
ds_read_b64_tr_b16 a[150:151], v17 offset:29696
v_lshlrev_b32 v31, 16, v43
v_and_b32 v32, v38, v43
v_mfma_f32_32x32x16_bf16 v[224:239], a[136:139], a[160:163], v[224:239]
buffer_load_dwordx4 v10, s[8:11], s34 offen offset:2048 lds
v_add_f32 v23, v23, v31
v_mfma_f32_32x32x16_bf16 v[240:255], a[136:139], a[164:167], v[240:255]
buffer_load_dwordx4 v11, s[8:11], s35 offen offset:3072 lds
v_add_f32 v24, v24, v32
s_waitcnt lgkmcnt(0)
v_mfma_f32_32x32x16_bf16 v[64:79], v[56:59], a[168:171], v[64:79]
s_lshl_b32 s82, s3, 19
ds_read_b64_tr_b16 v[48:49], v18 offset:26624
s_add_u32 m0, s46, 0x1000
s_add_u32 s82, s82, 0x60000
ds_read_b64_tr_b16 v[50:51], v18 offset:26880
v_mfma_f32_32x32x16_bf16 v[80:95], v[56:59], a[172:175], v[80:95]
s_lshl_b32 s83, s4, 14
ds_read_b64_tr_b16 v[40:41], v14 offset:32768
buffer_load_dwordx4 v10, s[8:11], s36 offen lds
v_lshlrev_b32 v29, 16, v44
v_mfma_f32_32x32x16_bf16 v[128:143], v[44:47], a[168:171], v[128:143]
s_add_u32 s82, s82, s83
ds_read_b64_tr_b16 v[42:43], v14 offset:33792
buffer_load_dwordx4 v11, s[8:11], s37 offen offset:1024 lds
v_and_b32 v30, v38, v44
v_mfma_f32_16x16x32_bf16 a[0:3], v[56:59], a[8:11], a[0:3]
s_add_u32 s24, s60, s82
s_addc_u32 s25, s61, 0
ds_read_b64_tr_b16 a[128:129], v15 offset:32768
v_add_f32 v23, v23, v29
v_add_f32 v24, v24, v30
v_mfma_f32_32x32x16_bf16 v[144:159], v[44:47], a[172:175], v[144:159]
ds_read_b64_tr_b16 a[130:131], v15 offset:33792
s_and_b32 s25, s25, 0xffff
buffer_load_dwordx4 v10, s[8:11], s38 offen offset:2048 lds
v_lshlrev_b32 v31, 16, v45
v_mfma_f32_32x32x16_bf16 v[160:175], a[140:143], a[168:171], v[160:175]
ds_read_b64_tr_b16 a[132:133], v16 offset:32768
s_cmp_eq_u32 s5, 2
s_cselect_b32 s26, 0x2000, 0
v_and_b32 v32, v38, v45
v_add_f32 v23, v23, v31
v_mfma_f32_32x32x16_bf16 v[176:191], a[140:143], a[172:175], v[176:191]
ds_read_b64_tr_b16 a[134:135], v16 offset:33792
buffer_load_dwordx4 v11, s[8:11], s39 offen offset:3072 lds
v_add_f32 v24, v24, v32
v_mfma_f32_32x32x16_bf16 v[192:207], a[144:147], a[168:171], v[192:207]
ds_read_b64_tr_b16 a[136:137], v17 offset:32768
s_mov_b32 s27, 0x20000
v_lshlrev_b32 v29, 16, v46
v_and_b32 v30, v38, v46
v_mfma_f32_32x32x16_bf16 v[208:223], a[144:147], a[172:175], v[208:223]
ds_read_b64_tr_b16 a[138:139], v17 offset:33792
v_add_f32 v23, v23, v29
v_lshlrev_b32 v4, 7, v1
v_add_f32 v24, v24, v30
v_mfma_f32_32x32x16_bf16 v[224:239], a[148:151], a[168:171], v[224:239]
buffer_load_dword a254, v4, s[24:27], 0 offen
v_lshlrev_b32 v31, 16, v47
v_add_u32 v10, 0x80, v10
v_mfma_f32_32x32x16_bf16 v[240:255], a[148:151], a[172:175], v[240:255]
v_and_b32 v32, v38, v47
v_add_f32 v23, v23, v31
v_add_u32 v11, 0x80, v11
v_add_f32 v24, v24, v32
s_waitcnt vmcnt(9)
s_barrier
s_waitcnt lgkmcnt(0)
v_mfma_f32_32x32x16_bf16 v[64:79], v[48:51], a[176:179], v[64:79]
ds_read_b64_tr_b16 v[56:57], v18 offset:27648
s_add_u32 m0, s47, 0
ds_read_b128 a[192:195], v19 offset:8192
ds_read_b64_tr_b16 v[58:59], v18 offset:27904
ds_read_b128 a[196:199], v19 offset:12288
v_mfma_f32_32x32x16_bf16 v[80:95], v[48:51], a[180:183], v[80:95]
buffer_load_dwordx4 v12, s[12:15], s40 offen lds
ds_read_b64_tr_b16 v[44:45], v14 offset:36864
ds_read_b128 a[200:203], v20 offset:8192
v_lshlrev_b32 v29, 16, v40
v_mfma_f32_32x32x16_bf16 v[128:143], v[40:43], a[176:179], v[128:143]
ds_read_b64_tr_b16 v[46:47], v14 offset:37888
buffer_load_dwordx4 v12, s[12:15], s41 offen offset:1024 lds
v_and_b32 v30, v38, v40
v_mfma_f32_16x16x32_bf16 a[0:3], v[48:51], a[8:11], a[0:3]
ds_read_b64_tr_b16 a[140:141], v15 offset:36864
buffer_load_dwordx4 v12, s[12:15], s42 offen offset:2048 lds
v_add_f32 v23, v23, v29
v_mfma_f32_32x32x16_bf16 v[144:159], v[40:43], a[180:183], v[144:159]
ds_read_b64_tr_b16 a[142:143], v15 offset:37888
ds_read_b128 a[204:207], v20 offset:12288
v_add_f32 v24, v24, v30
v_lshlrev_b32 v31, 16, v41
v_mfma_f32_32x32x16_bf16 v[160:175], a[128:131], a[176:179], v[160:175]
ds_read_b64_tr_b16 a[144:145], v16 offset:36864
buffer_load_dwordx4 v12, s[12:15], s43 offen offset:3072 lds
v_and_b32 v32, v38, v41
v_mfma_f32_32x32x16_bf16 v[176:191], a[128:131], a[180:183], v[176:191]
ds_read_b64_tr_b16 a[146:147], v16 offset:37888
ds_read_b128 a[208:211], v21 offset:8192
v_add_f32 v23, v23, v31
v_add_f32 v24, v24, v32
v_mfma_f32_32x32x16_bf16 v[192:207], a[132:135], a[176:179], v[192:207]
ds_read_b64_tr_b16 a[148:149], v17 offset:36864
ds_read_b128 a[212:215], v21 offset:12288
v_lshlrev_b32 v29, 16, v42
v_and_b32 v30, v38, v42
v_mfma_f32_32x32x16_bf16 v[208:223], a[132:135], a[180:183], v[208:223]
ds_read_b64_tr_b16 a[150:151], v17 offset:37888
ds_read_b128 a[216:219], v22 offset:8192
s_add_u32 m0, s48, 0
v_add_f32 v23, v23, v29
v_mfma_f32_32x32x16_bf16 v[224:239], a[136:139], a[176:179], v[224:239]
ds_read_b128 a[220:223], v22 offset:12288
v_add_f32 v24, v24, v30
v_lshlrev_b32 v31, 16, v43
v_and_b32 v32, v38, v43
v_mfma_f32_32x32x16_bf16 v[240:255], a[136:139], a[180:183], v[240:255]
buffer_load_dwordx4 v13, s[16:19], s44 offen lds
v_add_f32 v23, v23, v31
v_add_f32 v24, v24, v32
s_waitcnt lgkmcnt(0)
v_mfma_f32_32x32x16_bf16 v[64:79], v[56:59], a[184:187], v[64:79]
ds_read_b64_tr_b16 v[48:49], v18 offset:49152
ds_read_b64_tr_b16 v[50:51], v18 offset:49408
v_add_u32 v12, 0x80000, v12
v_mfma_f32_32x32x16_bf16 v[80:95], v[56:59], a[188:191], v[80:95]
ds_read_b64_tr_b16 v[40:41], v14 offset:49152
v_lshlrev_b32 v29, 16, v44
v_and_b32 v30, v38, v44
v_mfma_f32_32x32x16_bf16 v[128:143], v[44:47], a[184:187], v[128:143]
ds_read_b64_tr_b16 v[42:43], v14 offset:50176
v_add_f32 v23, v23, v29
v_add_f32 v24, v24, v30
v_mfma_f32_16x16x32_bf16 a[0:3], v[56:59], a[8:11], a[0:3]
ds_read_b64_tr_b16 a[128:129], v15 offset:49152
v_lshlrev_b32 v31, 16, v45
v_and_b32 v32, v38, v45
v_mfma_f32_32x32x16_bf16 v[144:159], v[44:47], a[188:191], v[144:159]
ds_read_b64_tr_b16 a[130:131], v15 offset:50176
v_add_f32 v23, v23, v31
v_add_f32 v24, v24, v32
v_mfma_f32_32x32x16_bf16 v[160:175], a[140:143], a[184:187], v[160:175]
ds_read_b64_tr_b16 a[132:133], v16 offset:49152
v_lshlrev_b32 v29, 16, v46
v_and_b32 v30, v38, v46
v_mfma_f32_32x32x16_bf16 v[176:191], a[140:143], a[188:191], v[176:191]
ds_read_b64_tr_b16 a[134:135], v16 offset:50176
v_add_f32 v23, v23, v29
v_mfma_f32_32x32x16_bf16 v[192:207], a[144:147], a[184:187], v[192:207]
ds_read_b64_tr_b16 a[136:137], v17 offset:49152
v_add_f32 v24, v24, v30
v_mfma_f32_32x32x16_bf16 v[208:223], a[144:147], a[188:191], v[208:223]
ds_read_b64_tr_b16 a[138:139], v17 offset:50176
v_lshlrev_b32 v31, 16, v47
v_mfma_f32_32x32x16_bf16 v[224:239], a[148:151], a[184:187], v[224:239]
v_and_b32 v32, v38, v47
v_add_u32 v13, 0x2b000, v13
v_mfma_f32_32x32x16_bf16 v[240:255], a[148:151], a[188:191], v[240:255]
v_add_f32 v23, v23, v31
v_add_f32 v24, v24, v32
s_waitcnt lgkmcnt(0)
v_mfma_f32_32x32x16_bf16 v[64:79], v[48:51], a[192:195], v[64:79]
ds_read_b64_tr_b16 v[56:57], v18 offset:50176
ds_read_b64_tr_b16 v[58:59], v18 offset:50432
v_mfma_f32_32x32x16_bf16 v[80:95], v[48:51], a[196:199], v[80:95]
ds_read_b64_tr_b16 v[44:45], v14 offset:53248
s_add_u32 m0, s46, 0x2000
v_lshlrev_b32 v29, 16, v40
v_and_b32 v30, v38, v40
v_mfma_f32_32x32x16_bf16 v[128:143], v[40:43], a[192:195], v[128:143]
ds_read_b64_tr_b16 v[46:47], v14 offset:54272
buffer_load_dwordx4 v10, s[8:11], 0 offen lds
v_add_f32 v23, v23, v29
v_mfma_f32_16x16x32_bf16 a[0:3], v[48:51], a[8:11], a[0:3]
ds_read_b64_tr_b16 a[140:141], v15 offset:53248
buffer_load_dwordx4 v11, s[8:11], s33 offen offset:1024 lds
v_add_f32 v24, v24, v30
v_mfma_f32_32x32x16_bf16 v[144:159], v[40:43], a[196:199], v[144:159]
ds_read_b64_tr_b16 a[142:143], v15 offset:54272
v_lshlrev_b32 v31, 16, v41
v_and_b32 v32, v38, v41
v_mfma_f32_32x32x16_bf16 v[160:175], a[128:131], a[192:195], v[160:175]
ds_read_b64_tr_b16 a[144:145], v16 offset:53248
v_add_f32 v23, v23, v31
v_add_f32 v24, v24, v32
v_mfma_f32_32x32x16_bf16 v[176:191], a[128:131], a[196:199], v[176:191]
ds_read_b64_tr_b16 a[146:147], v16 offset:54272
v_lshlrev_b32 v29, 16, v42
v_and_b32 v30, v38, v42
v_mfma_f32_32x32x16_bf16 v[192:207], a[132:135], a[192:195], v[192:207]
ds_read_b64_tr_b16 a[148:149], v17 offset:53248
v_add_f32 v23, v23, v29
v_add_f32 v24, v24, v30
v_mfma_f32_32x32x16_bf16 v[208:223], a[132:135], a[196:199], v[208:223]
ds_read_b64_tr_b16 a[150:151], v17 offset:54272
v_lshlrev_b32 v31, 16, v43
v_and_b32 v32, v38, v43
v_mfma_f32_32x32x16_bf16 v[224:239], a[136:139], a[192:195], v[224:239]
buffer_load_dwordx4 v10, s[8:11], s34 offen offset:2048 lds
v_add_f32 v23, v23, v31
v_mfma_f32_32x32x16_bf16 v[240:255], a[136:139], a[196:199], v[240:255]
buffer_load_dwordx4 v11, s[8:11], s35 offen offset:3072 lds
v_add_f32 v24, v24, v32
s_waitcnt lgkmcnt(0)
v_mfma_f32_32x32x16_bf16 v[64:79], v[56:59], a[200:203], v[64:79]
s_lshl_b32 s82, s3, 19
ds_read_b64_tr_b16 v[48:49], v18 offset:51200
s_add_u32 m0, s46, 0x3000
s_add_u32 s82, s82, 0x62000
ds_read_b64_tr_b16 v[50:51], v18 offset:51456
v_mfma_f32_32x32x16_bf16 v[80:95], v[56:59], a[204:207], v[80:95]
s_lshl_b32 s83, s4, 14
ds_read_b64_tr_b16 v[40:41], v14 offset:57344
buffer_load_dwordx4 v10, s[8:11], s36 offen lds
v_lshlrev_b32 v29, 16, v44
v_mfma_f32_32x32x16_bf16 v[128:143], v[44:47], a[200:203], v[128:143]
s_add_u32 s82, s82, s83
ds_read_b64_tr_b16 v[42:43], v14 offset:58368
buffer_load_dwordx4 v11, s[8:11], s37 offen offset:1024 lds
v_and_b32 v30, v38, v44
v_mfma_f32_16x16x32_bf16 a[0:3], v[56:59], a[8:11], a[0:3]
s_add_u32 s24, s60, s82
s_addc_u32 s25, s61, 0
ds_read_b64_tr_b16 a[128:129], v15 offset:57344
v_add_f32 v23, v23, v29
v_add_f32 v24, v24, v30
v_mfma_f32_32x32x16_bf16 v[144:159], v[44:47], a[204:207], v[144:159]
ds_read_b64_tr_b16 a[130:131], v15 offset:58368
s_and_b32 s25, s25, 0xffff
buffer_load_dwordx4 v10, s[8:11], s38 offen offset:2048 lds
v_lshlrev_b32 v31, 16, v45
v_mfma_f32_32x32x16_bf16 v[160:175], a[140:143], a[200:203], v[160:175]
ds_read_b64_tr_b16 a[132:133], v16 offset:57344
s_cmp_eq_u32 s5, 3
s_cselect_b32 s26, 0x2000, 0
v_and_b32 v32, v38, v45
v_add_f32 v23, v23, v31
v_mfma_f32_32x32x16_bf16 v[176:191], a[140:143], a[204:207], v[176:191]
ds_read_b64_tr_b16 a[134:135], v16 offset:58368
buffer_load_dwordx4 v11, s[8:11], s39 offen offset:3072 lds
v_add_f32 v24, v24, v32
v_mfma_f32_32x32x16_bf16 v[192:207], a[144:147], a[200:203], v[192:207]
ds_read_b64_tr_b16 a[136:137], v17 offset:57344
s_mov_b32 s27, 0x20000
v_lshlrev_b32 v29, 16, v46
v_and_b32 v30, v38, v46
v_mfma_f32_32x32x16_bf16 v[208:223], a[144:147], a[204:207], v[208:223]
ds_read_b64_tr_b16 a[138:139], v17 offset:58368
v_add_f32 v23, v23, v29
v_lshlrev_b32 v4, 7, v1
v_add_f32 v24, v24, v30
v_mfma_f32_32x32x16_bf16 v[224:239], a[148:151], a[200:203], v[224:239]
buffer_load_dword a254, v4, s[24:27], 0 offen
v_lshlrev_b32 v31, 16, v47
v_add_u32 v10, 0x80, v10
v_mfma_f32_32x32x16_bf16 v[240:255], a[148:151], a[204:207], v[240:255]
v_and_b32 v32, v38, v47
v_add_f32 v23, v23, v31
v_add_u32 v11, 0x80, v11
v_add_f32 v24, v24, v32
s_waitcnt vmcnt(9)
s_barrier
s_waitcnt lgkmcnt(0)
v_mfma_f32_32x32x16_bf16 v[64:79], v[48:51], a[208:211], v[64:79]
ds_read_b64_tr_b16 v[56:57], v18 offset:52224
s_add_u32 m0, s47, 0x6000
ds_read_b128 a[160:163], v19 offset:0
ds_read_b64_tr_b16 v[58:59], v18 offset:52480
ds_read_b128 a[164:167], v19 offset:4096
v_mfma_f32_32x32x16_bf16 v[80:95], v[48:51], a[212:215], v[80:95]
buffer_load_dwordx4 v12, s[12:15], s40 offen lds
ds_read_b64_tr_b16 v[44:45], v14 offset:61440
ds_read_b128 a[168:171], v20 offset:0
v_lshlrev_b32 v29, 16, v40
v_mfma_f32_32x32x16_bf16 v[128:143], v[40:43], a[208:211], v[128:143]
ds_read_b64_tr_b16 v[46:47], v14 offset:62464
buffer_load_dwordx4 v12, s[12:15], s41 offen offset:1024 lds
v_and_b32 v30, v38, v40
v_mfma_f32_16x16x32_bf16 a[0:3], v[48:51], a[8:11], a[0:3]
ds_read_b64_tr_b16 a[140:141], v15 offset:61440
buffer_load_dwordx4 v12, s[12:15], s42 offen offset:2048 lds
v_add_f32 v23, v23, v29
v_mfma_f32_32x32x16_bf16 v[144:159], v[40:43], a[212:215], v[144:159]
ds_read_b64_tr_b16 a[142:143], v15 offset:62464
ds_read_b128 a[172:175], v20 offset:4096
v_add_f32 v24, v24, v30
v_lshlrev_b32 v31, 16, v41
v_mfma_f32_32x32x16_bf16 v[160:175], a[128:131], a[208:211], v[160:175]
ds_read_b64_tr_b16 a[144:145], v16 offset:61440
buffer_load_dwordx4 v12, s[12:15], s43 offen offset:3072 lds
v_and_b32 v32, v38, v41
v_mfma_f32_32x32x16_bf16 v[176:191], a[128:131], a[212:215], v[176:191]
ds_read_b64_tr_b16 a[146:147], v16 offset:62464
ds_read_b128 a[176:179], v21 offset:0
v_add_f32 v23, v23, v31
v_add_f32 v24, v24, v32
v_mfma_f32_32x32x16_bf16 v[192:207], a[132:135], a[208:211], v[192:207]
ds_read_b64_tr_b16 a[148:149], v17 offset:61440
ds_read_b128 a[180:183], v21 offset:4096
v_lshlrev_b32 v29, 16, v42
v_and_b32 v30, v38, v42
v_mfma_f32_32x32x16_bf16 v[208:223], a[132:135], a[212:215], v[208:223]
ds_read_b64_tr_b16 a[150:151], v17 offset:62464
ds_read_b128 a[184:187], v22 offset:0
s_add_u32 m0, s48, 0x6000
v_add_f32 v23, v23, v29
v_mfma_f32_32x32x16_bf16 v[224:239], a[136:139], a[208:211], v[224:239]
ds_read_b128 a[188:191], v22 offset:4096
v_add_f32 v24, v24, v30
v_lshlrev_b32 v31, 16, v43
v_and_b32 v32, v38, v43
v_mfma_f32_32x32x16_bf16 v[240:255], a[136:139], a[212:215], v[240:255]
buffer_load_dwordx4 v13, s[16:19], s44 offen lds
v_add_f32 v23, v23, v31
v_add_f32 v24, v24, v32
s_waitcnt lgkmcnt(0)
v_mfma_f32_32x32x16_bf16 v[64:79], v[56:59], a[216:219], v[64:79]
ds_read_b64_tr_b16 v[48:49], v18 offset:0
ds_read_b64_tr_b16 v[50:51], v18 offset:256
v_add_u32 v12, 0x80000, v12
v_mfma_f32_32x32x16_bf16 v[80:95], v[56:59], a[220:223], v[80:95]
ds_read_b64_tr_b16 v[40:41], v14 offset:0
v_lshlrev_b32 v29, 16, v44
v_and_b32 v30, v38, v44
v_mfma_f32_32x32x16_bf16 v[128:143], v[44:47], a[216:219], v[128:143]
ds_read_b64_tr_b16 v[42:43], v14 offset:1024
v_add_f32 v23, v23, v29
v_add_f32 v24, v24, v30
v_mfma_f32_16x16x32_bf16 a[0:3], v[56:59], a[8:11], a[0:3]
ds_read_b64_tr_b16 a[128:129], v15 offset:0
v_lshlrev_b32 v31, 16, v45
v_and_b32 v32, v38, v45
v_mfma_f32_32x32x16_bf16 v[144:159], v[44:47], a[220:223], v[144:159]
ds_read_b64_tr_b16 a[130:131], v15 offset:1024
v_add_f32 v23, v23, v31
v_add_f32 v24, v24, v32
v_mfma_f32_32x32x16_bf16 v[160:175], a[140:143], a[216:219], v[160:175]
ds_read_b64_tr_b16 a[132:133], v16 offset:0
v_lshlrev_b32 v29, 16, v46
v_and_b32 v30, v38, v46
v_mfma_f32_32x32x16_bf16 v[176:191], a[140:143], a[220:223], v[176:191]
ds_read_b64_tr_b16 a[134:135], v16 offset:1024
v_add_f32 v23, v23, v29
v_mfma_f32_32x32x16_bf16 v[192:207], a[144:147], a[216:219], v[192:207]
ds_read_b64_tr_b16 a[136:137], v17 offset:0
v_add_f32 v24, v24, v30
v_mfma_f32_32x32x16_bf16 v[208:223], a[144:147], a[220:223], v[208:223]
ds_read_b64_tr_b16 a[138:139], v17 offset:1024
v_lshlrev_b32 v31, 16, v47
v_mfma_f32_32x32x16_bf16 v[224:239], a[148:151], a[216:219], v[224:239]
v_and_b32 v32, v38, v47
v_add_u32 v13, 0x2b000, v13
v_mfma_f32_32x32x16_bf16 v[240:255], a[148:151], a[220:223], v[240:255]
v_add_f32 v23, v23, v31
v_add_f32 v24, v24, v32
s_lshl_b32 s82, s3, 19
s_add_u32 s82, s82, 0x60000
s_add_u32 s20, s58, s82
s_addc_u32 s21, s59, 0
s_and_b32 s21, s21, 0xffff
s_mov_b32 s22, 0x20000
s_mov_b32 s23, 0x20000
s_add_u32 s24, s60, s82
s_addc_u32 s25, s61, 0
s_and_b32 s25, s25, 0xffff
s_mov_b32 s26, 0x20000
s_mov_b32 s27, 0x20000
s_lshl_b32 s90, s5, 11
s_mov_b32 s88, 0
s_mov_b32 s89, 0
v_lshrrev_b32 v36, 4, v1
v_and_b32 v37, 15, v1
s_lshl_b32 s82, s5, 3
s_and_b32 s82, s82, 15
v_add_u32 v2, s82, v36
v_xor_b32 v3, v37, v2
v_lshlrev_b32 v4, 8, v36
v_lshl_add_u32 v33, v3, 4, v4
v_add_u32 v2, 4, v2
v_xor_b32 v3, v37, v2
v_lshl_add_u32 v34, v3, 4, v4
v_lshlrev_b32 v2, 2, v36
v_xor_b32 v3, v37, v2
v_lshl_add_u32 v35, v3, 4, v4
s_lshl_b32 s82, s5, 11
v_add_u32 v33, s82, v33
v_add_u32 v34, s82, v34
v_add_u32 v35, s82, v35
s_waitcnt lgkmcnt(0)
v_mfma_f32_32x32x16_bf16 v[64:79], v[48:51], a[160:163], v[64:79]
ds_read_b64_tr_b16 v[56:57], v18 offset:1024
ds_read_b64_tr_b16 v[58:59], v18 offset:1280
v_mfma_f32_32x32x16_bf16 v[80:95], v[48:51], a[164:167], v[80:95]
ds_read_b64_tr_b16 v[44:45], v14 offset:4096
v_lshlrev_b32 v29, 16, v40
v_and_b32 v30, v38, v40
v_mfma_f32_32x32x16_bf16 v[128:143], v[40:43], a[160:163], v[128:143]
ds_read_b64_tr_b16 v[46:47], v14 offset:5120
v_add_f32 v23, v23, v29
v_add_f32 v24, v24, v30
v_mfma_f32_16x16x32_bf16 a[0:3], v[48:51], a[8:11], a[0:3]
ds_read_b64_tr_b16 a[140:141], v15 offset:4096
v_lshlrev_b32 v31, 16, v41
v_and_b32 v32, v38, v41
v_mfma_f32_32x32x16_bf16 v[144:159], v[40:43], a[164:167], v[144:159]
ds_read_b64_tr_b16 a[142:143], v15 offset:5120
v_add_f32 v23, v23, v31
v_add_f32 v24, v24, v32
v_mfma_f32_32x32x16_bf16 v[160:175], a[128:131], a[160:163], v[160:175]
ds_read_b64_tr_b16 a[144:145], v16 offset:4096
v_lshlrev_b32 v29, 16, v42
v_mfma_f32_32x32x16_bf16 v[176:191], a[128:131], a[164:167], v[176:191]
ds_read_b64_tr_b16 a[146:147], v16 offset:5120
v_and_b32 v30, v38, v42
v_mfma_f32_32x32x16_bf16 v[192:207], a[132:135], a[160:163], v[192:207]
ds_read_b64_tr_b16 a[148:149], v17 offset:4096
v_add_f32 v23, v23, v29
v_mfma_f32_32x32x16_bf16 v[208:223], a[132:135], a[164:167], v[208:223]
ds_read_b64_tr_b16 a[150:151], v17 offset:5120
v_add_f32 v24, v24, v30
v_mfma_f32_32x32x16_bf16 v[224:239], a[136:139], a[160:163], v[224:239]
v_lshlrev_b32 v31, 16, v43
v_and_b32 v32, v38, v43
v_mfma_f32_32x32x16_bf16 v[240:255], a[136:139], a[164:167], v[240:255]
v_add_f32 v23, v23, v31
v_add_f32 v24, v24, v32
s_waitcnt lgkmcnt(0)
v_mfma_f32_32x32x16_bf16 v[64:79], v[56:59], a[168:171], v[64:79]
ds_read_b64_tr_b16 v[48:49], v18 offset:2048
ds_read_b64_tr_b16 v[50:51], v18 offset:2304
v_mfma_f32_32x32x16_bf16 v[80:95], v[56:59], a[172:175], v[80:95]
ds_read_b64_tr_b16 v[40:41], v14 offset:8192
v_lshlrev_b32 v29, 16, v44
v_and_b32 v30, v38, v44
v_mfma_f32_32x32x16_bf16 v[128:143], v[44:47], a[168:171], v[128:143]
ds_read_b64_tr_b16 v[42:43], v14 offset:9216
v_add_f32 v23, v23, v29
v_add_f32 v24, v24, v30
v_mfma_f32_16x16x32_bf16 a[0:3], v[56:59], a[8:11], a[0:3]
ds_read_b64_tr_b16 a[128:129], v15 offset:8192
v_lshlrev_b32 v31, 16, v45
v_and_b32 v32, v38, v45
v_mfma_f32_32x32x16_bf16 v[144:159], v[44:47], a[172:175], v[144:159]
ds_read_b64_tr_b16 a[130:131], v15 offset:9216
v_add_f32 v23, v23, v31
v_add_f32 v24, v24, v32
v_mfma_f32_32x32x16_bf16 v[160:175], a[140:143], a[168:171], v[160:175]
ds_read_b64_tr_b16 a[132:133], v16 offset:8192
v_lshlrev_b32 v29, 16, v46
v_mfma_f32_32x32x16_bf16 v[176:191], a[140:143], a[172:175], v[176:191]
ds_read_b64_tr_b16 a[134:135], v16 offset:9216
v_and_b32 v30, v38, v46
v_mfma_f32_32x32x16_bf16 v[192:207], a[144:147], a[168:171], v[192:207]
ds_read_b64_tr_b16 a[136:137], v17 offset:8192
v_add_f32 v23, v23, v29
v_mfma_f32_32x32x16_bf16 v[208:223], a[144:147], a[172:175], v[208:223]
ds_read_b64_tr_b16 a[138:139], v17 offset:9216
v_add_f32 v24, v24, v30
v_mfma_f32_32x32x16_bf16 v[224:239], a[148:151], a[168:171], v[224:239]
v_lshlrev_b32 v31, 16, v47
v_and_b32 v32, v38, v47
v_mfma_f32_32x32x16_bf16 v[240:255], a[148:151], a[172:175], v[240:255]
v_add_f32 v23, v23, v31
v_add_f32 v24, v24, v32
s_waitcnt vmcnt(0)
s_barrier
s_waitcnt lgkmcnt(0)
v_mfma_f32_32x32x16_bf16 v[64:79], v[48:51], a[176:179], v[64:79]
ds_read_b64_tr_b16 v[56:57], v18 offset:3072
s_add_u32 m0, s90, 0x1c000
ds_read_b128 a[192:195], v19 offset:8192
ds_read_b64_tr_b16 v[58:59], v18 offset:3328
ds_read_b128 a[196:199], v19 offset:12288
v_mfma_f32_32x32x16_bf16 v[80:95], v[48:51], a[180:183], v[80:95]
buffer_load_dwordx4 v33, s[20:23], s88 offen lds
ds_read_b64_tr_b16 v[44:45], v14 offset:12288
ds_read_b128 a[200:203], v20 offset:8192
v_lshlrev_b32 v29, 16, v40
v_mfma_f32_32x32x16_bf16 v[128:143], v[40:43], a[176:179], v[128:143]
ds_read_b64_tr_b16 v[46:47], v14 offset:13312
buffer_load_dwordx4 v34, s[20:23], s88 offen offset:1024 lds
v_and_b32 v30, v38, v40
v_mfma_f32_16x16x32_bf16 a[0:3], v[48:51], a[8:11], a[0:3]
ds_read_b64_tr_b16 a[140:141], v15 offset:12288
s_add_u32 s88, s88, 0x2000
ds_read_b128 a[204:207], v20 offset:12288
v_add_f32 v23, v23, v29
v_mfma_f32_32x32x16_bf16 v[144:159], v[40:43], a[180:183], v[144:159]
ds_read_b64_tr_b16 a[142:143], v15 offset:13312
s_add_u32 m0, s90, 0x22000
v_add_f32 v24, v24, v30
v_lshlrev_b32 v31, 16, v41
v_mfma_f32_32x32x16_bf16 v[160:175], a[128:131], a[176:179], v[160:175]
ds_read_b64_tr_b16 a[144:145], v16 offset:12288
buffer_load_dwordx4 v35, s[24:27], s89 offen lds
v_and_b32 v32, v38, v41
v_mfma_f32_32x32x16_bf16 v[176:191], a[128:131], a[180:183], v[176:191]
ds_read_b64_tr_b16 a[146:147], v16 offset:13312
ds_read_b128 a[208:211], v21 offset:8192
v_add_f32 v23, v23, v31
v_add_f32 v24, v24, v32
v_mfma_f32_32x32x16_bf16 v[192:207], a[132:135], a[176:179], v[192:207]
ds_read_b64_tr_b16 a[148:149], v17 offset:12288
ds_read_b128 a[212:215], v21 offset:12288
v_lshlrev_b32 v29, 16, v42
v_and_b32 v30, v38, v42
v_mfma_f32_32x32x16_bf16 v[208:223], a[132:135], a[180:183], v[208:223]
ds_read_b64_tr_b16 a[150:151], v17 offset:13312
ds_read_b128 a[216:219], v22 offset:8192
v_add_f32 v23, v23, v29
v_add_f32 v24, v24, v30
v_mfma_f32_32x32x16_bf16 v[224:239], a[136:139], a[176:179], v[224:239]
ds_read_b128 a[220:223], v22 offset:12288
buffer_load_dwordx4 v35, s[24:27], s89 offen offset:1024 lds
v_lshlrev_b32 v31, 16, v43
v_mfma_f32_32x32x16_bf16 v[240:255], a[136:139], a[180:183], v[240:255]
s_add_u32 s89, s89, 0x2000
v_and_b32 v32, v38, v43
v_add_f32 v23, v23, v31
v_add_f32 v24, v24, v32
s_waitcnt lgkmcnt(0)
v_mfma_f32_32x32x16_bf16 v[64:79], v[56:59], a[184:187], v[64:79]
ds_read_b64_tr_b16 v[48:49], v18 offset:24576
s_add_u32 m0, s90, 0x1e000
ds_read_b64_tr_b16 v[50:51], v18 offset:24832
v_mfma_f32_32x32x16_bf16 v[80:95], v[56:59], a[188:191], v[80:95]
buffer_load_dwordx4 v33, s[20:23], s88 offen lds
ds_read_b64_tr_b16 v[40:41], v14 offset:24576
v_lshlrev_b32 v29, 16, v44
v_mfma_f32_32x32x16_bf16 v[128:143], v[44:47], a[184:187], v[128:143]
ds_read_b64_tr_b16 v[42:43], v14 offset:25600
buffer_load_dwordx4 v34, s[20:23], s88 offen offset:1024 lds
v_and_b32 v30, v38, v44
v_mfma_f32_16x16x32_bf16 a[0:3], v[56:59], a[8:11], a[0:3]
ds_read_b64_tr_b16 a[128:129], v15 offset:24576
s_add_u32 s88, s88, 0x2000
v_add_f32 v23, v23, v29
v_add_f32 v24, v24, v30
v_mfma_f32_32x32x16_bf16 v[144:159], v[44:47], a[188:191], v[144:159]
ds_read_b64_tr_b16 a[130:131], v15 offset:25600
s_add_u32 m0, s90, 0x20000
v_lshlrev_b32 v31, 16, v45
v_and_b32 v32, v38, v45
v_mfma_f32_32x32x16_bf16 v[160:175], a[140:143], a[184:187], v[160:175]
ds_read_b64_tr_b16 a[132:133], v16 offset:24576
buffer_load_dwordx4 v33, s[20:23], s88 offen lds
v_add_f32 v23, v23, v31
v_mfma_f32_32x32x16_bf16 v[176:191], a[140:143], a[188:191], v[176:191]
ds_read_b64_tr_b16 a[134:135], v16 offset:25600
v_add_f32 v24, v24, v32
v_lshlrev_b32 v29, 16, v46
v_mfma_f32_32x32x16_bf16 v[192:207], a[144:147], a[184:187], v[192:207]
ds_read_b64_tr_b16 a[136:137], v17 offset:24576
v_and_b32 v30, v38, v46
v_add_f32 v23, v23, v29
v_mfma_f32_32x32x16_bf16 v[208:223], a[144:147], a[188:191], v[208:223]
ds_read_b64_tr_b16 a[138:139], v17 offset:25600
v_add_f32 v24, v24, v30
v_lshlrev_b32 v31, 16, v47
v_mfma_f32_32x32x16_bf16 v[224:239], a[148:151], a[184:187], v[224:239]
buffer_load_dwordx4 v34, s[20:23], s88 offen offset:1024 lds
v_and_b32 v32, v38, v47
v_mfma_f32_32x32x16_bf16 v[240:255], a[148:151], a[188:191], v[240:255]
s_add_u32 s88, s88, 0x2000
v_add_f32 v23, v23, v31
v_add_f32 v24, v24, v32
s_waitcnt lgkmcnt(0)
v_mfma_f32_32x32x16_bf16 v[64:79], v[48:51], a[192:195], v[64:79]
ds_read_b64_tr_b16 v[56:57], v18 offset:25600
s_add_u32 m0, s90, 0x24000
ds_read_b64_tr_b16 v[58:59], v18 offset:25856
v_mfma_f32_32x32x16_bf16 v[80:95], v[48:51], a[196:199], v[80:95]
buffer_load_dwordx4 v35, s[24:27], s89 offen lds
ds_read_b64_tr_b16 v[44:45], v14 offset:28672
v_lshlrev_b32 v29, 16, v40
v_mfma_f32_32x32x16_bf16 v[128:143], v[40:43], a[192:195], v[128:143]
ds_read_b64_tr_b16 v[46:47], v14 offset:29696
buffer_load_dwordx4 v35, s[24:27], s89 offen offset:1024 lds
v_and_b32 v30, v38, v40
v_mfma_f32_16x16x32_bf16 a[0:3], v[48:51], a[8:11], a[0:3]
ds_read_b64_tr_b16 a[140:141], v15 offset:28672
s_add_u32 s89, s89, 0x2000
v_add_f32 v23, v23, v29
v_add_f32 v24, v24, v30
v_mfma_f32_32x32x16_bf16 v[144:159], v[40:43], a[196:199], v[144:159]
ds_read_b64_tr_b16 a[142:143], v15 offset:29696
v_lshlrev_b32 v31, 16, v41
v_and_b32 v39, 31, v1
v_and_b32 v32, v38, v41
v_mfma_f32_32x32x16_bf16 v[160:175], a[128:131], a[192:195], v[160:175]
ds_read_b64_tr_b16 a[144:145], v16 offset:28672
v_add_f32 v23, v23, v31
v_lshlrev_b32 v39, 4, v39
v_add_f32 v24, v24, v32
v_mfma_f32_32x32x16_bf16 v[176:191], a[128:131], a[196:199], v[176:191]
ds_read_b64_tr_b16 a[146:147], v16 offset:29696
v_lshlrev_b32 v29, 16, v42
v_and_b32 v30, v38, v42
v_mfma_f32_32x32x16_bf16 v[192:207], a[132:135], a[192:195], v[192:207]
ds_read_b64_tr_b16 a[148:149], v17 offset:28672
v_add_f32 v23, v23, v29
v_add_f32 v24, v24, v30
v_mfma_f32_32x32x16_bf16 v[208:223], a[132:135], a[196:199], v[208:223]
ds_read_b64_tr_b16 a[150:151], v17 offset:29696
v_lshlrev_b32 v31, 16, v43
v_and_b32 v32, v38, v43
v_mfma_f32_32x32x16_bf16 v[224:239], a[136:139], a[192:195], v[224:239]
buffer_load_dwordx4 a[224:227], v39, s[28:31], s7 offen sc0 sc1
v_add_f32 v23, v23, v31
v_mfma_f32_32x32x16_bf16 v[240:255], a[136:139], a[196:199], v[240:255]
buffer_load_dwordx4 a[228:231], v39, s[28:31], s7 offen offset:512 sc0 sc1
v_add_f32 v24, v24, v32
s_waitcnt lgkmcnt(0)
v_mfma_f32_32x32x16_bf16 v[64:79], v[56:59], a[200:203], v[64:79]
ds_read_b64_tr_b16 v[48:49], v18 offset:26624
ds_read_b64_tr_b16 v[50:51], v18 offset:26880
v_and_b32 v36, 31, v1
v_lshrrev_b32 v37, 5, v1
v_and_b32 v4, 15, v1
v_xor_b32 v4, v4, v37
v_mfma_f32_32x32x16_bf16 v[80:95], v[56:59], a[204:207], v[80:95]
ds_read_b64_tr_b16 v[40:41], v14 offset:32768
v_lshlrev_b32 v36, 8, v36
v_add_u32 v36, 0x1c000, v36
v_lshlrev_b32 v29, 16, v44
s_lshl_b32 s85, s5, 2
v_and_b32 v30, v38, v44
v_mfma_f32_32x32x16_bf16 v[128:143], v[44:47], a[200:203], v[128:143]
s_add_u32 s84, s85, 0
s_and_b32 s84, s84, 15
ds_read_b64_tr_b16 v[42:43], v14 offset:33792
v_add_f32 v23, v23, v29
v_xor_b32 v5, s84, v4
v_add_f32 v24, v24, v30
v_mfma_f32_16x16x32_bf16 a[0:3], v[56:59], a[8:11], a[0:3]
ds_read_b64_tr_b16 a[128:129], v15 offset:32768
v_lshl_add_u32 v5, v5, 4, v36
v_accvgpr_write_b32 a12, v5
v_lshlrev_b32 v31, 16, v45
s_add_u32 s84, s85, 2
v_and_b32 v32, v38, v45
v_mfma_f32_32x32x16_bf16 v[144:159], v[44:47], a[204:207], v[144:159]
s_and_b32 s84, s84, 15
ds_read_b64_tr_b16 a[130:131], v15 offset:33792
v_xor_b32 v5, s84, v4
v_add_f32 v23, v23, v31
v_lshl_add_u32 v5, v5, 4, v36
v_add_f32 v24, v24, v32
v_mfma_f32_32x32x16_bf16 v[160:175], a[140:143], a[200:203], v[160:175]
ds_read_b64_tr_b16 a[132:133], v16 offset:32768
v_accvgpr_write_b32 a13, v5
s_add_u32 s84, s85, 4
v_lshlrev_b32 v29, 16, v46
s_and_b32 s84, s84, 15
v_and_b32 v30, v38, v46
v_mfma_f32_32x32x16_bf16 v[176:191], a[140:143], a[204:207], v[176:191]
ds_read_b64_tr_b16 a[134:135], v16 offset:33792
v_xor_b32 v5, s84, v4
v_lshl_add_u32 v5, v5, 4, v36
v_add_f32 v23, v23, v29
v_accvgpr_write_b32 a14, v5
v_add_f32 v24, v24, v30
v_mfma_f32_32x32x16_bf16 v[192:207], a[144:147], a[200:203], v[192:207]
s_add_u32 s84, s85, 6
s_and_b32 s84, s84, 15
ds_read_b64_tr_b16 a[136:137], v17 offset:32768
v_lshlrev_b32 v31, 16, v47
v_xor_b32 v5, s84, v4
v_mfma_f32_32x32x16_bf16 v[208:223], a[144:147], a[204:207], v[208:223]
ds_read_b64_tr_b16 a[138:139], v17 offset:33792
v_lshl_add_u32 v5, v5, 4, v36
v_accvgpr_write_b32 a15, v5
v_and_b32 v32, v38, v47
s_add_u32 s84, s85, 8
v_mfma_f32_32x32x16_bf16 v[224:239], a[148:151], a[200:203], v[224:239]
s_and_b32 s84, s84, 15
v_xor_b32 v5, s84, v4
v_add_f32 v23, v23, v31
v_lshl_add_u32 v5, v5, 4, v36
v_add_f32 v24, v24, v32
v_mfma_f32_32x32x16_bf16 v[240:255], a[148:151], a[204:207], v[240:255]
v_accvgpr_write_b32 a16, v5
s_add_u32 s84, s85, 10
s_and_b32 s84, s84, 15
v_xor_b32 v5, s84, v4
v_lshl_add_u32 v5, v5, 4, v36
s_waitcnt lgkmcnt(0)
v_mfma_f32_32x32x16_bf16 v[64:79], v[48:51], a[208:211], v[64:79]
ds_read_b64_tr_b16 v[56:57], v18 offset:27648
ds_read_b64_tr_b16 v[58:59], v18 offset:27904
v_accvgpr_write_b32 a17, v5
s_add_u32 s84, s85, 12
s_and_b32 s84, s84, 15
v_xor_b32 v5, s84, v4
v_mfma_f32_32x32x16_bf16 v[80:95], v[48:51], a[212:215], v[80:95]
ds_read_b64_tr_b16 v[44:45], v14 offset:36864
v_lshl_add_u32 v5, v5, 4, v36
v_accvgpr_write_b32 a18, v5
v_lshlrev_b32 v29, 16, v40
s_add_u32 s84, s85, 14
v_and_b32 v30, v38, v40
v_mfma_f32_32x32x16_bf16 v[128:143], v[40:43], a[208:211], v[128:143]
s_and_b32 s84, s84, 15
ds_read_b64_tr_b16 v[46:47], v14 offset:37888
v_xor_b32 v5, s84, v4
v_add_f32 v23, v23, v29
v_lshl_add_u32 v5, v5, 4, v36
v_add_f32 v24, v24, v30
v_mfma_f32_16x16x32_bf16 a[0:3], v[48:51], a[8:11], a[0:3]
ds_read_b64_tr_b16 a[140:141], v15 offset:36864
v_accvgpr_write_b32 a19, v5
v_lshrrev_b32 v36, 5, v1
v_lshlrev_b32 v31, 16, v41
v_bfe_u32 v37, v1, 4, 1
v_and_b32 v32, v38, v41
v_mfma_f32_32x32x16_bf16 v[144:159], v[40:43], a[212:215], v[144:159]
ds_read_b64_tr_b16 a[142:143], v15 offset:37888
v_bfe_u32 v4, v1, 2, 2
v_and_b32 v5, 3, v1
v_add_f32 v23, v23, v31
v_and_b32 v6, 1, v5
v_add_f32 v24, v24, v32
v_mfma_f32_32x32x16_bf16 v[160:175], a[128:131], a[208:211], v[160:175]
ds_read_b64_tr_b16 a[144:145], v16 offset:36864
v_lshl_add_u32 v6, v37, 1, v6
v_lshrrev_b32 v7, 1, v5
v_lshlrev_b32 v29, 16, v42
v_lshlrev_b32 v7, 3, v7
v_and_b32 v30, v38, v42
v_mfma_f32_32x32x16_bf16 v[176:191], a[128:131], a[212:215], v[176:191]
ds_read_b64_tr_b16 a[146:147], v16 offset:37888
v_lshl_add_u32 v8, v36, 2, v4
v_lshlrev_b32 v8, 8, v8
v_add_f32 v23, v23, v29
v_add_u32 v8, v8, v7
v_add_f32 v24, v24, v30
v_mfma_f32_32x32x16_bf16 v[192:207], a[132:135], a[208:211], v[192:207]
ds_read_b64_tr_b16 a[148:149], v17 offset:36864
v_lshl_add_u32 v8, v6, 4, v8
v_add_u32 v8, 0x22000, v8
v_lshlrev_b32 v31, 16, v43
v_xor_b32 v9, 0, v4
v_mfma_f32_32x32x16_bf16 v[208:223], a[132:135], a[212:215], v[208:223]
ds_read_b64_tr_b16 a[150:151], v17 offset:37888
v_lshl_add_u32 v9, v9, 6, v8
v_accvgpr_write_b32 a20, v9
v_and_b32 v32, v38, v43
v_xor_b32 v9, 1, v4
v_mfma_f32_32x32x16_bf16 v[224:239], a[136:139], a[208:211], v[224:239]
v_lshl_add_u32 v9, v9, 6, v8
v_accvgpr_write_b32 a21, v9
v_add_f32 v23, v23, v31
v_xor_b32 v9, 2, v4
v_add_f32 v24, v24, v32
v_mfma_f32_32x32x16_bf16 v[240:255], a[136:139], a[212:215], v[240:255]
v_lshl_add_u32 v9, v9, 6, v8
v_accvgpr_write_b32 a22, v9
v_xor_b32 v9, 3, v4
v_lshl_add_u32 v9, v9, 6, v8
v_accvgpr_write_b32 a23, v9
s_waitcnt lgkmcnt(0)
v_mfma_f32_32x32x16_bf16 v[64:79], v[56:59], a[216:219], v[64:79]
v_mfma_f32_32x32x16_bf16 v[80:95], v[56:59], a[220:223], v[80:95]
v_lshlrev_b32 v29, 16, v44
v_and_b32 v30, v38, v44
v_mfma_f32_32x32x16_bf16 v[128:143], v[44:47], a[216:219], v[128:143]
v_add_f32 v23, v23, v29
v_add_f32 v24, v24, v30
v_mfma_f32_16x16x32_bf16 a[0:3], v[56:59], a[8:11], a[0:3]
v_lshlrev_b32 v31, 16, v45
v_and_b32 v32, v38, v45
v_mfma_f32_32x32x16_bf16 v[144:159], v[44:47], a[220:223], v[144:159]
v_add_f32 v23, v23, v31
v_add_f32 v24, v24, v32
v_mfma_f32_32x32x16_bf16 v[160:175], a[140:143], a[216:219], v[160:175]
v_lshlrev_b32 v29, 16, v46
v_and_b32 v30, v38, v46
v_mfma_f32_32x32x16_bf16 v[176:191], a[140:143], a[220:223], v[176:191]
v_add_f32 v23, v23, v29
v_add_f32 v24, v24, v30
v_mfma_f32_32x32x16_bf16 v[192:207], a[144:147], a[216:219], v[192:207]
v_lshlrev_b32 v31, 16, v47
v_mfma_f32_32x32x16_bf16 v[208:223], a[144:147], a[220:223], v[208:223]
v_and_b32 v32, v38, v47
v_mfma_f32_32x32x16_bf16 v[224:239], a[148:151], a[216:219], v[224:239]
v_add_f32 v23, v23, v31
v_mfma_f32_32x32x16_bf16 v[240:255], a[148:151], a[220:223], v[240:255]
v_add_f32 v24, v24, v32
s_lshl_b32 s82, s5, 14
s_add_u32 s82, s82, 0x400
v_and_b32 v7, 15, v1
v_lshlrev_b32 v7, 6, v7
v_lshrrev_b32 v8, 4, v1
v_lshl_add_u32 v7, v8, 4, v7
v_add_u32 v7, s82, v7
ds_write_b128 v7, a[0:3]
v_and_b32 v8, 31, v1
v_lshlrev_b32 v8, 2, v8
v_add_u32 v8, s82, v8
s_waitcnt lgkmcnt(0)
ds_read_b32 v25, v8
v_add_f32 v23, v23, v24
v_mov_b32 v4, v23
v_and_b32 v3, 31, v1
v_lshlrev_b32 v3, 2, v3
v_permlane32_swap_b32 v23, v4
v_add_f32 v23, v23, v4
s_lshl_b32 s82, s5, 14
v_add_u32 v4, s82, v3
ds_write_b32 v4, v23
v_accvgpr_read_b32 v10, a12
v_accvgpr_read_b32 v11, a13
v_accvgpr_read_b32 v12, a14
v_accvgpr_read_b32 v13, a15
v_accvgpr_read_b32 v14, a16
v_accvgpr_read_b32 v15, a17
v_accvgpr_read_b32 v16, a18
v_accvgpr_read_b32 v17, a19
v_accvgpr_read_b32 v18, a20
v_accvgpr_read_b32 v19, a21
v_accvgpr_read_b32 v20, a22
v_accvgpr_read_b32 v21, a23
s_waitcnt lgkmcnt(0)
s_barrier
v_and_b32 v3, 31, v1
v_lshlrev_b32 v3, 2, v3
s_add_u32 s82, s5, 1
s_and_b32 s82, s82, 3
s_lshl_b32 s82, s82, 14
v_add_u32 v4, s82, v3
ds_read_b32 v31, v4
s_add_u32 s82, s5, 2
s_and_b32 s82, s82, 3
s_lshl_b32 s82, s82, 14
v_add_u32 v4, s82, v3
ds_read_b32 v32, v4
s_add_u32 s82, s5, 3
s_and_b32 s82, s82, 3
s_lshl_b32 s82, s82, 14
v_add_u32 v4, s82, v3
ds_read_b32 v29, v4
s_waitcnt vmcnt(0)
v_accvgpr_read_b32 v56, a224
v_accvgpr_read_b32 v57, a225
v_accvgpr_read_b32 v58, a226
v_accvgpr_read_b32 v60, a228
v_accvgpr_read_b32 v61, a229
v_accvgpr_read_b32 v62, a230
v_xor_b32 v6, s32, v58
v_xor_b32 v7, s32, v62
v_or_b32 v6, v6, v7
v_cmp_eq_u32 vcc, 0, v6
s_cmp_eq_u64 vcc, exec
s_cbranch_scc1 L_xst_4
s_mov_b32 s91, 0
L_poll_5:
buffer_load_dwordx4 v[56:59], v39, s[28:31], s7 offen sc0 sc1
buffer_load_dwordx4 v[60:63], v39, s[28:31], s7 offen offset:512 sc0 sc1
s_waitcnt vmcnt(1)
v_xor_b32 v6, s32, v58
s_waitcnt vmcnt(0)
v_xor_b32 v62, s32, v62
v_or_b32 v6, v6, v62
v_cmp_eq_u32 vcc, 0, v6
s_cmp_eq_u64 vcc, exec
s_cbranch_scc1 L_polld_6
s_add_u32 s91, s91, 1
s_cmp_lt_u32 s91, 0x4e20
s_cbranch_scc0 L_polld_6_to
s_sleep 2
s_branch L_poll_5
L_polld_6_to:
s_or_b32 s67, s67, 2
L_polld_6:
L_xst_4:
v_cmp_gt_u32 vcc, 32, v1
s_nop 1
v_cndmask_b32 v6, 0, 1.0, vcc
v_sub_f32 v7, 0, v56
v_cvt_pk_bf16_f32 v8, v7, v7
v_lshlrev_b32 v9, 16, v8
v_sub_f32 v9, v7, v9
v_cvt_pk_bf16_f32 v40, v7, v9
v_cvt_pk_bf16_f32 v41, v7, 0
v_mov_b32 v42, 0
v_mov_b32 v43, 0
v_sub_f32 v7, 0, v60
v_cvt_pk_bf16_f32 v8, v7, v7
v_lshlrev_b32 v9, 16, v8
v_sub_f32 v9, v7, v9
v_cvt_pk_bf16_f32 v44, v7, v9
v_cvt_pk_bf16_f32 v45, v7, 0
v_mov_b32 v46, 0
v_mov_b32 v47, 0
v_mov_b32 v50, 0
v_mov_b32 v51, 0
v_mov_b32 v54, 0
v_mov_b32 v55, 0
v_mul_f32 v7, v23, v6
v_cvt_pk_bf16_f32 v48, v7, v7
v_lshlrev_b32 v8, 16, v48
v_sub_f32 v8, v7, v8
v_cvt_pk_bf16_f32 v49, v8, 0
v_mul_f32 v2, 0x3e0293ee, v57
v_mul_f32 v4, 0x3e0293ee, v61
s_waitcnt lgkmcnt(2)
v_mul_f32 v7, v31, v6
v_cvt_pk_bf16_f32 v52, v7, v7
v_lshlrev_b32 v8, 16, v52
v_sub_f32 v8, v7, v8
v_cvt_pk_bf16_f32 v53, v8, 0
v_mfma_f32_32x32x16_bf16 v[128:143], v[48:51], v[40:43], v[128:143]
v_mfma_f32_32x32x16_bf16 v[144:159], v[48:51], v[44:47], v[144:159]
s_waitcnt lgkmcnt(1)
v_mul_f32 v7, v32, v6
v_cvt_pk_bf16_f32 v48, v7, v7
v_lshlrev_b32 v8, 16, v48
v_sub_f32 v8, v7, v8
v_cvt_pk_bf16_f32 v49, v8, 0
v_mfma_f32_32x32x16_bf16 v[160:175], v[52:55], v[40:43], v[160:175]
v_mfma_f32_32x32x16_bf16 v[176:191], v[52:55], v[44:47], v[176:191]
s_waitcnt lgkmcnt(0)
v_mul_f32 v7, v29, v6
v_cvt_pk_bf16_f32 v52, v7, v7
v_lshlrev_b32 v8, 16, v52
v_sub_f32 v8, v7, v8
v_cvt_pk_bf16_f32 v53, v8, 0
v_mfma_f32_32x32x16_bf16 v[192:207], v[48:51], v[40:43], v[192:207]
v_mfma_f32_32x32x16_bf16 v[208:223], v[48:51], v[44:47], v[208:223]
v_mul_f32 v7, v25, v6
v_cvt_pk_bf16_f32 v48, v7, v7
v_lshlrev_b32 v8, 16, v48
v_sub_f32 v8, v7, v8
v_cvt_pk_bf16_f32 v49, v8, 0
v_mfma_f32_32x32x16_bf16 v[224:239], v[52:55], v[40:43], v[224:239]
v_mfma_f32_32x32x16_bf16 v[240:255], v[52:55], v[44:47], v[240:255]
v_mfma_f32_32x32x16_bf16 v[64:79], v[48:51], v[40:43], v[64:79]
v_mfma_f32_32x32x16_bf16 v[80:95], v[48:51], v[44:47], v[80:95]
v_pk_mul_f32 v[128:129], v[128:129], v[2:3] op_sel_hi:[1,0]
v_pk_mul_f32 v[130:131], v[130:131], v[2:3] op_sel_hi:[1,0]
v_pk_mul_f32 v[132:133], v[132:133], v[2:3] op_sel_hi:[1,0]
v_pk_mul_f32 v[134:135], v[134:135], v[2:3] op_sel_hi:[1,0]
v_pk_mul_f32 v[136:137], v[136:137], v[2:3] op_sel_hi:[1,0]
v_pk_mul_f32 v[138:139], v[138:139], v[2:3] op_sel_hi:[1,0]
v_pk_mul_f32 v[140:141], v[140:141], v[2:3] op_sel_hi:[1,0]
v_pk_mul_f32 v[142:143], v[142:143], v[2:3] op_sel_hi:[1,0]
v_cvt_pk_bf16_f32 v128, v128, v129
v_cvt_pk_bf16_f32 v129, v130, v131
v_cvt_pk_bf16_f32 v130, v132, v133
v_cvt_pk_bf16_f32 v131, v134, v135
v_cvt_pk_bf16_f32 v132, v136, v137
v_cvt_pk_bf16_f32 v133, v138, v139
v_cvt_pk_bf16_f32 v134, v140, v141
v_cvt_pk_bf16_f32 v135, v142, v143
v_pk_mul_f32 v[144:145], v[144:145], v[4:5] op_sel_hi:[1,0]
v_pk_mul_f32 v[146:147], v[146:147], v[4:5] op_sel_hi:[1,0]
v_pk_mul_f32 v[148:149], v[148:149], v[4:5] op_sel_hi:[1,0]
v_pk_mul_f32 v[150:151], v[150:151], v[4:5] op_sel_hi:[1,0]
v_pk_mul_f32 v[152:153], v[152:153], v[4:5] op_sel_hi:[1,0]
v_pk_mul_f32 v[154:155], v[154:155], v[4:5] op_sel_hi:[1,0]
v_pk_mul_f32 v[156:157], v[156:157], v[4:5] op_sel_hi:[1,0]
v_pk_mul_f32 v[158:159], v[158:159], v[4:5] op_sel_hi:[1,0]
v_cvt_pk_bf16_f32 v136, v144, v145
v_cvt_pk_bf16_f32 v137, v146, v147
v_cvt_pk_bf16_f32 v138, v148, v149
v_cvt_pk_bf16_f32 v139, v150, v151
v_cvt_pk_bf16_f32 v140, v152, v153
v_cvt_pk_bf16_f32 v141, v154, v155
v_cvt_pk_bf16_f32 v142, v156, v157
v_cvt_pk_bf16_f32 v143, v158, v159
v_pk_mul_f32 v[160:161], v[160:161], v[2:3] op_sel_hi:[1,0]
v_pk_mul_f32 v[162:163], v[162:163], v[2:3] op_sel_hi:[1,0]
v_pk_mul_f32 v[164:165], v[164:165], v[2:3] op_sel_hi:[1,0]
v_pk_mul_f32 v[166:167], v[166:167], v[2:3] op_sel_hi:[1,0]
v_pk_mul_f32 v[168:169], v[168:169], v[2:3] op_sel_hi:[1,0]
v_pk_mul_f32 v[170:171], v[170:171], v[2:3] op_sel_hi:[1,0]
v_pk_mul_f32 v[172:173], v[172:173], v[2:3] op_sel_hi:[1,0]
v_pk_mul_f32 v[174:175], v[174:175], v[2:3] op_sel_hi:[1,0]
v_cvt_pk_bf16_f32 v144, v160, v161
v_cvt_pk_bf16_f32 v145, v162, v163
v_cvt_pk_bf16_f32 v146, v164, v165
v_cvt_pk_bf16_f32 v147, v166, v167
v_cvt_pk_bf16_f32 v148, v168, v169
v_cvt_pk_bf16_f32 v149, v170, v171
v_cvt_pk_bf16_f32 v150, v172, v173
v_cvt_pk_bf16_f32 v151, v174, v175
v_pk_mul_f32 v[176:177], v[176:177], v[4:5] op_sel_hi:[1,0]
v_pk_mul_f32 v[178:179], v[178:179], v[4:5] op_sel_hi:[1,0]
v_pk_mul_f32 v[180:181], v[180:181], v[4:5] op_sel_hi:[1,0]
v_pk_mul_f32 v[182:183], v[182:183], v[4:5] op_sel_hi:[1,0]
v_pk_mul_f32 v[184:185], v[184:185], v[4:5] op_sel_hi:[1,0]
v_pk_mul_f32 v[186:187], v[186:187], v[4:5] op_sel_hi:[1,0]
v_pk_mul_f32 v[188:189], v[188:189], v[4:5] op_sel_hi:[1,0]
v_pk_mul_f32 v[190:191], v[190:191], v[4:5] op_sel_hi:[1,0]
v_cvt_pk_bf16_f32 v152, v176, v177
v_cvt_pk_bf16_f32 v153, v178, v179
v_cvt_pk_bf16_f32 v154, v180, v181
v_cvt_pk_bf16_f32 v155, v182, v183
v_cvt_pk_bf16_f32 v156, v184, v185
v_cvt_pk_bf16_f32 v157, v186, v187
v_cvt_pk_bf16_f32 v158, v188, v189
v_cvt_pk_bf16_f32 v159, v190, v191
v_pk_mul_f32 v[192:193], v[192:193], v[2:3] op_sel_hi:[1,0]
v_pk_mul_f32 v[194:195], v[194:195], v[2:3] op_sel_hi:[1,0]
v_pk_mul_f32 v[196:197], v[196:197], v[2:3] op_sel_hi:[1,0]
v_pk_mul_f32 v[198:199], v[198:199], v[2:3] op_sel_hi:[1,0]
v_pk_mul_f32 v[200:201], v[200:201], v[2:3] op_sel_hi:[1,0]
v_pk_mul_f32 v[202:203], v[202:203], v[2:3] op_sel_hi:[1,0]
v_pk_mul_f32 v[204:205], v[204:205], v[2:3] op_sel_hi:[1,0]
v_pk_mul_f32 v[206:207], v[206:207], v[2:3] op_sel_hi:[1,0]
v_cvt_pk_bf16_f32 v160, v192, v193
v_cvt_pk_bf16_f32 v161, v194, v195
v_cvt_pk_bf16_f32 v162, v196, v197
v_cvt_pk_bf16_f32 v163, v198, v199
v_cvt_pk_bf16_f32 v164, v200, v201
v_cvt_pk_bf16_f32 v165, v202, v203
v_cvt_pk_bf16_f32 v166, v204, v205
v_cvt_pk_bf16_f32 v167, v206, v207
v_pk_mul_f32 v[208:209], v[208:209], v[4:5] op_sel_hi:[1,0]
v_pk_mul_f32 v[210:211], v[210:211], v[4:5] op_sel_hi:[1,0]
v_pk_mul_f32 v[212:213], v[212:213], v[4:5] op_sel_hi:[1,0]
v_pk_mul_f32 v[214:215], v[214:215], v[4:5] op_sel_hi:[1,0]
v_pk_mul_f32 v[216:217], v[216:217], v[4:5] op_sel_hi:[1,0]
v_pk_mul_f32 v[218:219], v[218:219], v[4:5] op_sel_hi:[1,0]
v_pk_mul_f32 v[220:221], v[220:221], v[4:5] op_sel_hi:[1,0]
v_pk_mul_f32 v[222:223], v[222:223], v[4:5] op_sel_hi:[1,0]
v_cvt_pk_bf16_f32 v168, v208, v209
v_cvt_pk_bf16_f32 v169, v210, v211
v_cvt_pk_bf16_f32 v170, v212, v213
v_cvt_pk_bf16_f32 v171, v214, v215
v_cvt_pk_bf16_f32 v172, v216, v217
v_cvt_pk_bf16_f32 v173, v218, v219
v_cvt_pk_bf16_f32 v174, v220, v221
v_cvt_pk_bf16_f32 v175, v222, v223
v_pk_mul_f32 v[224:225], v[224:225], v[2:3] op_sel_hi:[1,0]
v_pk_mul_f32 v[226:227], v[226:227], v[2:3] op_sel_hi:[1,0]
v_pk_mul_f32 v[228:229], v[228:229], v[2:3] op_sel_hi:[1,0]
v_pk_mul_f32 v[230:231], v[230:231], v[2:3] op_sel_hi:[1,0]
v_pk_mul_f32 v[232:233], v[232:233], v[2:3] op_sel_hi:[1,0]
v_pk_mul_f32 v[234:235], v[234:235], v[2:3] op_sel_hi:[1,0]
v_pk_mul_f32 v[236:237], v[236:237], v[2:3] op_sel_hi:[1,0]
v_pk_mul_f32 v[238:239], v[238:239], v[2:3] op_sel_hi:[1,0]
v_cvt_pk_bf16_f32 v176, v224, v225
v_cvt_pk_bf16_f32 v177, v226, v227
v_cvt_pk_bf16_f32 v178, v228, v229
v_cvt_pk_bf16_f32 v179, v230, v231
v_cvt_pk_bf16_f32 v180, v232, v233
v_cvt_pk_bf16_f32 v181, v234, v235
v_cvt_pk_bf16_f32 v182, v236, v237
v_cvt_pk_bf16_f32 v183, v238, v239
v_pk_mul_f32 v[240:241], v[240:241], v[4:5] op_sel_hi:[1,0]
v_pk_mul_f32 v[242:243], v[242:243], v[4:5] op_sel_hi:[1,0]
v_pk_mul_f32 v[244:245], v[244:245], v[4:5] op_sel_hi:[1,0]
v_pk_mul_f32 v[246:247], v[246:247], v[4:5] op_sel_hi:[1,0]
v_pk_mul_f32 v[248:249], v[248:249], v[4:5] op_sel_hi:[1,0]
v_pk_mul_f32 v[250:251], v[250:251], v[4:5] op_sel_hi:[1,0]
v_pk_mul_f32 v[252:253], v[252:253], v[4:5] op_sel_hi:[1,0]
v_pk_mul_f32 v[254:255], v[254:255], v[4:5] op_sel_hi:[1,0]
v_cvt_pk_bf16_f32 v184, v240, v241
v_cvt_pk_bf16_f32 v185, v242, v243
v_cvt_pk_bf16_f32 v186, v244, v245
v_cvt_pk_bf16_f32 v187, v246, v247
v_cvt_pk_bf16_f32 v188, v248, v249
v_cvt_pk_bf16_f32 v189, v250, v251
v_cvt_pk_bf16_f32 v190, v252, v253
v_cvt_pk_bf16_f32 v191, v254, v255
s_barrier
ds_read_b128 a[192:195], v10
ds_read_b128 a[196:199], v11
ds_read_b128 a[200:203], v12
ds_read_b128 a[204:207], v13
ds_read_b128 a[208:211], v14
ds_read_b128 a[212:215], v15
ds_read_b128 a[216:219], v16
ds_read_b128 a[220:223], v17
s_mov_b32 s98, 0x3dd2d3e8
s_mov_b32 s100, 1.0
v_mov_b32 v46, 0x40135761
v_mov_b32 v44, v57
v_pk_mul_f32 v[64:65], v[64:65], v[44:45] op_sel_hi:[1,0]
v_pk_mul_f32 v[66:67], v[66:67], v[44:45] op_sel_hi:[1,0]
v_pk_mul_f32 v[68:69], v[68:69], v[44:45] op_sel_hi:[1,0]
v_pk_mul_f32 v[70:71], v[70:71], v[44:45] op_sel_hi:[1,0]
v_pk_mul_f32 v[48:49], v[64:65], v[64:65]
v_pk_mul_f32 v[50:51], v[66:67], v[66:67]
v_pk_mul_f32 v[52:53], v[68:69], v[68:69]
v_pk_mul_f32 v[54:55], v[70:71], v[70:71]
v_pk_fma_f32 v[48:49], v[48:49], s[98:99], v[46:47] op_sel_hi:[1,0,0]
v_pk_fma_f32 v[50:51], v[50:51], s[98:99], v[46:47] op_sel_hi:[1,0,0]
v_pk_fma_f32 v[52:53], v[52:53], s[98:99], v[46:47] op_sel_hi:[1,0,0]
v_pk_fma_f32 v[54:55], v[54:55], s[98:99], v[46:47] op_sel_hi:[1,0,0]
v_pk_mul_f32 v[48:49], v[48:49], v[64:65]
v_pk_mul_f32 v[50:51], v[50:51], v[66:67]
v_pk_mul_f32 v[52:53], v[52:53], v[68:69]
v_pk_mul_f32 v[54:55], v[54:55], v[70:71]
s_waitcnt lgkmcnt(7)
v_mfma_f32_32x32x16_bf16 v[192:207], a[192:195], v[128:131], 0
v_exp_f32 v48, -v48
v_exp_f32 v49, -v49
v_exp_f32 v50, -v50
v_exp_f32 v51, -v51
s_waitcnt lgkmcnt(6)
v_mfma_f32_32x32x16_bf16 v[192:207], a[196:199], v[132:135], v[192:207]
v_exp_f32 v52, -v52
v_exp_f32 v53, -v53
v_exp_f32 v54, -v54
v_exp_f32 v55, -v55
v_pk_add_f32 v[48:49], v[48:49], s[100:101] op_sel_hi:[1,0]
v_pk_add_f32 v[50:51], v[50:51], s[100:101] op_sel_hi:[1,0]
v_pk_add_f32 v[52:53], v[52:53], s[100:101] op_sel_hi:[1,0]
v_pk_add_f32 v[54:55], v[54:55], s[100:101] op_sel_hi:[1,0]
s_waitcnt lgkmcnt(5)
v_mfma_f32_32x32x16_bf16 v[192:207], a[200:203], v[144:147], v[192:207]
v_rcp_f32 v48, v48
v_rcp_f32 v49, v49
v_rcp_f32 v50, v50
v_rcp_f32 v51, v51
s_waitcnt lgkmcnt(4)
v_mfma_f32_32x32x16_bf16 v[192:207], a[204:207], v[148:151], v[192:207]
v_rcp_f32 v52, v52
v_rcp_f32 v53, v53
v_rcp_f32 v54, v54
v_rcp_f32 v55, v55
v_pk_mul_f32 v[64:65], v[64:65], v[48:49]
v_pk_mul_f32 v[66:67], v[66:67], v[50:51]
v_pk_mul_f32 v[68:69], v[68:69], v[52:53]
v_pk_mul_f32 v[70:71], v[70:71], v[54:55]
v_pk_mul_f32 v[72:73], v[72:73], v[44:45] op_sel_hi:[1,0]
v_pk_mul_f32 v[74:75], v[74:75], v[44:45] op_sel_hi:[1,0]
v_pk_mul_f32 v[76:77], v[76:77], v[44:45] op_sel_hi:[1,0]
v_pk_mul_f32 v[78:79], v[78:79], v[44:45] op_sel_hi:[1,0]
v_pk_mul_f32 v[48:49], v[72:73], v[72:73]
v_pk_mul_f32 v[50:51], v[74:75], v[74:75]
v_pk_mul_f32 v[52:53], v[76:77], v[76:77]
v_pk_mul_f32 v[54:55], v[78:79], v[78:79]
v_pk_fma_f32 v[48:49], v[48:49], s[98:99], v[46:47] op_sel_hi:[1,0,0]
v_pk_fma_f32 v[50:51], v[50:51], s[98:99], v[46:47] op_sel_hi:[1,0,0]
v_pk_fma_f32 v[52:53], v[52:53], s[98:99], v[46:47] op_sel_hi:[1,0,0]
v_pk_fma_f32 v[54:55], v[54:55], s[98:99], v[46:47] op_sel_hi:[1,0,0]
v_pk_mul_f32 v[48:49], v[48:49], v[72:73]
v_pk_mul_f32 v[50:51], v[50:51], v[74:75]
v_pk_mul_f32 v[52:53], v[52:53], v[76:77]
v_pk_mul_f32 v[54:55], v[54:55], v[78:79]
s_waitcnt lgkmcnt(3)
v_mfma_f32_32x32x16_bf16 v[192:207], a[208:211], v[160:163], v[192:207]
v_exp_f32 v48, -v48
v_exp_f32 v49, -v49
v_exp_f32 v50, -v50
v_exp_f32 v51, -v51
s_waitcnt lgkmcnt(2)
v_mfma_f32_32x32x16_bf16 v[192:207], a[212:215], v[164:167], v[192:207]
v_exp_f32 v52, -v52
v_exp_f32 v53, -v53
v_exp_f32 v54, -v54
v_exp_f32 v55, -v55
v_pk_add_f32 v[48:49], v[48:49], s[100:101] op_sel_hi:[1,0]
v_pk_add_f32 v[50:51], v[50:51], s[100:101] op_sel_hi:[1,0]
v_pk_add_f32 v[52:53], v[52:53], s[100:101] op_sel_hi:[1,0]
v_pk_add_f32 v[54:55], v[54:55], s[100:101] op_sel_hi:[1,0]
s_waitcnt lgkmcnt(1)
v_mfma_f32_32x32x16_bf16 v[192:207], a[216:219], v[176:179], v[192:207]
v_rcp_f32 v48, v48
v_rcp_f32 v49, v49
v_rcp_f32 v50, v50
v_rcp_f32 v51, v51
s_waitcnt lgkmcnt(0)
v_mfma_f32_32x32x16_bf16 v[192:207], a[220:223], v[180:183], v[192:207]
v_rcp_f32 v52, v52
v_rcp_f32 v53, v53
v_rcp_f32 v54, v54
v_rcp_f32 v55, v55
v_pk_mul_f32 v[72:73], v[72:73], v[48:49]
v_pk_mul_f32 v[74:75], v[74:75], v[50:51]
v_pk_mul_f32 v[76:77], v[76:77], v[52:53]
v_pk_mul_f32 v[78:79], v[78:79], v[54:55]
v_mov_b32 v44, v61
v_pk_mul_f32 v[80:81], v[80:81], v[44:45] op_sel_hi:[1,0]
v_pk_mul_f32 v[82:83], v[82:83], v[44:45] op_sel_hi:[1,0]
v_pk_mul_f32 v[84:85], v[84:85], v[44:45] op_sel_hi:[1,0]
v_pk_mul_f32 v[86:87], v[86:87], v[44:45] op_sel_hi:[1,0]
v_pk_mul_f32 v[48:49], v[80:81], v[80:81]
v_pk_mul_f32 v[50:51], v[82:83], v[82:83]
v_pk_mul_f32 v[52:53], v[84:85], v[84:85]
v_pk_mul_f32 v[54:55], v[86:87], v[86:87]
v_pk_fma_f32 v[48:49], v[48:49], s[98:99], v[46:47] op_sel_hi:[1,0,0]
v_pk_fma_f32 v[50:51], v[50:51], s[98:99], v[46:47] op_sel_hi:[1,0,0]
v_pk_fma_f32 v[52:53], v[52:53], s[98:99], v[46:47] op_sel_hi:[1,0,0]
v_pk_fma_f32 v[54:55], v[54:55], s[98:99], v[46:47] op_sel_hi:[1,0,0]
v_pk_mul_f32 v[48:49], v[48:49], v[80:81]
v_pk_mul_f32 v[50:51], v[50:51], v[82:83]
v_pk_mul_f32 v[52:53], v[52:53], v[84:85]
v_pk_mul_f32 v[54:55], v[54:55], v[86:87]
v_mfma_f32_32x32x16_bf16 v[208:223], a[192:195], v[136:139], 0
v_exp_f32 v48, -v48
v_exp_f32 v49, -v49
v_exp_f32 v50, -v50
v_exp_f32 v51, -v51
v_mfma_f32_32x32x16_bf16 v[208:223], a[196:199], v[140:143], v[208:223]
v_exp_f32 v52, -v52
v_exp_f32 v53, -v53
v_exp_f32 v54, -v54
v_exp_f32 v55, -v55
v_pk_add_f32 v[48:49], v[48:49], s[100:101] op_sel_hi:[1,0]
v_pk_add_f32 v[50:51], v[50:51], s[100:101] op_sel_hi:[1,0]
v_pk_add_f32 v[52:53], v[52:53], s[100:101] op_sel_hi:[1,0]
v_pk_add_f32 v[54:55], v[54:55], s[100:101] op_sel_hi:[1,0]
v_mfma_f32_32x32x16_bf16 v[208:223], a[200:203], v[152:155], v[208:223]
v_rcp_f32 v48, v48
v_rcp_f32 v49, v49
v_rcp_f32 v50, v50
v_rcp_f32 v51, v51
v_mfma_f32_32x32x16_bf16 v[208:223], a[204:207], v[156:159], v[208:223]
v_rcp_f32 v52, v52
v_rcp_f32 v53, v53
v_rcp_f32 v54, v54
v_rcp_f32 v55, v55
v_pk_mul_f32 v[80:81], v[80:81], v[48:49]
v_pk_mul_f32 v[82:83], v[82:83], v[50:51]
v_pk_mul_f32 v[84:85], v[84:85], v[52:53]
v_pk_mul_f32 v[86:87], v[86:87], v[54:55]
v_pk_mul_f32 v[88:89], v[88:89], v[44:45] op_sel_hi:[1,0]
v_pk_mul_f32 v[90:91], v[90:91], v[44:45] op_sel_hi:[1,0]
v_pk_mul_f32 v[92:93], v[92:93], v[44:45] op_sel_hi:[1,0]
v_pk_mul_f32 v[94:95], v[94:95], v[44:45] op_sel_hi:[1,0]
v_pk_mul_f32 v[48:49], v[88:89], v[88:89]
v_pk_mul_f32 v[50:51], v[90:91], v[90:91]
v_pk_mul_f32 v[52:53], v[92:93], v[92:93]
v_pk_mul_f32 v[54:55], v[94:95], v[94:95]
v_pk_fma_f32 v[48:49], v[48:49], s[98:99], v[46:47] op_sel_hi:[1,0,0]
v_pk_fma_f32 v[50:51], v[50:51], s[98:99], v[46:47] op_sel_hi:[1,0,0]
v_pk_fma_f32 v[52:53], v[52:53], s[98:99], v[46:47] op_sel_hi:[1,0,0]
v_pk_fma_f32 v[54:55], v[54:55], s[98:99], v[46:47] op_sel_hi:[1,0,0]
v_pk_mul_f32 v[48:49], v[48:49], v[88:89]
v_pk_mul_f32 v[50:51], v[50:51], v[90:91]
v_pk_mul_f32 v[52:53], v[52:53], v[92:93]
v_pk_mul_f32 v[54:55], v[54:55], v[94:95]
v_mfma_f32_32x32x16_bf16 v[208:223], a[208:211], v[168:171], v[208:223]
v_exp_f32 v48, -v48
v_exp_f32 v49, -v49
v_exp_f32 v50, -v50
v_exp_f32 v51, -v51
v_mfma_f32_32x32x16_bf16 v[208:223], a[212:215], v[172:175], v[208:223]
v_exp_f32 v52, -v52
v_exp_f32 v53, -v53
v_exp_f32 v54, -v54
v_exp_f32 v55, -v55
v_pk_add_f32 v[48:49], v[48:49], s[100:101] op_sel_hi:[1,0]
v_pk_add_f32 v[50:51], v[50:51], s[100:101] op_sel_hi:[1,0]
v_pk_add_f32 v[52:53], v[52:53], s[100:101] op_sel_hi:[1,0]
v_pk_add_f32 v[54:55], v[54:55], s[100:101] op_sel_hi:[1,0]
v_mfma_f32_32x32x16_bf16 v[208:223], a[216:219], v[184:187], v[208:223]
v_rcp_f32 v48, v48
v_rcp_f32 v49, v49
v_rcp_f32 v50, v50
v_rcp_f32 v51, v51
v_mfma_f32_32x32x16_bf16 v[208:223], a[220:223], v[188:191], v[208:223]
v_rcp_f32 v52, v52
v_rcp_f32 v53, v53
v_rcp_f32 v54, v54
v_rcp_f32 v55, v55
v_pk_mul_f32 v[88:89], v[88:89], v[48:49]
v_pk_mul_f32 v[90:91], v[90:91], v[50:51]
v_pk_mul_f32 v[92:93], v[92:93], v[52:53]
v_pk_mul_f32 v[94:95], v[94:95], v[54:55]
s_cmp_lt_u32 s3, 22
s_cbranch_scc0 L_light_z2
v_lshlrev_b32 v2, 4, v1
v_cvt_pk_bf16_f32 v64, v64, v65
v_cvt_pk_bf16_f32 v65, v66, v67
v_cvt_pk_bf16_f32 v66, v68, v69
v_cvt_pk_bf16_f32 v67, v70, v71
v_cvt_pk_bf16_f32 v68, v72, v73
v_cvt_pk_bf16_f32 v69, v74, v75
v_cvt_pk_bf16_f32 v70, v76, v77
v_cvt_pk_bf16_f32 v71, v78, v79
s_lshl_b32 s82, s4, 3
s_lshl_b32 s83, s5, 1
s_add_u32 s82, s82, s83
s_add_u32 s82, s82, 0
s_mul_i32 s82, s82, 44
s_lshl_b32 s83, s95, 1
s_add_u32 s82, s82, s83
s_lshl_b32 s82, s82, 10
s_add_u32 s82, s82, 0x1100000
buffer_store_dwordx4 v[64:67], v2, s[28:31], s82 offen sc0 sc1
buffer_store_dwordx4 v[68:71], v2, s[28:31], s82 offen offset:1024 sc0 sc1
v_cvt_pk_bf16_f32 v80, v80, v81
v_cvt_pk_bf16_f32 v81, v82, v83
v_cvt_pk_bf16_f32 v82, v84, v85
v_cvt_pk_bf16_f32 v83, v86, v87
v_cvt_pk_bf16_f32 v84, v88, v89
v_cvt_pk_bf16_f32 v85, v90, v91
v_cvt_pk_bf16_f32 v86, v92, v93
v_cvt_pk_bf16_f32 v87, v94, v95
s_lshl_b32 s82, s4, 3
s_lshl_b32 s83, s5, 1
s_add_u32 s82, s82, s83
s_add_u32 s82, s82, 1
s_mul_i32 s82, s82, 44
s_lshl_b32 s83, s95, 1
s_add_u32 s82, s82, s83
s_lshl_b32 s82, s82, 10
s_add_u32 s82, s82, 0x1100000
buffer_store_dwordx4 v[80:83], v2, s[28:31], s82 offen sc0 sc1
buffer_store_dwordx4 v[84:87], v2, s[28:31], s82 offen offset:1024 sc0 sc1
s_branch L_p2
L_light_z2:
s_sub_u32 s84, s95, 22
s_cmp_eq_u32 s84, 21
s_cselect_b32 s85, 0, 1.0
v_pk_add_f32 v[44:45], v[64:65], v[66:67]
v_pk_mul_f32 v[48:49], v[64:65], v[64:65]
v_pk_add_f32 v[44:45], v[44:45], v[68:69]
v_pk_fma_f32 v[48:49], v[66:67], v[66:67], v[48:49]
v_pk_add_f32 v[44:45], v[44:45], v[70:71]
v_pk_fma_f32 v[48:49], v[68:69], v[68:69], v[48:49]
v_pk_fma_f32 v[48:49], v[70:71], v[70:71], v[48:49]
v_pk_add_f32 v[46:47], v[72:73], v[74:75]
v_pk_mul_f32 v[50:51], v[72:73], v[72:73]
v_pk_add_f32 v[46:47], v[46:47], v[76:77]
v_pk_fma_f32 v[50:51], v[74:75], v[74:75], v[50:51]
v_pk_add_f32 v[46:47], v[46:47], v[78:79]
v_pk_fma_f32 v[50:51], v[76:77], v[76:77], v[50:51]
v_pk_fma_f32 v[50:51], v[78:79], v[78:79], v[50:51]
v_add_f32 v2, v44, v45
v_add_f32 v3, v46, v47
v_add_f32 v4, v48, v49
v_add_f32 v5, v50, v51
v_fma_f32 v2, v3, s85, v2
v_fma_f32 v4, v5, s85, v4
v_mov_b32 v3, v2
v_mov_b32 v5, v4
s_nop 0
v_permlane32_swap_b32 v2, v3
v_permlane32_swap_b32 v4, v5
v_add_f32 v40, v2, v3
v_add_f32 v41, v4, v5
s_mul_i32 s82, s4, 22
s_add_u32 s82, s82, s84
s_lshl_b32 s82, s82, 8
s_lshl_b32 s83, s5, 6
s_add_u32 s82, s82, s83
s_add_u32 s82, s82, 0
s_lshl_b32 s82, s82, 3
s_add_u32 s82, s82, 0x1400000
v_and_b32 v6, 31, v1
v_lshlrev_b32 v6, 3, v6
buffer_store_dwordx2 v[40:41], v6, s[28:31], s82 offen sc0 sc1
v_cvt_pk_bf16_f32 v240, v64, v65
v_cvt_pk_bf16_f32 v241, v66, v67
v_cvt_pk_bf16_f32 v242, v68, v69
v_cvt_pk_bf16_f32 v243, v70, v71
v_cvt_pk_bf16_f32 v244, v72, v73
v_cvt_pk_bf16_f32 v245, v74, v75
v_cvt_pk_bf16_f32 v246, v76, v77
v_cvt_pk_bf16_f32 v247, v78, v79
v_pk_add_f32 v[44:45], v[80:81], v[82:83]
v_pk_mul_f32 v[48:49], v[80:81], v[80:81]
v_pk_add_f32 v[44:45], v[44:45], v[84:85]
v_pk_fma_f32 v[48:49], v[82:83], v[82:83], v[48:49]
v_pk_add_f32 v[44:45], v[44:45], v[86:87]
v_pk_fma_f32 v[48:49], v[84:85], v[84:85], v[48:49]
v_pk_fma_f32 v[48:49], v[86:87], v[86:87], v[48:49]
v_pk_add_f32 v[46:47], v[88:89], v[90:91]
v_pk_mul_f32 v[50:51], v[88:89], v[88:89]
v_pk_add_f32 v[46:47], v[46:47], v[92:93]
v_pk_fma_f32 v[50:51], v[90:91], v[90:91], v[50:51]
v_pk_add_f32 v[46:47], v[46:47], v[94:95]
v_pk_fma_f32 v[50:51], v[92:93], v[92:93], v[50:51]
v_pk_fma_f32 v[50:51], v[94:95], v[94:95], v[50:51]
v_add_f32 v2, v44, v45
v_add_f32 v3, v46, v47
v_add_f32 v4, v48, v49
v_add_f32 v5, v50, v51
v_fma_f32 v2, v3, s85, v2
v_fma_f32 v4, v5, s85, v4
v_mov_b32 v3, v2
v_mov_b32 v5, v4
s_nop 0
v_permlane32_swap_b32 v2, v3
v_permlane32_swap_b32 v4, v5
v_add_f32 v42, v2, v3
v_add_f32 v43, v4, v5
s_mul_i32 s82, s4, 22
s_add_u32 s82, s82, s84
s_lshl_b32 s82, s82, 8
s_lshl_b32 s83, s5, 6
s_add_u32 s82, s82, s83
s_add_u32 s82, s82, 32
s_lshl_b32 s82, s82, 3
s_add_u32 s82, s82, 0x1400000
v_and_b32 v6, 31, v1
v_lshlrev_b32 v6, 3, v6
buffer_store_dwordx2 v[42:43], v6, s[28:31], s82 offen sc0 sc1
v_cvt_pk_bf16_f32 v248, v80, v81
v_cvt_pk_bf16_f32 v249, v82, v83
v_cvt_pk_bf16_f32 v250, v84, v85
v_cvt_pk_bf16_f32 v251, v86, v87
v_cvt_pk_bf16_f32 v252, v88, v89
v_cvt_pk_bf16_f32 v253, v90, v91
v_cvt_pk_bf16_f32 v254, v92, v93
v_cvt_pk_bf16_f32 v255, v94, v95
s_branch L_p2
L_heavy:
s_lshl_b32 s86, s4, 8
s_lshl_b32 s87, s3, 3
s_add_u32 s86, s86, s87
s_lshl_b32 s87, s5, 1
s_add_u32 s97, s86, s87
s_lshl_b32 s87, s97, 10
s_mov_b32 s20, s56
s_and_b32 s21, s57, 0xffff
s_mov_b32 s22, 0x200000
s_mov_b32 s23, 0x20000
v_lshlrev_b32 v3, 4, v1
buffer_load_dwordx4 v[40:43], v3, s[20:23], s87 offen
buffer_load_dwordx4 v[44:47], v3, s[20:23], s87 offen offset:1024
s_add_u32 m0, s47, 0
s_nop 0
buffer_load_dwordx4 v12, s[12:15], s40 offen lds
buffer_load_dwordx4 v12, s[12:15], s41 offen offset:1024 lds
buffer_load_dwordx4 v12, s[12:15], s42 offen offset:2048 lds
buffer_load_dwordx4 v12, s[12:15], s43 offen offset:3072 lds
s_add_u32 m0, s48, 0
s_nop 0
buffer_load_dwordx4 v13, s[16:19], s44 offen lds
s_add_u32 m0, s48, 0x1000
s_nop 0
buffer_load_dwordx4 v13, s[16:19], s45 offen lds
s_add_u32 m0, s46, 0
s_nop 0
buffer_load_dwordx4 v10, s[8:11], 0 offen lds
buffer_load_dwordx4 v11, s[8:11], s33 offen offset:1024 lds
buffer_load_dwordx4 v10, s[8:11], s34 offen offset:2048 lds
buffer_load_dwordx4 v11, s[8:11], s35 offen offset:3072 lds
s_add_u32 m0, s46, 0x1000
s_nop 0
buffer_load_dwordx4 v10, s[8:11], s36 offen lds
buffer_load_dwordx4 v11, s[8:11], s37 offen offset:1024 lds
buffer_load_dwordx4 v10, s[8:11], s38 offen offset:2048 lds
buffer_load_dwordx4 v11, s[8:11], s39 offen offset:3072 lds
v_add_u32 v10, 0x80, v10
v_add_u32 v11, 0x80, v11
v_add_u32 v12, 0x80000, v12
v_add_u32 v13, 0x2b000, v13
v_mov_b32 v3, 0
global_load_dword v33, v3, s[78:79] sc0 sc1
v_lshrrev_b32 v2, 5, v1
v_bfe_u32 v3, v1, 4, 1
v_bfe_u32 v4, v1, 2, 2
v_and_b32 v5, 3, v1
v_and_b32 v6, 1, v5
v_lshl_add_u32 v6, v3, 1, v6
v_lshrrev_b32 v7, 1, v5
v_lshlrev_b32 v7, 3, v7
v_lshl_add_u32 v8, v2, 3, v4
v_lshlrev_b32 v9, 6, v8
v_lshl_add_u32 v9, v6, 4, v9
v_add_u32 v9, v9, v7
v_add_u32 v18, 0x14000, v9
v_lshlrev_b32 v8, 8, v8
v_add_u32 v8, v8, v7
v_lshl_add_u32 v8, v6, 4, v8
v_add_u32 v8, 0x10000, v8
s_add_u32 s82, s5, 0
s_and_b32 s82, s82, 3
v_xor_b32 v9, s82, v4
v_lshl_add_u32 v14, v9, 6, v8
s_add_u32 s82, s5, 1
s_and_b32 s82, s82, 3
v_xor_b32 v9, s82, v4
v_lshl_add_u32 v15, v9, 6, v8
s_add_u32 s82, s5, 2
s_and_b32 s82, s82, 3
v_xor_b32 v9, s82, v4
v_lshl_add_u32 v16, v9, 6, v8
s_add_u32 s82, s5, 3
s_and_b32 s82, s82, 3
v_xor_b32 v9, s82, v4
v_lshl_add_u32 v17, v9, 6, v8
v_and_b32 v3, 31, v1
v_bfe_u32 v4, v1, 1, 3
v_lshlrev_b32 v3, 7, v3
v_add_u32 v3, s46, v3
v_xor_b32 v4, v4, v2
v_xor_b32 v5, 0, v4
v_lshl_add_u32 v19, v5, 4, v3
v_xor_b32 v5, 2, v4
v_lshl_add_u32 v20, v5, 4, v3
v_xor_b32 v5, 4, v4
v_lshl_add_u32 v21, v5, 4, v3
v_xor_b32 v5, 6, v4
v_lshl_add_u32 v22, v5, 4, v3
s_lshl_b32 s82, s4, 8
s_and_b32 s83, s3, 3
s_lshl_b32 s83, s83, 6
s_add_u32 s82, s82, s83
s_lshl_b32 s82, s82, 10
s_lshl_b32 s83, s4, 16
s_lshl_b32 s84, s3, 8
s_add_u32 s83, s83, s84
s_cmp_eq_u32 s5, 2
s_cselect_b32 s84, s44, s45
s_mul_i32 s85, s5, 0xac00
s_sub_u32 s84, s84, s85
s_min_u32 s84, s84, 0xa80
s_mul_i32 s85, s4, 0x5600
s_add_u32 s84, s84, s85
s_mov_b32 s49, 0x80000
s_cmp_eq_u32 s5, 0
s_cselect_b32 s50, s56, s62
s_cselect_b32 s51, s57, s63
s_cselect_b32 s82, s82, s83
s_cselect_b32 s49, 0x80, s49
s_cmp_lt_u32 s5, 2
s_cselect_b32 s50, s50, s68
s_cselect_b32 s51, s51, s69
s_cselect_b32 s82, s82, s84
s_mov_b32 s83, 0x2b000
s_cmp_lt_u32 s5, 2
s_cselect_b32 s49, s49, s83
s_add_u32 s50, s50, s82
s_addc_u32 s51, s51, 0
s_add_u32 s50, s50, s49
s_addc_u32 s51, s51, 0
s_mov_b32 s82, 0xac0
s_cmp_eq_u32 s5, 1
s_cselect_b32 s82, 0x2000, s82
s_cselect_b32 s83, 0x80, 60
v_bfe_u32 v2, v1, 1, 3
v_mul_lo_u32 v2, v2, s82
v_and_b32 v3, 1, v1
v_mul_lo_u32 v3, v3, s83
v_add_u32 v2, v2, v3
v_lshlrev_b32 v3, 10, v1
s_cmp_eq_u32 s5, 0
s_cselect_b64 s[98:99], -1, 0
v_cndmask_b32 v39, v2, v3, s[98:99]
global_load_dword a254, v39, s[50:51]
s_add_u32 s50, s50, s49
s_addc_u32 s51, s51, 0
global_load_dword a254, v39, s[50:51]
s_add_u32 s50, s50, s49
s_addc_u32 s51, s51, 0
global_load_dword a254, v39, s[50:51]
s_add_u32 s50, s50, s49
s_addc_u32 s51, s51, 0
global_load_dword a254, v39, s[50:51]
s_add_u32 s50, s50, s49
s_addc_u32 s51, s51, 0
s_lshl_b32 s82, s4, 8
s_lshl_b32 s83, s5, 6
s_add_u32 s82, s82, s83
s_lshl_b32 s82, s82, 4
s_add_u32 s7, s82, 0x1000000
v_mov_b32 v23, 0
v_mov_b32 v24, 0
v_and_b32 v2, 15, v1
v_bfe_u32 v3, v1, 4, 1
v_cmp_eq_u32 vcc, v2, v3
v_mov_b32 v4, 0x3f803f80
s_nop 0
v_cndmask_b32 v4, 0, v4, vcc
v_accvgpr_write_b32 a8, v4
v_accvgpr_write_b32 a9, v4
v_accvgpr_write_b32 a10, v4
v_accvgpr_write_b32 a11, v4
v_mov_b32 v38, 0xffff0000
s_waitcnt vmcnt(20)
v_lshlrev_b32 v48, 16, v40
v_and_b32 v49, v38, v40
v_lshlrev_b32 v50, 16, v41
v_and_b32 v51, v38, v41
v_lshlrev_b32 v52, 16, v42
v_and_b32 v53, v38, v42
v_lshlrev_b32 v54, 16, v43
v_and_b32 v55, v38, v43
v_add_f32 v4, v48, v49
v_add_f32 v4, v4, v50
v_add_f32 v4, v4, v51
v_add_f32 v4, v4, v52
v_add_f32 v4, v4, v53
v_add_f32 v4, v4, v54
v_add_f32 v4, v4, v55
s_waitcnt vmcnt(19)
v_lshlrev_b32 v56, 16, v44
v_and_b32 v57, v38, v44
v_lshlrev_b32 v58, 16, v45
v_and_b32 v59, v38, v45
v_lshlrev_b32 v60, 16, v46
v_and_b32 v61, v38, v46
v_lshlrev_b32 v62, 16, v47
v_and_b32 v63, v38, v47
v_add_f32 v5, v56, v57
v_add_f32 v5, v5, v58
v_add_f32 v5, v5, v59
v_add_f32 v5, v5, v60
v_add_f32 v5, v5, v61
v_add_f32 v5, v5, v62
v_add_f32 v5, v5, v63
v_add_f32_dpp v4, v4, v4 quad_perm:[1,0,3,2] row_mask:0xf bank_mask:0xf
s_nop 0
v_add_f32_dpp v5, v5, v5 quad_perm:[1,0,3,2] row_mask:0xf bank_mask:0xf
v_add_f32_dpp v4, v4, v4 quad_perm:[2,3,0,1] row_mask:0xf bank_mask:0xf
s_nop 0
v_add_f32_dpp v5, v5, v5 quad_perm:[2,3,0,1] row_mask:0xf bank_mask:0xf
v_add_f32_dpp v4, v4, v4 row_half_mirror row_mask:0xf bank_mask:0xf
s_nop 0
v_add_f32_dpp v5, v5, v5 row_half_mirror row_mask:0xf bank_mask:0xf
v_add_f32_dpp v4, v4, v4 row_mirror row_mask:0xf bank_mask:0xf
s_nop 0
v_add_f32_dpp v5, v5, v5 row_mirror row_mask:0xf bank_mask:0xf
v_mov_b32 v8, v4
v_mov_b32 v9, v5
s_nop 0
v_permlane16_swap_b32 v4, v8
v_permlane16_swap_b32 v5, v9
v_add_f32 v4, v4, v8
v_add_f32 v5, v5, v9
v_mov_b32 v8, v4
v_mov_b32 v9, v5
s_nop 0
v_permlane32_swap_b32 v4, v8
v_permlane32_swap_b32 v5, v9
v_add_f32 v4, v4, v8
v_add_f32 v5, v5, v9
v_mul_f32 v4, 0x3b000000, v4
v_sub_f32 v48, v48, v4
v_sub_f32 v49, v49, v4
v_sub_f32 v50, v50, v4
v_sub_f32 v51, v51, v4
v_sub_f32 v52, v52, v4
v_sub_f32 v53, v53, v4
v_sub_f32 v54, v54, v4
v_sub_f32 v55, v55, v4
v_mul_f32 v6, v48, v48
v_fmac_f32 v6, v49, v49
v_fmac_f32 v6, v50, v50
v_fmac_f32 v6, v51, v51
v_fmac_f32 v6, v52, v52
v_fmac_f32 v6, v53, v53
v_fmac_f32 v6, v54, v54
v_fmac_f32 v6, v55, v55
v_mul_f32 v5, 0x3b000000, v5
v_sub_f32 v56, v56, v5
v_sub_f32 v57, v57, v5
v_sub_f32 v58, v58, v5
v_sub_f32 v59, v59, v5
v_sub_f32 v60, v60, v5
v_sub_f32 v61, v61, v5
v_sub_f32 v62, v62, v5
v_sub_f32 v63, v63, v5
v_mul_f32 v7, v56, v56
v_fmac_f32 v7, v57, v57
v_fmac_f32 v7, v58, v58
v_fmac_f32 v7, v59, v59
v_fmac_f32 v7, v60, v60
v_fmac_f32 v7, v61, v61
v_fmac_f32 v7, v62, v62
v_fmac_f32 v7, v63, v63
v_add_f32_dpp v6, v6, v6 quad_perm:[1,0,3,2] row_mask:0xf bank_mask:0xf
s_nop 0
v_add_f32_dpp v7, v7, v7 quad_perm:[1,0,3,2] row_mask:0xf bank_mask:0xf
v_add_f32_dpp v6, v6, v6 quad_perm:[2,3,0,1] row_mask:0xf bank_mask:0xf
s_nop 0
v_add_f32_dpp v7, v7, v7 quad_perm:[2,3,0,1] row_mask:0xf bank_mask:0xf
v_add_f32_dpp v6, v6, v6 row_half_mirror row_mask:0xf bank_mask:0xf
s_nop 0
v_add_f32_dpp v7, v7, v7 row_half_mirror row_mask:0xf bank_mask:0xf
v_add_f32_dpp v6, v6, v6 row_mirror row_mask:0xf bank_mask:0xf
s_nop 0
v_add_f32_dpp v7, v7, v7 row_mirror row_mask:0xf bank_mask:0xf
v_mov_b32 v8, v6
v_mov_b32 v9, v7
s_nop 0
v_permlane16_swap_b32 v6, v8
v_permlane16_swap_b32 v7, v9
v_add_f32 v6, v6, v8
v_add_f32 v7, v7, v9
v_mov_b32 v8, v6
v_mov_b32 v9, v7
s_nop 0
v_permlane32_swap_b32 v6, v8
v_permlane32_swap_b32 v7, v9
v_add_f32 v6, v6, v8
v_add_f32 v7, v7, v9
v_mov_b32 v8, 0x3727c5ac
v_fmac_f32 v8, 0x3b000000, v6
v_rsq_f32 v35, v8
v_mov_b32 v34, v4
v_mov_b32 v9, 0x3727c5ac
v_fmac_f32 v9, 0x3b000000, v7
v_rsq_f32 v37, v9
v_mov_b32 v36, v5
s_waitcnt vmcnt(5)
s_barrier
ds_read_b128 a[160:163], v19 offset:0
ds_read_b128 a[164:167], v19 offset:4096
ds_read_b128 a[168:171], v20 offset:0
ds_read_b128 a[172:175], v20 offset:4096
ds_read_b128 a[176:179], v21 offset:0
ds_read_b128 a[180:183], v21 offset:4096
ds_read_b128 a[184:187], v22 offset:0
ds_read_b128 a[188:191], v22 offset:4096
ds_read_b64_tr_b16 v[48:49], v18 offset:0
ds_read_b64_tr_b16 v[50:51], v18 offset:256
ds_read_b64_tr_b16 v[52:53], v18 offset:4096
ds_read_b64_tr_b16 v[54:55], v18 offset:4352
ds_read_b64_tr_b16 v[40:41], v14 offset:0
ds_read_b64_tr_b16 v[42:43], v14 offset:1024
ds_read_b64_tr_b16 a[128:129], v15 offset:0
ds_read_b64_tr_b16 a[130:131], v15 offset:1024
ds_read_b64_tr_b16 a[132:133], v16 offset:0
ds_read_b64_tr_b16 a[134:135], v16 offset:1024
ds_read_b64_tr_b16 a[136:137], v17 offset:0
ds_read_b64_tr_b16 a[138:139], v17 offset:1024
s_waitcnt lgkmcnt(0)
v_mfma_f32_32x32x16_bf16 v[64:79], v[48:51], a[160:163], 0
s_add_u32 m0, s47, 0x6000
s_nop 0
buffer_load_dwordx4 v12, s[12:15], s40 offen lds
ds_read_b64_tr_b16 v[56:57], v18 offset:1024
ds_read_b64_tr_b16 v[58:59], v18 offset:1280
v_mfma_f32_32x32x16_bf16 v[80:95], v[48:51], a[164:167], 0
buffer_load_dwordx4 v12, s[12:15], s41 offen offset:1024 lds
ds_read_b64_tr_b16 v[60:61], v18 offset:5120
v_lshlrev_b32 v29, 16, v40
v_and_b32 v30, v38, v40
v_mfma_f32_32x32x16_bf16 v[96:111], v[52:55], a[160:163], 0
buffer_load_dwordx4 v12, s[12:15], s42 offen offset:2048 lds
ds_read_b64_tr_b16 v[62:63], v18 offset:5376
v_add_f32 v23, v23, v29
v_add_f32 v24, v24, v30
v_mfma_f32_32x32x16_bf16 v[112:127], v[52:55], a[164:167], 0
buffer_load_dwordx4 v12, s[12:15], s43 offen offset:3072 lds
ds_read_b64_tr_b16 v[44:45], v14 offset:4096
s_add_u32 m0, s48, 0x6000
v_lshlrev_b32 v31, 16, v41
v_mfma_f32_32x32x16_bf16 v[128:143], v[40:43], a[160:163], 0
buffer_load_dwordx4 v13, s[16:19], s44 offen lds
ds_read_b64_tr_b16 v[46:47], v14 offset:5120
s_add_u32 m0, s48, 0x7000
v_and_b32 v32, v38, v41
v_mfma_f32_16x16x32_bf16 a[0:3], v[48:51], a[8:11], 0
buffer_load_dwordx4 v13, s[16:19], s45 offen lds
ds_read_b64_tr_b16 a[140:141], v15 offset:4096
v_add_f32 v23, v23, v31
v_add_u32 v12, 0x80000, v12
v_mfma_f32_32x32x16_bf16 v[144:159], v[40:43], a[164:167], 0
ds_read_b64_tr_b16 a[142:143], v15 offset:5120
v_add_u32 v13, 0x2b000, v13
s_add_u32 m0, s46, 0x2000
v_add_f32 v24, v24, v32
v_lshlrev_b32 v29, 16, v42
v_mfma_f32_16x16x32_bf16 a[4:7], v[52:55], a[8:11], 0
buffer_load_dwordx4 v10, s[8:11], 0 offen lds
ds_read_b64_tr_b16 a[144:145], v16 offset:4096
v_and_b32 v30, v38, v42
v_add_f32 v23, v23, v29
v_mfma_f32_32x32x16_bf16 v[160:175], a[128:131], a[160:163], 0
buffer_load_dwordx4 v11, s[8:11], s33 offen offset:1024 lds
ds_read_b64_tr_b16 a[146:147], v16 offset:5120
v_add_f32 v24, v24, v30
v_lshlrev_b32 v31, 16, v43
v_mfma_f32_32x32x16_bf16 v[176:191], a[128:131], a[164:167], 0
buffer_load_dwordx4 v10, s[8:11], s34 offen offset:2048 lds
ds_read_b64_tr_b16 a[148:149], v17 offset:4096
v_and_b32 v32, v38, v43
v_mfma_f32_32x32x16_bf16 v[192:207], a[132:135], a[160:163], 0
buffer_load_dwordx4 v11, s[8:11], s35 offen offset:3072 lds
s_add_u32 m0, s46, 0x3000
ds_read_b64_tr_b16 a[150:151], v17 offset:5120
v_mfma_f32_32x32x16_bf16 v[208:223], a[132:135], a[164:167], 0
buffer_load_dwordx4 v10, s[8:11], s36 offen lds
v_add_f32 v23, v23, v31
v_add_f32 v24, v24, v32
v_mfma_f32_32x32x16_bf16 v[224:239], a[136:139], a[160:163], 0
buffer_load_dwordx4 v11, s[8:11], s37 offen offset:1024 lds
buffer_load_dwordx4 v10, s[8:11], s38 offen offset:2048 lds
v_mfma_f32_32x32x16_bf16 v[240:255], a[136:139], a[164:167], 0
buffer_load_dwordx4 v11, s[8:11], s39 offen offset:3072 lds
v_add_u32 v10, 0x80, v10
v_add_u32 v11, 0x80, v11
s_waitcnt lgkmcnt(0)
v_mfma_f32_32x32x16_bf16 v[64:79], v[56:59], a[168:171], v[64:79]
s_add_u32 m0, s46, 0
ds_read_b64_tr_b16 v[48:49], v18 offset:2048
buffer_load_dwordx4 v10, s[8:11], 0 offen lds
v_mfma_f32_32x32x16_bf16 v[80:95], v[56:59], a[172:175], v[80:95]
buffer_load_dwordx4 v11, s[8:11], s33 offen offset:1024 lds
ds_read_b64_tr_b16 v[50:51], v18 offset:2304
v_lshlrev_b32 v29, 16, v44
v_mfma_f32_32x32x16_bf16 v[96:111], v[60:63], a[168:171], v[96:111]
buffer_load_dwordx4 v10, s[8:11], s34 offen offset:2048 lds
ds_read_b64_tr_b16 v[52:53], v18 offset:6144
v_and_b32 v30, v38, v44
v_mfma_f32_32x32x16_bf16 v[112:127], v[60:63], a[172:175], v[112:127]
buffer_load_dwordx4 v11, s[8:11], s35 offen offset:3072 lds
ds_read_b64_tr_b16 v[54:55], v18 offset:6400
v_add_f32 v23, v23, v29
v_mfma_f32_32x32x16_bf16 v[128:143], v[44:47], a[168:171], v[128:143]
s_add_u32 m0, s46, 0x1000
ds_read_b64_tr_b16 v[40:41], v14 offset:8192
v_add_f32 v24, v24, v30
v_lshlrev_b32 v31, 16, v45
v_mfma_f32_16x16x32_bf16 a[0:3], v[56:59], a[8:11], a[0:3]
buffer_load_dwordx4 v10, s[8:11], s36 offen lds
ds_read_b64_tr_b16 v[42:43], v14 offset:9216
v_and_b32 v32, v38, v45
v_mfma_f32_32x32x16_bf16 v[144:159], v[44:47], a[172:175], v[144:159]
ds_read_b64_tr_b16 a[128:129], v15 offset:8192
v_add_f32 v23, v23, v31
v_add_f32 v24, v24, v32
v_mfma_f32_16x16x32_bf16 a[4:7], v[60:63], a[8:11], a[4:7]
buffer_load_dwordx4 v11, s[8:11], s37 offen offset:1024 lds
v_lshlrev_b32 v29, 16, v46
v_mfma_f32_32x32x16_bf16 v[160:175], a[140:143], a[168:171], v[160:175]
ds_read_b64_tr_b16 a[130:131], v15 offset:9216
ds_read_b64_tr_b16 a[132:133], v16 offset:8192
v_and_b32 v30, v38, v46
v_mfma_f32_32x32x16_bf16 v[176:191], a[140:143], a[172:175], v[176:191]
buffer_load_dwordx4 v10, s[8:11], s38 offen offset:2048 lds
v_add_f32 v23, v23, v29
v_mfma_f32_32x32x16_bf16 v[192:207], a[144:147], a[168:171], v[192:207]
ds_read_b64_tr_b16 a[134:135], v16 offset:9216
ds_read_b64_tr_b16 a[136:137], v17 offset:8192
v_add_f32 v24, v24, v30
v_mfma_f32_32x32x16_bf16 v[208:223], a[144:147], a[172:175], v[208:223]
ds_read_b64_tr_b16 a[138:139], v17 offset:9216
v_lshlrev_b32 v31, 16, v47
v_and_b32 v32, v38, v47
v_mfma_f32_32x32x16_bf16 v[224:239], a[148:151], a[168:171], v[224:239]
buffer_load_dwordx4 v11, s[8:11], s39 offen offset:3072 lds
v_add_f32 v23, v23, v31
v_mfma_f32_32x32x16_bf16 v[240:255], a[148:151], a[172:175], v[240:255]
v_add_u32 v10, 0x80, v10
v_add_f32 v24, v24, v32
v_add_u32 v11, 0x80, v11
s_waitcnt vmcnt(8)
s_barrier
s_waitcnt lgkmcnt(0)
v_mfma_f32_32x32x16_bf16 v[64:79], v[48:51], a[176:179], v[64:79]
s_add_u32 m0, s47, 0xc000
ds_read_b64_tr_b16 v[56:57], v18 offset:3072
ds_read_b128 a[192:195], v19 offset:8192
ds_read_b64_tr_b16 v[58:59], v18 offset:3328
v_mfma_f32_32x32x16_bf16 v[80:95], v[48:51], a[180:183], v[80:95]
buffer_load_dwordx4 v12, s[12:15], s40 offen lds
ds_read_b64_tr_b16 v[60:61], v18 offset:7168
v_lshlrev_b32 v29, 16, v40
v_mfma_f32_32x32x16_bf16 v[96:111], v[52:55], a[176:179], v[96:111]
buffer_load_dwordx4 v12, s[12:15], s41 offen offset:1024 lds
ds_read_b64_tr_b16 v[62:63], v18 offset:7424
v_and_b32 v30, v38, v40
v_mfma_f32_32x32x16_bf16 v[112:127], v[52:55], a[180:183], v[112:127]
buffer_load_dwordx4 v12, s[12:15], s42 offen offset:2048 lds
ds_read_b64_tr_b16 v[44:45], v14 offset:12288
v_add_f32 v23, v23, v29
v_mfma_f32_32x32x16_bf16 v[128:143], v[40:43], a[176:179], v[128:143]
ds_read_b64_tr_b16 v[46:47], v14 offset:13312
buffer_load_dwordx4 v12, s[12:15], s43 offen offset:3072 lds
v_add_f32 v24, v24, v30
v_mfma_f32_16x16x32_bf16 a[0:3], v[48:51], a[8:11], a[0:3]
ds_read_b128 a[196:199], v19 offset:12288
ds_read_b64_tr_b16 a[140:141], v15 offset:12288
s_add_u32 m0, s48, 0xc000
v_lshlrev_b32 v31, 16, v41
v_mfma_f32_32x32x16_bf16 v[144:159], v[40:43], a[180:183], v[144:159]
ds_read_b128 a[200:203], v20 offset:8192
ds_read_b64_tr_b16 a[142:143], v15 offset:13312
v_and_b32 v32, v38, v41
v_add_f32 v23, v23, v31
v_mfma_f32_16x16x32_bf16 a[4:7], v[52:55], a[8:11], a[4:7]
ds_read_b128 a[204:207], v20 offset:12288
ds_read_b64_tr_b16 a[144:145], v16 offset:12288
v_add_f32 v24, v24, v32
v_lshlrev_b32 v29, 16, v42
v_mfma_f32_32x32x16_bf16 v[160:175], a[128:131], a[176:179], v[160:175]
buffer_load_dwordx4 v13, s[16:19], s44 offen lds
ds_read_b128 a[208:211], v21 offset:8192
v_and_b32 v30, v38, v42
v_mfma_f32_32x32x16_bf16 v[176:191], a[128:131], a[180:183], v[176:191]
ds_read_b64_tr_b16 a[146:147], v16 offset:13312
ds_read_b128 a[212:215], v21 offset:12288
v_add_f32 v23, v23, v29
v_mfma_f32_32x32x16_bf16 v[192:207], a[132:135], a[176:179], v[192:207]
ds_read_b64_tr_b16 a[148:149], v17 offset:12288
s_add_u32 m0, s48, 0xd000
v_add_f32 v24, v24, v30
v_mfma_f32_32x32x16_bf16 v[208:223], a[132:135], a[180:183], v[208:223]
ds_read_b64_tr_b16 a[150:151], v17 offset:13312
ds_read_b128 a[216:219], v22 offset:8192
v_lshlrev_b32 v31, 16, v43
v_mfma_f32_32x32x16_bf16 v[224:239], a[136:139], a[176:179], v[224:239]
ds_read_b128 a[220:223], v22 offset:12288
v_and_b32 v32, v38, v43
v_add_f32 v23, v23, v31
v_mfma_f32_32x32x16_bf16 v[240:255], a[136:139], a[180:183], v[240:255]
buffer_load_dwordx4 v13, s[16:19], s45 offen lds
v_add_f32 v24, v24, v32
s_waitcnt lgkmcnt(0)
v_mfma_f32_32x32x16_bf16 v[64:79], v[56:59], a[184:187], v[64:79]
ds_read_b64_tr_b16 v[48:49], v18 offset:24576
ds_read_b64_tr_b16 v[50:51], v18 offset:24832
v_add_u32 v12, 0x80000, v12
v_mfma_f32_32x32x16_bf16 v[80:95], v[56:59], a[188:191], v[80:95]
ds_read_b64_tr_b16 v[52:53], v18 offset:28672
v_lshlrev_b32 v29, 16, v44
v_add_u32 v13, 0x2b000, v13
v_mfma_f32_32x32x16_bf16 v[96:111], v[60:63], a[184:187], v[96:111]
ds_read_b64_tr_b16 v[54:55], v18 offset:28928
v_and_b32 v30, v38, v44
v_add_f32 v23, v23, v29
v_mfma_f32_32x32x16_bf16 v[112:127], v[60:63], a[188:191], v[112:127]
ds_read_b64_tr_b16 v[40:41], v14 offset:24576
v_add_f32 v24, v24, v30
v_lshlrev_b32 v31, 16, v45
v_mfma_f32_32x32x16_bf16 v[128:143], v[44:47], a[184:187], v[128:143]
ds_read_b64_tr_b16 v[42:43], v14 offset:25600
v_and_b32 v32, v38, v45
v_add_f32 v23, v23, v31
v_mfma_f32_16x16x32_bf16 a[0:3], v[56:59], a[8:11], a[0:3]
ds_read_b64_tr_b16 a[128:129], v15 offset:24576
v_add_f32 v24, v24, v32
v_lshlrev_b32 v29, 16, v46
v_mfma_f32_32x32x16_bf16 v[144:159], v[44:47], a[188:191], v[144:159]
ds_read_b64_tr_b16 a[130:131], v15 offset:25600
v_and_b32 v30, v38, v46
v_mfma_f32_16x16x32_bf16 a[4:7], v[60:63], a[8:11], a[4:7]
ds_read_b64_tr_b16 a[132:133], v16 offset:24576
v_add_f32 v23, v23, v29
v_mfma_f32_32x32x16_bf16 v[160:175], a[140:143], a[184:187], v[160:175]
ds_read_b64_tr_b16 a[134:135], v16 offset:25600
v_add_f32 v24, v24, v30
v_mfma_f32_32x32x16_bf16 v[176:191], a[140:143], a[188:191], v[176:191]
ds_read_b64_tr_b16 a[136:137], v17 offset:24576
v_lshlrev_b32 v31, 16, v47
v_mfma_f32_32x32x16_bf16 v[192:207], a[144:147], a[184:187], v[192:207]
global_load_dword a254, v39, s[50:51]
v_mfma_f32_32x32x16_bf16 v[208:223], a[144:147], a[188:191], v[208:223]
ds_read_b64_tr_b16 a[138:139], v17 offset:25600
v_and_b32 v32, v38, v47
v_mfma_f32_32x32x16_bf16 v[224:239], a[148:151], a[184:187], v[224:239]
v_add_f32 v23, v23, v31
v_add_f32 v24, v24, v32
v_mfma_f32_32x32x16_bf16 v[240:255], a[148:151], a[188:191], v[240:255]
s_add_u32 s50, s50, s49
s_addc_u32 s51, s51, 0
s_waitcnt lgkmcnt(0)
v_mfma_f32_32x32x16_bf16 v[64:79], v[48:51], a[192:195], v[64:79]
ds_read_b64_tr_b16 v[56:57], v18 offset:25600
ds_read_b64_tr_b16 v[58:59], v18 offset:25856
v_mfma_f32_32x32x16_bf16 v[80:95], v[48:51], a[196:199], v[80:95]
ds_read_b64_tr_b16 v[60:61], v18 offset:29696
s_add_u32 m0, s46, 0x2000
v_lshlrev_b32 v29, 16, v40
v_mfma_f32_32x32x16_bf16 v[96:111], v[52:55], a[192:195], v[96:111]
ds_read_b64_tr_b16 v[62:63], v18 offset:29952
v_and_b32 v30, v38, v40
v_add_f32 v23, v23, v29
v_mfma_f32_32x32x16_bf16 v[112:127], v[52:55], a[196:199], v[112:127]
ds_read_b64_tr_b16 v[44:45], v14 offset:28672
v_add_f32 v24, v24, v30
v_lshlrev_b32 v31, 16, v41
v_mfma_f32_32x32x16_bf16 v[128:143], v[40:43], a[192:195], v[128:143]
ds_read_b64_tr_b16 v[46:47], v14 offset:29696
v_and_b32 v32, v38, v41
v_add_f32 v23, v23, v31
v_mfma_f32_16x16x32_bf16 a[0:3], v[48:51], a[8:11], a[0:3]
buffer_load_dwordx4 v10, s[8:11], 0 offen lds
v_add_f32 v24, v24, v32
v_mfma_f32_32x32x16_bf16 v[144:159], v[40:43], a[196:199], v[144:159]
ds_read_b64_tr_b16 a[140:141], v15 offset:28672
v_lshlrev_b32 v29, 16, v42
v_and_b32 v30, v38, v42
v_mfma_f32_16x16x32_bf16 a[4:7], v[52:55], a[8:11], a[4:7]
ds_read_b64_tr_b16 a[142:143], v15 offset:29696
ds_read_b64_tr_b16 a[144:145], v16 offset:28672
v_add_f32 v23, v23, v29
v_mfma_f32_32x32x16_bf16 v[160:175], a[128:131], a[192:195], v[160:175]
buffer_load_dwordx4 v11, s[8:11], s33 offen offset:1024 lds
v_add_f32 v24, v24, v30
v_mfma_f32_32x32x16_bf16 v[176:191], a[128:131], a[196:199], v[176:191]
ds_read_b64_tr_b16 a[146:147], v16 offset:29696
ds_read_b64_tr_b16 a[148:149], v17 offset:28672
v_lshlrev_b32 v31, 16, v43
v_mfma_f32_32x32x16_bf16 v[192:207], a[132:135], a[192:195], v[192:207]
buffer_load_dwordx4 v10, s[8:11], s34 offen offset:2048 lds
v_mfma_f32_32x32x16_bf16 v[208:223], a[132:135], a[196:199], v[208:223]
ds_read_b64_tr_b16 a[150:151], v17 offset:29696
v_and_b32 v32, v38, v43
v_mfma_f32_32x32x16_bf16 v[224:239], a[136:139], a[192:195], v[224:239]
v_add_f32 v23, v23, v31
v_add_f32 v24, v24, v32
v_mfma_f32_32x32x16_bf16 v[240:255], a[136:139], a[196:199], v[240:255]
buffer_load_dwordx4 v11, s[8:11], s35 offen offset:3072 lds
s_waitcnt lgkmcnt(0)
v_mfma_f32_32x32x16_bf16 v[64:79], v[56:59], a[200:203], v[64:79]
ds_read_b64_tr_b16 v[48:49], v18 offset:26624
s_add_u32 m0, s46, 0x3000
ds_read_b64_tr_b16 v[50:51], v18 offset:26880
v_mfma_f32_32x32x16_bf16 v[80:95], v[56:59], a[204:207], v[80:95]
ds_read_b64_tr_b16 v[52:53], v18 offset:30720
v_lshlrev_b32 v29, 16, v44
v_and_b32 v30, v38, v44
v_mfma_f32_32x32x16_bf16 v[96:111], v[60:63], a[200:203], v[96:111]
ds_read_b64_tr_b16 v[54:55], v18 offset:30976
v_add_f32 v23, v23, v29
v_add_f32 v24, v24, v30
v_mfma_f32_32x32x16_bf16 v[112:127], v[60:63], a[204:207], v[112:127]
buffer_load_dwordx4 v10, s[8:11], s36 offen lds
v_lshlrev_b32 v31, 16, v45
v_mfma_f32_32x32x16_bf16 v[128:143], v[44:47], a[200:203], v[128:143]
ds_read_b64_tr_b16 v[40:41], v14 offset:32768
v_and_b32 v32, v38, v45
v_add_f32 v23, v23, v31
v_mfma_f32_16x16x32_bf16 a[0:3], v[56:59], a[8:11], a[0:3]
ds_read_b64_tr_b16 v[42:43], v14 offset:33792
v_add_f32 v24, v24, v32
v_lshlrev_b32 v29, 16, v46
v_mfma_f32_32x32x16_bf16 v[144:159], v[44:47], a[204:207], v[144:159]
ds_read_b64_tr_b16 a[128:129], v15 offset:32768
buffer_load_dwordx4 v11, s[8:11], s37 offen offset:1024 lds
v_mfma_f32_16x16x32_bf16 a[4:7], v[60:63], a[8:11], a[4:7]
ds_read_b64_tr_b16 a[130:131], v15 offset:33792
v_and_b32 v30, v38, v46
v_add_f32 v23, v23, v29
v_mfma_f32_32x32x16_bf16 v[160:175], a[140:143], a[200:203], v[160:175]
ds_read_b64_tr_b16 a[132:133], v16 offset:32768
buffer_load_dwordx4 v10, s[8:11], s38 offen offset:2048 lds
v_mfma_f32_32x32x16_bf16 v[176:191], a[140:143], a[204:207], v[176:191]
ds_read_b64_tr_b16 a[134:135], v16 offset:33792
v_add_f32 v24, v24, v30
v_lshlrev_b32 v31, 16, v47
v_mfma_f32_32x32x16_bf16 v[192:207], a[144:147], a[200:203], v[192:207]
ds_read_b64_tr_b16 a[136:137], v17 offset:32768
buffer_load_dwordx4 v11, s[8:11], s39 offen offset:3072 lds
v_mfma_f32_32x32x16_bf16 v[208:223], a[144:147], a[204:207], v[208:223]
ds_read_b64_tr_b16 a[138:139], v17 offset:33792
v_and_b32 v32, v38, v47
v_mfma_f32_32x32x16_bf16 v[224:239], a[148:151], a[200:203], v[224:239]
v_add_f32 v23, v23, v31
v_add_u32 v10, 0x80, v10
v_mfma_f32_32x32x16_bf16 v[240:255], a[148:151], a[204:207], v[240:255]
v_add_f32 v24, v24, v32
v_add_u32 v11, 0x80, v11
s_waitcnt vmcnt(9)
s_barrier
s_waitcnt lgkmcnt(0)
v_mfma_f32_32x32x16_bf16 v[64:79], v[48:51], a[208:211], v[64:79]
s_add_u32 m0, s47, 0
ds_read_b64_tr_b16 v[56:57], v18 offset:27648
ds_read_b128 a[160:163], v19 offset:0
ds_read_b64_tr_b16 v[58:59], v18 offset:27904
v_mfma_f32_32x32x16_bf16 v[80:95], v[48:51], a[212:215], v[80:95]
buffer_load_dwordx4 v12, s[12:15], s40 offen lds
ds_read_b64_tr_b16 v[60:61], v18 offset:31744
v_lshlrev_b32 v29, 16, v40
v_mfma_f32_32x32x16_bf16 v[96:111], v[52:55], a[208:211], v[96:111]
buffer_load_dwordx4 v12, s[12:15], s41 offen offset:1024 lds
ds_read_b64_tr_b16 v[62:63], v18 offset:32000
v_and_b32 v30, v38, v40
v_mfma_f32_32x32x16_bf16 v[112:127], v[52:55], a[212:215], v[112:127]
buffer_load_dwordx4 v12, s[12:15], s42 offen offset:2048 lds
ds_read_b64_tr_b16 v[44:45], v14 offset:36864
v_add_f32 v23, v23, v29
v_mfma_f32_32x32x16_bf16 v[128:143], v[40:43], a[208:211], v[128:143]
ds_read_b64_tr_b16 v[46:47], v14 offset:37888
buffer_load_dwordx4 v12, s[12:15], s43 offen offset:3072 lds
v_add_f32 v24, v24, v30
v_mfma_f32_16x16x32_bf16 a[0:3], v[48:51], a[8:11], a[0:3]
ds_read_b128 a[164:167], v19 offset:4096
ds_read_b64_tr_b16 a[140:141], v15 offset:36864
s_add_u32 m0, s48, 0
v_lshlrev_b32 v31, 16, v41
v_mfma_f32_32x32x16_bf16 v[144:159], v[40:43], a[212:215], v[144:159]
ds_read_b128 a[168:171], v20 offset:0
ds_read_b64_tr_b16 a[142:143], v15 offset:37888
v_and_b32 v32, v38, v41
v_add_f32 v23, v23, v31
v_mfma_f32_16x16x32_bf16 a[4:7], v[52:55], a[8:11], a[4:7]
ds_read_b128 a[172:175], v20 offset:4096
ds_read_b64_tr_b16 a[144:145], v16 offset:36864
v_add_f32 v24, v24, v32
v_lshlrev_b32 v29, 16, v42
v_mfma_f32_32x32x16_bf16 v[160:175], a[128:131], a[208:211], v[160:175]
buffer_load_dwordx4 v13, s[16:19], s44 offen lds
ds_read_b128 a[176:179], v21 offset:0
v_and_b32 v30, v38, v42
v_mfma_f32_32x32x16_bf16 v[176:191], a[128:131], a[212:215], v[176:191]
ds_read_b64_tr_b16 a[146:147], v16 offset:37888
ds_read_b128 a[180:183], v21 offset:4096
v_add_f32 v23, v23, v29
v_mfma_f32_32x32x16_bf16 v[192:207], a[132:135], a[208:211], v[192:207]
ds_read_b64_tr_b16 a[148:149], v17 offset:36864
s_add_u32 m0, s48, 0x1000
v_add_f32 v24, v24, v30
v_mfma_f32_32x32x16_bf16 v[208:223], a[132:135], a[212:215], v[208:223]
ds_read_b64_tr_b16 a[150:151], v17 offset:37888
ds_read_b128 a[184:187], v22 offset:0
v_lshlrev_b32 v31, 16, v43
v_mfma_f32_32x32x16_bf16 v[224:239], a[136:139], a[208:211], v[224:239]
ds_read_b128 a[188:191], v22 offset:4096
v_and_b32 v32, v38, v43
v_add_f32 v23, v23, v31
v_mfma_f32_32x32x16_bf16 v[240:255], a[136:139], a[212:215], v[240:255]
buffer_load_dwordx4 v13, s[16:19], s45 offen lds
v_add_f32 v24, v24, v32
s_waitcnt lgkmcnt(0)
v_mfma_f32_32x32x16_bf16 v[64:79], v[56:59], a[216:219], v[64:79]
ds_read_b64_tr_b16 v[48:49], v18 offset:49152
ds_read_b64_tr_b16 v[50:51], v18 offset:49408
v_add_u32 v12, 0x80000, v12
v_mfma_f32_32x32x16_bf16 v[80:95], v[56:59], a[220:223], v[80:95]
ds_read_b64_tr_b16 v[52:53], v18 offset:53248
v_lshlrev_b32 v29, 16, v44
v_add_u32 v13, 0x2b000, v13
v_mfma_f32_32x32x16_bf16 v[96:111], v[60:63], a[216:219], v[96:111]
ds_read_b64_tr_b16 v[54:55], v18 offset:53504
v_and_b32 v30, v38, v44
v_add_f32 v23, v23, v29
v_mfma_f32_32x32x16_bf16 v[112:127], v[60:63], a[220:223], v[112:127]
ds_read_b64_tr_b16 v[40:41], v14 offset:49152
v_add_f32 v24, v24, v30
v_lshlrev_b32 v31, 16, v45
v_mfma_f32_32x32x16_bf16 v[128:143], v[44:47], a[216:219], v[128:143]
ds_read_b64_tr_b16 v[42:43], v14 offset:50176
v_and_b32 v32, v38, v45
v_add_f32 v23, v23, v31
v_mfma_f32_16x16x32_bf16 a[0:3], v[56:59], a[8:11], a[0:3]
ds_read_b64_tr_b16 a[128:129], v15 offset:49152
v_add_f32 v24, v24, v32
v_lshlrev_b32 v29, 16, v46
v_mfma_f32_32x32x16_bf16 v[144:159], v[44:47], a[220:223], v[144:159]
ds_read_b64_tr_b16 a[130:131], v15 offset:50176
v_and_b32 v30, v38, v46
v_mfma_f32_16x16x32_bf16 a[4:7], v[60:63], a[8:11], a[4:7]
ds_read_b64_tr_b16 a[132:133], v16 offset:49152
v_add_f32 v23, v23, v29
v_mfma_f32_32x32x16_bf16 v[160:175], a[140:143], a[216:219], v[160:175]
ds_read_b64_tr_b16 a[134:135], v16 offset:50176
v_add_f32 v24, v24, v30
v_mfma_f32_32x32x16_bf16 v[176:191], a[140:143], a[220:223], v[176:191]
ds_read_b64_tr_b16 a[136:137], v17 offset:49152
v_lshlrev_b32 v31, 16, v47
v_mfma_f32_32x32x16_bf16 v[192:207], a[144:147], a[216:219], v[192:207]
global_load_dword a254, v39, s[50:51]
v_mfma_f32_32x32x16_bf16 v[208:223], a[144:147], a[220:223], v[208:223]
ds_read_b64_tr_b16 a[138:139], v17 offset:50176
v_and_b32 v32, v38, v47
v_mfma_f32_32x32x16_bf16 v[224:239], a[148:151], a[216:219], v[224:239]
v_add_f32 v23, v23, v31
v_add_f32 v24, v24, v32
v_mfma_f32_32x32x16_bf16 v[240:255], a[148:151], a[220:223], v[240:255]
s_add_u32 s50, s50, s49
s_addc_u32 s51, s51, 0
s_waitcnt lgkmcnt(0)
v_mfma_f32_32x32x16_bf16 v[64:79], v[48:51], a[160:163], v[64:79]
ds_read_b64_tr_b16 v[56:57], v18 offset:50176
ds_read_b64_tr_b16 v[58:59], v18 offset:50432
v_mfma_f32_32x32x16_bf16 v[80:95], v[48:51], a[164:167], v[80:95]
ds_read_b64_tr_b16 v[60:61], v18 offset:54272
s_add_u32 m0, s46, 0
v_lshlrev_b32 v29, 16, v40
v_mfma_f32_32x32x16_bf16 v[96:111], v[52:55], a[160:163], v[96:111]
ds_read_b64_tr_b16 v[62:63], v18 offset:54528
v_and_b32 v30, v38, v40
v_add_f32 v23, v23, v29
v_mfma_f32_32x32x16_bf16 v[112:127], v[52:55], a[164:167], v[112:127]
ds_read_b64_tr_b16 v[44:45], v14 offset:53248
v_add_f32 v24, v24, v30
v_lshlrev_b32 v31, 16, v41
v_mfma_f32_32x32x16_bf16 v[128:143], v[40:43], a[160:163], v[128:143]
ds_read_b64_tr_b16 v[46:47], v14 offset:54272
v_and_b32 v32, v38, v41
v_add_f32 v23, v23, v31
v_mfma_f32_16x16x32_bf16 a[0:3], v[48:51], a[8:11], a[0:3]
buffer_load_dwordx4 v10, s[8:11], 0 offen lds
v_add_f32 v24, v24, v32
v_mfma_f32_32x32x16_bf16 v[144:159], v[40:43], a[164:167], v[144:159]
ds_read_b64_tr_b16 a[140:141], v15 offset:53248
v_lshlrev_b32 v29, 16, v42
v_and_b32 v30, v38, v42
v_mfma_f32_16x16x32_bf16 a[4:7], v[52:55], a[8:11], a[4:7]
ds_read_b64_tr_b16 a[142:143], v15 offset:54272
ds_read_b64_tr_b16 a[144:145], v16 offset:53248
v_add_f32 v23, v23, v29
v_mfma_f32_32x32x16_bf16 v[160:175], a[128:131], a[160:163], v[160:175]
buffer_load_dwordx4 v11, s[8:11], s33 offen offset:1024 lds
v_add_f32 v24, v24, v30
v_mfma_f32_32x32x16_bf16 v[176:191], a[128:131], a[164:167], v[176:191]
ds_read_b64_tr_b16 a[146:147], v16 offset:54272
ds_read_b64_tr_b16 a[148:149], v17 offset:53248
v_lshlrev_b32 v31, 16, v43
v_mfma_f32_32x32x16_bf16 v[192:207], a[132:135], a[160:163], v[192:207]
buffer_load_dwordx4 v10, s[8:11], s34 offen offset:2048 lds
v_mfma_f32_32x32x16_bf16 v[208:223], a[132:135], a[164:167], v[208:223]
ds_read_b64_tr_b16 a[150:151], v17 offset:54272
v_and_b32 v32, v38, v43
v_mfma_f32_32x32x16_bf16 v[224:239], a[136:139], a[160:163], v[224:239]
v_add_f32 v23, v23, v31
v_add_f32 v24, v24, v32
v_mfma_f32_32x32x16_bf16 v[240:255], a[136:139], a[164:167], v[240:255]
buffer_load_dwordx4 v11, s[8:11], s35 offen offset:3072 lds
s_waitcnt lgkmcnt(0)
v_mfma_f32_32x32x16_bf16 v[64:79], v[56:59], a[168:171], v[64:79]
ds_read_b64_tr_b16 v[48:49], v18 offset:51200
s_lshl_b32 s82, s3, 19
s_add_u32 m0, s46, 0x1000
ds_read_b64_tr_b16 v[50:51], v18 offset:51456
v_mfma_f32_32x32x16_bf16 v[80:95], v[56:59], a[172:175], v[80:95]
s_add_u32 s82, s82, 0x60000
ds_read_b64_tr_b16 v[52:53], v18 offset:55296
v_lshlrev_b32 v29, 16, v44
v_and_b32 v30, v38, v44
v_mfma_f32_32x32x16_bf16 v[96:111], v[60:63], a[168:171], v[96:111]
s_lshl_b32 s83, s4, 14
ds_read_b64_tr_b16 v[54:55], v18 offset:55552
v_add_f32 v23, v23, v29
v_add_f32 v24, v24, v30
v_mfma_f32_32x32x16_bf16 v[112:127], v[60:63], a[172:175], v[112:127]
buffer_load_dwordx4 v10, s[8:11], s36 offen lds
s_add_u32 s82, s82, s83
v_lshlrev_b32 v31, 16, v45
v_mfma_f32_32x32x16_bf16 v[128:143], v[44:47], a[168:171], v[128:143]
ds_read_b64_tr_b16 v[40:41], v14 offset:57344
s_add_u32 s24, s58, s82
s_addc_u32 s25, s59, 0
v_and_b32 v32, v38, v45
v_mfma_f32_16x16x32_bf16 a[0:3], v[56:59], a[8:11], a[0:3]
ds_read_b64_tr_b16 v[42:43], v14 offset:58368
buffer_load_dwordx4 v11, s[8:11], s37 offen offset:1024 lds
v_add_f32 v23, v23, v31
v_mfma_f32_32x32x16_bf16 v[144:159], v[44:47], a[172:175], v[144:159]
ds_read_b64_tr_b16 a[128:129], v15 offset:57344
s_and_b32 s25, s25, 0xffff
v_add_f32 v24, v24, v32
v_lshlrev_b32 v29, 16, v46
v_mfma_f32_16x16x32_bf16 a[4:7], v[60:63], a[8:11], a[4:7]
ds_read_b64_tr_b16 a[130:131], v15 offset:58368
buffer_load_dwordx4 v10, s[8:11], s38 offen offset:2048 lds
v_and_b32 v30, v38, v46
v_mfma_f32_32x32x16_bf16 v[160:175], a[140:143], a[168:171], v[160:175]
ds_read_b64_tr_b16 a[132:133], v16 offset:57344
s_cmp_eq_u32 s5, 0
s_cselect_b32 s26, 0x2000, 0
v_add_f32 v23, v23, v29
v_mfma_f32_32x32x16_bf16 v[176:191], a[140:143], a[172:175], v[176:191]
ds_read_b64_tr_b16 a[134:135], v16 offset:58368
buffer_load_dwordx4 v11, s[8:11], s39 offen offset:3072 lds
v_add_f32 v24, v24, v30
v_mfma_f32_32x32x16_bf16 v[192:207], a[144:147], a[168:171], v[192:207]
ds_read_b64_tr_b16 a[136:137], v17 offset:57344
s_mov_b32 s27, 0x20000
v_lshlrev_b32 v31, 16, v47
v_mfma_f32_32x32x16_bf16 v[208:223], a[144:147], a[172:175], v[208:223]
ds_read_b64_tr_b16 a[138:139], v17 offset:58368
v_and_b32 v32, v38, v47
v_lshlrev_b32 v4, 7, v1
v_mfma_f32_32x32x16_bf16 v[224:239], a[148:151], a[168:171], v[224:239]
v_add_f32 v23, v23, v31
v_add_u32 v10, 0x80, v10
v_add_f32 v24, v24, v32
v_mfma_f32_32x32x16_bf16 v[240:255], a[148:151], a[172:175], v[240:255]
buffer_load_dword a254, v4, s[24:27], 0 offen
v_add_u32 v11, 0x80, v11
s_waitcnt vmcnt(10)
s_barrier
s_waitcnt lgkmcnt(0)
v_mfma_f32_32x32x16_bf16 v[64:79], v[48:51], a[176:179], v[64:79]
s_add_u32 m0, s47, 0x6000
ds_read_b64_tr_b16 v[56:57], v18 offset:52224
ds_read_b128 a[192:195], v19 offset:8192
ds_read_b64_tr_b16 v[58:59], v18 offset:52480
v_mfma_f32_32x32x16_bf16 v[80:95], v[48:51], a[180:183], v[80:95]
buffer_load_dwordx4 v12, s[12:15], s40 offen lds
ds_read_b64_tr_b16 v[60:61], v18 offset:56320
v_lshlrev_b32 v29, 16, v40
v_mfma_f32_32x32x16_bf16 v[96:111], v[52:55], a[176:179], v[96:111]
buffer_load_dwordx4 v12, s[12:15], s41 offen offset:1024 lds
ds_read_b64_tr_b16 v[62:63], v18 offset:56576
v_and_b32 v30, v38, v40
v_mfma_f32_32x32x16_bf16 v[112:127], v[52:55], a[180:183], v[112:127]
buffer_load_dwordx4 v12, s[12:15], s42 offen offset:2048 lds
ds_read_b64_tr_b16 v[44:45], v14 offset:61440
v_add_f32 v23, v23, v29
v_mfma_f32_32x32x16_bf16 v[128:143], v[40:43], a[176:179], v[128:143]
ds_read_b64_tr_b16 v[46:47], v14 offset:62464
buffer_load_dwordx4 v12, s[12:15], s43 offen offset:3072 lds
v_add_f32 v24, v24, v30
v_mfma_f32_16x16x32_bf16 a[0:3], v[48:51], a[8:11], a[0:3]
ds_read_b128 a[196:199], v19 offset:12288
ds_read_b64_tr_b16 a[140:141], v15 offset:61440
s_add_u32 m0, s48, 0x6000
v_lshlrev_b32 v31, 16, v41
v_mfma_f32_32x32x16_bf16 v[144:159], v[40:43], a[180:183], v[144:159]
ds_read_b128 a[200:203], v20 offset:8192
ds_read_b64_tr_b16 a[142:143], v15 offset:62464
v_and_b32 v32, v38, v41
v_add_f32 v23, v23, v31
v_mfma_f32_16x16x32_bf16 a[4:7], v[52:55], a[8:11], a[4:7]
ds_read_b128 a[204:207], v20 offset:12288
ds_read_b64_tr_b16 a[144:145], v16 offset:61440
v_add_f32 v24, v24, v32
v_lshlrev_b32 v29, 16, v42
v_mfma_f32_32x32x16_bf16 v[160:175], a[128:131], a[176:179], v[160:175]
buffer_load_dwordx4 v13, s[16:19], s44 offen lds
ds_read_b128 a[208:211], v21 offset:8192
v_and_b32 v30, v38, v42
v_mfma_f32_32x32x16_bf16 v[176:191], a[128:131], a[180:183], v[176:191]
ds_read_b64_tr_b16 a[146:147], v16 offset:62464
ds_read_b128 a[212:215], v21 offset:12288
v_add_f32 v23, v23, v29
v_mfma_f32_32x32x16_bf16 v[192:207], a[132:135], a[176:179], v[192:207]
ds_read_b64_tr_b16 a[148:149], v17 offset:61440
s_add_u32 m0, s48, 0x7000
v_add_f32 v24, v24, v30
v_mfma_f32_32x32x16_bf16 v[208:223], a[132:135], a[180:183], v[208:223]
ds_read_b64_tr_b16 a[150:151], v17 offset:62464
ds_read_b128 a[216:219], v22 offset:8192
v_lshlrev_b32 v31, 16, v43
v_mfma_f32_32x32x16_bf16 v[224:239], a[136:139], a[176:179], v[224:239]
ds_read_b128 a[220:223], v22 offset:12288
v_and_b32 v32, v38, v43
v_add_f32 v23, v23, v31
v_mfma_f32_32x32x16_bf16 v[240:255], a[136:139], a[180:183], v[240:255]
buffer_load_dwordx4 v13, s[16:19], s45 offen lds
v_add_f32 v24, v24, v32
s_waitcnt lgkmcnt(0)
v_mfma_f32_32x32x16_bf16 v[64:79], v[56:59], a[184:187], v[64:79]
v_readfirstlane_b32 s32, v33
s_cmp_lg_u32 s32, 0
s_cbranch_scc0 L_slow_7
L_slow_7_r:
ds_read_b64_tr_b16 v[48:49], v18 offset:0
v_mfma_f32_32x32x16_bf16 v[80:95], v[56:59], a[188:191], v[80:95]
ds_read_b64_tr_b16 v[50:51], v18 offset:256
v_mov_b32 v2, v34
v_lshlrev_b32 v29, 16, v44
v_add_u32 v12, 0x80000, v12
v_mfma_f32_32x32x16_bf16 v[96:111], v[60:63], a[184:187], v[96:111]
ds_read_b64_tr_b16 v[52:53], v18 offset:4096
v_mov_b32 v3, v35
v_and_b32 v30, v38, v44
v_add_u32 v13, 0x2b000, v13
v_mfma_f32_32x32x16_bf16 v[112:127], v[60:63], a[188:191], v[112:127]
ds_read_b64_tr_b16 v[54:55], v18 offset:4352
v_mov_b32 v4, s32
v_add_f32 v23, v23, v29
v_mov_b32 v5, 0
v_mfma_f32_32x32x16_bf16 v[128:143], v[44:47], a[184:187], v[128:143]
ds_read_b64_tr_b16 v[40:41], v14 offset:0
v_add_f32 v24, v24, v30
v_mov_b32 v6, v36
v_lshlrev_b32 v31, 16, v45
v_mfma_f32_16x16x32_bf16 a[0:3], v[56:59], a[8:11], a[0:3]
ds_read_b64_tr_b16 v[42:43], v14 offset:1024
v_mov_b32 v7, v37
v_and_b32 v32, v38, v45
v_mov_b32 v8, s32
v_mfma_f32_32x32x16_bf16 v[144:159], v[44:47], a[188:191], v[144:159]
ds_read_b64_tr_b16 a[128:129], v15 offset:0
v_add_f32 v23, v23, v31
v_mov_b32 v9, 0
v_add_f32 v24, v24, v32
v_mfma_f32_16x16x32_bf16 a[4:7], v[60:63], a[8:11], a[4:7]
s_lshl_b32 s87, s97, 4
s_add_u32 s87, s87, 0x1000000
ds_read_b64_tr_b16 a[130:131], v15 offset:1024
v_lshlrev_b32 v29, 16, v46
v_mfma_f32_32x32x16_bf16 v[160:175], a[140:143], a[184:187], v[160:175]
ds_read_b64_tr_b16 a[132:133], v16 offset:0
v_and_b32 v30, v38, v46
v_mov_b32 v33, 0
v_add_f32 v23, v23, v29
v_mfma_f32_32x32x16_bf16 v[176:191], a[140:143], a[188:191], v[176:191]
ds_read_b64_tr_b16 a[134:135], v16 offset:1024
global_load_dword a254, v39, s[50:51]
v_add_f32 v24, v24, v30
v_mfma_f32_32x32x16_bf16 v[192:207], a[144:147], a[184:187], v[192:207]
ds_read_b64_tr_b16 a[136:137], v17 offset:0
s_add_u32 s50, s50, s49
s_addc_u32 s51, s51, 0
v_lshlrev_b32 v31, 16, v47
v_mfma_f32_32x32x16_bf16 v[208:223], a[144:147], a[188:191], v[208:223]
ds_read_b64_tr_b16 a[138:139], v17 offset:1024
v_and_b32 v32, v38, v47
v_add_f32 v23, v23, v31
v_mfma_f32_32x32x16_bf16 v[224:239], a[148:151], a[184:187], v[224:239]
v_add_f32 v24, v24, v32
v_mfma_f32_32x32x16_bf16 v[240:255], a[148:151], a[188:191], v[240:255]
s_mov_b64 exec, 1
buffer_store_dwordx4 v[2:5], v33, s[28:31], s87 offen sc0 sc1
buffer_store_dwordx4 v[6:9], v33, s[28:31], s87 offen offset:16 sc0 sc1
s_mov_b64 exec, -1
s_waitcnt lgkmcnt(0)
v_mfma_f32_32x32x16_bf16 v[64:79], v[48:51], a[192:195], v[64:79]
ds_read_b64_tr_b16 v[56:57], v18 offset:1024
ds_read_b64_tr_b16 v[58:59], v18 offset:1280
v_mfma_f32_32x32x16_bf16 v[80:95], v[48:51], a[196:199], v[80:95]
ds_read_b64_tr_b16 v[60:61], v18 offset:5120
s_add_u32 m0, s46, 0x2000
v_lshlrev_b32 v29, 16, v40
v_mfma_f32_32x32x16_bf16 v[96:111], v[52:55], a[192:195], v[96:111]
ds_read_b64_tr_b16 v[62:63], v18 offset:5376
v_and_b32 v30, v38, v40
v_add_f32 v23, v23, v29
v_mfma_f32_32x32x16_bf16 v[112:127], v[52:55], a[196:199], v[112:127]
ds_read_b64_tr_b16 v[44:45], v14 offset:4096
v_add_f32 v24, v24, v30
v_lshlrev_b32 v31, 16, v41
v_mfma_f32_32x32x16_bf16 v[128:143], v[40:43], a[192:195], v[128:143]
ds_read_b64_tr_b16 v[46:47], v14 offset:5120
v_and_b32 v32, v38, v41
v_add_f32 v23, v23, v31
v_mfma_f32_16x16x32_bf16 a[0:3], v[48:51], a[8:11], a[0:3]
buffer_load_dwordx4 v10, s[8:11], 0 offen lds
v_add_f32 v24, v24, v32
v_mfma_f32_32x32x16_bf16 v[144:159], v[40:43], a[196:199], v[144:159]
ds_read_b64_tr_b16 a[140:141], v15 offset:4096
v_lshlrev_b32 v29, 16, v42
v_and_b32 v30, v38, v42
v_mfma_f32_16x16x32_bf16 a[4:7], v[52:55], a[8:11], a[4:7]
ds_read_b64_tr_b16 a[142:143], v15 offset:5120
ds_read_b64_tr_b16 a[144:145], v16 offset:4096
v_add_f32 v23, v23, v29
v_mfma_f32_32x32x16_bf16 v[160:175], a[128:131], a[192:195], v[160:175]
buffer_load_dwordx4 v11, s[8:11], s33 offen offset:1024 lds
v_add_f32 v24, v24, v30
v_mfma_f32_32x32x16_bf16 v[176:191], a[128:131], a[196:199], v[176:191]
ds_read_b64_tr_b16 a[146:147], v16 offset:5120
ds_read_b64_tr_b16 a[148:149], v17 offset:4096
v_lshlrev_b32 v31, 16, v43
v_mfma_f32_32x32x16_bf16 v[192:207], a[132:135], a[192:195], v[192:207]
buffer_load_dwordx4 v10, s[8:11], s34 offen offset:2048 lds
v_mfma_f32_32x32x16_bf16 v[208:223], a[132:135], a[196:199], v[208:223]
ds_read_b64_tr_b16 a[150:151], v17 offset:5120
v_and_b32 v32, v38, v43
v_mfma_f32_32x32x16_bf16 v[224:239], a[136:139], a[192:195], v[224:239]
v_add_f32 v23, v23, v31
v_add_f32 v24, v24, v32
v_mfma_f32_32x32x16_bf16 v[240:255], a[136:139], a[196:199], v[240:255]
buffer_load_dwordx4 v11, s[8:11], s35 offen offset:3072 lds
s_waitcnt lgkmcnt(0)
v_mfma_f32_32x32x16_bf16 v[64:79], v[56:59], a[200:203], v[64:79]
ds_read_b64_tr_b16 v[48:49], v18 offset:2048
s_lshl_b32 s82, s3, 19
s_add_u32 m0, s46, 0x3000
ds_read_b64_tr_b16 v[50:51], v18 offset:2304
v_mfma_f32_32x32x16_bf16 v[80:95], v[56:59], a[204:207], v[80:95]
s_add_u32 s82, s82, 0x62000
ds_read_b64_tr_b16 v[52:53], v18 offset:6144
v_lshlrev_b32 v29, 16, v44
v_and_b32 v30, v38, v44
v_mfma_f32_32x32x16_bf16 v[96:111], v[60:63], a[200:203], v[96:111]
s_lshl_b32 s83, s4, 14
ds_read_b64_tr_b16 v[54:55], v18 offset:6400
v_add_f32 v23, v23, v29
v_add_f32 v24, v24, v30
v_mfma_f32_32x32x16_bf16 v[112:127], v[60:63], a[204:207], v[112:127]
buffer_load_dwordx4 v10, s[8:11], s36 offen lds
s_add_u32 s82, s82, s83
v_lshlrev_b32 v31, 16, v45
v_mfma_f32_32x32x16_bf16 v[128:143], v[44:47], a[200:203], v[128:143]
ds_read_b64_tr_b16 v[40:41], v14 offset:8192
s_add_u32 s24, s58, s82
s_addc_u32 s25, s59, 0
v_and_b32 v32, v38, v45
v_mfma_f32_16x16x32_bf16 a[0:3], v[56:59], a[8:11], a[0:3]
ds_read_b64_tr_b16 v[42:43], v14 offset:9216
buffer_load_dwordx4 v11, s[8:11], s37 offen offset:1024 lds
v_add_f32 v23, v23, v31
v_mfma_f32_32x32x16_bf16 v[144:159], v[44:47], a[204:207], v[144:159]
ds_read_b64_tr_b16 a[128:129], v15 offset:8192
s_and_b32 s25, s25, 0xffff
v_add_f32 v24, v24, v32
v_lshlrev_b32 v29, 16, v46
v_mfma_f32_16x16x32_bf16 a[4:7], v[60:63], a[8:11], a[4:7]
ds_read_b64_tr_b16 a[130:131], v15 offset:9216
buffer_load_dwordx4 v10, s[8:11], s38 offen offset:2048 lds
v_and_b32 v30, v38, v46
v_mfma_f32_32x32x16_bf16 v[160:175], a[140:143], a[200:203], v[160:175]
ds_read_b64_tr_b16 a[132:133], v16 offset:8192
s_cmp_eq_u32 s5, 1
s_cselect_b32 s26, 0x2000, 0
v_add_f32 v23, v23, v29
v_mfma_f32_32x32x16_bf16 v[176:191], a[140:143], a[204:207], v[176:191]
ds_read_b64_tr_b16 a[134:135], v16 offset:9216
buffer_load_dwordx4 v11, s[8:11], s39 offen offset:3072 lds
v_add_f32 v24, v24, v30
v_mfma_f32_32x32x16_bf16 v[192:207], a[144:147], a[200:203], v[192:207]
ds_read_b64_tr_b16 a[136:137], v17 offset:8192
s_mov_b32 s27, 0x20000
v_lshlrev_b32 v31, 16, v47
v_mfma_f32_32x32x16_bf16 v[208:223], a[144:147], a[204:207], v[208:223]
ds_read_b64_tr_b16 a[138:139], v17 offset:9216
v_and_b32 v32, v38, v47
v_lshlrev_b32 v4, 7, v1
v_mfma_f32_32x32x16_bf16 v[224:239], a[148:151], a[200:203], v[224:239]
v_add_f32 v23, v23, v31
v_add_u32 v10, 0x80, v10
v_add_f32 v24, v24, v32
v_mfma_f32_32x32x16_bf16 v[240:255], a[148:151], a[204:207], v[240:255]
buffer_load_dword a254, v4, s[24:27], 0 offen
v_add_u32 v11, 0x80, v11
s_waitcnt vmcnt(12)
s_barrier
s_waitcnt lgkmcnt(0)
v_mfma_f32_32x32x16_bf16 v[64:79], v[48:51], a[208:211], v[64:79]
s_add_u32 m0, s47, 0xc000
ds_read_b64_tr_b16 v[56:57], v18 offset:3072
ds_read_b128 a[160:163], v19 offset:0
ds_read_b64_tr_b16 v[58:59], v18 offset:3328
v_mfma_f32_32x32x16_bf16 v[80:95], v[48:51], a[212:215], v[80:95]
buffer_load_dwordx4 v12, s[12:15], s40 offen lds
ds_read_b64_tr_b16 v[60:61], v18 offset:7168
v_lshlrev_b32 v29, 16, v40
v_mfma_f32_32x32x16_bf16 v[96:111], v[52:55], a[208:211], v[96:111]
buffer_load_dwordx4 v12, s[12:15], s41 offen offset:1024 lds
ds_read_b64_tr_b16 v[62:63], v18 offset:7424
v_and_b32 v30, v38, v40
v_mfma_f32_32x32x16_bf16 v[112:127], v[52:55], a[212:215], v[112:127]
buffer_load_dwordx4 v12, s[12:15], s42 offen offset:2048 lds
ds_read_b64_tr_b16 v[44:45], v14 offset:12288
v_add_f32 v23, v23, v29
v_mfma_f32_32x32x16_bf16 v[128:143], v[40:43], a[208:211], v[128:143]
ds_read_b64_tr_b16 v[46:47], v14 offset:13312
buffer_load_dwordx4 v12, s[12:15], s43 offen offset:3072 lds
v_add_f32 v24, v24, v30
v_mfma_f32_16x16x32_bf16 a[0:3], v[48:51], a[8:11], a[0:3]
ds_read_b128 a[164:167], v19 offset:4096
ds_read_b64_tr_b16 a[140:141], v15 offset:12288
s_add_u32 m0, s48, 0xc000
v_lshlrev_b32 v31, 16, v41
v_mfma_f32_32x32x16_bf16 v[144:159], v[40:43], a[212:215], v[144:159]
ds_read_b128 a[168:171], v20 offset:0
ds_read_b64_tr_b16 a[142:143], v15 offset:13312
v_and_b32 v32, v38, v41
v_add_f32 v23, v23, v31
v_mfma_f32_16x16x32_bf16 a[4:7], v[52:55], a[8:11], a[4:7]
ds_read_b128 a[172:175], v20 offset:4096
ds_read_b64_tr_b16 a[144:145], v16 offset:12288
v_add_f32 v24, v24, v32
v_lshlrev_b32 v29, 16, v42
v_mfma_f32_32x32x16_bf16 v[160:175], a[128:131], a[208:211], v[160:175]
buffer_load_dwordx4 v13, s[16:19], s44 offen lds
ds_read_b128 a[176:179], v21 offset:0
v_and_b32 v30, v38, v42
v_mfma_f32_32x32x16_bf16 v[176:191], a[128:131], a[212:215], v[176:191]
ds_read_b64_tr_b16 a[146:147], v16 offset:13312
ds_read_b128 a[180:183], v21 offset:4096
v_add_f32 v23, v23, v29
v_mfma_f32_32x32x16_bf16 v[192:207], a[132:135], a[208:211], v[192:207]
ds_read_b64_tr_b16 a[148:149], v17 offset:12288
s_add_u32 m0, s48, 0xd000
v_add_f32 v24, v24, v30
v_mfma_f32_32x32x16_bf16 v[208:223], a[132:135], a[212:215], v[208:223]
ds_read_b64_tr_b16 a[150:151], v17 offset:13312
ds_read_b128 a[184:187], v22 offset:0
v_lshlrev_b32 v31, 16, v43
v_mfma_f32_32x32x16_bf16 v[224:239], a[136:139], a[208:211], v[224:239]
ds_read_b128 a[188:191], v22 offset:4096
v_and_b32 v32, v38, v43
v_add_f32 v23, v23, v31
v_mfma_f32_32x32x16_bf16 v[240:255], a[136:139], a[212:215], v[240:255]
buffer_load_dwordx4 v13, s[16:19], s45 offen lds
v_add_f32 v24, v24, v32
s_waitcnt lgkmcnt(0)
v_mfma_f32_32x32x16_bf16 v[64:79], v[56:59], a[216:219], v[64:79]
ds_read_b64_tr_b16 v[48:49], v18 offset:24576
ds_read_b64_tr_b16 v[50:51], v18 offset:24832
v_add_u32 v12, 0x80000, v12
v_mfma_f32_32x32x16_bf16 v[80:95], v[56:59], a[220:223], v[80:95]
ds_read_b64_tr_b16 v[52:53], v18 offset:28672
v_lshlrev_b32 v29, 16, v44
v_and_b32 v30, v38, v44
v_mfma_f32_32x32x16_bf16 v[96:111], v[60:63], a[216:219], v[96:111]
ds_read_b64_tr_b16 v[54:55], v18 offset:28928
v_add_f32 v23, v23, v29
v_mfma_f32_32x32x16_bf16 v[112:127], v[60:63], a[220:223], v[112:127]
ds_read_b64_tr_b16 v[40:41], v14 offset:24576
v_add_f32 v24, v24, v30
v_mfma_f32_32x32x16_bf16 v[128:143], v[44:47], a[216:219], v[128:143]
ds_read_b64_tr_b16 v[42:43], v14 offset:25600
v_lshlrev_b32 v31, 16, v45
v_mfma_f32_16x16x32_bf16 a[0:3], v[56:59], a[8:11], a[0:3]
ds_read_b64_tr_b16 a[128:129], v15 offset:24576
v_and_b32 v32, v38, v45
v_mfma_f32_32x32x16_bf16 v[144:159], v[44:47], a[220:223], v[144:159]
ds_read_b64_tr_b16 a[130:131], v15 offset:25600
v_add_f32 v23, v23, v31
v_mfma_f32_16x16x32_bf16 a[4:7], v[60:63], a[8:11], a[4:7]
ds_read_b64_tr_b16 a[132:133], v16 offset:24576
v_add_f32 v24, v24, v32
v_mfma_f32_32x32x16_bf16 v[160:175], a[140:143], a[216:219], v[160:175]
ds_read_b64_tr_b16 a[134:135], v16 offset:25600
v_lshlrev_b32 v29, 16, v46
v_mfma_f32_32x32x16_bf16 v[176:191], a[140:143], a[220:223], v[176:191]
ds_read_b64_tr_b16 a[136:137], v17 offset:24576
v_and_b32 v30, v38, v46
v_mfma_f32_32x32x16_bf16 v[192:207], a[144:147], a[216:219], v[192:207]
ds_read_b64_tr_b16 a[138:139], v17 offset:25600
v_add_f32 v23, v23, v29
v_mfma_f32_32x32x16_bf16 v[208:223], a[144:147], a[220:223], v[208:223]
v_add_f32 v24, v24, v30
v_add_u32 v13, 0x2b000, v13
v_mfma_f32_32x32x16_bf16 v[224:239], a[148:151], a[216:219], v[224:239]
v_lshlrev_b32 v31, 16, v47
v_and_b32 v32, v38, v47
v_mfma_f32_32x32x16_bf16 v[240:255], a[148:151], a[220:223], v[240:255]
v_add_f32 v23, v23, v31
v_add_f32 v24, v24, v32
s_waitcnt lgkmcnt(0)
v_mfma_f32_32x32x16_bf16 v[64:79], v[48:51], a[160:163], v[64:79]
ds_read_b64_tr_b16 v[56:57], v18 offset:25600
ds_read_b64_tr_b16 v[58:59], v18 offset:25856
v_mfma_f32_32x32x16_bf16 v[80:95], v[48:51], a[164:167], v[80:95]
ds_read_b64_tr_b16 v[60:61], v18 offset:29696
s_add_u32 m0, s46, 0
v_lshlrev_b32 v29, 16, v40
v_mfma_f32_32x32x16_bf16 v[96:111], v[52:55], a[160:163], v[96:111]
ds_read_b64_tr_b16 v[62:63], v18 offset:29952
v_and_b32 v30, v38, v40
v_add_f32 v23, v23, v29
v_mfma_f32_32x32x16_bf16 v[112:127], v[52:55], a[164:167], v[112:127]
ds_read_b64_tr_b16 v[44:45], v14 offset:28672
v_add_f32 v24, v24, v30
v_lshlrev_b32 v31, 16, v41
v_mfma_f32_32x32x16_bf16 v[128:143], v[40:43], a[160:163], v[128:143]
ds_read_b64_tr_b16 v[46:47], v14 offset:29696
v_and_b32 v32, v38, v41
v_add_f32 v23, v23, v31
v_mfma_f32_16x16x32_bf16 a[0:3], v[48:51], a[8:11], a[0:3]
buffer_load_dwordx4 v10, s[8:11], 0 offen lds
v_add_f32 v24, v24, v32
v_mfma_f32_32x32x16_bf16 v[144:159], v[40:43], a[164:167], v[144:159]
ds_read_b64_tr_b16 a[140:141], v15 offset:28672
v_lshlrev_b32 v29, 16, v42
v_and_b32 v30, v38, v42
v_mfma_f32_16x16x32_bf16 a[4:7], v[52:55], a[8:11], a[4:7]
ds_read_b64_tr_b16 a[142:143], v15 offset:29696
ds_read_b64_tr_b16 a[144:145], v16 offset:28672
v_add_f32 v23, v23, v29
v_mfma_f32_32x32x16_bf16 v[160:175], a[128:131], a[160:163], v[160:175]
buffer_load_dwordx4 v11, s[8:11], s33 offen offset:1024 lds
v_add_f32 v24, v24, v30
v_mfma_f32_32x32x16_bf16 v[176:191], a[128:131], a[164:167], v[176:191]
ds_read_b64_tr_b16 a[146:147], v16 offset:29696
ds_read_b64_tr_b16 a[148:149], v17 offset:28672
v_lshlrev_b32 v31, 16, v43
v_mfma_f32_32x32x16_bf16 v[192:207], a[132:135], a[160:163], v[192:207]
buffer_load_dwordx4 v10, s[8:11], s34 offen offset:2048 lds
v_mfma_f32_32x32x16_bf16 v[208:223], a[132:135], a[164:167], v[208:223]
ds_read_b64_tr_b16 a[150:151], v17 offset:29696
v_and_b32 v32, v38, v43
v_mfma_f32_32x32x16_bf16 v[224:239], a[136:139], a[160:163], v[224:239]
v_add_f32 v23, v23, v31
v_add_f32 v24, v24, v32
v_mfma_f32_32x32x16_bf16 v[240:255], a[136:139], a[164:167], v[240:255]
buffer_load_dwordx4 v11, s[8:11], s35 offen offset:3072 lds
s_waitcnt lgkmcnt(0)
v_mfma_f32_32x32x16_bf16 v[64:79], v[56:59], a[168:171], v[64:79]
ds_read_b64_tr_b16 v[48:49], v18 offset:26624
s_lshl_b32 s82, s3, 19
s_add_u32 m0, s46, 0x1000
ds_read_b64_tr_b16 v[50:51], v18 offset:26880
v_mfma_f32_32x32x16_bf16 v[80:95], v[56:59], a[172:175], v[80:95]
s_add_u32 s82, s82, 0x60000
ds_read_b64_tr_b16 v[52:53], v18 offset:30720
v_lshlrev_b32 v29, 16, v44
v_and_b32 v30, v38, v44
v_mfma_f32_32x32x16_bf16 v[96:111], v[60:63], a[168:171], v[96:111]
s_lshl_b32 s83, s4, 14
ds_read_b64_tr_b16 v[54:55], v18 offset:30976
v_add_f32 v23, v23, v29
v_add_f32 v24, v24, v30
v_mfma_f32_32x32x16_bf16 v[112:127], v[60:63], a[172:175], v[112:127]
buffer_load_dwordx4 v10, s[8:11], s36 offen lds
s_add_u32 s82, s82, s83
v_lshlrev_b32 v31, 16, v45
v_mfma_f32_32x32x16_bf16 v[128:143], v[44:47], a[168:171], v[128:143]
ds_read_b64_tr_b16 v[40:41], v14 offset:32768
s_add_u32 s24, s60, s82
s_addc_u32 s25, s61, 0
v_and_b32 v32, v38, v45
v_mfma_f32_16x16x32_bf16 a[0:3], v[56:59], a[8:11], a[0:3]
ds_read_b64_tr_b16 v[42:43], v14 offset:33792
buffer_load_dwordx4 v11, s[8:11], s37 offen offset:1024 lds
v_add_f32 v23, v23, v31
v_mfma_f32_32x32x16_bf16 v[144:159], v[44:47], a[172:175], v[144:159]
ds_read_b64_tr_b16 a[128:129], v15 offset:32768
s_and_b32 s25, s25, 0xffff
v_add_f32 v24, v24, v32
v_lshlrev_b32 v29, 16, v46
v_mfma_f32_16x16x32_bf16 a[4:7], v[60:63], a[8:11], a[4:7]
ds_read_b64_tr_b16 a[130:131], v15 offset:33792
buffer_load_dwordx4 v10, s[8:11], s38 offen offset:2048 lds
v_and_b32 v30, v38, v46
v_mfma_f32_32x32x16_bf16 v[160:175], a[140:143], a[168:171], v[160:175]
ds_read_b64_tr_b16 a[132:133], v16 offset:32768
s_cmp_eq_u32 s5, 2
s_cselect_b32 s26, 0x2000, 0
v_add_f32 v23, v23, v29
v_mfma_f32_32x32x16_bf16 v[176:191], a[140:143], a[172:175], v[176:191]
ds_read_b64_tr_b16 a[134:135], v16 offset:33792
buffer_load_dwordx4 v11, s[8:11], s39 offen offset:3072 lds
v_add_f32 v24, v24, v30
v_mfma_f32_32x32x16_bf16 v[192:207], a[144:147], a[168:171], v[192:207]
ds_read_b64_tr_b16 a[136:137], v17 offset:32768
s_mov_b32 s27, 0x20000
v_lshlrev_b32 v31, 16, v47
v_mfma_f32_32x32x16_bf16 v[208:223], a[144:147], a[172:175], v[208:223]
ds_read_b64_tr_b16 a[138:139], v17 offset:33792
v_and_b32 v32, v38, v47
v_lshlrev_b32 v4, 7, v1
v_mfma_f32_32x32x16_bf16 v[224:239], a[148:151], a[168:171], v[224:239]
v_add_f32 v23, v23, v31
v_add_u32 v10, 0x80, v10
v_add_f32 v24, v24, v32
v_mfma_f32_32x32x16_bf16 v[240:255], a[148:151], a[172:175], v[240:255]
buffer_load_dword a254, v4, s[24:27], 0 offen
v_add_u32 v11, 0x80, v11
s_waitcnt vmcnt(9)
s_barrier
s_waitcnt lgkmcnt(0)
v_mfma_f32_32x32x16_bf16 v[64:79], v[48:51], a[176:179], v[64:79]
s_add_u32 m0, s47, 0
ds_read_b64_tr_b16 v[56:57], v18 offset:27648
ds_read_b128 a[192:195], v19 offset:8192
ds_read_b64_tr_b16 v[58:59], v18 offset:27904
v_mfma_f32_32x32x16_bf16 v[80:95], v[48:51], a[180:183], v[80:95]
buffer_load_dwordx4 v12, s[12:15], s40 offen lds
ds_read_b64_tr_b16 v[60:61], v18 offset:31744
v_lshlrev_b32 v29, 16, v40
v_mfma_f32_32x32x16_bf16 v[96:111], v[52:55], a[176:179], v[96:111]
buffer_load_dwordx4 v12, s[12:15], s41 offen offset:1024 lds
ds_read_b64_tr_b16 v[62:63], v18 offset:32000
v_and_b32 v30, v38, v40
v_mfma_f32_32x32x16_bf16 v[112:127], v[52:55], a[180:183], v[112:127]
buffer_load_dwordx4 v12, s[12:15], s42 offen offset:2048 lds
ds_read_b64_tr_b16 v[44:45], v14 offset:36864
v_add_f32 v23, v23, v29
v_mfma_f32_32x32x16_bf16 v[128:143], v[40:43], a[176:179], v[128:143]
ds_read_b64_tr_b16 v[46:47], v14 offset:37888
buffer_load_dwordx4 v12, s[12:15], s43 offen offset:3072 lds
v_add_f32 v24, v24, v30
v_mfma_f32_16x16x32_bf16 a[0:3], v[48:51], a[8:11], a[0:3]
ds_read_b128 a[196:199], v19 offset:12288
ds_read_b64_tr_b16 a[140:141], v15 offset:36864
s_add_u32 m0, s48, 0
v_lshlrev_b32 v31, 16, v41
v_mfma_f32_32x32x16_bf16 v[144:159], v[40:43], a[180:183], v[144:159]
ds_read_b128 a[200:203], v20 offset:8192
ds_read_b64_tr_b16 a[142:143], v15 offset:37888
v_and_b32 v32, v38, v41
v_add_f32 v23, v23, v31
v_mfma_f32_16x16x32_bf16 a[4:7], v[52:55], a[8:11], a[4:7]
ds_read_b128 a[204:207], v20 offset:12288
ds_read_b64_tr_b16 a[144:145], v16 offset:36864
v_add_f32 v24, v24, v32
v_lshlrev_b32 v29, 16, v42
v_mfma_f32_32x32x16_bf16 v[160:175], a[128:131], a[176:179], v[160:175]
buffer_load_dwordx4 v13, s[16:19], s44 offen lds
ds_read_b128 a[208:211], v21 offset:8192
v_and_b32 v30, v38, v42
v_mfma_f32_32x32x16_bf16 v[176:191], a[128:131], a[180:183], v[176:191]
ds_read_b64_tr_b16 a[146:147], v16 offset:37888
ds_read_b128 a[212:215], v21 offset:12288
v_add_f32 v23, v23, v29
v_mfma_f32_32x32x16_bf16 v[192:207], a[132:135], a[176:179], v[192:207]
ds_read_b64_tr_b16 a[148:149], v17 offset:36864
s_add_u32 m0, s48, 0x1000
v_add_f32 v24, v24, v30
v_mfma_f32_32x32x16_bf16 v[208:223], a[132:135], a[180:183], v[208:223]
ds_read_b64_tr_b16 a[150:151], v17 offset:37888
ds_read_b128 a[216:219], v22 offset:8192
v_lshlrev_b32 v31, 16, v43
v_mfma_f32_32x32x16_bf16 v[224:239], a[136:139], a[176:179], v[224:239]
ds_read_b128 a[220:223], v22 offset:12288
v_and_b32 v32, v38, v43
v_add_f32 v23, v23, v31
v_mfma_f32_32x32x16_bf16 v[240:255], a[136:139], a[180:183], v[240:255]
buffer_load_dwordx4 v13, s[16:19], s45 offen lds
v_add_f32 v24, v24, v32
s_waitcnt lgkmcnt(0)
v_mfma_f32_32x32x16_bf16 v[64:79], v[56:59], a[184:187], v[64:79]
ds_read_b64_tr_b16 v[48:49], v18 offset:49152
ds_read_b64_tr_b16 v[50:51], v18 offset:49408
v_add_u32 v12, 0x80000, v12
v_mfma_f32_32x32x16_bf16 v[80:95], v[56:59], a[188:191], v[80:95]
ds_read_b64_tr_b16 v[52:53], v18 offset:53248
v_lshlrev_b32 v29, 16, v44
v_and_b32 v30, v38, v44
v_mfma_f32_32x32x16_bf16 v[96:111], v[60:63], a[184:187], v[96:111]
ds_read_b64_tr_b16 v[54:55], v18 offset:53504
v_add_f32 v23, v23, v29
v_mfma_f32_32x32x16_bf16 v[112:127], v[60:63], a[188:191], v[112:127]
ds_read_b64_tr_b16 v[40:41], v14 offset:49152
v_add_f32 v24, v24, v30
v_mfma_f32_32x32x16_bf16 v[128:143], v[44:47], a[184:187], v[128:143]
ds_read_b64_tr_b16 v[42:43], v14 offset:50176
v_lshlrev_b32 v31, 16, v45
v_mfma_f32_16x16x32_bf16 a[0:3], v[56:59], a[8:11], a[0:3]
ds_read_b64_tr_b16 a[128:129], v15 offset:49152
v_and_b32 v32, v38, v45
v_mfma_f32_32x32x16_bf16 v[144:159], v[44:47], a[188:191], v[144:159]
ds_read_b64_tr_b16 a[130:131], v15 offset:50176
v_add_f32 v23, v23, v31
v_mfma_f32_16x16x32_bf16 a[4:7], v[60:63], a[8:11], a[4:7]
ds_read_b64_tr_b16 a[132:133], v16 offset:49152
v_add_f32 v24, v24, v32
v_mfma_f32_32x32x16_bf16 v[160:175], a[140:143], a[184:187], v[160:175]
ds_read_b64_tr_b16 a[134:135], v16 offset:50176
v_lshlrev_b32 v29, 16, v46
v_mfma_f32_32x32x16_bf16 v[176:191], a[140:143], a[188:191], v[176:191]
ds_read_b64_tr_b16 a[136:137], v17 offset:49152
v_and_b32 v30, v38, v46
v_mfma_f32_32x32x16_bf16 v[192:207], a[144:147], a[184:187], v[192:207]
ds_read_b64_tr_b16 a[138:139], v17 offset:50176
v_add_f32 v23, v23, v29
v_mfma_f32_32x32x16_bf16 v[208:223], a[144:147], a[188:191], v[208:223]
v_add_f32 v24, v24, v30
v_add_u32 v13, 0x2b000, v13
v_mfma_f32_32x32x16_bf16 v[224:239], a[148:151], a[184:187], v[224:239]
v_lshlrev_b32 v31, 16, v47
v_and_b32 v32, v38, v47
v_mfma_f32_32x32x16_bf16 v[240:255], a[148:151], a[188:191], v[240:255]
v_add_f32 v23, v23, v31
v_add_f32 v24, v24, v32
s_waitcnt lgkmcnt(0)
v_mfma_f32_32x32x16_bf16 v[64:79], v[48:51], a[192:195], v[64:79]
ds_read_b64_tr_b16 v[56:57], v18 offset:50176
ds_read_b64_tr_b16 v[58:59], v18 offset:50432
v_mfma_f32_32x32x16_bf16 v[80:95], v[48:51], a[196:199], v[80:95]
ds_read_b64_tr_b16 v[60:61], v18 offset:54272
s_add_u32 m0, s46, 0x2000
v_lshlrev_b32 v29, 16, v40
v_mfma_f32_32x32x16_bf16 v[96:111], v[52:55], a[192:195], v[96:111]
ds_read_b64_tr_b16 v[62:63], v18 offset:54528
v_and_b32 v30, v38, v40
v_add_f32 v23, v23, v29
v_mfma_f32_32x32x16_bf16 v[112:127], v[52:55], a[196:199], v[112:127]
ds_read_b64_tr_b16 v[44:45], v14 offset:53248
v_add_f32 v24, v24, v30
v_lshlrev_b32 v31, 16, v41
v_mfma_f32_32x32x16_bf16 v[128:143], v[40:43], a[192:195], v[128:143]
ds_read_b64_tr_b16 v[46:47], v14 offset:54272
v_and_b32 v32, v38, v41
v_add_f32 v23, v23, v31
v_mfma_f32_16x16x32_bf16 a[0:3], v[48:51], a[8:11], a[0:3]
buffer_load_dwordx4 v10, s[8:11], 0 offen lds
v_add_f32 v24, v24, v32
v_mfma_f32_32x32x16_bf16 v[144:159], v[40:43], a[196:199], v[144:159]
ds_read_b64_tr_b16 a[140:141], v15 offset:53248
v_lshlrev_b32 v29, 16, v42
v_and_b32 v30, v38, v42
v_mfma_f32_16x16x32_bf16 a[4:7], v[52:55], a[8:11], a[4:7]
ds_read_b64_tr_b16 a[142:143], v15 offset:54272
ds_read_b64_tr_b16 a[144:145], v16 offset:53248
v_add_f32 v23, v23, v29
v_mfma_f32_32x32x16_bf16 v[160:175], a[128:131], a[192:195], v[160:175]
buffer_load_dwordx4 v11, s[8:11], s33 offen offset:1024 lds
v_add_f32 v24, v24, v30
v_mfma_f32_32x32x16_bf16 v[176:191], a[128:131], a[196:199], v[176:191]
ds_read_b64_tr_b16 a[146:147], v16 offset:54272
ds_read_b64_tr_b16 a[148:149], v17 offset:53248
v_lshlrev_b32 v31, 16, v43
v_mfma_f32_32x32x16_bf16 v[192:207], a[132:135], a[192:195], v[192:207]
buffer_load_dwordx4 v10, s[8:11], s34 offen offset:2048 lds
v_mfma_f32_32x32x16_bf16 v[208:223], a[132:135], a[196:199], v[208:223]
ds_read_b64_tr_b16 a[150:151], v17 offset:54272
v_and_b32 v32, v38, v43
v_mfma_f32_32x32x16_bf16 v[224:239], a[136:139], a[192:195], v[224:239]
v_add_f32 v23, v23, v31
v_add_f32 v24, v24, v32
v_mfma_f32_32x32x16_bf16 v[240:255], a[136:139], a[196:199], v[240:255]
buffer_load_dwordx4 v11, s[8:11], s35 offen offset:3072 lds
s_waitcnt lgkmcnt(0)
v_mfma_f32_32x32x16_bf16 v[64:79], v[56:59], a[200:203], v[64:79]
ds_read_b64_tr_b16 v[48:49], v18 offset:51200
s_lshl_b32 s82, s3, 19
s_add_u32 m0, s46, 0x3000
ds_read_b64_tr_b16 v[50:51], v18 offset:51456
v_mfma_f32_32x32x16_bf16 v[80:95], v[56:59], a[204:207], v[80:95]
s_add_u32 s82, s82, 0x62000
ds_read_b64_tr_b16 v[52:53], v18 offset:55296
v_lshlrev_b32 v29, 16, v44
v_and_b32 v30, v38, v44
v_mfma_f32_32x32x16_bf16 v[96:111], v[60:63], a[200:203], v[96:111]
s_lshl_b32 s83, s4, 14
ds_read_b64_tr_b16 v[54:55], v18 offset:55552
v_add_f32 v23, v23, v29
v_add_f32 v24, v24, v30
v_mfma_f32_32x32x16_bf16 v[112:127], v[60:63], a[204:207], v[112:127]
buffer_load_dwordx4 v10, s[8:11], s36 offen lds
s_add_u32 s82, s82, s83
v_lshlrev_b32 v31, 16, v45
v_mfma_f32_32x32x16_bf16 v[128:143], v[44:47], a[200:203], v[128:143]
ds_read_b64_tr_b16 v[40:41], v14 offset:57344
s_add_u32 s24, s60, s82
s_addc_u32 s25, s61, 0
v_and_b32 v32, v38, v45
v_mfma_f32_16x16x32_bf16 a[0:3], v[56:59], a[8:11], a[0:3]
ds_read_b64_tr_b16 v[42:43], v14 offset:58368
buffer_load_dwordx4 v11, s[8:11], s37 offen offset:1024 lds
v_add_f32 v23, v23, v31
v_mfma_f32_32x32x16_bf16 v[144:159], v[44:47], a[204:207], v[144:159]
ds_read_b64_tr_b16 a[128:129], v15 offset:57344
s_and_b32 s25, s25, 0xffff
v_add_f32 v24, v24, v32
v_lshlrev_b32 v29, 16, v46
v_mfma_f32_16x16x32_bf16 a[4:7], v[60:63], a[8:11], a[4:7]
ds_read_b64_tr_b16 a[130:131], v15 offset:58368
buffer_load_dwordx4 v10, s[8:11], s38 offen offset:2048 lds
v_and_b32 v30, v38, v46
v_mfma_f32_32x32x16_bf16 v[160:175], a[140:143], a[200:203], v[160:175]
ds_read_b64_tr_b16 a[132:133], v16 offset:57344
s_cmp_eq_u32 s5, 3
s_cselect_b32 s26, 0x2000, 0
v_add_f32 v23, v23, v29
v_mfma_f32_32x32x16_bf16 v[176:191], a[140:143], a[204:207], v[176:191]
ds_read_b64_tr_b16 a[134:135], v16 offset:58368
buffer_load_dwordx4 v11, s[8:11], s39 offen offset:3072 lds
v_add_f32 v24, v24, v30
v_mfma_f32_32x32x16_bf16 v[192:207], a[144:147], a[200:203], v[192:207]
ds_read_b64_tr_b16 a[136:137], v17 offset:57344
s_mov_b32 s27, 0x20000
v_lshlrev_b32 v31, 16, v47
v_mfma_f32_32x32x16_bf16 v[208:223], a[144:147], a[204:207], v[208:223]
ds_read_b64_tr_b16 a[138:139], v17 offset:58368
v_and_b32 v32, v38, v47
v_lshlrev_b32 v4, 7, v1
v_mfma_f32_32x32x16_bf16 v[224:239], a[148:151], a[200:203], v[224:239]
v_add_f32 v23, v23, v31
v_add_u32 v10, 0x80, v10
v_add_f32 v24, v24, v32
v_mfma_f32_32x32x16_bf16 v[240:255], a[148:151], a[204:207], v[240:255]
buffer_load_dword a254, v4, s[24:27], 0 offen
v_add_u32 v11, 0x80, v11
s_waitcnt vmcnt(9)
s_barrier
s_waitcnt lgkmcnt(0)
v_mfma_f32_32x32x16_bf16 v[64:79], v[48:51], a[208:211], v[64:79]
s_add_u32 m0, s47, 0x6000
ds_read_b64_tr_b16 v[56:57], v18 offset:52224
ds_read_b128 a[160:163], v19 offset:0
ds_read_b64_tr_b16 v[58:59], v18 offset:52480
v_mfma_f32_32x32x16_bf16 v[80:95], v[48:51], a[212:215], v[80:95]
buffer_load_dwordx4 v12, s[12:15], s40 offen lds
ds_read_b64_tr_b16 v[60:61], v18 offset:56320
v_lshlrev_b32 v29, 16, v40
v_mfma_f32_32x32x16_bf16 v[96:111], v[52:55], a[208:211], v[96:111]
buffer_load_dwordx4 v12, s[12:15], s41 offen offset:1024 lds
ds_read_b64_tr_b16 v[62:63], v18 offset:56576
v_and_b32 v30, v38, v40
v_mfma_f32_32x32x16_bf16 v[112:127], v[52:55], a[212:215], v[112:127]
buffer_load_dwordx4 v12, s[12:15], s42 offen offset:2048 lds
ds_read_b64_tr_b16 v[44:45], v14 offset:61440
v_add_f32 v23, v23, v29
v_mfma_f32_32x32x16_bf16 v[128:143], v[40:43], a[208:211], v[128:143]
ds_read_b64_tr_b16 v[46:47], v14 offset:62464
buffer_load_dwordx4 v12, s[12:15], s43 offen offset:3072 lds
v_add_f32 v24, v24, v30
v_mfma_f32_16x16x32_bf16 a[0:3], v[48:51], a[8:11], a[0:3]
ds_read_b128 a[164:167], v19 offset:4096
ds_read_b64_tr_b16 a[140:141], v15 offset:61440
s_add_u32 m0, s48, 0x6000
v_lshlrev_b32 v31, 16, v41
v_mfma_f32_32x32x16_bf16 v[144:159], v[40:43], a[212:215], v[144:159]
ds_read_b128 a[168:171], v20 offset:0
ds_read_b64_tr_b16 a[142:143], v15 offset:62464
v_and_b32 v32, v38, v41
v_add_f32 v23, v23, v31
v_mfma_f32_16x16x32_bf16 a[4:7], v[52:55], a[8:11], a[4:7]
ds_read_b128 a[172:175], v20 offset:4096
ds_read_b64_tr_b16 a[144:145], v16 offset:61440
v_add_f32 v24, v24, v32
v_lshlrev_b32 v29, 16, v42
v_mfma_f32_32x32x16_bf16 v[160:175], a[128:131], a[208:211], v[160:175]
buffer_load_dwordx4 v13, s[16:19], s44 offen lds
ds_read_b128 a[176:179], v21 offset:0
v_and_b32 v30, v38, v42
v_mfma_f32_32x32x16_bf16 v[176:191], a[128:131], a[212:215], v[176:191]
ds_read_b64_tr_b16 a[146:147], v16 offset:62464
ds_read_b128 a[180:183], v21 offset:4096
v_add_f32 v23, v23, v29
v_mfma_f32_32x32x16_bf16 v[192:207], a[132:135], a[208:211], v[192:207]
ds_read_b64_tr_b16 a[148:149], v17 offset:61440
s_add_u32 m0, s48, 0x7000
v_add_f32 v24, v24, v30
v_mfma_f32_32x32x16_bf16 v[208:223], a[132:135], a[212:215], v[208:223]
ds_read_b64_tr_b16 a[150:151], v17 offset:62464
ds_read_b128 a[184:187], v22 offset:0
v_lshlrev_b32 v31, 16, v43
v_mfma_f32_32x32x16_bf16 v[224:239], a[136:139], a[208:211], v[224:239]
ds_read_b128 a[188:191], v22 offset:4096
v_and_b32 v32, v38, v43
v_add_f32 v23, v23, v31
v_mfma_f32_32x32x16_bf16 v[240:255], a[136:139], a[212:215], v[240:255]
buffer_load_dwordx4 v13, s[16:19], s45 offen lds
v_add_f32 v24, v24, v32
s_waitcnt lgkmcnt(0)
v_mfma_f32_32x32x16_bf16 v[64:79], v[56:59], a[216:219], v[64:79]
ds_read_b64_tr_b16 v[48:49], v18 offset:0
ds_read_b64_tr_b16 v[50:51], v18 offset:256
v_add_u32 v12, 0x80000, v12
v_mfma_f32_32x32x16_bf16 v[80:95], v[56:59], a[220:223], v[80:95]
ds_read_b64_tr_b16 v[52:53], v18 offset:4096
v_lshlrev_b32 v29, 16, v44
v_and_b32 v30, v38, v44
v_mfma_f32_32x32x16_bf16 v[96:111], v[60:63], a[216:219], v[96:111]
ds_read_b64_tr_b16 v[54:55], v18 offset:4352
v_add_f32 v23, v23, v29
v_mfma_f32_32x32x16_bf16 v[112:127], v[60:63], a[220:223], v[112:127]
ds_read_b64_tr_b16 v[40:41], v14 offset:0
v_add_f32 v24, v24, v30
v_mfma_f32_32x32x16_bf16 v[128:143], v[44:47], a[216:219], v[128:143]
ds_read_b64_tr_b16 v[42:43], v14 offset:1024
v_lshlrev_b32 v31, 16, v45
v_mfma_f32_16x16x32_bf16 a[0:3], v[56:59], a[8:11], a[0:3]
ds_read_b64_tr_b16 a[128:129], v15 offset:0
v_and_b32 v32, v38, v45
v_mfma_f32_32x32x16_bf16 v[144:159], v[44:47], a[220:223], v[144:159]
ds_read_b64_tr_b16 a[130:131], v15 offset:1024
v_add_f32 v23, v23, v31
v_mfma_f32_16x16x32_bf16 a[4:7], v[60:63], a[8:11], a[4:7]
ds_read_b64_tr_b16 a[132:133], v16 offset:0
v_add_f32 v24, v24, v32
v_mfma_f32_32x32x16_bf16 v[160:175], a[140:143], a[216:219], v[160:175]
ds_read_b64_tr_b16 a[134:135], v16 offset:1024
v_lshlrev_b32 v29, 16, v46
v_mfma_f32_32x32x16_bf16 v[176:191], a[140:143], a[220:223], v[176:191]
ds_read_b64_tr_b16 a[136:137], v17 offset:0
v_and_b32 v30, v38, v46
v_mfma_f32_32x32x16_bf16 v[192:207], a[144:147], a[216:219], v[192:207]
ds_read_b64_tr_b16 a[138:139], v17 offset:1024
v_add_f32 v23, v23, v29
v_mfma_f32_32x32x16_bf16 v[208:223], a[144:147], a[220:223], v[208:223]
v_add_f32 v24, v24, v30
v_add_u32 v13, 0x2b000, v13
v_mfma_f32_32x32x16_bf16 v[224:239], a[148:151], a[216:219], v[224:239]
v_lshlrev_b32 v31, 16, v47
v_and_b32 v32, v38, v47
v_mfma_f32_32x32x16_bf16 v[240:255], a[148:151], a[220:223], v[240:255]
v_add_f32 v23, v23, v31
v_add_f32 v24, v24, v32
s_lshl_b32 s82, s3, 19
s_add_u32 s82, s82, 0x60000
s_add_u32 s20, s58, s82
s_addc_u32 s21, s59, 0
s_and_b32 s21, s21, 0xffff
s_mov_b32 s22, 0x20000
s_mov_b32 s23, 0x20000
s_add_u32 s24, s60, s82
s_addc_u32 s25, s61, 0
s_and_b32 s25, s25, 0xffff
s_mov_b32 s26, 0x20000
s_mov_b32 s27, 0x20000
s_lshl_b32 s90, s5, 11
s_mov_b32 s88, 0
s_mov_b32 s89, 0
v_lshrrev_b32 v36, 4, v1
v_and_b32 v37, 15, v1
s_lshl_b32 s82, s5, 3
s_and_b32 s82, s82, 15
v_add_u32 v2, s82, v36
v_xor_b32 v3, v37, v2
v_lshlrev_b32 v4, 8, v36
v_lshl_add_u32 v33, v3, 4, v4
v_add_u32 v2, 4, v2
v_xor_b32 v3, v37, v2
v_lshl_add_u32 v34, v3, 4, v4
v_lshlrev_b32 v2, 2, v36
v_xor_b32 v3, v37, v2
v_lshl_add_u32 v35, v3, 4, v4
s_lshl_b32 s82, s5, 11
v_add_u32 v33, s82, v33
v_add_u32 v34, s82, v34
v_add_u32 v35, s82, v35
s_waitcnt lgkmcnt(0)
v_mfma_f32_32x32x16_bf16 v[64:79], v[48:51], a[160:163], v[64:79]
ds_read_b64_tr_b16 v[56:57], v18 offset:1024
ds_read_b64_tr_b16 v[58:59], v18 offset:1280
v_mfma_f32_32x32x16_bf16 v[80:95], v[48:51], a[164:167], v[80:95]
ds_read_b64_tr_b16 v[60:61], v18 offset:5120
v_lshlrev_b32 v29, 16, v40
v_mfma_f32_32x32x16_bf16 v[96:111], v[52:55], a[160:163], v[96:111]
ds_read_b64_tr_b16 v[62:63], v18 offset:5376
v_and_b32 v30, v38, v40
v_mfma_f32_32x32x16_bf16 v[112:127], v[52:55], a[164:167], v[112:127]
ds_read_b64_tr_b16 v[44:45], v14 offset:4096
v_add_f32 v23, v23, v29
v_mfma_f32_32x32x16_bf16 v[128:143], v[40:43], a[160:163], v[128:143]
ds_read_b64_tr_b16 v[46:47], v14 offset:5120
v_add_f32 v24, v24, v30
v_mfma_f32_16x16x32_bf16 a[0:3], v[48:51], a[8:11], a[0:3]
ds_read_b64_tr_b16 a[140:141], v15 offset:4096
v_lshlrev_b32 v31, 16, v41
v_mfma_f32_32x32x16_bf16 v[144:159], v[40:43], a[164:167], v[144:159]
ds_read_b64_tr_b16 a[142:143], v15 offset:5120
v_and_b32 v32, v38, v41
v_mfma_f32_16x16x32_bf16 a[4:7], v[52:55], a[8:11], a[4:7]
ds_read_b64_tr_b16 a[144:145], v16 offset:4096
v_add_f32 v23, v23, v31
v_mfma_f32_32x32x16_bf16 v[160:175], a[128:131], a[160:163], v[160:175]
ds_read_b64_tr_b16 a[146:147], v16 offset:5120
v_add_f32 v24, v24, v32
v_mfma_f32_32x32x16_bf16 v[176:191], a[128:131], a[164:167], v[176:191]
ds_read_b64_tr_b16 a[148:149], v17 offset:4096
v_lshlrev_b32 v29, 16, v42
v_mfma_f32_32x32x16_bf16 v[192:207], a[132:135], a[160:163], v[192:207]
ds_read_b64_tr_b16 a[150:151], v17 offset:5120
v_and_b32 v30, v38, v42
v_mfma_f32_32x32x16_bf16 v[208:223], a[132:135], a[164:167], v[208:223]
v_add_f32 v23, v23, v29
v_add_f32 v24, v24, v30
v_mfma_f32_32x32x16_bf16 v[224:239], a[136:139], a[160:163], v[224:239]
v_lshlrev_b32 v31, 16, v43
v_and_b32 v32, v38, v43
v_mfma_f32_32x32x16_bf16 v[240:255], a[136:139], a[164:167], v[240:255]
v_add_f32 v23, v23, v31
v_add_f32 v24, v24, v32
s_waitcnt lgkmcnt(0)
v_mfma_f32_32x32x16_bf16 v[64:79], v[56:59], a[168:171], v[64:79]
ds_read_b64_tr_b16 v[48:49], v18 offset:2048
ds_read_b64_tr_b16 v[50:51], v18 offset:2304
v_mfma_f32_32x32x16_bf16 v[80:95], v[56:59], a[172:175], v[80:95]
ds_read_b64_tr_b16 v[52:53], v18 offset:6144
v_lshlrev_b32 v29, 16, v44
v_mfma_f32_32x32x16_bf16 v[96:111], v[60:63], a[168:171], v[96:111]
ds_read_b64_tr_b16 v[54:55], v18 offset:6400
v_and_b32 v30, v38, v44
v_mfma_f32_32x32x16_bf16 v[112:127], v[60:63], a[172:175], v[112:127]
ds_read_b64_tr_b16 v[40:41], v14 offset:8192
v_add_f32 v23, v23, v29
v_mfma_f32_32x32x16_bf16 v[128:143], v[44:47], a[168:171], v[128:143]
ds_read_b64_tr_b16 v[42:43], v14 offset:9216
v_add_f32 v24, v24, v30
v_mfma_f32_16x16x32_bf16 a[0:3], v[56:59], a[8:11], a[0:3]
ds_read_b64_tr_b16 a[128:129], v15 offset:8192
v_lshlrev_b32 v31, 16, v45
v_mfma_f32_32x32x16_bf16 v[144:159], v[44:47], a[172:175], v[144:159]
ds_read_b64_tr_b16 a[130:131], v15 offset:9216
v_and_b32 v32, v38, v45
v_mfma_f32_16x16x32_bf16 a[4:7], v[60:63], a[8:11], a[4:7]
ds_read_b64_tr_b16 a[132:133], v16 offset:8192
v_add_f32 v23, v23, v31
v_mfma_f32_32x32x16_bf16 v[160:175], a[140:143], a[168:171], v[160:175]
ds_read_b64_tr_b16 a[134:135], v16 offset:9216
v_add_f32 v24, v24, v32
v_mfma_f32_32x32x16_bf16 v[176:191], a[140:143], a[172:175], v[176:191]
ds_read_b64_tr_b16 a[136:137], v17 offset:8192
v_lshlrev_b32 v29, 16, v46
v_mfma_f32_32x32x16_bf16 v[192:207], a[144:147], a[168:171], v[192:207]
ds_read_b64_tr_b16 a[138:139], v17 offset:9216
v_and_b32 v30, v38, v46
v_mfma_f32_32x32x16_bf16 v[208:223], a[144:147], a[172:175], v[208:223]
v_add_f32 v23, v23, v29
v_add_f32 v24, v24, v30
v_mfma_f32_32x32x16_bf16 v[224:239], a[148:151], a[168:171], v[224:239]
v_lshlrev_b32 v31, 16, v47
v_and_b32 v32, v38, v47
v_mfma_f32_32x32x16_bf16 v[240:255], a[148:151], a[172:175], v[240:255]
v_add_f32 v23, v23, v31
v_add_f32 v24, v24, v32
s_waitcnt vmcnt(0)
s_barrier
s_waitcnt lgkmcnt(0)
v_mfma_f32_32x32x16_bf16 v[64:79], v[48:51], a[176:179], v[64:79]
ds_read_b64_tr_b16 v[56:57], v18 offset:3072
s_add_u32 m0, s90, 0x1c000
ds_read_b128 a[192:195], v19 offset:8192
ds_read_b64_tr_b16 v[58:59], v18 offset:3328
v_mfma_f32_32x32x16_bf16 v[80:95], v[48:51], a[180:183], v[80:95]
ds_read_b64_tr_b16 v[60:61], v18 offset:7168
buffer_load_dwordx4 v33, s[20:23], s88 offen lds
v_lshlrev_b32 v29, 16, v40
v_mfma_f32_32x32x16_bf16 v[96:111], v[52:55], a[176:179], v[96:111]
ds_read_b64_tr_b16 v[62:63], v18 offset:7424
buffer_load_dwordx4 v34, s[20:23], s88 offen offset:1024 lds
v_and_b32 v30, v38, v40
v_mfma_f32_32x32x16_bf16 v[112:127], v[52:55], a[180:183], v[112:127]
ds_read_b64_tr_b16 v[44:45], v14 offset:12288
ds_read_b128 a[196:199], v19 offset:12288
s_add_u32 s88, s88, 0x2000
v_add_f32 v23, v23, v29
v_mfma_f32_32x32x16_bf16 v[128:143], v[40:43], a[176:179], v[128:143]
ds_read_b64_tr_b16 v[46:47], v14 offset:13312
ds_read_b128 a[200:203], v20 offset:8192
s_add_u32 m0, s90, 0x22000
v_add_f32 v24, v24, v30
v_mfma_f32_16x16x32_bf16 a[0:3], v[48:51], a[8:11], a[0:3]
ds_read_b64_tr_b16 a[140:141], v15 offset:12288
ds_read_b128 a[204:207], v20 offset:12288
v_lshlrev_b32 v31, 16, v41
v_and_b32 v32, v38, v41
v_mfma_f32_32x32x16_bf16 v[144:159], v[40:43], a[180:183], v[144:159]
ds_read_b64_tr_b16 a[142:143], v15 offset:13312
ds_read_b128 a[208:211], v21 offset:8192
v_add_f32 v23, v23, v31
v_mfma_f32_16x16x32_bf16 a[4:7], v[52:55], a[8:11], a[4:7]
ds_read_b64_tr_b16 a[144:145], v16 offset:12288
ds_read_b128 a[212:215], v21 offset:12288
v_add_f32 v24, v24, v32
v_mfma_f32_32x32x16_bf16 v[160:175], a[128:131], a[176:179], v[160:175]
buffer_load_dwordx4 v35, s[24:27], s89 offen lds
v_lshlrev_b32 v29, 16, v42
v_mfma_f32_32x32x16_bf16 v[176:191], a[128:131], a[180:183], v[176:191]
ds_read_b64_tr_b16 a[146:147], v16 offset:13312
ds_read_b128 a[216:219], v22 offset:8192
v_and_b32 v30, v38, v42
v_mfma_f32_32x32x16_bf16 v[192:207], a[132:135], a[176:179], v[192:207]
ds_read_b64_tr_b16 a[148:149], v17 offset:12288
ds_read_b128 a[220:223], v22 offset:12288
v_add_f32 v23, v23, v29
v_mfma_f32_32x32x16_bf16 v[208:223], a[132:135], a[180:183], v[208:223]
ds_read_b64_tr_b16 a[150:151], v17 offset:13312
v_add_f32 v24, v24, v30
v_lshlrev_b32 v31, 16, v43
v_mfma_f32_32x32x16_bf16 v[224:239], a[136:139], a[176:179], v[224:239]
buffer_load_dwordx4 v35, s[24:27], s89 offen offset:1024 lds
v_and_b32 v32, v38, v43
v_mfma_f32_32x32x16_bf16 v[240:255], a[136:139], a[180:183], v[240:255]
s_add_u32 s89, s89, 0x2000
v_add_f32 v23, v23, v31
v_add_f32 v24, v24, v32
s_waitcnt lgkmcnt(0)
v_mfma_f32_32x32x16_bf16 v[64:79], v[56:59], a[184:187], v[64:79]
ds_read_b64_tr_b16 v[48:49], v18 offset:24576
s_add_u32 m0, s90, 0x1e000
ds_read_b64_tr_b16 v[50:51], v18 offset:24832
v_mfma_f32_32x32x16_bf16 v[80:95], v[56:59], a[188:191], v[80:95]
ds_read_b64_tr_b16 v[52:53], v18 offset:28672
v_lshlrev_b32 v29, 16, v44
v_and_b32 v30, v38, v44
v_mfma_f32_32x32x16_bf16 v[96:111], v[60:63], a[184:187], v[96:111]
buffer_load_dwordx4 v33, s[20:23], s88 offen lds
v_add_f32 v23, v23, v29
v_mfma_f32_32x32x16_bf16 v[112:127], v[60:63], a[188:191], v[112:127]
ds_read_b64_tr_b16 v[54:55], v18 offset:28928
v_add_f32 v24, v24, v30
v_lshlrev_b32 v31, 16, v45
v_mfma_f32_32x32x16_bf16 v[128:143], v[44:47], a[184:187], v[128:143]
ds_read_b64_tr_b16 v[40:41], v14 offset:24576
v_and_b32 v32, v38, v45
v_add_f32 v23, v23, v31
v_mfma_f32_16x16x32_bf16 a[0:3], v[56:59], a[8:11], a[0:3]
ds_read_b64_tr_b16 v[42:43], v14 offset:25600
v_add_f32 v24, v24, v32
v_lshlrev_b32 v29, 16, v46
v_mfma_f32_32x32x16_bf16 v[144:159], v[44:47], a[188:191], v[144:159]
buffer_load_dwordx4 v34, s[20:23], s88 offen offset:1024 lds
ds_read_b64_tr_b16 a[128:129], v15 offset:24576
v_mfma_f32_16x16x32_bf16 a[4:7], v[60:63], a[8:11], a[4:7]
ds_read_b64_tr_b16 a[130:131], v15 offset:25600
s_add_u32 s88, s88, 0x2000
v_and_b32 v30, v38, v46
v_mfma_f32_32x32x16_bf16 v[160:175], a[140:143], a[184:187], v[160:175]
ds_read_b64_tr_b16 a[132:133], v16 offset:24576
s_add_u32 m0, s90, 0x20000
v_add_f32 v23, v23, v29
v_mfma_f32_32x32x16_bf16 v[176:191], a[140:143], a[188:191], v[176:191]
ds_read_b64_tr_b16 a[134:135], v16 offset:25600
v_add_f32 v24, v24, v30
v_lshlrev_b32 v31, 16, v47
v_mfma_f32_32x32x16_bf16 v[192:207], a[144:147], a[184:187], v[192:207]
buffer_load_dwordx4 v33, s[20:23], s88 offen lds
ds_read_b64_tr_b16 a[136:137], v17 offset:24576
v_mfma_f32_32x32x16_bf16 v[208:223], a[144:147], a[188:191], v[208:223]
ds_read_b64_tr_b16 a[138:139], v17 offset:25600
v_and_b32 v32, v38, v47
v_add_f32 v23, v23, v31
v_mfma_f32_32x32x16_bf16 v[224:239], a[148:151], a[184:187], v[224:239]
buffer_load_dwordx4 v34, s[20:23], s88 offen offset:1024 lds
v_mfma_f32_32x32x16_bf16 v[240:255], a[148:151], a[188:191], v[240:255]
s_add_u32 s88, s88, 0x2000
v_add_f32 v24, v24, v32
s_waitcnt lgkmcnt(0)
v_mfma_f32_32x32x16_bf16 v[64:79], v[48:51], a[192:195], v[64:79]
ds_read_b64_tr_b16 v[56:57], v18 offset:25600
s_add_u32 m0, s90, 0x24000
ds_read_b64_tr_b16 v[58:59], v18 offset:25856
v_mfma_f32_32x32x16_bf16 v[80:95], v[48:51], a[196:199], v[80:95]
ds_read_b64_tr_b16 v[60:61], v18 offset:29696
v_lshlrev_b32 v29, 16, v40
v_and_b32 v30, v38, v40
v_mfma_f32_32x32x16_bf16 v[96:111], v[52:55], a[192:195], v[96:111]
buffer_load_dwordx4 v35, s[24:27], s89 offen lds
v_add_f32 v23, v23, v29
v_mfma_f32_32x32x16_bf16 v[112:127], v[52:55], a[196:199], v[112:127]
ds_read_b64_tr_b16 v[62:63], v18 offset:29952
v_add_f32 v24, v24, v30
v_lshlrev_b32 v31, 16, v41
v_mfma_f32_32x32x16_bf16 v[128:143], v[40:43], a[192:195], v[128:143]
ds_read_b64_tr_b16 v[44:45], v14 offset:28672
v_and_b32 v32, v38, v41
v_add_f32 v23, v23, v31
v_mfma_f32_16x16x32_bf16 a[0:3], v[48:51], a[8:11], a[0:3]
ds_read_b64_tr_b16 v[46:47], v14 offset:29696
v_add_f32 v24, v24, v32
v_lshlrev_b32 v29, 16, v42
v_mfma_f32_32x32x16_bf16 v[144:159], v[40:43], a[196:199], v[144:159]
buffer_load_dwordx4 v35, s[24:27], s89 offen offset:1024 lds
ds_read_b64_tr_b16 a[140:141], v15 offset:28672
v_mfma_f32_16x16x32_bf16 a[4:7], v[52:55], a[8:11], a[4:7]
ds_read_b64_tr_b16 a[142:143], v15 offset:29696
s_add_u32 s89, s89, 0x2000
v_and_b32 v30, v38, v42
v_mfma_f32_32x32x16_bf16 v[160:175], a[128:131], a[192:195], v[160:175]
ds_read_b64_tr_b16 a[144:145], v16 offset:28672
v_add_f32 v23, v23, v29
v_and_b32 v39, 31, v1
v_mfma_f32_32x32x16_bf16 v[176:191], a[128:131], a[196:199], v[176:191]
ds_read_b64_tr_b16 a[146:147], v16 offset:29696
v_add_f32 v24, v24, v30
v_lshlrev_b32 v39, 4, v39
v_mfma_f32_32x32x16_bf16 v[192:207], a[132:135], a[192:195], v[192:207]
ds_read_b64_tr_b16 a[148:149], v17 offset:28672
v_lshlrev_b32 v31, 16, v43
v_and_b32 v32, v38, v43
v_mfma_f32_32x32x16_bf16 v[208:223], a[132:135], a[196:199], v[208:223]
ds_read_b64_tr_b16 a[150:151], v17 offset:29696
buffer_load_dwordx4 a[224:227], v39, s[28:31], s7 offen sc0 sc1
v_mfma_f32_32x32x16_bf16 v[224:239], a[136:139], a[192:195], v[224:239]
v_add_f32 v23, v23, v31
v_add_f32 v24, v24, v32
v_mfma_f32_32x32x16_bf16 v[240:255], a[136:139], a[196:199], v[240:255]
buffer_load_dwordx4 a[228:231], v39, s[28:31], s7 offen offset:512 sc0 sc1
s_waitcnt lgkmcnt(0)
v_mfma_f32_32x32x16_bf16 v[64:79], v[56:59], a[200:203], v[64:79]
ds_read_b64_tr_b16 v[48:49], v18 offset:26624
ds_read_b64_tr_b16 v[50:51], v18 offset:26880
v_and_b32 v36, 31, v1
v_lshrrev_b32 v37, 5, v1
v_and_b32 v4, 15, v1
v_mfma_f32_32x32x16_bf16 v[80:95], v[56:59], a[204:207], v[80:95]
ds_read_b64_tr_b16 v[52:53], v18 offset:30720
v_xor_b32 v4, v4, v37
v_lshlrev_b32 v36, 8, v36
v_lshlrev_b32 v29, 16, v44
v_add_u32 v36, 0x1c000, v36
v_mfma_f32_32x32x16_bf16 v[96:111], v[60:63], a[200:203], v[96:111]
s_lshl_b32 s85, s5, 2
s_add_u32 s84, s85, 0
ds_read_b64_tr_b16 v[54:55], v18 offset:30976
s_and_b32 s84, s84, 15
v_and_b32 v30, v38, v44
v_mfma_f32_32x32x16_bf16 v[112:127], v[60:63], a[204:207], v[112:127]
ds_read_b64_tr_b16 v[40:41], v14 offset:32768
v_xor_b32 v5, s84, v4
v_lshl_add_u32 v5, v5, 4, v36
v_add_f32 v23, v23, v29
v_accvgpr_write_b32 a12, v5
v_mfma_f32_32x32x16_bf16 v[128:143], v[44:47], a[200:203], v[128:143]
s_add_u32 s84, s85, 2
s_and_b32 s84, s84, 15
ds_read_b64_tr_b16 v[42:43], v14 offset:33792
v_add_f32 v24, v24, v30
v_xor_b32 v5, s84, v4
v_mfma_f32_16x16x32_bf16 a[0:3], v[56:59], a[8:11], a[0:3]
ds_read_b64_tr_b16 a[128:129], v15 offset:32768
v_lshl_add_u32 v5, v5, 4, v36
v_lshlrev_b32 v31, 16, v45
v_accvgpr_write_b32 a13, v5
v_and_b32 v32, v38, v45
v_mfma_f32_32x32x16_bf16 v[144:159], v[44:47], a[204:207], v[144:159]
s_add_u32 s84, s85, 4
s_and_b32 s84, s84, 15
ds_read_b64_tr_b16 a[130:131], v15 offset:33792
v_add_f32 v23, v23, v31
v_add_f32 v24, v24, v32
v_mfma_f32_16x16x32_bf16 a[4:7], v[60:63], a[8:11], a[4:7]
ds_read_b64_tr_b16 a[132:133], v16 offset:32768
v_xor_b32 v5, s84, v4
v_lshl_add_u32 v5, v5, 4, v36
v_lshlrev_b32 v29, 16, v46
v_accvgpr_write_b32 a14, v5
v_mfma_f32_32x32x16_bf16 v[160:175], a[140:143], a[200:203], v[160:175]
s_add_u32 s84, s85, 6
s_and_b32 s84, s84, 15
ds_read_b64_tr_b16 a[134:135], v16 offset:33792
v_and_b32 v30, v38, v46
v_mfma_f32_32x32x16_bf16 v[176:191], a[140:143], a[204:207], v[176:191]
ds_read_b64_tr_b16 a[136:137], v17 offset:32768
v_xor_b32 v5, s84, v4
v_lshl_add_u32 v5, v5, 4, v36
v_add_f32 v23, v23, v29
v_mfma_f32_32x32x16_bf16 v[192:207], a[144:147], a[200:203], v[192:207]
ds_read_b64_tr_b16 a[138:139], v17 offset:33792
v_accvgpr_write_b32 a15, v5
v_add_f32 v24, v24, v30
s_add_u32 s84, s85, 8
v_mfma_f32_32x32x16_bf16 v[208:223], a[144:147], a[204:207], v[208:223]
s_and_b32 s84, s84, 15
v_xor_b32 v5, s84, v4
v_lshlrev_b32 v31, 16, v47
v_and_b32 v32, v38, v47
v_mfma_f32_32x32x16_bf16 v[224:239], a[148:151], a[200:203], v[224:239]
v_lshl_add_u32 v5, v5, 4, v36
v_accvgpr_write_b32 a16, v5
v_add_f32 v23, v23, v31
s_add_u32 s84, s85, 10
v_mfma_f32_32x32x16_bf16 v[240:255], a[148:151], a[204:207], v[240:255]
s_and_b32 s84, s84, 15
v_add_f32 v24, v24, v32
v_xor_b32 v5, s84, v4
v_lshl_add_u32 v5, v5, 4, v36
s_waitcnt lgkmcnt(0)
v_mfma_f32_32x32x16_bf16 v[64:79], v[48:51], a[208:211], v[64:79]
ds_read_b64_tr_b16 v[56:57], v18 offset:27648
ds_read_b64_tr_b16 v[58:59], v18 offset:27904
v_accvgpr_write_b32 a17, v5
s_add_u32 s84, s85, 12
s_and_b32 s84, s84, 15
v_mfma_f32_32x32x16_bf16 v[80:95], v[48:51], a[212:215], v[80:95]
ds_read_b64_tr_b16 v[60:61], v18 offset:31744
v_xor_b32 v5, s84, v4
v_lshl_add_u32 v5, v5, 4, v36
v_lshlrev_b32 v29, 16, v40
v_accvgpr_write_b32 a18, v5
v_mfma_f32_32x32x16_bf16 v[96:111], v[52:55], a[208:211], v[96:111]
s_add_u32 s84, s85, 14
s_and_b32 s84, s84, 15
ds_read_b64_tr_b16 v[62:63], v18 offset:32000
v_and_b32 v30, v38, v40
v_xor_b32 v5, s84, v4
v_mfma_f32_32x32x16_bf16 v[112:127], v[52:55], a[212:215], v[112:127]
ds_read_b64_tr_b16 v[44:45], v14 offset:36864
v_lshl_add_u32 v5, v5, 4, v36
v_accvgpr_write_b32 a19, v5
v_add_f32 v23, v23, v29
v_lshrrev_b32 v36, 5, v1
v_mfma_f32_32x32x16_bf16 v[128:143], v[40:43], a[208:211], v[128:143]
ds_read_b64_tr_b16 v[46:47], v14 offset:37888
v_bfe_u32 v37, v1, 4, 1
v_add_f32 v24, v24, v30
v_bfe_u32 v4, v1, 2, 2
v_and_b32 v5, 3, v1
v_mfma_f32_16x16x32_bf16 a[0:3], v[48:51], a[8:11], a[0:3]
ds_read_b64_tr_b16 a[140:141], v15 offset:36864
v_and_b32 v6, 1, v5
v_lshlrev_b32 v31, 16, v41
v_lshl_add_u32 v6, v37, 1, v6
v_and_b32 v32, v38, v41
v_mfma_f32_32x32x16_bf16 v[144:159], v[40:43], a[212:215], v[144:159]
ds_read_b64_tr_b16 a[142:143], v15 offset:37888
v_lshrrev_b32 v7, 1, v5
v_add_f32 v23, v23, v31
v_lshlrev_b32 v7, 3, v7
v_add_f32 v24, v24, v32
v_mfma_f32_16x16x32_bf16 a[4:7], v[52:55], a[8:11], a[4:7]
ds_read_b64_tr_b16 a[144:145], v16 offset:36864
v_lshl_add_u32 v8, v36, 2, v4
v_lshlrev_b32 v8, 8, v8
v_lshlrev_b32 v29, 16, v42
v_add_u32 v8, v8, v7
v_mfma_f32_32x32x16_bf16 v[160:175], a[128:131], a[208:211], v[160:175]
ds_read_b64_tr_b16 a[146:147], v16 offset:37888
v_lshl_add_u32 v8, v6, 4, v8
v_and_b32 v30, v38, v42
v_add_u32 v8, 0x22000, v8
v_mfma_f32_32x32x16_bf16 v[176:191], a[128:131], a[212:215], v[176:191]
ds_read_b64_tr_b16 a[148:149], v17 offset:36864
v_xor_b32 v9, 0, v4
v_lshl_add_u32 v9, v9, 6, v8
v_add_f32 v23, v23, v29
v_mfma_f32_32x32x16_bf16 v[192:207], a[132:135], a[208:211], v[192:207]
ds_read_b64_tr_b16 a[150:151], v17 offset:37888
v_accvgpr_write_b32 a20, v9
v_add_f32 v24, v24, v30
v_xor_b32 v9, 1, v4
v_mfma_f32_32x32x16_bf16 v[208:223], a[132:135], a[212:215], v[208:223]
v_lshl_add_u32 v9, v9, 6, v8
v_accvgpr_write_b32 a21, v9
v_lshlrev_b32 v31, 16, v43
v_and_b32 v32, v38, v43
v_mfma_f32_32x32x16_bf16 v[224:239], a[136:139], a[208:211], v[224:239]
v_xor_b32 v9, 2, v4
v_lshl_add_u32 v9, v9, 6, v8
v_add_f32 v23, v23, v31
v_accvgpr_write_b32 a22, v9
v_mfma_f32_32x32x16_bf16 v[240:255], a[136:139], a[212:215], v[240:255]
v_xor_b32 v9, 3, v4
v_add_f32 v24, v24, v32
v_lshl_add_u32 v9, v9, 6, v8
v_accvgpr_write_b32 a23, v9
s_waitcnt lgkmcnt(0)
v_mfma_f32_32x32x16_bf16 v[64:79], v[56:59], a[216:219], v[64:79]
v_mfma_f32_32x32x16_bf16 v[80:95], v[56:59], a[220:223], v[80:95]
v_lshlrev_b32 v29, 16, v44
v_and_b32 v30, v38, v44
v_mfma_f32_32x32x16_bf16 v[96:111], v[60:63], a[216:219], v[96:111]
v_add_f32 v23, v23, v29
v_add_f32 v24, v24, v30
v_mfma_f32_32x32x16_bf16 v[112:127], v[60:63], a[220:223], v[112:127]
v_lshlrev_b32 v31, 16, v45
v_and_b32 v32, v38, v45
v_mfma_f32_32x32x16_bf16 v[128:143], v[44:47], a[216:219], v[128:143]
v_add_f32 v23, v23, v31
v_mfma_f32_16x16x32_bf16 a[0:3], v[56:59], a[8:11], a[0:3]
v_add_f32 v24, v24, v32
v_mfma_f32_32x32x16_bf16 v[144:159], v[44:47], a[220:223], v[144:159]
v_lshlrev_b32 v29, 16, v46
v_mfma_f32_16x16x32_bf16 a[4:7], v[60:63], a[8:11], a[4:7]
v_and_b32 v30, v38, v46
v_mfma_f32_32x32x16_bf16 v[160:175], a[140:143], a[216:219], v[160:175]
v_add_f32 v23, v23, v29
v_mfma_f32_32x32x16_bf16 v[176:191], a[140:143], a[220:223], v[176:191]
v_add_f32 v24, v24, v30
v_mfma_f32_32x32x16_bf16 v[192:207], a[144:147], a[216:219], v[192:207]
v_lshlrev_b32 v31, 16, v47
v_mfma_f32_32x32x16_bf16 v[208:223], a[144:147], a[220:223], v[208:223]
v_and_b32 v32, v38, v47
v_mfma_f32_32x32x16_bf16 v[224:239], a[148:151], a[216:219], v[224:239]
v_add_f32 v23, v23, v31
v_mfma_f32_32x32x16_bf16 v[240:255], a[148:151], a[220:223], v[240:255]
v_add_f32 v24, v24, v32
s_lshl_b32 s82, s5, 14
s_add_u32 s82, s82, 0x400
v_and_b32 v7, 15, v1
v_lshlrev_b32 v7, 6, v7
v_lshrrev_b32 v8, 4, v1
v_lshl_add_u32 v7, v8, 4, v7
v_add_u32 v7, s82, v7
ds_write_b128 v7, a[0:3]
ds_write_b128 v7, a[4:7] offset:1024
v_and_b32 v8, 31, v1
v_lshlrev_b32 v8, 2, v8
v_add_u32 v8, s82, v8
s_waitcnt lgkmcnt(0)
ds_read_b32 v25, v8
ds_read_b32 v27, v8 offset:1024
v_add_f32 v23, v23, v24
v_mov_b32 v4, v23
v_and_b32 v3, 31, v1
v_lshlrev_b32 v3, 2, v3
v_permlane32_swap_b32 v23, v4
v_add_f32 v23, v23, v4
s_lshl_b32 s82, s5, 14
v_add_u32 v4, s82, v3
ds_write_b32 v4, v23
v_accvgpr_read_b32 v10, a12
v_accvgpr_read_b32 v11, a13
v_accvgpr_read_b32 v12, a14
v_accvgpr_read_b32 v13, a15
v_accvgpr_read_b32 v14, a16
v_accvgpr_read_b32 v15, a17
v_accvgpr_read_b32 v16, a18
v_accvgpr_read_b32 v17, a19
v_accvgpr_read_b32 v18, a20
v_accvgpr_read_b32 v19, a21
v_accvgpr_read_b32 v20, a22
v_accvgpr_read_b32 v21, a23
s_waitcnt lgkmcnt(0)
s_barrier
v_and_b32 v3, 31, v1
v_lshlrev_b32 v3, 2, v3
s_add_u32 s82, s5, 1
s_and_b32 s82, s82, 3
s_lshl_b32 s82, s82, 14
v_add_u32 v4, s82, v3
ds_read_b32 v31, v4
s_add_u32 s82, s5, 2
s_and_b32 s82, s82, 3
s_lshl_b32 s82, s82, 14
v_add_u32 v4, s82, v3
ds_read_b32 v32, v4
s_add_u32 s82, s5, 3
s_and_b32 s82, s82, 3
s_lshl_b32 s82, s82, 14
v_add_u32 v4, s82, v3
ds_read_b32 v29, v4
s_waitcnt vmcnt(0)
v_accvgpr_read_b32 v56, a224
v_accvgpr_read_b32 v57, a225
v_accvgpr_read_b32 v58, a226
v_accvgpr_read_b32 v60, a228
v_accvgpr_read_b32 v61, a229
v_accvgpr_read_b32 v62, a230
v_xor_b32 v6, s32, v58
v_xor_b32 v7, s32, v62
v_or_b32 v6, v6, v7
v_cmp_eq_u32 vcc, 0, v6
s_cmp_eq_u64 vcc, exec
s_cbranch_scc1 L_xst_8
s_mov_b32 s91, 0
L_poll_9:
buffer_load_dwordx4 v[56:59], v39, s[28:31], s7 offen sc0 sc1
buffer_load_dwordx4 v[60:63], v39, s[28:31], s7 offen offset:512 sc0 sc1
s_waitcnt vmcnt(1)
v_xor_b32 v6, s32, v58
s_waitcnt vmcnt(0)
v_xor_b32 v62, s32, v62
v_or_b32 v6, v6, v62
v_cmp_eq_u32 vcc, 0, v6
s_cmp_eq_u64 vcc, exec
s_cbranch_scc1 L_polld_10
s_add_u32 s91, s91, 1
s_cmp_lt_u32 s91, 0x4e20
s_cbranch_scc0 L_polld_10_to
s_sleep 2
s_branch L_poll_9
L_polld_10_to:
s_or_b32 s67, s67, 2
L_polld_10:
L_xst_8:
v_cmp_gt_u32 vcc, 32, v1
s_nop 1
v_cndmask_b32 v6, 0, 1.0, vcc
v_sub_f32 v7, 0, v56
v_cvt_pk_bf16_f32 v8, v7, v7
v_lshlrev_b32 v9, 16, v8
v_sub_f32 v9, v7, v9
v_cvt_pk_bf16_f32 v40, v7, v9
v_cvt_pk_bf16_f32 v41, v7, 0
v_mov_b32 v42, 0
v_mov_b32 v43, 0
v_sub_f32 v7, 0, v60
v_cvt_pk_bf16_f32 v8, v7, v7
v_lshlrev_b32 v9, 16, v8
v_sub_f32 v9, v7, v9
v_cvt_pk_bf16_f32 v44, v7, v9
v_cvt_pk_bf16_f32 v45, v7, 0
v_mov_b32 v46, 0
v_mov_b32 v47, 0
v_mov_b32 v50, 0
v_mov_b32 v51, 0
v_mov_b32 v54, 0
v_mov_b32 v55, 0
v_mul_f32 v7, v23, v6
v_cvt_pk_bf16_f32 v48, v7, v7
v_lshlrev_b32 v8, 16, v48
v_sub_f32 v8, v7, v8
v_cvt_pk_bf16_f32 v49, v8, 0
v_mul_f32 v2, 0x3e0293ee, v57
v_mul_f32 v4, 0x3e0293ee, v61
s_waitcnt lgkmcnt(2)
v_mul_f32 v7, v31, v6
v_cvt_pk_bf16_f32 v52, v7, v7
v_lshlrev_b32 v8, 16, v52
v_sub_f32 v8, v7, v8
v_cvt_pk_bf16_f32 v53, v8, 0
v_mfma_f32_32x32x16_bf16 v[128:143], v[48:51], v[40:43], v[128:143]
v_mfma_f32_32x32x16_bf16 v[144:159], v[48:51], v[44:47], v[144:159]
s_waitcnt lgkmcnt(1)
v_mul_f32 v7, v32, v6
v_cvt_pk_bf16_f32 v48, v7, v7
v_lshlrev_b32 v8, 16, v48
v_sub_f32 v8, v7, v8
v_cvt_pk_bf16_f32 v49, v8, 0
v_mfma_f32_32x32x16_bf16 v[160:175], v[52:55], v[40:43], v[160:175]
v_mfma_f32_32x32x16_bf16 v[176:191], v[52:55], v[44:47], v[176:191]
s_waitcnt lgkmcnt(0)
v_mul_f32 v7, v29, v6
v_cvt_pk_bf16_f32 v52, v7, v7
v_lshlrev_b32 v8, 16, v52
v_sub_f32 v8, v7, v8
v_cvt_pk_bf16_f32 v53, v8, 0
v_mfma_f32_32x32x16_bf16 v[192:207], v[48:51], v[40:43], v[192:207]
v_mfma_f32_32x32x16_bf16 v[208:223], v[48:51], v[44:47], v[208:223]
v_mul_f32 v7, v25, v6
v_cvt_pk_bf16_f32 v48, v7, v7
v_lshlrev_b32 v8, 16, v48
v_sub_f32 v8, v7, v8
v_cvt_pk_bf16_f32 v49, v8, 0
v_mfma_f32_32x32x16_bf16 v[224:239], v[52:55], v[40:43], v[224:239]
v_mfma_f32_32x32x16_bf16 v[240:255], v[52:55], v[44:47], v[240:255]
v_mul_f32 v7, v27, v6
v_cvt_pk_bf16_f32 v52, v7, v7
v_lshlrev_b32 v8, 16, v52
v_sub_f32 v8, v7, v8
v_cvt_pk_bf16_f32 v53, v8, 0
v_mfma_f32_32x32x16_bf16 v[64:79], v[48:51], v[40:43], v[64:79]
v_mfma_f32_32x32x16_bf16 v[80:95], v[48:51], v[44:47], v[80:95]
v_mfma_f32_32x32x16_bf16 v[96:111], v[52:55], v[40:43], v[96:111]
v_mfma_f32_32x32x16_bf16 v[112:127], v[52:55], v[44:47], v[112:127]
v_pk_mul_f32 v[128:129], v[128:129], v[2:3] op_sel_hi:[1,0]
v_pk_mul_f32 v[130:131], v[130:131], v[2:3] op_sel_hi:[1,0]
v_pk_mul_f32 v[132:133], v[132:133], v[2:3] op_sel_hi:[1,0]
v_pk_mul_f32 v[134:135], v[134:135], v[2:3] op_sel_hi:[1,0]
v_pk_mul_f32 v[136:137], v[136:137], v[2:3] op_sel_hi:[1,0]
v_pk_mul_f32 v[138:139], v[138:139], v[2:3] op_sel_hi:[1,0]
v_pk_mul_f32 v[140:141], v[140:141], v[2:3] op_sel_hi:[1,0]
v_pk_mul_f32 v[142:143], v[142:143], v[2:3] op_sel_hi:[1,0]
v_cvt_pk_bf16_f32 v128, v128, v129
v_cvt_pk_bf16_f32 v129, v130, v131
v_cvt_pk_bf16_f32 v130, v132, v133
v_cvt_pk_bf16_f32 v131, v134, v135
v_cvt_pk_bf16_f32 v132, v136, v137
v_cvt_pk_bf16_f32 v133, v138, v139
v_cvt_pk_bf16_f32 v134, v140, v141
v_cvt_pk_bf16_f32 v135, v142, v143
v_pk_mul_f32 v[144:145], v[144:145], v[4:5] op_sel_hi:[1,0]
v_pk_mul_f32 v[146:147], v[146:147], v[4:5] op_sel_hi:[1,0]
v_pk_mul_f32 v[148:149], v[148:149], v[4:5] op_sel_hi:[1,0]
v_pk_mul_f32 v[150:151], v[150:151], v[4:5] op_sel_hi:[1,0]
v_pk_mul_f32 v[152:153], v[152:153], v[4:5] op_sel_hi:[1,0]
v_pk_mul_f32 v[154:155], v[154:155], v[4:5] op_sel_hi:[1,0]
v_pk_mul_f32 v[156:157], v[156:157], v[4:5] op_sel_hi:[1,0]
v_pk_mul_f32 v[158:159], v[158:159], v[4:5] op_sel_hi:[1,0]
v_cvt_pk_bf16_f32 v136, v144, v145
v_cvt_pk_bf16_f32 v137, v146, v147
v_cvt_pk_bf16_f32 v138, v148, v149
v_cvt_pk_bf16_f32 v139, v150, v151
v_cvt_pk_bf16_f32 v140, v152, v153
v_cvt_pk_bf16_f32 v141, v154, v155
v_cvt_pk_bf16_f32 v142, v156, v157
v_cvt_pk_bf16_f32 v143, v158, v159
v_pk_mul_f32 v[160:161], v[160:161], v[2:3] op_sel_hi:[1,0]
v_pk_mul_f32 v[162:163], v[162:163], v[2:3] op_sel_hi:[1,0]
v_pk_mul_f32 v[164:165], v[164:165], v[2:3] op_sel_hi:[1,0]
v_pk_mul_f32 v[166:167], v[166:167], v[2:3] op_sel_hi:[1,0]
v_pk_mul_f32 v[168:169], v[168:169], v[2:3] op_sel_hi:[1,0]
v_pk_mul_f32 v[170:171], v[170:171], v[2:3] op_sel_hi:[1,0]
v_pk_mul_f32 v[172:173], v[172:173], v[2:3] op_sel_hi:[1,0]
v_pk_mul_f32 v[174:175], v[174:175], v[2:3] op_sel_hi:[1,0]
v_cvt_pk_bf16_f32 v144, v160, v161
v_cvt_pk_bf16_f32 v145, v162, v163
v_cvt_pk_bf16_f32 v146, v164, v165
v_cvt_pk_bf16_f32 v147, v166, v167
v_cvt_pk_bf16_f32 v148, v168, v169
v_cvt_pk_bf16_f32 v149, v170, v171
v_cvt_pk_bf16_f32 v150, v172, v173
v_cvt_pk_bf16_f32 v151, v174, v175
v_pk_mul_f32 v[176:177], v[176:177], v[4:5] op_sel_hi:[1,0]
v_pk_mul_f32 v[178:179], v[178:179], v[4:5] op_sel_hi:[1,0]
v_pk_mul_f32 v[180:181], v[180:181], v[4:5] op_sel_hi:[1,0]
v_pk_mul_f32 v[182:183], v[182:183], v[4:5] op_sel_hi:[1,0]
v_pk_mul_f32 v[184:185], v[184:185], v[4:5] op_sel_hi:[1,0]
v_pk_mul_f32 v[186:187], v[186:187], v[4:5] op_sel_hi:[1,0]
v_pk_mul_f32 v[188:189], v[188:189], v[4:5] op_sel_hi:[1,0]
v_pk_mul_f32 v[190:191], v[190:191], v[4:5] op_sel_hi:[1,0]
v_cvt_pk_bf16_f32 v152, v176, v177
v_cvt_pk_bf16_f32 v153, v178, v179
v_cvt_pk_bf16_f32 v154, v180, v181
v_cvt_pk_bf16_f32 v155, v182, v183
v_cvt_pk_bf16_f32 v156, v184, v185
v_cvt_pk_bf16_f32 v157, v186, v187
v_cvt_pk_bf16_f32 v158, v188, v189
v_cvt_pk_bf16_f32 v159, v190, v191
v_pk_mul_f32 v[192:193], v[192:193], v[2:3] op_sel_hi:[1,0]
v_pk_mul_f32 v[194:195], v[194:195], v[2:3] op_sel_hi:[1,0]
v_pk_mul_f32 v[196:197], v[196:197], v[2:3] op_sel_hi:[1,0]
v_pk_mul_f32 v[198:199], v[198:199], v[2:3] op_sel_hi:[1,0]
v_pk_mul_f32 v[200:201], v[200:201], v[2:3] op_sel_hi:[1,0]
v_pk_mul_f32 v[202:203], v[202:203], v[2:3] op_sel_hi:[1,0]
v_pk_mul_f32 v[204:205], v[204:205], v[2:3] op_sel_hi:[1,0]
v_pk_mul_f32 v[206:207], v[206:207], v[2:3] op_sel_hi:[1,0]
v_cvt_pk_bf16_f32 v160, v192, v193
v_cvt_pk_bf16_f32 v161, v194, v195
v_cvt_pk_bf16_f32 v162, v196, v197
v_cvt_pk_bf16_f32 v163, v198, v199
v_cvt_pk_bf16_f32 v164, v200, v201
v_cvt_pk_bf16_f32 v165, v202, v203
v_cvt_pk_bf16_f32 v166, v204, v205
v_cvt_pk_bf16_f32 v167, v206, v207
v_pk_mul_f32 v[208:209], v[208:209], v[4:5] op_sel_hi:[1,0]
v_pk_mul_f32 v[210:211], v[210:211], v[4:5] op_sel_hi:[1,0]
v_pk_mul_f32 v[212:213], v[212:213], v[4:5] op_sel_hi:[1,0]
v_pk_mul_f32 v[214:215], v[214:215], v[4:5] op_sel_hi:[1,0]
v_pk_mul_f32 v[216:217], v[216:217], v[4:5] op_sel_hi:[1,0]
v_pk_mul_f32 v[218:219], v[218:219], v[4:5] op_sel_hi:[1,0]
v_pk_mul_f32 v[220:221], v[220:221], v[4:5] op_sel_hi:[1,0]
v_pk_mul_f32 v[222:223], v[222:223], v[4:5] op_sel_hi:[1,0]
v_cvt_pk_bf16_f32 v168, v208, v209
v_cvt_pk_bf16_f32 v169, v210, v211
v_cvt_pk_bf16_f32 v170, v212, v213
v_cvt_pk_bf16_f32 v171, v214, v215
v_cvt_pk_bf16_f32 v172, v216, v217
v_cvt_pk_bf16_f32 v173, v218, v219
v_cvt_pk_bf16_f32 v174, v220, v221
v_cvt_pk_bf16_f32 v175, v222, v223
v_pk_mul_f32 v[224:225], v[224:225], v[2:3] op_sel_hi:[1,0]
v_pk_mul_f32 v[226:227], v[226:227], v[2:3] op_sel_hi:[1,0]
v_pk_mul_f32 v[228:229], v[228:229], v[2:3] op_sel_hi:[1,0]
v_pk_mul_f32 v[230:231], v[230:231], v[2:3] op_sel_hi:[1,0]
v_pk_mul_f32 v[232:233], v[232:233], v[2:3] op_sel_hi:[1,0]
v_pk_mul_f32 v[234:235], v[234:235], v[2:3] op_sel_hi:[1,0]
v_pk_mul_f32 v[236:237], v[236:237], v[2:3] op_sel_hi:[1,0]
v_pk_mul_f32 v[238:239], v[238:239], v[2:3] op_sel_hi:[1,0]
v_cvt_pk_bf16_f32 v176, v224, v225
v_cvt_pk_bf16_f32 v177, v226, v227
v_cvt_pk_bf16_f32 v178, v228, v229
v_cvt_pk_bf16_f32 v179, v230, v231
v_cvt_pk_bf16_f32 v180, v232, v233
v_cvt_pk_bf16_f32 v181, v234, v235
v_cvt_pk_bf16_f32 v182, v236, v237
v_cvt_pk_bf16_f32 v183, v238, v239
v_pk_mul_f32 v[240:241], v[240:241], v[4:5] op_sel_hi:[1,0]
v_pk_mul_f32 v[242:243], v[242:243], v[4:5] op_sel_hi:[1,0]
v_pk_mul_f32 v[244:245], v[244:245], v[4:5] op_sel_hi:[1,0]
v_pk_mul_f32 v[246:247], v[246:247], v[4:5] op_sel_hi:[1,0]
v_pk_mul_f32 v[248:249], v[248:249], v[4:5] op_sel_hi:[1,0]
v_pk_mul_f32 v[250:251], v[250:251], v[4:5] op_sel_hi:[1,0]
v_pk_mul_f32 v[252:253], v[252:253], v[4:5] op_sel_hi:[1,0]
v_pk_mul_f32 v[254:255], v[254:255], v[4:5] op_sel_hi:[1,0]
v_cvt_pk_bf16_f32 v184, v240, v241
v_cvt_pk_bf16_f32 v185, v242, v243
v_cvt_pk_bf16_f32 v186, v244, v245
v_cvt_pk_bf16_f32 v187, v246, v247
v_cvt_pk_bf16_f32 v188, v248, v249
v_cvt_pk_bf16_f32 v189, v250, v251
v_cvt_pk_bf16_f32 v190, v252, v253
v_cvt_pk_bf16_f32 v191, v254, v255
s_mov_b32 s98, 0x3dd2d3e8
s_mov_b32 s100, 1.0
v_mov_b32 v46, 0x40135761
v_mov_b32 v44, v57
v_pk_mul_f32 v[96:97], v[96:97], v[44:45] op_sel_hi:[1,0]
v_pk_mul_f32 v[98:99], v[98:99], v[44:45] op_sel_hi:[1,0]
v_pk_mul_f32 v[100:101], v[100:101], v[44:45] op_sel_hi:[1,0]
v_pk_mul_f32 v[102:103], v[102:103], v[44:45] op_sel_hi:[1,0]
v_pk_mul_f32 v[48:49], v[96:97], v[96:97]
v_pk_mul_f32 v[50:51], v[98:99], v[98:99]
v_pk_mul_f32 v[52:53], v[100:101], v[100:101]
v_pk_mul_f32 v[54:55], v[102:103], v[102:103]
v_pk_fma_f32 v[48:49], v[48:49], s[98:99], v[46:47] op_sel_hi:[1,0,0]
v_pk_fma_f32 v[50:51], v[50:51], s[98:99], v[46:47] op_sel_hi:[1,0,0]
v_pk_fma_f32 v[52:53], v[52:53], s[98:99], v[46:47] op_sel_hi:[1,0,0]
v_pk_fma_f32 v[54:55], v[54:55], s[98:99], v[46:47] op_sel_hi:[1,0,0]
v_pk_mul_f32 v[48:49], v[48:49], v[96:97]
v_pk_mul_f32 v[50:51], v[50:51], v[98:99]
v_pk_mul_f32 v[52:53], v[52:53], v[100:101]
v_pk_mul_f32 v[54:55], v[54:55], v[102:103]
v_exp_f32 v48, -v48
v_exp_f32 v49, -v49
v_exp_f32 v50, -v50
v_exp_f32 v51, -v51
v_exp_f32 v52, -v52
v_exp_f32 v53, -v53
v_exp_f32 v54, -v54
v_exp_f32 v55, -v55
v_pk_add_f32 v[48:49], v[48:49], s[100:101] op_sel_hi:[1,0]
v_pk_add_f32 v[50:51], v[50:51], s[100:101] op_sel_hi:[1,0]
v_pk_add_f32 v[52:53], v[52:53], s[100:101] op_sel_hi:[1,0]
v_pk_add_f32 v[54:55], v[54:55], s[100:101] op_sel_hi:[1,0]
v_rcp_f32 v48, v48
v_rcp_f32 v49, v49
v_rcp_f32 v50, v50
v_rcp_f32 v51, v51
v_rcp_f32 v52, v52
v_rcp_f32 v53, v53
v_rcp_f32 v54, v54
v_rcp_f32 v55, v55
v_pk_mul_f32 v[96:97], v[96:97], v[48:49]
v_pk_mul_f32 v[98:99], v[98:99], v[50:51]
v_pk_mul_f32 v[100:101], v[100:101], v[52:53]
v_pk_mul_f32 v[102:103], v[102:103], v[54:55]
v_pk_mul_f32 v[104:105], v[104:105], v[44:45] op_sel_hi:[1,0]
v_pk_mul_f32 v[106:107], v[106:107], v[44:45] op_sel_hi:[1,0]
v_pk_mul_f32 v[108:109], v[108:109], v[44:45] op_sel_hi:[1,0]
v_pk_mul_f32 v[110:111], v[110:111], v[44:45] op_sel_hi:[1,0]
v_pk_mul_f32 v[48:49], v[104:105], v[104:105]
v_pk_mul_f32 v[50:51], v[106:107], v[106:107]
v_pk_mul_f32 v[52:53], v[108:109], v[108:109]
v_pk_mul_f32 v[54:55], v[110:111], v[110:111]
v_pk_fma_f32 v[48:49], v[48:49], s[98:99], v[46:47] op_sel_hi:[1,0,0]
v_pk_fma_f32 v[50:51], v[50:51], s[98:99], v[46:47] op_sel_hi:[1,0,0]
v_pk_fma_f32 v[52:53], v[52:53], s[98:99], v[46:47] op_sel_hi:[1,0,0]
v_pk_fma_f32 v[54:55], v[54:55], s[98:99], v[46:47] op_sel_hi:[1,0,0]
v_pk_mul_f32 v[48:49], v[48:49], v[104:105]
v_pk_mul_f32 v[50:51], v[50:51], v[106:107]
v_pk_mul_f32 v[52:53], v[52:53], v[108:109]
v_pk_mul_f32 v[54:55], v[54:55], v[110:111]
v_exp_f32 v48, -v48
v_exp_f32 v49, -v49
v_exp_f32 v50, -v50
v_exp_f32 v51, -v51
v_exp_f32 v52, -v52
v_exp_f32 v53, -v53
v_exp_f32 v54, -v54
v_exp_f32 v55, -v55
v_pk_add_f32 v[48:49], v[48:49], s[100:101] op_sel_hi:[1,0]
v_pk_add_f32 v[50:51], v[50:51], s[100:101] op_sel_hi:[1,0]
v_pk_add_f32 v[52:53], v[52:53], s[100:101] op_sel_hi:[1,0]
v_pk_add_f32 v[54:55], v[54:55], s[100:101] op_sel_hi:[1,0]
v_rcp_f32 v48, v48
v_rcp_f32 v49, v49
v_rcp_f32 v50, v50
v_rcp_f32 v51, v51
v_rcp_f32 v52, v52
v_rcp_f32 v53, v53
v_rcp_f32 v54, v54
v_rcp_f32 v55, v55
v_pk_mul_f32 v[104:105], v[104:105], v[48:49]
v_pk_mul_f32 v[106:107], v[106:107], v[50:51]
v_pk_mul_f32 v[108:109], v[108:109], v[52:53]
v_pk_mul_f32 v[110:111], v[110:111], v[54:55]
v_mov_b32 v44, v61
v_pk_mul_f32 v[112:113], v[112:113], v[44:45] op_sel_hi:[1,0]
v_pk_mul_f32 v[114:115], v[114:115], v[44:45] op_sel_hi:[1,0]
v_pk_mul_f32 v[116:117], v[116:117], v[44:45] op_sel_hi:[1,0]
v_pk_mul_f32 v[118:119], v[118:119], v[44:45] op_sel_hi:[1,0]
v_pk_mul_f32 v[48:49], v[112:113], v[112:113]
v_pk_mul_f32 v[50:51], v[114:115], v[114:115]
v_pk_mul_f32 v[52:53], v[116:117], v[116:117]
v_pk_mul_f32 v[54:55], v[118:119], v[118:119]
v_pk_fma_f32 v[48:49], v[48:49], s[98:99], v[46:47] op_sel_hi:[1,0,0]
v_pk_fma_f32 v[50:51], v[50:51], s[98:99], v[46:47] op_sel_hi:[1,0,0]
v_pk_fma_f32 v[52:53], v[52:53], s[98:99], v[46:47] op_sel_hi:[1,0,0]
v_pk_fma_f32 v[54:55], v[54:55], s[98:99], v[46:47] op_sel_hi:[1,0,0]
v_pk_mul_f32 v[48:49], v[48:49], v[112:113]
v_pk_mul_f32 v[50:51], v[50:51], v[114:115]
v_pk_mul_f32 v[52:53], v[52:53], v[116:117]
v_pk_mul_f32 v[54:55], v[54:55], v[118:119]
v_exp_f32 v48, -v48
v_exp_f32 v49, -v49
v_exp_f32 v50, -v50
v_exp_f32 v51, -v51
v_exp_f32 v52, -v52
v_exp_f32 v53, -v53
v_exp_f32 v54, -v54
v_exp_f32 v55, -v55
v_pk_add_f32 v[48:49], v[48:49], s[100:101] op_sel_hi:[1,0]
v_pk_add_f32 v[50:51], v[50:51], s[100:101] op_sel_hi:[1,0]
v_pk_add_f32 v[52:53], v[52:53], s[100:101] op_sel_hi:[1,0]
v_pk_add_f32 v[54:55], v[54:55], s[100:101] op_sel_hi:[1,0]
v_rcp_f32 v48, v48
v_rcp_f32 v49, v49
v_rcp_f32 v50, v50
v_rcp_f32 v51, v51
v_rcp_f32 v52, v52
v_rcp_f32 v53, v53
v_rcp_f32 v54, v54
v_rcp_f32 v55, v55
v_pk_mul_f32 v[112:113], v[112:113], v[48:49]
v_pk_mul_f32 v[114:115], v[114:115], v[50:51]
v_pk_mul_f32 v[116:117], v[116:117], v[52:53]
v_pk_mul_f32 v[118:119], v[118:119], v[54:55]
v_pk_mul_f32 v[120:121], v[120:121], v[44:45] op_sel_hi:[1,0]
v_pk_mul_f32 v[122:123], v[122:123], v[44:45] op_sel_hi:[1,0]
v_pk_mul_f32 v[124:125], v[124:125], v[44:45] op_sel_hi:[1,0]
v_pk_mul_f32 v[126:127], v[126:127], v[44:45] op_sel_hi:[1,0]
v_pk_mul_f32 v[48:49], v[120:121], v[120:121]
v_pk_mul_f32 v[50:51], v[122:123], v[122:123]
v_pk_mul_f32 v[52:53], v[124:125], v[124:125]
v_pk_mul_f32 v[54:55], v[126:127], v[126:127]
v_pk_fma_f32 v[48:49], v[48:49], s[98:99], v[46:47] op_sel_hi:[1,0,0]
v_pk_fma_f32 v[50:51], v[50:51], s[98:99], v[46:47] op_sel_hi:[1,0,0]
v_pk_fma_f32 v[52:53], v[52:53], s[98:99], v[46:47] op_sel_hi:[1,0,0]
v_pk_fma_f32 v[54:55], v[54:55], s[98:99], v[46:47] op_sel_hi:[1,0,0]
v_pk_mul_f32 v[48:49], v[48:49], v[120:121]
v_pk_mul_f32 v[50:51], v[50:51], v[122:123]
v_pk_mul_f32 v[52:53], v[52:53], v[124:125]
v_pk_mul_f32 v[54:55], v[54:55], v[126:127]
v_exp_f32 v48, -v48
v_exp_f32 v49, -v49
v_exp_f32 v50, -v50
v_exp_f32 v51, -v51
v_exp_f32 v52, -v52
v_exp_f32 v53, -v53
v_exp_f32 v54, -v54
v_exp_f32 v55, -v55
v_pk_add_f32 v[48:49], v[48:49], s[100:101] op_sel_hi:[1,0]
v_pk_add_f32 v[50:51], v[50:51], s[100:101] op_sel_hi:[1,0]
v_pk_add_f32 v[52:53], v[52:53], s[100:101] op_sel_hi:[1,0]
v_pk_add_f32 v[54:55], v[54:55], s[100:101] op_sel_hi:[1,0]
v_rcp_f32 v48, v48
v_rcp_f32 v49, v49
v_rcp_f32 v50, v50
v_rcp_f32 v51, v51
v_rcp_f32 v52, v52
v_rcp_f32 v53, v53
v_rcp_f32 v54, v54
v_rcp_f32 v55, v55
v_pk_mul_f32 v[120:121], v[120:121], v[48:49]
v_pk_mul_f32 v[122:123], v[122:123], v[50:51]
v_pk_mul_f32 v[124:125], v[124:125], v[52:53]
v_pk_mul_f32 v[126:127], v[126:127], v[54:55]
s_sub_u32 s84, s96, 22
s_cmp_eq_u32 s84, 21
s_cselect_b32 s85, 0, 1.0
v_pk_add_f32 v[44:45], v[96:97], v[98:99]
v_pk_mul_f32 v[48:49], v[96:97], v[96:97]
v_pk_add_f32 v[44:45], v[44:45], v[100:101]
v_pk_fma_f32 v[48:49], v[98:99], v[98:99], v[48:49]
v_pk_add_f32 v[44:45], v[44:45], v[102:103]
v_pk_fma_f32 v[48:49], v[100:101], v[100:101], v[48:49]
v_pk_fma_f32 v[48:49], v[102:103], v[102:103], v[48:49]
v_pk_add_f32 v[46:47], v[104:105], v[106:107]
v_pk_mul_f32 v[50:51], v[104:105], v[104:105]
v_pk_add_f32 v[46:47], v[46:47], v[108:109]
v_pk_fma_f32 v[50:51], v[106:107], v[106:107], v[50:51]
v_pk_add_f32 v[46:47], v[46:47], v[110:111]
v_pk_fma_f32 v[50:51], v[108:109], v[108:109], v[50:51]
v_pk_fma_f32 v[50:51], v[110:111], v[110:111], v[50:51]
v_add_f32 v2, v44, v45
v_add_f32 v3, v46, v47
v_add_f32 v4, v48, v49
v_add_f32 v5, v50, v51
v_fma_f32 v2, v3, s85, v2
v_fma_f32 v4, v5, s85, v4
v_mov_b32 v3, v2
v_mov_b32 v5, v4
s_nop 0
v_permlane32_swap_b32 v2, v3
v_permlane32_swap_b32 v4, v5
v_add_f32 v40, v2, v3
v_add_f32 v41, v4, v5
s_mul_i32 s82, s4, 22
s_add_u32 s82, s82, s84
s_lshl_b32 s82, s82, 8
s_lshl_b32 s83, s5, 6
s_add_u32 s82, s82, s83
s_add_u32 s82, s82, 0
s_lshl_b32 s82, s82, 3
s_add_u32 s82, s82, 0x1400000
v_and_b32 v6, 31, v1
v_lshlrev_b32 v6, 3, v6
buffer_store_dwordx2 v[40:41], v6, s[28:31], s82 offen sc0 sc1
v_cvt_pk_bf16_f32 v240, v96, v97
v_cvt_pk_bf16_f32 v241, v98, v99
v_cvt_pk_bf16_f32 v242, v100, v101
v_cvt_pk_bf16_f32 v243, v102, v103
v_cvt_pk_bf16_f32 v244, v104, v105
v_cvt_pk_bf16_f32 v245, v106, v107
v_cvt_pk_bf16_f32 v246, v108, v109
v_cvt_pk_bf16_f32 v247, v110, v111
v_pk_add_f32 v[44:45], v[112:113], v[114:115]
v_pk_mul_f32 v[48:49], v[112:113], v[112:113]
v_pk_add_f32 v[44:45], v[44:45], v[116:117]
v_pk_fma_f32 v[48:49], v[114:115], v[114:115], v[48:49]
v_pk_add_f32 v[44:45], v[44:45], v[118:119]
v_pk_fma_f32 v[48:49], v[116:117], v[116:117], v[48:49]
v_pk_fma_f32 v[48:49], v[118:119], v[118:119], v[48:49]
v_pk_add_f32 v[46:47], v[120:121], v[122:123]
v_pk_mul_f32 v[50:51], v[120:121], v[120:121]
v_pk_add_f32 v[46:47], v[46:47], v[124:125]
v_pk_fma_f32 v[50:51], v[122:123], v[122:123], v[50:51]
v_pk_add_f32 v[46:47], v[46:47], v[126:127]
v_pk_fma_f32 v[50:51], v[124:125], v[124:125], v[50:51]
v_pk_fma_f32 v[50:51], v[126:127], v[126:127], v[50:51]
v_add_f32 v2, v44, v45
v_add_f32 v3, v46, v47
v_add_f32 v4, v48, v49
v_add_f32 v5, v50, v51
v_fma_f32 v2, v3, s85, v2
v_fma_f32 v4, v5, s85, v4
v_mov_b32 v3, v2
v_mov_b32 v5, v4
s_nop 0
v_permlane32_swap_b32 v2, v3
v_permlane32_swap_b32 v4, v5
v_add_f32 v42, v2, v3
v_add_f32 v43, v4, v5
s_mul_i32 s82, s4, 22
s_add_u32 s82, s82, s84
s_lshl_b32 s82, s82, 8
s_lshl_b32 s83, s5, 6
s_add_u32 s82, s82, s83
s_add_u32 s82, s82, 32
s_lshl_b32 s82, s82, 3
s_add_u32 s82, s82, 0x1400000
v_and_b32 v6, 31, v1
v_lshlrev_b32 v6, 3, v6
buffer_store_dwordx2 v[42:43], v6, s[28:31], s82 offen sc0 sc1
v_cvt_pk_bf16_f32 v248, v112, v113
v_cvt_pk_bf16_f32 v249, v114, v115
v_cvt_pk_bf16_f32 v250, v116, v117
v_cvt_pk_bf16_f32 v251, v118, v119
v_cvt_pk_bf16_f32 v252, v120, v121
v_cvt_pk_bf16_f32 v253, v122, v123
v_cvt_pk_bf16_f32 v254, v124, v125
v_cvt_pk_bf16_f32 v255, v126, v127
s_barrier
ds_read_b128 a[192:195], v10
ds_read_b128 a[196:199], v11
ds_read_b128 a[200:203], v12
ds_read_b128 a[204:207], v13
ds_read_b128 a[208:211], v14
ds_read_b128 a[212:215], v15
ds_read_b128 a[216:219], v16
ds_read_b128 a[220:223], v17
s_mov_b32 s98, 0x3dd2d3e8
s_mov_b32 s100, 1.0
v_mov_b32 v46, 0x40135761
v_mov_b32 v44, v57
v_pk_mul_f32 v[64:65], v[64:65], v[44:45] op_sel_hi:[1,0]
v_pk_mul_f32 v[66:67], v[66:67], v[44:45] op_sel_hi:[1,0]
v_pk_mul_f32 v[68:69], v[68:69], v[44:45] op_sel_hi:[1,0]
v_pk_mul_f32 v[70:71], v[70:71], v[44:45] op_sel_hi:[1,0]
v_pk_mul_f32 v[48:49], v[64:65], v[64:65]
v_pk_mul_f32 v[50:51], v[66:67], v[66:67]
v_pk_mul_f32 v[52:53], v[68:69], v[68:69]
v_pk_mul_f32 v[54:55], v[70:71], v[70:71]
v_pk_fma_f32 v[48:49], v[48:49], s[98:99], v[46:47] op_sel_hi:[1,0,0]
v_pk_fma_f32 v[50:51], v[50:51], s[98:99], v[46:47] op_sel_hi:[1,0,0]
v_pk_fma_f32 v[52:53], v[52:53], s[98:99], v[46:47] op_sel_hi:[1,0,0]
v_pk_fma_f32 v[54:55], v[54:55], s[98:99], v[46:47] op_sel_hi:[1,0,0]
v_pk_mul_f32 v[48:49], v[48:49], v[64:65]
v_pk_mul_f32 v[50:51], v[50:51], v[66:67]
v_pk_mul_f32 v[52:53], v[52:53], v[68:69]
v_pk_mul_f32 v[54:55], v[54:55], v[70:71]
s_waitcnt lgkmcnt(7)
v_mfma_f32_32x32x16_bf16 v[192:207], a[192:195], v[128:131], 0
v_exp_f32 v48, -v48
v_exp_f32 v49, -v49
v_exp_f32 v50, -v50
v_exp_f32 v51, -v51
s_waitcnt lgkmcnt(6)
v_mfma_f32_32x32x16_bf16 v[192:207], a[196:199], v[132:135], v[192:207]
v_exp_f32 v52, -v52
v_exp_f32 v53, -v53
v_exp_f32 v54, -v54
v_exp_f32 v55, -v55
v_pk_add_f32 v[48:49], v[48:49], s[100:101] op_sel_hi:[1,0]
v_pk_add_f32 v[50:51], v[50:51], s[100:101] op_sel_hi:[1,0]
v_pk_add_f32 v[52:53], v[52:53], s[100:101] op_sel_hi:[1,0]
v_pk_add_f32 v[54:55], v[54:55], s[100:101] op_sel_hi:[1,0]
s_waitcnt lgkmcnt(5)
v_mfma_f32_32x32x16_bf16 v[192:207], a[200:203], v[144:147], v[192:207]
v_rcp_f32 v48, v48
v_rcp_f32 v49, v49
v_rcp_f32 v50, v50
v_rcp_f32 v51, v51
s_waitcnt lgkmcnt(4)
v_mfma_f32_32x32x16_bf16 v[192:207], a[204:207], v[148:151], v[192:207]
v_rcp_f32 v52, v52
v_rcp_f32 v53, v53
v_rcp_f32 v54, v54
v_rcp_f32 v55, v55
v_pk_mul_f32 v[64:65], v[64:65], v[48:49]
v_pk_mul_f32 v[66:67], v[66:67], v[50:51]
v_pk_mul_f32 v[68:69], v[68:69], v[52:53]
v_pk_mul_f32 v[70:71], v[70:71], v[54:55]
v_pk_mul_f32 v[72:73], v[72:73], v[44:45] op_sel_hi:[1,0]
v_pk_mul_f32 v[74:75], v[74:75], v[44:45] op_sel_hi:[1,0]
v_pk_mul_f32 v[76:77], v[76:77], v[44:45] op_sel_hi:[1,0]
v_pk_mul_f32 v[78:79], v[78:79], v[44:45] op_sel_hi:[1,0]
v_pk_mul_f32 v[48:49], v[72:73], v[72:73]
v_pk_mul_f32 v[50:51], v[74:75], v[74:75]
v_pk_mul_f32 v[52:53], v[76:77], v[76:77]
v_pk_mul_f32 v[54:55], v[78:79], v[78:79]
v_pk_fma_f32 v[48:49], v[48:49], s[98:99], v[46:47] op_sel_hi:[1,0,0]
v_pk_fma_f32 v[50:51], v[50:51], s[98:99], v[46:47] op_sel_hi:[1,0,0]
v_pk_fma_f32 v[52:53], v[52:53], s[98:99], v[46:47] op_sel_hi:[1,0,0]
v_pk_fma_f32 v[54:55], v[54:55], s[98:99], v[46:47] op_sel_hi:[1,0,0]
v_pk_mul_f32 v[48:49], v[48:49], v[72:73]
v_pk_mul_f32 v[50:51], v[50:51], v[74:75]
v_pk_mul_f32 v[52:53], v[52:53], v[76:77]
v_pk_mul_f32 v[54:55], v[54:55], v[78:79]
s_waitcnt lgkmcnt(3)
v_mfma_f32_32x32x16_bf16 v[192:207], a[208:211], v[160:163], v[192:207]
v_exp_f32 v48, -v48
v_exp_f32 v49, -v49
v_exp_f32 v50, -v50
v_exp_f32 v51, -v51
s_waitcnt lgkmcnt(2)
v_mfma_f32_32x32x16_bf16 v[192:207], a[212:215], v[164:167], v[192:207]
v_exp_f32 v52, -v52
v_exp_f32 v53, -v53
v_exp_f32 v54, -v54
v_exp_f32 v55, -v55
v_pk_add_f32 v[48:49], v[48:49], s[100:101] op_sel_hi:[1,0]
v_pk_add_f32 v[50:51], v[50:51], s[100:101] op_sel_hi:[1,0]
v_pk_add_f32 v[52:53], v[52:53], s[100:101] op_sel_hi:[1,0]
v_pk_add_f32 v[54:55], v[54:55], s[100:101] op_sel_hi:[1,0]
s_waitcnt lgkmcnt(1)
v_mfma_f32_32x32x16_bf16 v[192:207], a[216:219], v[176:179], v[192:207]
v_rcp_f32 v48, v48
v_rcp_f32 v49, v49
v_rcp_f32 v50, v50
v_rcp_f32 v51, v51
s_waitcnt lgkmcnt(0)
v_mfma_f32_32x32x16_bf16 v[192:207], a[220:223], v[180:183], v[192:207]
v_rcp_f32 v52, v52
v_rcp_f32 v53, v53
v_rcp_f32 v54, v54
v_rcp_f32 v55, v55
v_pk_mul_f32 v[72:73], v[72:73], v[48:49]
v_pk_mul_f32 v[74:75], v[74:75], v[50:51]
v_pk_mul_f32 v[76:77], v[76:77], v[52:53]
v_pk_mul_f32 v[78:79], v[78:79], v[54:55]
v_mov_b32 v44, v61
v_pk_mul_f32 v[80:81], v[80:81], v[44:45] op_sel_hi:[1,0]
v_pk_mul_f32 v[82:83], v[82:83], v[44:45] op_sel_hi:[1,0]
v_pk_mul_f32 v[84:85], v[84:85], v[44:45] op_sel_hi:[1,0]
v_pk_mul_f32 v[86:87], v[86:87], v[44:45] op_sel_hi:[1,0]
v_pk_mul_f32 v[48:49], v[80:81], v[80:81]
v_pk_mul_f32 v[50:51], v[82:83], v[82:83]
v_pk_mul_f32 v[52:53], v[84:85], v[84:85]
v_pk_mul_f32 v[54:55], v[86:87], v[86:87]
v_pk_fma_f32 v[48:49], v[48:49], s[98:99], v[46:47] op_sel_hi:[1,0,0]
v_pk_fma_f32 v[50:51], v[50:51], s[98:99], v[46:47] op_sel_hi:[1,0,0]
v_pk_fma_f32 v[52:53], v[52:53], s[98:99], v[46:47] op_sel_hi:[1,0,0]
v_pk_fma_f32 v[54:55], v[54:55], s[98:99], v[46:47] op_sel_hi:[1,0,0]
v_pk_mul_f32 v[48:49], v[48:49], v[80:81]
v_pk_mul_f32 v[50:51], v[50:51], v[82:83]
v_pk_mul_f32 v[52:53], v[52:53], v[84:85]
v_pk_mul_f32 v[54:55], v[54:55], v[86:87]
v_mfma_f32_32x32x16_bf16 v[208:223], a[192:195], v[136:139], 0
v_exp_f32 v48, -v48
v_exp_f32 v49, -v49
v_exp_f32 v50, -v50
v_exp_f32 v51, -v51
v_mfma_f32_32x32x16_bf16 v[208:223], a[196:199], v[140:143], v[208:223]
v_exp_f32 v52, -v52
v_exp_f32 v53, -v53
v_exp_f32 v54, -v54
v_exp_f32 v55, -v55
v_pk_add_f32 v[48:49], v[48:49], s[100:101] op_sel_hi:[1,0]
v_pk_add_f32 v[50:51], v[50:51], s[100:101] op_sel_hi:[1,0]
v_pk_add_f32 v[52:53], v[52:53], s[100:101] op_sel_hi:[1,0]
v_pk_add_f32 v[54:55], v[54:55], s[100:101] op_sel_hi:[1,0]
v_mfma_f32_32x32x16_bf16 v[208:223], a[200:203], v[152:155], v[208:223]
v_rcp_f32 v48, v48
v_rcp_f32 v49, v49
v_rcp_f32 v50, v50
v_rcp_f32 v51, v51
v_mfma_f32_32x32x16_bf16 v[208:223], a[204:207], v[156:159], v[208:223]
v_rcp_f32 v52, v52
v_rcp_f32 v53, v53
v_rcp_f32 v54, v54
v_rcp_f32 v55, v55
v_pk_mul_f32 v[80:81], v[80:81], v[48:49]
v_pk_mul_f32 v[82:83], v[82:83], v[50:51]
v_pk_mul_f32 v[84:85], v[84:85], v[52:53]
v_pk_mul_f32 v[86:87], v[86:87], v[54:55]
v_pk_mul_f32 v[88:89], v[88:89], v[44:45] op_sel_hi:[1,0]
v_pk_mul_f32 v[90:91], v[90:91], v[44:45] op_sel_hi:[1,0]
v_pk_mul_f32 v[92:93], v[92:93], v[44:45] op_sel_hi:[1,0]
v_pk_mul_f32 v[94:95], v[94:95], v[44:45] op_sel_hi:[1,0]
v_pk_mul_f32 v[48:49], v[88:89], v[88:89]
v_pk_mul_f32 v[50:51], v[90:91], v[90:91]
v_pk_mul_f32 v[52:53], v[92:93], v[92:93]
v_pk_mul_f32 v[54:55], v[94:95], v[94:95]
v_pk_fma_f32 v[48:49], v[48:49], s[98:99], v[46:47] op_sel_hi:[1,0,0]
v_pk_fma_f32 v[50:51], v[50:51], s[98:99], v[46:47] op_sel_hi:[1,0,0]
v_pk_fma_f32 v[52:53], v[52:53], s[98:99], v[46:47] op_sel_hi:[1,0,0]
v_pk_fma_f32 v[54:55], v[54:55], s[98:99], v[46:47] op_sel_hi:[1,0,0]
v_pk_mul_f32 v[48:49], v[48:49], v[88:89]
v_pk_mul_f32 v[50:51], v[50:51], v[90:91]
v_pk_mul_f32 v[52:53], v[52:53], v[92:93]
v_pk_mul_f32 v[54:55], v[54:55], v[94:95]
v_mfma_f32_32x32x16_bf16 v[208:223], a[208:211], v[168:171], v[208:223]
v_exp_f32 v48, -v48
v_exp_f32 v49, -v49
v_exp_f32 v50, -v50
v_exp_f32 v51, -v51
v_mfma_f32_32x32x16_bf16 v[208:223], a[212:215], v[172:175], v[208:223]
v_exp_f32 v52, -v52
v_exp_f32 v53, -v53
v_exp_f32 v54, -v54
v_exp_f32 v55, -v55
v_pk_add_f32 v[48:49], v[48:49], s[100:101] op_sel_hi:[1,0]
v_pk_add_f32 v[50:51], v[50:51], s[100:101] op_sel_hi:[1,0]
v_pk_add_f32 v[52:53], v[52:53], s[100:101] op_sel_hi:[1,0]
v_pk_add_f32 v[54:55], v[54:55], s[100:101] op_sel_hi:[1,0]
v_mfma_f32_32x32x16_bf16 v[208:223], a[216:219], v[184:187], v[208:223]
v_rcp_f32 v48, v48
v_rcp_f32 v49, v49
v_rcp_f32 v50, v50
v_rcp_f32 v51, v51
v_mfma_f32_32x32x16_bf16 v[208:223], a[220:223], v[188:191], v[208:223]
v_rcp_f32 v52, v52
v_rcp_f32 v53, v53
v_rcp_f32 v54, v54
v_rcp_f32 v55, v55
v_pk_mul_f32 v[88:89], v[88:89], v[48:49]
v_pk_mul_f32 v[90:91], v[90:91], v[50:51]
v_pk_mul_f32 v[92:93], v[92:93], v[52:53]
v_pk_mul_f32 v[94:95], v[94:95], v[54:55]
v_lshlrev_b32 v2, 4, v1
v_cvt_pk_bf16_f32 v64, v64, v65
v_cvt_pk_bf16_f32 v65, v66, v67
v_cvt_pk_bf16_f32 v66, v68, v69
v_cvt_pk_bf16_f32 v67, v70, v71
v_cvt_pk_bf16_f32 v68, v72, v73
v_cvt_pk_bf16_f32 v69, v74, v75
v_cvt_pk_bf16_f32 v70, v76, v77
v_cvt_pk_bf16_f32 v71, v78, v79
s_lshl_b32 s82, s4, 3
s_lshl_b32 s83, s5, 1
s_add_u32 s82, s82, s83
s_add_u32 s82, s82, 0
s_mul_i32 s82, s82, 44
s_lshl_b32 s83, s95, 1
s_add_u32 s82, s82, s83
s_lshl_b32 s82, s82, 10
s_add_u32 s82, s82, 0x1100000
buffer_store_dwordx4 v[64:67], v2, s[28:31], s82 offen sc0 sc1
buffer_store_dwordx4 v[68:71], v2, s[28:31], s82 offen offset:1024 sc0 sc1
v_cvt_pk_bf16_f32 v80, v80, v81
v_cvt_pk_bf16_f32 v81, v82, v83
v_cvt_pk_bf16_f32 v82, v84, v85
v_cvt_pk_bf16_f32 v83, v86, v87
v_cvt_pk_bf16_f32 v84, v88, v89
v_cvt_pk_bf16_f32 v85, v90, v91
v_cvt_pk_bf16_f32 v86, v92, v93
v_cvt_pk_bf16_f32 v87, v94, v95
s_lshl_b32 s82, s4, 3
s_lshl_b32 s83, s5, 1
s_add_u32 s82, s82, s83
s_add_u32 s82, s82, 1
s_mul_i32 s82, s82, 44
s_lshl_b32 s83, s95, 1
s_add_u32 s82, s82, s83
s_lshl_b32 s82, s82, 10
s_add_u32 s82, s82, 0x1100000
buffer_store_dwordx4 v[80:83], v2, s[28:31], s82 offen sc0 sc1
buffer_store_dwordx4 v[84:87], v2, s[28:31], s82 offen offset:1024 sc0 sc1
s_waitcnt vmcnt(4)
s_lshl_b32 s83, s4, 2
s_add_u32 s83, s83, s5
s_lshl_b32 s83, s83, 7
s_add_u32 s55, s83, 0x300a000
s_add_u32 s82, s66, 10
s_lshl_b32 s82, s82, 2
s_add_u32 s82, s82, s55
v_mov_b32 v2, s32
v_mov_b32 v3, 0
s_mov_b64 exec, 1
buffer_store_dword v2, v3, s[28:31], s82 offen sc0 sc1
s_mov_b64 exec, -1
L_p2:
s_add_u32 s82, s66, 10
s_sub_u32 s83, s3, 22
s_cmp_lt_u32 s66, 12
s_cselect_b32 s92, s82, s83
s_waitcnt lgkmcnt(0)
s_barrier
s_add_u32 m0, s90, 0x1c000
s_nop 0
buffer_load_dwordx4 v33, s[20:23], s88 offen lds
buffer_load_dwordx4 v34, s[20:23], s88 offen offset:1024 lds
s_add_u32 s88, s88, 0x2000
ds_read_b128 a[192:195], v10 offset:8192
ds_read_b128 a[196:199], v11 offset:8192
ds_read_b128 a[200:203], v12 offset:8192
ds_read_b128 a[204:207], v13 offset:8192
ds_read_b128 a[208:211], v14 offset:8192
ds_read_b128 a[212:215], v15 offset:8192
ds_read_b128 a[216:219], v16 offset:8192
ds_read_b128 a[220:223], v17 offset:8192
v_max3_f32 v2, v192, v193, v194
v_max3_f32 v2, v2, v195, v196
v_max3_f32 v2, v2, v197, v198
v_max3_f32 v2, v2, v199, v200
v_max3_f32 v2, v2, v201, v202
v_max3_f32 v2, v2, v203, v204
v_max3_f32 v2, v2, v205, v206
v_max_f32 v2, v2, v207
v_max3_f32 v3, v208, v209, v210
v_max3_f32 v3, v3, v211, v212
v_max3_f32 v3, v3, v213, v214
v_max3_f32 v3, v3, v215, v216
v_max3_f32 v3, v3, v217, v218
v_max3_f32 v3, v3, v219, v220
v_max3_f32 v3, v3, v221, v222
v_max_f32 v3, v3, v223
v_mov_b32 v4, v2
v_mov_b32 v5, v3
s_nop 0
v_permlane32_swap_b32 v2, v4
v_permlane32_swap_b32 v3, v5
v_max_f32 v2, v2, v4
v_max_f32 v3, v3, v5
v_sub_f32 v40, 0, v2
v_mov_b32 v41, v40
v_sub_f32 v42, 0, v3
v_mov_b32 v43, v42
v_pk_add_f32 v[64:65], v[192:193], v[40:41]
v_pk_add_f32 v[66:67], v[194:195], v[40:41]
v_pk_add_f32 v[68:69], v[196:197], v[40:41]
v_pk_add_f32 v[70:71], v[198:199], v[40:41]
v_pk_add_f32 v[72:73], v[200:201], v[40:41]
v_pk_add_f32 v[74:75], v[202:203], v[40:41]
v_pk_add_f32 v[76:77], v[204:205], v[40:41]
v_pk_add_f32 v[78:79], v[206:207], v[40:41]
v_pk_add_f32 v[80:81], v[208:209], v[42:43]
v_pk_add_f32 v[82:83], v[210:211], v[42:43]
v_pk_add_f32 v[84:85], v[212:213], v[42:43]
v_pk_add_f32 v[86:87], v[214:215], v[42:43]
v_pk_add_f32 v[88:89], v[216:217], v[42:43]
v_pk_add_f32 v[90:91], v[218:219], v[42:43]
v_pk_add_f32 v[92:93], v[220:221], v[42:43]
v_pk_add_f32 v[94:95], v[222:223], v[42:43]
v_pk_mov_b32 v[192:193], v[40:41], v[40:41] op_sel:[0,1]
v_pk_mov_b32 v[194:195], v[40:41], v[40:41] op_sel:[0,1]
v_pk_mov_b32 v[196:197], v[40:41], v[40:41] op_sel:[0,1]
v_pk_mov_b32 v[198:199], v[40:41], v[40:41] op_sel:[0,1]
v_pk_mov_b32 v[200:201], v[40:41], v[40:41] op_sel:[0,1]
v_pk_mov_b32 v[202:203], v[40:41], v[40:41] op_sel:[0,1]
v_pk_mov_b32 v[204:205], v[40:41], v[40:41] op_sel:[0,1]
v_pk_mov_b32 v[206:207], v[40:41], v[40:41] op_sel:[0,1]
v_mov_b32 v224, 0
v_mov_b32 v225, 0
v_pk_mov_b32 v[208:209], v[42:43], v[42:43] op_sel:[0,1]
v_pk_mov_b32 v[210:211], v[42:43], v[42:43] op_sel:[0,1]
v_pk_mov_b32 v[212:213], v[42:43], v[42:43] op_sel:[0,1]
v_pk_mov_b32 v[214:215], v[42:43], v[42:43] op_sel:[0,1]
v_pk_mov_b32 v[216:217], v[42:43], v[42:43] op_sel:[0,1]
v_pk_mov_b32 v[218:219], v[42:43], v[42:43] op_sel:[0,1]
v_pk_mov_b32 v[220:221], v[42:43], v[42:43] op_sel:[0,1]
v_pk_mov_b32 v[222:223], v[42:43], v[42:43] op_sel:[0,1]
v_mov_b32 v226, 0
v_mov_b32 v227, 0
v_exp_f32 v64, v64
v_exp_f32 v65, v65
v_exp_f32 v66, v66
v_exp_f32 v67, v67
v_add_f32 v224, v224, v64
v_add_f32 v225, v225, v65
v_cvt_pk_bf16_f32 v96, v64, v65
v_exp_f32 v68, v68
v_exp_f32 v69, v69
v_add_f32 v224, v224, v66
v_add_f32 v225, v225, v67
v_cvt_pk_bf16_f32 v97, v66, v67
v_exp_f32 v70, v70
v_exp_f32 v71, v71
v_add_f32 v224, v224, v68
v_add_f32 v225, v225, v69
v_cvt_pk_bf16_f32 v98, v68, v69
v_exp_f32 v72, v72
v_exp_f32 v73, v73
v_add_f32 v224, v224, v70
v_add_f32 v225, v225, v71
v_cvt_pk_bf16_f32 v99, v70, v71
v_exp_f32 v74, v74
v_exp_f32 v75, v75
v_add_f32 v224, v224, v72
v_add_f32 v225, v225, v73
v_cvt_pk_bf16_f32 v100, v72, v73
v_exp_f32 v76, v76
v_exp_f32 v77, v77
v_add_f32 v224, v224, v74
v_add_f32 v225, v225, v75
v_cvt_pk_bf16_f32 v101, v74, v75
v_exp_f32 v78, v78
v_exp_f32 v79, v79
v_add_f32 v224, v224, v76
v_add_f32 v225, v225, v77
v_cvt_pk_bf16_f32 v102, v76, v77
v_add_f32 v224, v224, v78
v_add_f32 v225, v225, v79
v_cvt_pk_bf16_f32 v103, v78, v79
s_waitcnt lgkmcnt(0)
s_barrier
v_mfma_f32_32x32x16_bf16 v[64:79], a[192:195], v[128:131], v[192:207]
ds_read_b64_tr_b16 a[224:225], v18 offset:0
ds_read_b64_tr_b16 a[226:227], v18 offset:2048
s_waitcnt vmcnt(2)
v_exp_f32 v80, v80
v_mfma_f32_32x32x16_bf16 v[64:79], a[196:199], v[132:135], v[64:79]
ds_read_b64_tr_b16 a[232:233], v19 offset:0
ds_read_b64_tr_b16 a[234:235], v19 offset:2048
s_lshl_b32 s83, s4, 2
v_exp_f32 v81, v81
v_mfma_f32_32x32x16_bf16 v[64:79], a[200:203], v[144:147], v[64:79]
ds_read_b64_tr_b16 a[240:241], v20 offset:0
ds_read_b64_tr_b16 a[242:243], v20 offset:2048
s_add_u32 s83, s83, s5
v_exp_f32 v82, v82
v_mfma_f32_32x32x16_bf16 v[64:79], a[204:207], v[148:151], v[64:79]
ds_read_b64_tr_b16 a[248:249], v21 offset:0
ds_read_b64_tr_b16 a[250:251], v21 offset:2048
s_lshl_b32 s83, s83, 7
v_exp_f32 v83, v83
v_mfma_f32_32x32x16_bf16 v[64:79], a[208:211], v[160:163], v[64:79]
ds_read_b64_tr_b16 a[228:229], v18 offset:4096
ds_read_b64_tr_b16 a[230:231], v18 offset:6144
ds_read_b64_tr_b16 a[236:237], v19 offset:4096
v_add_f32 v226, v226, v80
v_add_f32 v227, v227, v81
v_mfma_f32_32x32x16_bf16 v[64:79], a[212:215], v[164:167], v[64:79]
ds_read_b64_tr_b16 a[238:239], v19 offset:6144
ds_read_b64_tr_b16 a[244:245], v20 offset:4096
v_cvt_pk_bf16_f32 v104, v80, v81
v_exp_f32 v84, v84
v_mfma_f32_32x32x16_bf16 v[64:79], a[216:219], v[176:179], v[64:79]
ds_read_b64_tr_b16 a[246:247], v20 offset:6144
ds_read_b64_tr_b16 a[252:253], v21 offset:4096
ds_read_b64_tr_b16 a[254:255], v21 offset:6144
v_mfma_f32_32x32x16_bf16 v[64:79], a[220:223], v[180:183], v[64:79]
v_exp_f32 v85, v85
v_add_f32 v226, v226, v82
v_add_f32 v227, v227, v83
v_cvt_pk_bf16_f32 v105, v82, v83
s_waitcnt lgkmcnt(0)
v_mfma_f32_32x32x16_bf16 a[0:15], a[224:227], v[96:99], 0
s_add_u32 s55, s83, 0x300a000
v_exp_f32 v86, v86
v_exp_f32 v87, v87
v_add_f32 v226, v226, v84
v_mfma_f32_32x32x16_bf16 a[32:47], a[232:235], v[96:99], 0
s_lshl_b32 s82, s92, 2
s_add_u32 s82, s82, s55
v_add_f32 v227, v227, v85
v_cvt_pk_bf16_f32 v106, v84, v85
v_exp_f32 v88, v88
v_mfma_f32_32x32x16_bf16 a[64:79], a[240:243], v[96:99], 0
s_cmp_ge_u32 s3, 22
s_cselect_b32 s82, s82, 0x10000000
v_exp_f32 v89, v89
v_add_f32 v226, v226, v86
v_add_f32 v227, v227, v87
v_mfma_f32_32x32x16_bf16 a[96:111], a[248:251], v[96:99], 0
v_cvt_pk_bf16_f32 v107, v86, v87
v_exp_f32 v90, v90
v_exp_f32 v91, v91
v_mfma_f32_32x32x16_bf16 a[0:15], a[228:231], v[100:103], a[0:15]
v_add_f32 v226, v226, v88
v_add_f32 v227, v227, v89
v_cvt_pk_bf16_f32 v108, v88, v89
v_exp_f32 v92, v92
v_mfma_f32_32x32x16_bf16 a[32:47], a[236:239], v[100:103], a[32:47]
v_exp_f32 v93, v93
v_add_f32 v226, v226, v90
v_add_f32 v227, v227, v91
v_cvt_pk_bf16_f32 v109, v90, v91
v_mfma_f32_32x32x16_bf16 a[64:79], a[244:247], v[100:103], a[64:79]
v_exp_f32 v94, v94
v_exp_f32 v95, v95
v_mfma_f32_32x32x16_bf16 a[96:111], a[252:255], v[100:103], a[96:111]
v_add_f32 v226, v226, v92
v_add_f32 v227, v227, v93
v_cvt_pk_bf16_f32 v110, v92, v93
v_add_f32 v226, v226, v94
v_add_f32 v227, v227, v95
v_cvt_pk_bf16_f32 v111, v94, v95
v_mfma_f32_32x32x16_bf16 v[80:95], a[192:195], v[136:139], v[208:223]
s_add_u32 m0, s90, 0x26000
v_exp_f32 v64, v64
v_exp_f32 v65, v65
v_mov_b32 v2, s32
v_mfma_f32_32x32x16_bf16 v[80:95], a[196:199], v[140:143], v[80:95]
buffer_load_dwordx4 v35, s[24:27], s89 offen lds
v_exp_f32 v66, v66
v_exp_f32 v67, v67
v_mfma_f32_32x32x16_bf16 v[80:95], a[200:203], v[152:155], v[80:95]
buffer_load_dwordx4 v35, s[24:27], s89 offen offset:1024 lds
v_add_f32 v224, v224, v64
v_add_f32 v225, v225, v65
v_cvt_pk_bf16_f32 v96, v64, v65
v_mov_b32 v3, 0
v_mfma_f32_32x32x16_bf16 v[80:95], a[204:207], v[156:159], v[80:95]
s_add_u32 s89, s89, 0x2000
s_add_u32 m0, s90, 0x1e000
v_exp_f32 v68, v68
v_exp_f32 v69, v69
v_mfma_f32_32x32x16_bf16 v[80:95], a[208:211], v[168:171], v[80:95]
buffer_load_dwordx4 v33, s[20:23], s88 offen lds
v_add_f32 v224, v224, v66
v_add_f32 v225, v225, v67
v_cvt_pk_bf16_f32 v97, v66, v67
v_mfma_f32_32x32x16_bf16 v[80:95], a[212:215], v[172:175], v[80:95]
v_exp_f32 v70, v70
v_exp_f32 v71, v71
v_add_f32 v224, v224, v68
v_mfma_f32_32x32x16_bf16 v[80:95], a[216:219], v[184:187], v[80:95]
buffer_load_dwordx4 v34, s[20:23], s88 offen offset:1024 lds
v_add_f32 v225, v225, v69
v_cvt_pk_bf16_f32 v98, v68, v69
v_mfma_f32_32x32x16_bf16 v[80:95], a[220:223], v[188:191], v[80:95]
s_add_u32 s88, s88, 0x2000
v_exp_f32 v72, v72
v_exp_f32 v73, v73
v_mfma_f32_32x32x16_bf16 a[16:31], a[224:227], v[104:107], 0
ds_read_b128 a[192:195], v10 offset:16384
v_add_f32 v224, v224, v70
v_add_f32 v225, v225, v71
v_cvt_pk_bf16_f32 v99, v70, v71
v_exp_f32 v74, v74
v_mfma_f32_32x32x16_bf16 a[48:63], a[232:235], v[104:107], 0
ds_read_b128 a[196:199], v11 offset:16384
ds_read_b128 a[200:203], v12 offset:16384
v_exp_f32 v75, v75
v_add_f32 v224, v224, v72
v_mfma_f32_32x32x16_bf16 a[80:95], a[240:243], v[104:107], 0
ds_read_b128 a[204:207], v13 offset:16384
v_add_f32 v225, v225, v73
v_cvt_pk_bf16_f32 v100, v72, v73
v_exp_f32 v76, v76
v_mfma_f32_32x32x16_bf16 a[112:127], a[248:251], v[104:107], 0
ds_read_b128 a[208:211], v14 offset:16384
ds_read_b128 a[212:215], v15 offset:16384
v_exp_f32 v77, v77
v_add_f32 v224, v224, v74
v_mfma_f32_32x32x16_bf16 a[16:31], a[228:231], v[108:111], a[16:31]
ds_read_b128 a[216:219], v16 offset:16384
v_add_f32 v225, v225, v75
v_cvt_pk_bf16_f32 v101, v74, v75
v_exp_f32 v78, v78
v_mfma_f32_32x32x16_bf16 a[48:63], a[236:239], v[108:111], a[48:63]
ds_read_b128 a[220:223], v17 offset:16384
v_exp_f32 v79, v79
v_add_f32 v224, v224, v76
v_mfma_f32_32x32x16_bf16 a[80:95], a[244:247], v[108:111], a[80:95]
s_mov_b64 exec, 1
buffer_store_dword v2, v3, s[28:31], s82 offen sc0 sc1
s_mov_b64 exec, -1
v_add_f32 v225, v225, v77
v_cvt_pk_bf16_f32 v102, v76, v77
v_mfma_f32_32x32x16_bf16 a[112:127], a[252:255], v[108:111], a[112:127]
v_add_f32 v224, v224, v78
v_min_u32 v37, 21, v1
v_add_f32 v225, v225, v79
v_lshlrev_b32 v37, 2, v37
v_cvt_pk_bf16_f32 v103, v78, v79
s_waitcnt vmcnt(5)
s_waitcnt lgkmcnt(0)
s_barrier
v_mfma_f32_32x32x16_bf16 v[64:79], a[192:195], v[128:131], v[192:207]
ds_read_b64_tr_b16 a[224:225], v18 offset:8192
ds_read_b64_tr_b16 a[226:227], v18 offset:10240
ds_read_b64_tr_b16 a[232:233], v19 offset:8192
v_exp_f32 v80, v80
v_mfma_f32_32x32x16_bf16 v[64:79], a[196:199], v[132:135], v[64:79]
ds_read_b64_tr_b16 a[234:235], v19 offset:10240
ds_read_b64_tr_b16 a[240:241], v20 offset:8192
ds_read_b64_tr_b16 a[242:243], v20 offset:10240
v_exp_f32 v81, v81
v_mfma_f32_32x32x16_bf16 v[64:79], a[200:203], v[144:147], v[64:79]
ds_read_b64_tr_b16 a[248:249], v21 offset:8192
ds_read_b64_tr_b16 a[250:251], v21 offset:10240
v_exp_f32 v82, v82
v_mfma_f32_32x32x16_bf16 v[64:79], a[204:207], v[148:151], v[64:79]
ds_read_b64_tr_b16 a[228:229], v18 offset:12288
ds_read_b64_tr_b16 a[230:231], v18 offset:14336
v_exp_f32 v83, v83
v_mfma_f32_32x32x16_bf16 v[64:79], a[208:211], v[160:163], v[64:79]
ds_read_b64_tr_b16 a[236:237], v19 offset:12288
ds_read_b64_tr_b16 a[238:239], v19 offset:14336
v_add_f32 v226, v226, v80
v_add_f32 v227, v227, v81
v_mfma_f32_32x32x16_bf16 v[64:79], a[212:215], v[164:167], v[64:79]
ds_read_b64_tr_b16 a[244:245], v20 offset:12288
v_cvt_pk_bf16_f32 v104, v80, v81
v_exp_f32 v84, v84
v_mfma_f32_32x32x16_bf16 v[64:79], a[216:219], v[176:179], v[64:79]
ds_read_b64_tr_b16 a[246:247], v20 offset:14336
ds_read_b64_tr_b16 a[252:253], v21 offset:12288
ds_read_b64_tr_b16 a[254:255], v21 offset:14336
v_mfma_f32_32x32x16_bf16 v[64:79], a[220:223], v[180:183], v[64:79]
v_exp_f32 v85, v85
v_add_f32 v226, v226, v82
v_add_f32 v227, v227, v83
v_cvt_pk_bf16_f32 v105, v82, v83
s_waitcnt lgkmcnt(0)
v_mfma_f32_32x32x16_bf16 a[0:15], a[224:227], v[96:99], a[0:15]
v_exp_f32 v86, v86
v_exp_f32 v87, v87
v_add_f32 v226, v226, v84
v_mfma_f32_32x32x16_bf16 a[32:47], a[232:235], v[96:99], a[32:47]
v_add_f32 v227, v227, v85
v_cvt_pk_bf16_f32 v106, v84, v85
v_exp_f32 v88, v88
v_mfma_f32_32x32x16_bf16 a[64:79], a[240:243], v[96:99], a[64:79]
buffer_load_dword v22, v37, s[28:31], s55 offen sc0 sc1
v_exp_f32 v89, v89
v_add_f32 v226, v226, v86
v_add_f32 v227, v227, v87
v_mfma_f32_32x32x16_bf16 a[96:111], a[248:251], v[96:99], a[96:111]
v_cvt_pk_bf16_f32 v107, v86, v87
v_exp_f32 v90, v90
v_exp_f32 v91, v91
v_mfma_f32_32x32x16_bf16 a[0:15], a[228:231], v[100:103], a[0:15]
v_add_f32 v226, v226, v88
v_add_f32 v227, v227, v89
v_cvt_pk_bf16_f32 v108, v88, v89
v_exp_f32 v92, v92
v_mfma_f32_32x32x16_bf16 a[32:47], a[236:239], v[100:103], a[32:47]
v_exp_f32 v93, v93
v_add_f32 v226, v226, v90
v_add_f32 v227, v227, v91
v_cvt_pk_bf16_f32 v109, v90, v91
v_mfma_f32_32x32x16_bf16 a[64:79], a[244:247], v[100:103], a[64:79]
v_exp_f32 v94, v94
v_exp_f32 v95, v95
v_mfma_f32_32x32x16_bf16 a[96:111], a[252:255], v[100:103], a[96:111]
v_add_f32 v226, v226, v92
v_add_f32 v227, v227, v93
v_cvt_pk_bf16_f32 v110, v92, v93
v_add_f32 v226, v226, v94
v_add_f32 v227, v227, v95
v_cvt_pk_bf16_f32 v111, v94, v95
v_mfma_f32_32x32x16_bf16 v[80:95], a[192:195], v[136:139], v[208:223]
s_add_u32 m0, s90, 0x22000
v_exp_f32 v64, v64
v_exp_f32 v65, v65
v_mfma_f32_32x32x16_bf16 v[80:95], a[196:199], v[140:143], v[80:95]
buffer_load_dwordx4 v35, s[24:27], s89 offen lds
v_exp_f32 v66, v66
v_mfma_f32_32x32x16_bf16 v[80:95], a[200:203], v[152:155], v[80:95]
buffer_load_dwordx4 v35, s[24:27], s89 offen offset:1024 lds
v_exp_f32 v67, v67
v_add_f32 v224, v224, v64
v_mfma_f32_32x32x16_bf16 v[80:95], a[204:207], v[156:159], v[80:95]
s_add_u32 s89, s89, 0x2000
v_add_f32 v225, v225, v65
v_cvt_pk_bf16_f32 v96, v64, v65
v_exp_f32 v68, v68
v_mfma_f32_32x32x16_bf16 v[80:95], a[208:211], v[168:171], v[80:95]
s_add_u32 m0, s90, 0x20000
v_exp_f32 v69, v69
v_add_f32 v224, v224, v66
v_add_f32 v225, v225, v67
v_mfma_f32_32x32x16_bf16 v[80:95], a[212:215], v[172:175], v[80:95]
buffer_load_dwordx4 v33, s[20:23], s88 offen lds
v_cvt_pk_bf16_f32 v97, v66, v67
v_exp_f32 v70, v70
v_mfma_f32_32x32x16_bf16 v[80:95], a[216:219], v[184:187], v[80:95]
buffer_load_dwordx4 v34, s[20:23], s88 offen offset:1024 lds
v_exp_f32 v71, v71
v_add_f32 v224, v224, v68
v_mfma_f32_32x32x16_bf16 v[80:95], a[220:223], v[188:191], v[80:95]
s_add_u32 s88, s88, 0x2000
v_add_f32 v225, v225, v69
v_cvt_pk_bf16_f32 v98, v68, v69
v_exp_f32 v72, v72
v_mfma_f32_32x32x16_bf16 a[16:31], a[224:227], v[104:107], a[16:31]
ds_read_b128 a[192:195], v10
v_exp_f32 v73, v73
v_add_f32 v224, v224, v70
v_add_f32 v225, v225, v71
v_mfma_f32_32x32x16_bf16 a[48:63], a[232:235], v[104:107], a[48:63]
ds_read_b128 a[196:199], v11
ds_read_b128 a[200:203], v12
v_cvt_pk_bf16_f32 v99, v70, v71
v_exp_f32 v74, v74
v_mfma_f32_32x32x16_bf16 a[80:95], a[240:243], v[104:107], a[80:95]
ds_read_b128 a[204:207], v13
v_exp_f32 v75, v75
v_add_f32 v224, v224, v72
v_add_f32 v225, v225, v73
v_mfma_f32_32x32x16_bf16 a[112:127], a[248:251], v[104:107], a[112:127]
ds_read_b128 a[208:211], v14
ds_read_b128 a[212:215], v15
v_cvt_pk_bf16_f32 v100, v72, v73
v_exp_f32 v76, v76
v_mfma_f32_32x32x16_bf16 a[16:31], a[228:231], v[108:111], a[16:31]
ds_read_b128 a[216:219], v16
v_exp_f32 v77, v77
v_add_f32 v224, v224, v74
v_add_f32 v225, v225, v75
v_mfma_f32_32x32x16_bf16 a[48:63], a[236:239], v[108:111], a[48:63]
ds_read_b128 a[220:223], v17
v_cvt_pk_bf16_f32 v101, v74, v75
v_exp_f32 v78, v78
v_mfma_f32_32x32x16_bf16 a[80:95], a[244:247], v[108:111], a[80:95]
v_exp_f32 v79, v79
v_add_f32 v224, v224, v76
v_add_f32 v225, v225, v77
v_mfma_f32_32x32x16_bf16 a[112:127], a[252:255], v[108:111], a[112:127]
v_cvt_pk_bf16_f32 v102, v76, v77
v_add_f32 v224, v224, v78
v_add_f32 v225, v225, v79
v_cvt_pk_bf16_f32 v103, v78, v79
s_waitcnt vmcnt(6)
s_waitcnt lgkmcnt(0)
s_barrier
v_mfma_f32_32x32x16_bf16 v[64:79], a[192:195], v[128:131], v[192:207]
ds_read_b64_tr_b16 a[224:225], v18 offset:16384
ds_read_b64_tr_b16 a[226:227], v18 offset:18432
s_and_b32 s6, s2, 7
ds_read_b64_tr_b16 a[232:233], v19 offset:16384
v_exp_f32 v80, v80
v_mfma_f32_32x32x16_bf16 v[64:79], a[196:199], v[132:135], v[64:79]
ds_read_b64_tr_b16 a[234:235], v19 offset:18432
ds_read_b64_tr_b16 a[240:241], v20 offset:16384
s_lshl_b32 s6, s6, 2
v_exp_f32 v81, v81
v_mfma_f32_32x32x16_bf16 v[64:79], a[200:203], v[144:147], v[64:79]
ds_read_b64_tr_b16 a[242:243], v20 offset:18432
ds_read_b64_tr_b16 a[248:249], v21 offset:16384
s_lshr_b32 s82, s2, 3
v_exp_f32 v82, v82
v_mfma_f32_32x32x16_bf16 v[64:79], a[204:207], v[148:151], v[64:79]
ds_read_b64_tr_b16 a[250:251], v21 offset:18432
ds_read_b64_tr_b16 a[228:229], v18 offset:20480
s_and_b32 s83, s82, 3
v_exp_f32 v83, v83
v_mfma_f32_32x32x16_bf16 v[64:79], a[208:211], v[160:163], v[64:79]
ds_read_b64_tr_b16 a[230:231], v18 offset:22528
ds_read_b64_tr_b16 a[236:237], v19 offset:20480
s_add_u32 s83, s83, s6
v_add_f32 v226, v226, v80
v_add_f32 v227, v227, v81
v_mfma_f32_32x32x16_bf16 v[64:79], a[212:215], v[164:167], v[64:79]
ds_read_b64_tr_b16 a[238:239], v19 offset:22528
ds_read_b64_tr_b16 a[244:245], v20 offset:20480
v_cvt_pk_bf16_f32 v104, v80, v81
v_exp_f32 v84, v84
v_mfma_f32_32x32x16_bf16 v[64:79], a[216:219], v[176:179], v[64:79]
ds_read_b64_tr_b16 a[246:247], v20 offset:22528
ds_read_b64_tr_b16 a[252:253], v21 offset:20480
ds_read_b64_tr_b16 a[254:255], v21 offset:22528
v_exp_f32 v85, v85
v_mfma_f32_32x32x16_bf16 v[64:79], a[220:223], v[180:183], v[64:79]
s_lshr_b32 s84, s2, 5
s_lshl_b32 s83, s83, 18
v_add_f32 v226, v226, v82
v_add_f32 v227, v227, v83
v_cvt_pk_bf16_f32 v105, v82, v83
s_waitcnt lgkmcnt(0)
v_mfma_f32_32x32x16_bf16 a[0:15], a[224:227], v[96:99], a[0:15]
s_lshl_b32 s84, s84, 15
v_exp_f32 v86, v86
v_exp_f32 v87, v87
v_add_f32 v226, v226, v84
v_mfma_f32_32x32x16_bf16 a[32:47], a[232:235], v[96:99], a[32:47]
s_add_u32 s83, s83, s84
s_lshl_b32 s84, s5, 13
v_add_f32 v227, v227, v85
v_cvt_pk_bf16_f32 v106, v84, v85
v_exp_f32 v88, v88
v_mfma_f32_32x32x16_bf16 a[64:79], a[240:243], v[96:99], a[64:79]
s_add_u32 s83, s83, s84
v_exp_f32 v89, v89
v_add_f32 v226, v226, v86
v_add_f32 v227, v227, v87
v_cvt_pk_bf16_f32 v107, v86, v87
v_mfma_f32_32x32x16_bf16 a[96:111], a[248:251], v[96:99], a[96:111]
s_add_u32 s98, s70, s83
s_addc_u32 s99, s71, 0
v_exp_f32 v90, v90
v_exp_f32 v91, v91
v_mfma_f32_32x32x16_bf16 a[0:15], a[228:231], v[100:103], a[0:15]
v_add_f32 v226, v226, v88
v_add_f32 v227, v227, v89
v_cvt_pk_bf16_f32 v108, v88, v89
v_exp_f32 v92, v92
v_mfma_f32_32x32x16_bf16 a[32:47], a[236:239], v[100:103], a[32:47]
v_exp_f32 v93, v93
v_add_f32 v226, v226, v90
v_add_f32 v227, v227, v91
v_lshlrev_b32 v4, 7, v1
v_mfma_f32_32x32x16_bf16 a[64:79], a[244:247], v[100:103], a[64:79]
global_load_dword v30, v4, s[98:99]
v_cvt_pk_bf16_f32 v109, v90, v91
v_exp_f32 v94, v94
v_exp_f32 v95, v95
v_mfma_f32_32x32x16_bf16 a[96:111], a[252:255], v[100:103], a[96:111]
v_add_f32 v226, v226, v92
v_add_f32 v227, v227, v93
v_cvt_pk_bf16_f32 v110, v92, v93
v_add_f32 v226, v226, v94
v_add_f32 v227, v227, v95
v_cvt_pk_bf16_f32 v111, v94, v95
v_mfma_f32_32x32x16_bf16 v[80:95], a[192:195], v[136:139], v[208:223]
s_add_u32 m0, s90, 0x24000
s_lshl_b32 s82, s4, 5
v_exp_f32 v64, v64
v_exp_f32 v65, v65
v_mfma_f32_32x32x16_bf16 v[80:95], a[196:199], v[140:143], v[80:95]
buffer_load_dwordx4 v35, s[24:27], s89 offen lds
v_exp_f32 v66, v66
v_exp_f32 v67, v67
v_mfma_f32_32x32x16_bf16 v[80:95], a[200:203], v[152:155], v[80:95]
buffer_load_dwordx4 v35, s[24:27], s89 offen offset:1024 lds
s_add_u32 s82, s82, s3
v_add_f32 v224, v224, v64
v_add_f32 v225, v225, v65
v_cvt_pk_bf16_f32 v96, v64, v65
v_mfma_f32_32x32x16_bf16 v[80:95], a[204:207], v[156:159], v[80:95]
s_add_u32 s89, s89, 0x2000
s_lshl_b32 s82, s82, 2
v_exp_f32 v68, v68
v_exp_f32 v69, v69
v_mfma_f32_32x32x16_bf16 v[80:95], a[208:211], v[168:171], v[80:95]
s_add_u32 m0, s90, 0x1c000
s_add_u32 s82, s82, s5
s_lshl_b32 s82, s82, 2
v_add_f32 v224, v224, v66
v_add_f32 v225, v225, v67
v_cvt_pk_bf16_f32 v97, v66, v67
v_mfma_f32_32x32x16_bf16 v[80:95], a[212:215], v[172:175], v[80:95]
buffer_load_dwordx4 v33, s[20:23], s88 offen lds
v_exp_f32 v70, v70
v_exp_f32 v71, v71
v_mfma_f32_32x32x16_bf16 v[80:95], a[216:219], v[184:187], v[80:95]
buffer_load_dwordx4 v34, s[20:23], s88 offen offset:1024 lds
s_add_u32 s82, s82, 0x3000000
v_add_f32 v224, v224, v68
v_add_f32 v225, v225, v69
v_cvt_pk_bf16_f32 v98, v68, v69
v_mfma_f32_32x32x16_bf16 v[80:95], a[220:223], v[188:191], v[80:95]
s_add_u32 s88, s88, 0x2000
v_exp_f32 v72, v72
v_exp_f32 v73, v73
v_mfma_f32_32x32x16_bf16 a[16:31], a[224:227], v[104:107], a[16:31]
ds_read_b128 a[192:195], v10 offset:8192
s_cmp_lt_u32 s3, 22
s_cselect_b32 s82, s82, 0x10000000
v_add_f32 v224, v224, v70
v_add_f32 v225, v225, v71
v_cvt_pk_bf16_f32 v99, v70, v71
v_mfma_f32_32x32x16_bf16 a[48:63], a[232:235], v[104:107], a[48:63]
ds_read_b128 a[196:199], v11 offset:8192
v_exp_f32 v74, v74
v_exp_f32 v75, v75
v_mov_b32 v2, s32
v_mfma_f32_32x32x16_bf16 a[80:95], a[240:243], v[104:107], a[80:95]
ds_read_b128 a[200:203], v12 offset:8192
ds_read_b128 a[204:207], v13 offset:8192
v_add_f32 v224, v224, v72
v_add_f32 v225, v225, v73
v_cvt_pk_bf16_f32 v100, v72, v73
v_mov_b32 v3, 0
v_mfma_f32_32x32x16_bf16 a[112:127], a[248:251], v[104:107], a[112:127]
ds_read_b128 a[208:211], v14 offset:8192
v_exp_f32 v76, v76
v_exp_f32 v77, v77
v_mfma_f32_32x32x16_bf16 a[16:31], a[228:231], v[108:111], a[16:31]
ds_read_b128 a[212:215], v15 offset:8192
ds_read_b128 a[216:219], v16 offset:8192
v_add_f32 v224, v224, v74
v_add_f32 v225, v225, v75
v_cvt_pk_bf16_f32 v101, v74, v75
v_mfma_f32_32x32x16_bf16 a[48:63], a[236:239], v[108:111], a[48:63]
ds_read_b128 a[220:223], v17 offset:8192
v_exp_f32 v78, v78
v_exp_f32 v79, v79
v_mfma_f32_32x32x16_bf16 a[80:95], a[244:247], v[108:111], a[80:95]
s_mov_b64 exec, 1
buffer_store_dword v2, v3, s[28:31], s82 offen sc0 sc1
s_mov_b64 exec, -1
v_add_f32 v224, v224, v76
v_mfma_f32_32x32x16_bf16 a[112:127], a[252:255], v[108:111], a[112:127]
v_add_f32 v225, v225, v77
v_cvt_pk_bf16_f32 v102, v76, v77
v_add_f32 v224, v224, v78
v_add_f32 v225, v225, v79
v_cvt_pk_bf16_f32 v103, v78, v79
s_waitcnt vmcnt(6)
s_waitcnt lgkmcnt(0)
s_barrier
v_mfma_f32_32x32x16_bf16 v[64:79], a[192:195], v[128:131], v[192:207]
ds_read_b64_tr_b16 a[224:225], v18 offset:0
ds_read_b64_tr_b16 a[226:227], v18 offset:2048
ds_read_b64_tr_b16 a[232:233], v19 offset:0
v_exp_f32 v80, v80
v_mfma_f32_32x32x16_bf16 v[64:79], a[196:199], v[132:135], v[64:79]
ds_read_b64_tr_b16 a[234:235], v19 offset:2048
ds_read_b64_tr_b16 a[240:241], v20 offset:0
v_exp_f32 v81, v81
v_exp_f32 v82, v82
v_mfma_f32_32x32x16_bf16 v[64:79], a[200:203], v[144:147], v[64:79]
ds_read_b64_tr_b16 a[242:243], v20 offset:2048
ds_read_b64_tr_b16 a[248:249], v21 offset:0
ds_read_b64_tr_b16 a[250:251], v21 offset:2048
v_exp_f32 v83, v83
v_add_f32 v226, v226, v80
v_mfma_f32_32x32x16_bf16 v[64:79], a[204:207], v[148:151], v[64:79]
ds_read_b64_tr_b16 a[228:229], v18 offset:4096
ds_read_b64_tr_b16 a[230:231], v18 offset:6144
ds_read_b64_tr_b16 a[236:237], v19 offset:4096
v_add_f32 v227, v227, v81
v_cvt_pk_bf16_f32 v104, v80, v81
v_mfma_f32_32x32x16_bf16 v[64:79], a[208:211], v[160:163], v[64:79]
v_cmp_eq_u32 vcc, s32, v22
s_cmp_eq_u64 vcc, exec
s_cbranch_scc0 L_slow_11
L_slow_11_r:
ds_read_b64_tr_b16 a[238:239], v19 offset:6144
v_mfma_f32_32x32x16_bf16 v[64:79], a[212:215], v[164:167], v[64:79]
ds_read_b64_tr_b16 a[244:245], v20 offset:4096
s_mul_i32 s82, s4, 0x1600
ds_read_b64_tr_b16 a[246:247], v20 offset:6144
v_exp_f32 v84, v84
v_mfma_f32_32x32x16_bf16 v[64:79], a[216:219], v[176:179], v[64:79]
ds_read_b64_tr_b16 a[252:253], v21 offset:4096
ds_read_b64_tr_b16 a[254:255], v21 offset:6144
s_lshl_b32 s83, s5, 6
v_exp_f32 v85, v85
v_mfma_f32_32x32x16_bf16 v[64:79], a[220:223], v[180:183], v[64:79]
s_add_u32 s82, s82, s83
s_lshl_b32 s82, s82, 3
v_add_f32 v226, v226, v82
v_add_f32 v227, v227, v83
v_cvt_pk_bf16_f32 v105, v82, v83
s_waitcnt lgkmcnt(0)
v_mfma_f32_32x32x16_bf16 a[0:15], a[224:227], v[96:99], a[0:15]
s_add_u32 s82, s82, 0x1400000
v_exp_f32 v86, v86
v_exp_f32 v87, v87
v_add_f32 v226, v226, v84
v_mfma_f32_32x32x16_bf16 a[32:47], a[232:235], v[96:99], a[32:47]
v_add_f32 v227, v227, v85
v_cvt_pk_bf16_f32 v106, v84, v85
v_exp_f32 v88, v88
v_and_b32 v2, 31, v1
v_mfma_f32_32x32x16_bf16 a[64:79], a[240:243], v[96:99], a[64:79]
v_exp_f32 v89, v89
v_add_f32 v226, v226, v86
v_lshrrev_b32 v3, 5, v1
v_add_f32 v227, v227, v87
v_mfma_f32_32x32x16_bf16 a[96:111], a[248:251], v[96:99], a[96:111]
v_cvt_pk_bf16_f32 v107, v86, v87
v_exp_f32 v90, v90
v_exp_f32 v91, v91
v_mfma_f32_32x32x16_bf16 a[0:15], a[228:231], v[100:103], a[0:15]
v_add_f32 v226, v226, v88
v_add_f32 v227, v227, v89
v_cvt_pk_bf16_f32 v108, v88, v89
v_lshlrev_b32 v3, 11, v3
v_lshl_add_u32 v2, v2, 3, v3
buffer_load_dwordx2 v[40:41], v2, s[28:31], s82 offen sc1
v_mfma_f32_32x32x16_bf16 a[32:47], a[236:239], v[100:103], a[32:47]
buffer_load_dwordx2 v[42:43], v2, s[28:31], s82 offen offset:256 sc1
v_exp_f32 v92, v92
v_exp_f32 v93, v93
v_add_f32 v226, v226, v90
v_mfma_f32_32x32x16_bf16 a[64:79], a[244:247], v[100:103], a[64:79]
s_add_u32 s82, s82, 0x1000
v_add_f32 v227, v227, v91
v_cvt_pk_bf16_f32 v109, v90, v91
v_exp_f32 v94, v94
v_mfma_f32_32x32x16_bf16 a[96:111], a[252:255], v[100:103], a[96:111]
v_exp_f32 v95, v95
v_add_f32 v226, v226, v92
v_add_f32 v227, v227, v93
v_cvt_pk_bf16_f32 v110, v92, v93
v_add_f32 v226, v226, v94
v_add_f32 v227, v227, v95
v_cvt_pk_bf16_f32 v111, v94, v95
v_mfma_f32_32x32x16_bf16 v[80:95], a[192:195], v[136:139], v[208:223]
s_add_u32 m0, s90, 0x26000
v_exp_f32 v64, v64
v_exp_f32 v65, v65
v_mfma_f32_32x32x16_bf16 v[80:95], a[196:199], v[140:143], v[80:95]
buffer_load_dwordx4 v35, s[24:27], s89 offen lds
v_exp_f32 v66, v66
v_exp_f32 v67, v67
v_mfma_f32_32x32x16_bf16 v[80:95], a[200:203], v[152:155], v[80:95]
buffer_load_dwordx4 v35, s[24:27], s89 offen offset:1024 lds
buffer_load_dwordx2 v[44:45], v2, s[28:31], s82 offen sc1
v_add_f32 v224, v224, v64
v_add_f32 v225, v225, v65
v_mfma_f32_32x32x16_bf16 v[80:95], a[204:207], v[156:159], v[80:95]
s_add_u32 s89, s89, 0x2000
buffer_load_dwordx2 v[46:47], v2, s[28:31], s82 offen offset:256 sc1
v_cvt_pk_bf16_f32 v96, v64, v65
v_exp_f32 v68, v68
v_mfma_f32_32x32x16_bf16 v[80:95], a[208:211], v[168:171], v[80:95]
s_add_u32 m0, s90, 0x1e000
s_add_u32 s82, s82, 0x1000
v_exp_f32 v69, v69
v_add_f32 v224, v224, v66
v_add_f32 v225, v225, v67
v_mfma_f32_32x32x16_bf16 v[80:95], a[212:215], v[172:175], v[80:95]
buffer_load_dwordx4 v33, s[20:23], s88 offen lds
v_cvt_pk_bf16_f32 v97, v66, v67
v_exp_f32 v70, v70
v_mfma_f32_32x32x16_bf16 v[80:95], a[216:219], v[184:187], v[80:95]
buffer_load_dwordx4 v34, s[20:23], s88 offen offset:1024 lds
buffer_load_dwordx2 v[48:49], v2, s[28:31], s82 offen sc1
v_exp_f32 v71, v71
v_add_f32 v224, v224, v68
v_mfma_f32_32x32x16_bf16 v[80:95], a[220:223], v[188:191], v[80:95]
s_add_u32 s88, s88, 0x2000
v_add_f32 v225, v225, v69
v_cvt_pk_bf16_f32 v98, v68, v69
v_exp_f32 v72, v72
v_mfma_f32_32x32x16_bf16 a[16:31], a[224:227], v[104:107], a[16:31]
buffer_load_dwordx2 v[50:51], v2, s[28:31], s82 offen offset:256 sc1
ds_read_b128 a[192:195], v10 offset:16384
v_exp_f32 v73, v73
v_add_f32 v224, v224, v70
v_add_f32 v225, v225, v71
v_mfma_f32_32x32x16_bf16 a[48:63], a[232:235], v[104:107], a[48:63]
s_add_u32 s82, s82, 0x1000
ds_read_b128 a[196:199], v11 offset:16384
ds_read_b128 a[200:203], v12 offset:16384
v_cvt_pk_bf16_f32 v99, v70, v71
v_exp_f32 v74, v74
v_mfma_f32_32x32x16_bf16 a[80:95], a[240:243], v[104:107], a[80:95]
buffer_load_dwordx2 v[52:53], v2, s[28:31], s82 offen sc1
ds_read_b128 a[204:207], v13 offset:16384
v_exp_f32 v75, v75
v_add_f32 v224, v224, v72
v_mfma_f32_32x32x16_bf16 a[112:127], a[248:251], v[104:107], a[112:127]
buffer_load_dwordx2 v[54:55], v2, s[28:31], s82 offen offset:256 sc1
v_add_f32 v225, v225, v73
v_cvt_pk_bf16_f32 v100, v72, v73
v_exp_f32 v76, v76
v_mfma_f32_32x32x16_bf16 a[16:31], a[228:231], v[108:111], a[16:31]
ds_read_b128 a[208:211], v14 offset:16384
s_add_u32 s82, s82, 0x1000
v_exp_f32 v77, v77
v_add_f32 v224, v224, v74
v_add_f32 v225, v225, v75
v_mfma_f32_32x32x16_bf16 a[48:63], a[236:239], v[108:111], a[48:63]
ds_read_b128 a[212:215], v15 offset:16384
buffer_load_dwordx2 v[56:57], v2, s[28:31], s82 offen sc1
v_cvt_pk_bf16_f32 v101, v74, v75
v_exp_f32 v78, v78
v_mfma_f32_32x32x16_bf16 a[80:95], a[244:247], v[108:111], a[80:95]
ds_read_b128 a[216:219], v16 offset:16384
ds_read_b128 a[220:223], v17 offset:16384
v_exp_f32 v79, v79
v_add_f32 v224, v224, v76
v_add_f32 v225, v225, v77
v_mfma_f32_32x32x16_bf16 a[112:127], a[252:255], v[108:111], a[112:127]
buffer_load_dwordx2 v[58:59], v2, s[28:31], s82 offen offset:256 sc1
v_cvt_pk_bf16_f32 v102, v76, v77
v_add_f32 v224, v224, v78
v_add_f32 v225, v225, v79
v_cvt_pk_bf16_f32 v103, v78, v79
s_waitcnt vmcnt(15)
s_waitcnt lgkmcnt(0)
s_barrier
v_mfma_f32_32x32x16_bf16 v[64:79], a[192:195], v[128:131], v[192:207]
ds_read_b64_tr_b16 a[224:225], v18 offset:8192
ds_read_b64_tr_b16 a[226:227], v18 offset:10240
s_add_u32 s82, s82, 0x1000
v_exp_f32 v80, v80
v_mfma_f32_32x32x16_bf16 v[64:79], a[196:199], v[132:135], v[64:79]
ds_read_b64_tr_b16 a[232:233], v19 offset:8192
ds_read_b64_tr_b16 a[234:235], v19 offset:10240
ds_read_b64_tr_b16 a[240:241], v20 offset:8192
v_exp_f32 v81, v81
v_mfma_f32_32x32x16_bf16 v[64:79], a[200:203], v[144:147], v[64:79]
ds_read_b64_tr_b16 a[242:243], v20 offset:10240
ds_read_b64_tr_b16 a[248:249], v21 offset:8192
ds_read_b64_tr_b16 a[250:251], v21 offset:10240
v_exp_f32 v82, v82
v_mfma_f32_32x32x16_bf16 v[64:79], a[204:207], v[148:151], v[64:79]
ds_read_b64_tr_b16 a[228:229], v18 offset:12288
buffer_load_dwordx2 v[60:61], v2, s[28:31], s82 offen sc1
v_exp_f32 v83, v83
v_mfma_f32_32x32x16_bf16 v[64:79], a[208:211], v[160:163], v[64:79]
ds_read_b64_tr_b16 a[230:231], v18 offset:14336
ds_read_b64_tr_b16 a[236:237], v19 offset:12288
v_add_f32 v226, v226, v80
v_add_f32 v227, v227, v81
v_cvt_pk_bf16_f32 v104, v80, v81
v_mfma_f32_32x32x16_bf16 v[64:79], a[212:215], v[164:167], v[64:79]
ds_read_b64_tr_b16 a[238:239], v19 offset:14336
ds_read_b64_tr_b16 a[244:245], v20 offset:12288
ds_read_b64_tr_b16 a[246:247], v20 offset:14336
v_exp_f32 v84, v84
v_mfma_f32_32x32x16_bf16 v[64:79], a[216:219], v[176:179], v[64:79]
ds_read_b64_tr_b16 a[252:253], v21 offset:12288
ds_read_b64_tr_b16 a[254:255], v21 offset:14336
v_exp_f32 v85, v85
v_add_f32 v226, v226, v82
v_mfma_f32_32x32x16_bf16 v[64:79], a[220:223], v[180:183], v[64:79]
buffer_load_dwordx2 v[62:63], v2, s[28:31], s82 offen offset:256 sc1
s_add_u32 s82, s82, 0x1000
v_add_f32 v227, v227, v83
v_cvt_pk_bf16_f32 v105, v82, v83
s_waitcnt lgkmcnt(0)
v_mfma_f32_32x32x16_bf16 a[0:15], a[224:227], v[96:99], a[0:15]
buffer_load_dwordx2 v[112:113], v2, s[28:31], s82 offen sc1
v_exp_f32 v86, v86
v_exp_f32 v87, v87
v_mfma_f32_32x32x16_bf16 a[32:47], a[232:235], v[96:99], a[32:47]
v_add_f32 v226, v226, v84
v_add_f32 v227, v227, v85
v_cvt_pk_bf16_f32 v106, v84, v85
v_exp_f32 v88, v88
v_mfma_f32_32x32x16_bf16 a[64:79], a[240:243], v[96:99], a[64:79]
buffer_load_dwordx2 v[114:115], v2, s[28:31], s82 offen offset:256 sc1
v_exp_f32 v89, v89
v_add_f32 v226, v226, v86
v_add_f32 v227, v227, v87
v_mfma_f32_32x32x16_bf16 a[96:111], a[248:251], v[96:99], a[96:111]
s_add_u32 s82, s82, 0x1000
v_cvt_pk_bf16_f32 v107, v86, v87
v_exp_f32 v90, v90
v_exp_f32 v91, v91
v_mfma_f32_32x32x16_bf16 a[0:15], a[228:231], v[100:103], a[0:15]
v_add_f32 v226, v226, v88
v_add_f32 v227, v227, v89
v_cvt_pk_bf16_f32 v108, v88, v89
v_exp_f32 v92, v92
v_mfma_f32_32x32x16_bf16 a[32:47], a[236:239], v[100:103], a[32:47]
buffer_load_dwordx2 v[116:117], v2, s[28:31], s82 offen sc1
v_exp_f32 v93, v93
v_add_f32 v226, v226, v90
v_add_f32 v227, v227, v91
v_cvt_pk_bf16_f32 v109, v90, v91
v_mfma_f32_32x32x16_bf16 a[64:79], a[244:247], v[100:103], a[64:79]
buffer_load_dwordx2 v[118:119], v2, s[28:31], s82 offen offset:256 sc1
v_exp_f32 v94, v94
v_exp_f32 v95, v95
v_mfma_f32_32x32x16_bf16 a[96:111], a[252:255], v[100:103], a[96:111]
v_add_f32 v226, v226, v92
v_add_f32 v227, v227, v93
v_cvt_pk_bf16_f32 v110, v92, v93
v_add_f32 v226, v226, v94
v_add_f32 v227, v227, v95
v_cvt_pk_bf16_f32 v111, v94, v95
v_mfma_f32_32x32x16_bf16 v[80:95], a[192:195], v[136:139], v[208:223]
s_add_u32 m0, s90, 0x22000
s_add_u32 s82, s82, 0x1000
v_exp_f32 v64, v64
v_exp_f32 v65, v65
v_mfma_f32_32x32x16_bf16 v[80:95], a[196:199], v[140:143], v[80:95]
buffer_load_dwordx4 v35, s[24:27], s89 offen lds
v_exp_f32 v66, v66
v_exp_f32 v67, v67
v_mfma_f32_32x32x16_bf16 v[80:95], a[200:203], v[152:155], v[80:95]
buffer_load_dwordx4 v35, s[24:27], s89 offen offset:1024 lds
s_add_u32 s89, s89, 0x2000
v_add_f32 v224, v224, v64
v_add_f32 v225, v225, v65
v_cvt_pk_bf16_f32 v96, v64, v65
v_mfma_f32_32x32x16_bf16 v[80:95], a[204:207], v[156:159], v[80:95]
s_add_u32 m0, s90, 0x20000
v_exp_f32 v68, v68
v_exp_f32 v69, v69
v_add_f32 v224, v224, v66
v_mfma_f32_32x32x16_bf16 v[80:95], a[208:211], v[168:171], v[80:95]
buffer_load_dwordx4 v33, s[20:23], s88 offen lds
buffer_load_dwordx2 v[120:121], v2, s[28:31], s82 offen sc1
v_add_f32 v225, v225, v67
v_cvt_pk_bf16_f32 v97, v66, v67
v_mfma_f32_32x32x16_bf16 v[80:95], a[212:215], v[172:175], v[80:95]
buffer_load_dwordx2 v[122:123], v2, s[28:31], s82 offen offset:256 sc1
v_exp_f32 v70, v70
v_exp_f32 v71, v71
v_mfma_f32_32x32x16_bf16 v[80:95], a[216:219], v[184:187], v[80:95]
buffer_load_dwordx4 v34, s[20:23], s88 offen offset:1024 lds
s_add_u32 s82, s82, 0x1000
v_add_f32 v224, v224, v68
v_add_f32 v225, v225, v69
v_cvt_pk_bf16_f32 v98, v68, v69
v_mfma_f32_32x32x16_bf16 v[80:95], a[220:223], v[188:191], v[80:95]
s_add_u32 s88, s88, 0x2000
v_exp_f32 v72, v72
v_exp_f32 v73, v73
v_mfma_f32_32x32x16_bf16 a[16:31], a[224:227], v[104:107], a[16:31]
ds_read_b128 a[192:195], v10
buffer_load_dwordx2 v[124:125], v2, s[28:31], s82 offen sc1
v_add_f32 v224, v224, v70
v_add_f32 v225, v225, v71
v_cvt_pk_bf16_f32 v99, v70, v71
v_mfma_f32_32x32x16_bf16 a[48:63], a[232:235], v[104:107], a[48:63]
ds_read_b128 a[196:199], v11
ds_read_b128 a[200:203], v12
v_exp_f32 v74, v74
v_exp_f32 v75, v75
v_mfma_f32_32x32x16_bf16 a[80:95], a[240:243], v[104:107], a[80:95]
buffer_load_dwordx2 v[126:127], v2, s[28:31], s82 offen offset:256 sc1
ds_read_b128 a[204:207], v13
v_add_f32 v224, v224, v72
v_add_f32 v225, v225, v73
v_cvt_pk_bf16_f32 v100, v72, v73
v_mfma_f32_32x32x16_bf16 a[112:127], a[248:251], v[104:107], a[112:127]
ds_read_b128 a[208:211], v14
s_add_u32 s82, s82, 0x1000
v_exp_f32 v76, v76
v_exp_f32 v77, v77
v_mfma_f32_32x32x16_bf16 a[16:31], a[228:231], v[108:111], a[16:31]
ds_read_b128 a[212:215], v15
buffer_load_dwordx2 v[228:229], v2, s[28:31], s82 offen sc1
v_add_f32 v224, v224, v74
v_add_f32 v225, v225, v75
v_mfma_f32_32x32x16_bf16 a[48:63], a[236:239], v[108:111], a[48:63]
ds_read_b128 a[216:219], v16
ds_read_b128 a[220:223], v17
v_cvt_pk_bf16_f32 v101, v74, v75
v_exp_f32 v78, v78
v_mfma_f32_32x32x16_bf16 a[80:95], a[244:247], v[108:111], a[80:95]
buffer_load_dwordx2 v[230:231], v2, s[28:31], s82 offen offset:256 sc1
v_exp_f32 v79, v79
v_add_f32 v224, v224, v76
v_mfma_f32_32x32x16_bf16 a[112:127], a[252:255], v[108:111], a[112:127]
v_add_f32 v225, v225, v77
v_cvt_pk_bf16_f32 v102, v76, v77
v_add_f32 v224, v224, v78
v_add_f32 v225, v225, v79
v_cvt_pk_bf16_f32 v103, v78, v79
s_waitcnt vmcnt(22)
s_waitcnt lgkmcnt(0)
s_barrier
v_mfma_f32_32x32x16_bf16 v[64:79], a[192:195], v[128:131], v[192:207]
ds_read_b64_tr_b16 a[224:225], v18 offset:16384
ds_read_b64_tr_b16 a[226:227], v18 offset:18432
v_mov_b32 v4, v40
v_exp_f32 v80, v80
v_mov_b32 v5, v41
v_mov_b32 v6, v42
v_mfma_f32_32x32x16_bf16 v[64:79], a[196:199], v[132:135], v[64:79]
ds_read_b64_tr_b16 a[232:233], v19 offset:16384
ds_read_b64_tr_b16 a[234:235], v19 offset:18432
v_mov_b32 v7, v43
v_exp_f32 v81, v81
v_add_f32 v4, v4, v44
v_add_f32 v5, v5, v45
v_mfma_f32_32x32x16_bf16 v[64:79], a[200:203], v[144:147], v[64:79]
ds_read_b64_tr_b16 a[240:241], v20 offset:16384
ds_read_b64_tr_b16 a[242:243], v20 offset:18432
v_add_f32 v6, v6, v46
v_exp_f32 v82, v82
v_add_f32 v7, v7, v47
s_waitcnt vmcnt(21)
v_add_f32 v4, v4, v48
v_mfma_f32_32x32x16_bf16 v[64:79], a[204:207], v[148:151], v[64:79]
ds_read_b64_tr_b16 a[248:249], v21 offset:16384
ds_read_b64_tr_b16 a[250:251], v21 offset:18432
v_add_f32 v5, v5, v49
v_exp_f32 v83, v83
s_waitcnt vmcnt(20)
v_add_f32 v6, v6, v50
v_add_f32 v7, v7, v51
v_mfma_f32_32x32x16_bf16 v[64:79], a[208:211], v[160:163], v[64:79]
ds_read_b64_tr_b16 a[228:229], v18 offset:20480
ds_read_b64_tr_b16 a[230:231], v18 offset:22528
ds_read_b64_tr_b16 a[236:237], v19 offset:20480
v_add_f32 v226, v226, v80
s_waitcnt vmcnt(19)
v_add_f32 v4, v4, v52
v_add_f32 v227, v227, v81
v_add_f32 v5, v5, v53
v_mfma_f32_32x32x16_bf16 v[64:79], a[212:215], v[164:167], v[64:79]
ds_read_b64_tr_b16 a[238:239], v19 offset:22528
ds_read_b64_tr_b16 a[244:245], v20 offset:20480
v_cvt_pk_bf16_f32 v104, v80, v81
s_waitcnt vmcnt(18)
v_add_f32 v6, v6, v54
v_exp_f32 v84, v84
v_add_f32 v7, v7, v55
v_mfma_f32_32x32x16_bf16 v[64:79], a[216:219], v[176:179], v[64:79]
ds_read_b64_tr_b16 a[246:247], v20 offset:22528
ds_read_b64_tr_b16 a[252:253], v21 offset:20480
ds_read_b64_tr_b16 a[254:255], v21 offset:22528
s_waitcnt vmcnt(17)
v_add_f32 v4, v4, v56
v_exp_f32 v85, v85
v_add_f32 v5, v5, v57
v_mfma_f32_32x32x16_bf16 v[64:79], a[220:223], v[180:183], v[64:79]
s_waitcnt vmcnt(16)
v_add_f32 v6, v6, v58
v_add_f32 v226, v226, v82
v_add_f32 v7, v7, v59
v_add_f32 v227, v227, v83
s_waitcnt vmcnt(15)
v_add_f32 v4, v4, v60
v_cvt_pk_bf16_f32 v105, v82, v83
v_add_f32 v5, v5, v61
s_waitcnt lgkmcnt(0)
v_mfma_f32_32x32x16_bf16 a[0:15], a[224:227], v[96:99], a[0:15]
v_exp_f32 v86, v86
s_waitcnt vmcnt(14)
v_add_f32 v6, v6, v62
v_exp_f32 v87, v87
v_mfma_f32_32x32x16_bf16 a[32:47], a[232:235], v[96:99], a[32:47]
v_add_f32 v226, v226, v84
v_add_f32 v7, v7, v63
v_add_f32 v227, v227, v85
s_waitcnt vmcnt(13)
v_add_f32 v4, v4, v112
v_cvt_pk_bf16_f32 v106, v84, v85
v_mfma_f32_32x32x16_bf16 a[64:79], a[240:243], v[96:99], a[64:79]
v_exp_f32 v88, v88
v_add_f32 v5, v5, v113
s_waitcnt vmcnt(12)
v_add_f32 v6, v6, v114
v_add_f32 v7, v7, v115
v_mfma_f32_32x32x16_bf16 a[96:111], a[248:251], v[96:99], a[96:111]
v_exp_f32 v89, v89
s_waitcnt vmcnt(11)
v_add_f32 v4, v4, v116
v_add_f32 v226, v226, v86
v_add_f32 v5, v5, v117
v_mfma_f32_32x32x16_bf16 a[0:15], a[228:231], v[100:103], a[0:15]
v_add_f32 v227, v227, v87
v_cvt_pk_bf16_f32 v107, v86, v87
s_waitcnt vmcnt(10)
v_add_f32 v6, v6, v118
v_exp_f32 v90, v90
v_mfma_f32_32x32x16_bf16 a[32:47], a[236:239], v[100:103], a[32:47]
v_exp_f32 v91, v91
v_add_f32 v7, v7, v119
s_waitcnt vmcnt(6)
v_add_f32 v4, v4, v120
v_add_f32 v226, v226, v88
v_mfma_f32_32x32x16_bf16 a[64:79], a[244:247], v[100:103], a[64:79]
v_add_f32 v227, v227, v89
v_add_f32 v5, v5, v121
v_cvt_pk_bf16_f32 v108, v88, v89
s_waitcnt vmcnt(5)
v_add_f32 v6, v6, v122
v_add_f32 v7, v7, v123
v_mfma_f32_32x32x16_bf16 a[96:111], a[252:255], v[100:103], a[96:111]
v_exp_f32 v92, v92
s_waitcnt vmcnt(3)
v_add_f32 v4, v4, v124
v_exp_f32 v93, v93
v_add_f32 v5, v5, v125
s_waitcnt vmcnt(2)
v_add_f32 v6, v6, v126
v_add_f32 v226, v226, v90
v_add_f32 v7, v7, v127
v_add_f32 v227, v227, v91
s_waitcnt vmcnt(1)
v_add_f32 v4, v4, v228
v_cvt_pk_bf16_f32 v109, v90, v91
v_add_f32 v5, v5, v229
v_exp_f32 v94, v94
s_waitcnt vmcnt(0)
v_add_f32 v6, v6, v230
v_add_f32 v7, v7, v231
v_exp_f32 v95, v95
v_mov_b32 v40, v4
v_mov_b32 v41, v5
v_add_f32 v226, v226, v92
v_mov_b32 v42, v6
v_add_f32 v227, v227, v93
v_mov_b32 v43, v7
v_cvt_pk_bf16_f32 v110, v92, v93
v_permlane32_swap_b32 v4, v40
v_add_f32 v226, v226, v94
v_permlane32_swap_b32 v5, v41
v_add_f32 v227, v227, v95
v_cvt_pk_bf16_f32 v111, v94, v95
v_mfma_f32_32x32x16_bf16 v[80:95], a[192:195], v[136:139], v[208:223]
s_add_u32 m0, s90, 0x24000
v_exp_f32 v64, v64
v_permlane32_swap_b32 v6, v42
v_permlane32_swap_b32 v7, v43
v_add_f32 v4, v4, v40
v_mfma_f32_32x32x16_bf16 v[80:95], a[196:199], v[140:143], v[80:95]
buffer_load_dwordx4 v35, s[24:27], s89 offen lds
v_exp_f32 v65, v65
v_add_f32 v5, v5, v41
v_add_f32 v6, v6, v42
v_add_f32 v7, v7, v43
v_mfma_f32_32x32x16_bf16 v[80:95], a[200:203], v[152:155], v[80:95]
buffer_load_dwordx4 v35, s[24:27], s89 offen offset:1024 lds
v_exp_f32 v66, v66
v_mul_f32 v4, 0x3abe82fa, v4
v_mul_f32 v5, 0x3abe82fa, v5
v_fma_f32 v5, -v4, v4, v5
v_mfma_f32_32x32x16_bf16 v[80:95], a[204:207], v[156:159], v[80:95]
s_add_u32 s89, s89, 0x2000
s_add_u32 m0, s90, 0x1c000
v_exp_f32 v67, v67
v_add_f32 v5, 0x3727c5ac, v5
v_rsq_f32 v5, v5
v_mfma_f32_32x32x16_bf16 v[80:95], a[208:211], v[168:171], v[80:95]
buffer_load_dwordx4 v33, s[20:23], s88 offen lds
v_add_f32 v224, v224, v64
v_mul_f32 v4, v4, v5
v_add_f32 v225, v225, v65
v_mul_f32 v6, 0x3abe82fa, v6
v_cvt_pk_bf16_f32 v96, v64, v65
v_mfma_f32_32x32x16_bf16 v[80:95], a[212:215], v[172:175], v[80:95]
buffer_load_dwordx4 v34, s[20:23], s88 offen offset:1024 lds
v_exp_f32 v68, v68
v_mul_f32 v7, 0x3abe82fa, v7
v_fma_f32 v7, -v6, v6, v7
v_add_f32 v7, 0x3727c5ac, v7
v_mfma_f32_32x32x16_bf16 v[80:95], a[216:219], v[184:187], v[80:95]
s_add_u32 s88, s88, 0x2000
v_exp_f32 v69, v69
v_rsq_f32 v7, v7
v_add_f32 v224, v224, v66
v_mfma_f32_32x32x16_bf16 v[80:95], a[220:223], v[188:191], v[80:95]
v_add_f32 v225, v225, v67
v_mul_f32 v6, v6, v7
v_cvt_pk_bf16_f32 v97, v66, v67
v_exp_f32 v70, v70
v_mfma_f32_32x32x16_bf16 a[16:31], a[224:227], v[104:107], a[16:31]
ds_read_b128 a[192:195], v10 offset:8192
ds_read_b128 a[196:199], v11 offset:8192
v_exp_f32 v71, v71
v_mov_b32 v43, 0xffff0000
v_lshlrev_b32 v44, 16, v240
v_add_f32 v224, v224, v68
v_mfma_f32_32x32x16_bf16 a[48:63], a[232:235], v[104:107], a[48:63]
ds_read_b128 a[200:203], v12 offset:8192
ds_read_b128 a[204:207], v13 offset:8192
v_add_f32 v225, v225, v69
v_and_b32 v45, v43, v240
v_cvt_pk_bf16_f32 v98, v68, v69
v_fma_f32 v44, v44, v5, -v4
v_fma_f32 v45, v45, v5, -v4
v_mfma_f32_32x32x16_bf16 a[80:95], a[240:243], v[104:107], a[80:95]
ds_read_b128 a[208:211], v14 offset:8192
ds_read_b128 a[212:215], v15 offset:8192
v_exp_f32 v72, v72
v_cvt_pk_bf16_f32 v240, v44, v45
v_lshlrev_b32 v46, 16, v241
v_and_b32 v47, v43, v241
v_mfma_f32_32x32x16_bf16 a[112:127], a[248:251], v[104:107], a[112:127]
ds_read_b128 a[216:219], v16 offset:8192
ds_read_b128 a[220:223], v17 offset:8192
v_exp_f32 v73, v73
v_fma_f32 v46, v46, v5, -v4
v_add_f32 v224, v224, v70
v_fma_f32 v47, v47, v5, -v4
v_mfma_f32_32x32x16_bf16 a[16:31], a[228:231], v[108:111], a[16:31]
v_add_f32 v225, v225, v71
v_cvt_pk_bf16_f32 v99, v70, v71
v_cvt_pk_bf16_f32 v241, v46, v47
v_exp_f32 v74, v74
v_mfma_f32_32x32x16_bf16 a[48:63], a[236:239], v[108:111], a[48:63]
v_exp_f32 v75, v75
v_lshlrev_b32 v44, 16, v242
v_add_f32 v224, v224, v72
v_and_b32 v45, v43, v242
v_mfma_f32_32x32x16_bf16 a[80:95], a[244:247], v[108:111], a[80:95]
v_add_f32 v225, v225, v73
v_cvt_pk_bf16_f32 v100, v72, v73
v_fma_f32 v44, v44, v5, -v4
v_exp_f32 v76, v76
v_mfma_f32_32x32x16_bf16 a[112:127], a[252:255], v[108:111], a[112:127]
v_exp_f32 v77, v77
v_fma_f32 v45, v45, v5, -v4
v_cvt_pk_bf16_f32 v242, v44, v45
v_add_f32 v224, v224, v74
v_lshlrev_b32 v46, 16, v243
v_add_f32 v225, v225, v75
v_and_b32 v47, v43, v243
v_cvt_pk_bf16_f32 v101, v74, v75
v_fma_f32 v46, v46, v5, -v4
v_exp_f32 v78, v78
v_fma_f32 v47, v47, v5, -v4
v_cvt_pk_bf16_f32 v243, v46, v47
v_exp_f32 v79, v79
v_lshlrev_b32 v44, 16, v244
v_and_b32 v45, v43, v244
v_add_f32 v224, v224, v76
v_fma_f32 v44, v44, v5, -v4
v_add_f32 v225, v225, v77
v_fma_f32 v45, v45, v5, -v4
v_cvt_pk_bf16_f32 v102, v76, v77
v_cvt_pk_bf16_f32 v244, v44, v45
v_add_f32 v224, v224, v78
v_lshlrev_b32 v46, 16, v245
v_add_f32 v225, v225, v79
v_and_b32 v47, v43, v245
v_cvt_pk_bf16_f32 v103, v78, v79
v_fma_f32 v46, v46, v5, -v4
s_waitcnt lgkmcnt(0)
s_barrier
v_mfma_f32_32x32x16_bf16 v[64:79], a[192:195], v[128:131], v[192:207]
ds_read_b64_tr_b16 a[224:225], v18 offset:0
ds_read_b64_tr_b16 a[226:227], v18 offset:2048
v_fma_f32 v47, v47, v5, -v4
v_exp_f32 v80, v80
v_cvt_pk_bf16_f32 v245, v46, v47
v_lshlrev_b32 v44, 16, v246
v_mfma_f32_32x32x16_bf16 v[64:79], a[196:199], v[132:135], v[64:79]
ds_read_b64_tr_b16 a[232:233], v19 offset:0
ds_read_b64_tr_b16 a[234:235], v19 offset:2048
v_and_b32 v45, v43, v246
v_exp_f32 v81, v81
v_fma_f32 v44, v44, v5, -v4
v_fma_f32 v45, v45, v5, -v4
v_mfma_f32_32x32x16_bf16 v[64:79], a[200:203], v[144:147], v[64:79]
ds_read_b64_tr_b16 a[240:241], v20 offset:0
ds_read_b64_tr_b16 a[242:243], v20 offset:2048
v_cvt_pk_bf16_f32 v246, v44, v45
v_exp_f32 v82, v82
v_lshlrev_b32 v46, 16, v247
v_and_b32 v47, v43, v247
v_mfma_f32_32x32x16_bf16 v[64:79], a[204:207], v[148:151], v[64:79]
ds_read_b64_tr_b16 a[248:249], v21 offset:0
ds_read_b64_tr_b16 a[250:251], v21 offset:2048
v_fma_f32 v46, v46, v5, -v4
v_exp_f32 v83, v83
v_fma_f32 v47, v47, v5, -v4
v_cvt_pk_bf16_f32 v247, v46, v47
v_mfma_f32_32x32x16_bf16 v[64:79], a[208:211], v[160:163], v[64:79]
ds_read_b64_tr_b16 a[228:229], v18 offset:4096
ds_read_b64_tr_b16 a[230:231], v18 offset:6144
ds_read_b64_tr_b16 a[236:237], v19 offset:4096
v_add_f32 v226, v226, v80
v_lshlrev_b32 v44, 16, v248
v_add_f32 v227, v227, v81
v_and_b32 v45, v43, v248
v_mfma_f32_32x32x16_bf16 v[64:79], a[212:215], v[164:167], v[64:79]
ds_read_b64_tr_b16 a[238:239], v19 offset:6144
ds_read_b64_tr_b16 a[244:245], v20 offset:4096
v_cvt_pk_bf16_f32 v104, v80, v81
v_fma_f32 v44, v44, v7, -v6
v_exp_f32 v84, v84
v_fma_f32 v45, v45, v7, -v6
v_mfma_f32_32x32x16_bf16 v[64:79], a[216:219], v[176:179], v[64:79]
ds_read_b64_tr_b16 a[246:247], v20 offset:6144
ds_read_b64_tr_b16 a[252:253], v21 offset:4096
ds_read_b64_tr_b16 a[254:255], v21 offset:6144
v_cvt_pk_bf16_f32 v248, v44, v45
v_exp_f32 v85, v85
v_lshlrev_b32 v46, 16, v249
v_mfma_f32_32x32x16_bf16 v[64:79], a[220:223], v[180:183], v[64:79]
v_and_b32 v47, v43, v249
v_add_f32 v226, v226, v82
v_fma_f32 v46, v46, v7, -v6
v_add_f32 v227, v227, v83
v_fma_f32 v47, v47, v7, -v6
v_cvt_pk_bf16_f32 v105, v82, v83
v_cvt_pk_bf16_f32 v249, v46, v47
s_waitcnt lgkmcnt(0)
v_mfma_f32_32x32x16_bf16 a[0:15], a[224:227], v[96:99], a[0:15]
v_exp_f32 v86, v86
v_lshlrev_b32 v44, 16, v250
v_exp_f32 v87, v87
v_mfma_f32_32x32x16_bf16 a[32:47], a[232:235], v[96:99], a[32:47]
v_add_f32 v226, v226, v84
v_and_b32 v45, v43, v250
v_add_f32 v227, v227, v85
v_fma_f32 v44, v44, v7, -v6
v_cvt_pk_bf16_f32 v106, v84, v85
v_mfma_f32_32x32x16_bf16 a[64:79], a[240:243], v[96:99], a[64:79]
v_exp_f32 v88, v88
v_fma_f32 v45, v45, v7, -v6
v_cvt_pk_bf16_f32 v250, v44, v45
v_lshlrev_b32 v46, 16, v251
v_mfma_f32_32x32x16_bf16 a[96:111], a[248:251], v[96:99], a[96:111]
v_exp_f32 v89, v89
v_and_b32 v47, v43, v251
v_add_f32 v226, v226, v86
v_fma_f32 v46, v46, v7, -v6
v_mfma_f32_32x32x16_bf16 a[0:15], a[228:231], v[100:103], a[0:15]
v_add_f32 v227, v227, v87
v_cvt_pk_bf16_f32 v107, v86, v87
v_fma_f32 v47, v47, v7, -v6
v_exp_f32 v90, v90
v_mfma_f32_32x32x16_bf16 a[32:47], a[236:239], v[100:103], a[32:47]
v_exp_f32 v91, v91
v_cvt_pk_bf16_f32 v251, v46, v47
v_lshlrev_b32 v44, 16, v252
v_add_f32 v226, v226, v88
v_mfma_f32_32x32x16_bf16 a[64:79], a[244:247], v[100:103], a[64:79]
v_add_f32 v227, v227, v89
v_and_b32 v45, v43, v252
v_cvt_pk_bf16_f32 v108, v88, v89
v_fma_f32 v44, v44, v7, -v6
v_fma_f32 v45, v45, v7, -v6
v_mfma_f32_32x32x16_bf16 a[96:111], a[252:255], v[100:103], a[96:111]
v_exp_f32 v92, v92
v_cvt_pk_bf16_f32 v252, v44, v45
v_exp_f32 v93, v93
v_lshlrev_b32 v46, 16, v253
v_and_b32 v47, v43, v253
v_add_f32 v226, v226, v90
v_fma_f32 v46, v46, v7, -v6
v_add_f32 v227, v227, v91
v_fma_f32 v47, v47, v7, -v6
v_cvt_pk_bf16_f32 v109, v90, v91
v_cvt_pk_bf16_f32 v253, v46, v47
v_exp_f32 v94, v94
v_lshlrev_b32 v44, 16, v254
v_and_b32 v45, v43, v254
v_exp_f32 v95, v95
v_fma_f32 v44, v44, v7, -v6
v_fma_f32 v45, v45, v7, -v6
v_add_f32 v226, v226, v92
v_cvt_pk_bf16_f32 v254, v44, v45
v_add_f32 v227, v227, v93
v_lshlrev_b32 v46, 16, v255
v_cvt_pk_bf16_f32 v110, v92, v93
v_and_b32 v47, v43, v255
v_add_f32 v226, v226, v94
v_fma_f32 v46, v46, v7, -v6
v_add_f32 v227, v227, v95
v_fma_f32 v47, v47, v7, -v6
v_cvt_pk_bf16_f32 v111, v94, v95
v_mfma_f32_32x32x16_bf16 v[80:95], a[192:195], v[136:139], v[208:223]
s_add_u32 m0, s90, 0x26000
v_exp_f32 v64, v64
v_cvt_pk_bf16_f32 v255, v46, v47
s_lshl_b32 s84, s5, 12
v_exp_f32 v65, v65
v_mfma_f32_32x32x16_bf16 v[80:95], a[196:199], v[140:143], v[80:95]
s_add_u32 s84, s84, 0x18000
buffer_load_dwordx4 v35, s[24:27], s89 offen lds
v_exp_f32 v66, v66
v_and_b32 v40, 31, v1
v_lshlrev_b32 v40, 6, v40
v_mfma_f32_32x32x16_bf16 v[80:95], a[200:203], v[152:155], v[80:95]
buffer_load_dwordx4 v35, s[24:27], s89 offen offset:1024 lds
v_exp_f32 v67, v67
v_lshrrev_b32 v41, 5, v1
v_lshl_add_u32 v40, v41, 4, v40
v_add_f32 v224, v224, v64
v_mfma_f32_32x32x16_bf16 v[80:95], a[204:207], v[156:159], v[80:95]
s_add_u32 s89, s89, 0x2000
v_add_f32 v225, v225, v65
v_add_u32 v40, s84, v40
v_cvt_pk_bf16_f32 v96, v64, v65
ds_write_b128 v40, v[240:243] offset:0
v_exp_f32 v68, v68
v_mfma_f32_32x32x16_bf16 v[80:95], a[208:211], v[168:171], v[80:95]
ds_write_b128 v40, v[244:247] offset:32
ds_write_b128 v40, v[248:251] offset:2048
s_add_u32 m0, s90, 0x1e000
ds_write_b128 v40, v[252:255] offset:2080
v_exp_f32 v69, v69
v_add_f32 v224, v224, v66
v_mfma_f32_32x32x16_bf16 v[80:95], a[212:215], v[172:175], v[80:95]
buffer_load_dwordx4 v33, s[20:23], s88 offen lds
v_add_f32 v225, v225, v67
v_lshrrev_b32 v2, 5, v1
v_cvt_pk_bf16_f32 v97, v66, v67
v_bfe_u32 v3, v1, 4, 1
v_bfe_u32 v8, v1, 2, 2
v_mfma_f32_32x32x16_bf16 v[80:95], a[216:219], v[184:187], v[80:95]
buffer_load_dwordx4 v34, s[20:23], s88 offen offset:1024 lds
v_exp_f32 v70, v70
v_and_b32 v9, 3, v1
v_lshl_add_u32 v41, v2, 3, v8
v_lshlrev_b32 v41, 6, v41
v_mfma_f32_32x32x16_bf16 v[80:95], a[220:223], v[188:191], v[80:95]
s_add_u32 s88, s88, 0x2000
v_exp_f32 v71, v71
v_lshl_add_u32 v41, v3, 5, v41
v_and_b32 v42, 1, v9
v_add_f32 v224, v224, v68
v_mfma_f32_32x32x16_bf16 a[16:31], a[224:227], v[104:107], a[16:31]
ds_read_b128 a[192:195], v10 offset:16384
ds_read_b128 a[196:199], v11 offset:16384
v_add_f32 v225, v225, v69
v_lshl_add_u32 v41, v42, 4, v41
v_cvt_pk_bf16_f32 v98, v68, v69
v_lshrrev_b32 v42, 1, v9
v_lshl_add_u32 v41, v42, 3, v41
v_mfma_f32_32x32x16_bf16 a[48:63], a[232:235], v[104:107], a[48:63]
v_exp_f32 v72, v72
v_add_u32 v41, s84, v41
s_waitcnt lgkmcnt(0)
v_exp_f32 v73, v73
ds_read_b64_tr_b16 v[48:49], v41 offset:0
v_mfma_f32_32x32x16_bf16 a[80:95], a[240:243], v[104:107], a[80:95]
ds_read_b64_tr_b16 v[50:51], v41 offset:256
ds_read_b64_tr_b16 v[52:53], v41 offset:1024
ds_read_b64_tr_b16 v[54:55], v41 offset:1280
ds_read_b128 a[200:203], v12 offset:16384
v_add_f32 v224, v224, v70
v_add_f32 v225, v225, v71
v_cvt_pk_bf16_f32 v99, v70, v71
v_mfma_f32_32x32x16_bf16 a[112:127], a[248:251], v[104:107], a[112:127]
ds_read_b64_tr_b16 v[56:57], v41 offset:2048
ds_read_b64_tr_b16 v[58:59], v41 offset:2304
ds_read_b64_tr_b16 v[60:61], v41 offset:3072
v_exp_f32 v74, v74
v_exp_f32 v75, v75
v_mfma_f32_32x32x16_bf16 a[16:31], a[228:231], v[108:111], a[16:31]
ds_read_b64_tr_b16 v[62:63], v41 offset:3328
s_lshl_b32 s82, s92, 7
s_lshl_b32 s83, s4, 4
ds_read_b128 a[204:207], v13 offset:16384
v_add_f32 v224, v224, v72
v_add_f32 v225, v225, v73
v_cvt_pk_bf16_f32 v100, v72, v73
v_mfma_f32_32x32x16_bf16 a[48:63], a[236:239], v[108:111], a[48:63]
s_add_u32 s82, s82, s83
s_lshl_b32 s83, s5, 2
s_add_u32 s82, s82, s83
v_exp_f32 v76, v76
v_exp_f32 v77, v77
v_mfma_f32_32x32x16_bf16 a[80:95], a[244:247], v[108:111], a[80:95]
ds_read_b128 a[208:211], v14 offset:16384
ds_read_b128 a[212:215], v15 offset:16384
ds_read_b128 a[216:219], v16 offset:16384
ds_read_b128 a[220:223], v17 offset:16384
s_lshl_b32 s82, s82, 10
v_add_f32 v224, v224, v74
v_add_f32 v225, v225, v75
v_mfma_f32_32x32x16_bf16 a[112:127], a[252:255], v[108:111], a[112:127]
s_add_u32 s82, s82, 0x1500000
s_cmp_lt_u32 s92, 22
s_cselect_b32 s82, s82, 0x10000000
v_cvt_pk_bf16_f32 v101, v74, v75
v_exp_f32 v78, v78
v_lshlrev_b32 v40, 4, v1
v_exp_f32 v79, v79
s_waitcnt lgkmcnt(12)
buffer_store_dwordx4 v[48:51], v40, s[28:31], s82 offen sc0 sc1
v_add_f32 v224, v224, v76
s_waitcnt lgkmcnt(10)
buffer_store_dwordx4 v[52:55], v40, s[28:31], s82 offen offset:1024 sc0 sc1
v_add_f32 v225, v225, v77
v_cvt_pk_bf16_f32 v102, v76, v77
s_waitcnt lgkmcnt(7)
buffer_store_dwordx4 v[56:59], v40, s[28:31], s82 offen offset:2048 sc0 sc1
v_add_f32 v224, v224, v78
v_add_f32 v225, v225, v79
s_waitcnt lgkmcnt(5)
buffer_store_dwordx4 v[60:63], v40, s[28:31], s82 offen offset:3072 sc0 sc1
v_cvt_pk_bf16_f32 v103, v78, v79
s_waitcnt vmcnt(8)
s_waitcnt lgkmcnt(0)
s_barrier
v_mfma_f32_32x32x16_bf16 v[64:79], a[192:195], v[128:131], v[192:207]
ds_read_b64_tr_b16 a[224:225], v18 offset:8192
s_and_b32 s6, s2, 7
ds_read_b64_tr_b16 a[226:227], v18 offset:10240
s_lshl_b32 s6, s6, 2
ds_read_b64_tr_b16 a[232:233], v19 offset:8192
v_exp_f32 v80, v80
v_mfma_f32_32x32x16_bf16 v[64:79], a[196:199], v[132:135], v[64:79]
ds_read_b64_tr_b16 a[234:235], v19 offset:10240
s_lshr_b32 s82, s2, 3
ds_read_b64_tr_b16 a[240:241], v20 offset:8192
s_and_b32 s40, s82, 3
ds_read_b64_tr_b16 a[242:243], v20 offset:10240
v_exp_f32 v81, v81
v_mfma_f32_32x32x16_bf16 v[64:79], a[200:203], v[144:147], v[64:79]
ds_read_b64_tr_b16 a[248:249], v21 offset:8192
s_add_u32 s40, s40, s6
s_lshr_b32 s41, s2, 5
ds_read_b64_tr_b16 a[250:251], v21 offset:10240
v_exp_f32 v82, v82
v_mfma_f32_32x32x16_bf16 v[64:79], a[204:207], v[148:151], v[64:79]
ds_read_b64_tr_b16 a[228:229], v18 offset:12288
s_mul_i32 s42, s41, 3
s_min_u32 s42, s42, 19
ds_read_b64_tr_b16 a[230:231], v18 offset:14336
v_exp_f32 v83, v83
v_mfma_f32_32x32x16_bf16 v[64:79], a[208:211], v[160:163], v[64:79]
ds_read_b64_tr_b16 a[236:237], v19 offset:12288
s_lshl_b32 s82, s40, 18
s_lshl_b32 s83, s5, 10
ds_read_b64_tr_b16 a[238:239], v19 offset:14336
v_add_f32 v226, v226, v80
v_add_f32 v227, v227, v81
v_mfma_f32_32x32x16_bf16 v[64:79], a[212:215], v[164:167], v[64:79]
ds_read_b64_tr_b16 a[244:245], v20 offset:12288
s_add_u32 s82, s82, s83
ds_read_b64_tr_b16 a[246:247], v20 offset:14336
v_cvt_pk_bf16_f32 v104, v80, v81
v_exp_f32 v84, v84
v_mfma_f32_32x32x16_bf16 v[64:79], a[216:219], v[176:179], v[64:79]
ds_read_b64_tr_b16 a[252:253], v21 offset:12288
ds_read_b64_tr_b16 a[254:255], v21 offset:14336
s_add_u32 s8, s70, s82
s_addc_u32 s9, s71, 0
v_exp_f32 v85, v85
v_mfma_f32_32x32x16_bf16 v[64:79], a[220:223], v[180:183], v[64:79]
s_and_b32 s9, s9, 0xffff
s_mov_b32 s10, 0x40000
s_mov_b32 s11, 0x20000
v_add_f32 v226, v226, v82
v_add_f32 v227, v227, v83
v_cvt_pk_bf16_f32 v105, v82, v83
s_waitcnt lgkmcnt(0)
v_mfma_f32_32x32x16_bf16 a[0:15], a[224:227], v[96:99], a[0:15]
s_mov_b32 s33, 0x7c00
s_mov_b32 s34, 0xf800
s_mov_b32 s35, 0x17400
v_exp_f32 v86, v86
v_exp_f32 v87, v87
v_mfma_f32_32x32x16_bf16 a[32:47], a[232:235], v[96:99], a[32:47]
s_mov_b32 s36, 0x20000
s_mov_b32 s37, 0x27c00
v_add_f32 v226, v226, v84
v_add_f32 v227, v227, v85
v_cvt_pk_bf16_f32 v106, v84, v85
v_exp_f32 v88, v88
v_mfma_f32_32x32x16_bf16 a[64:79], a[240:243], v[96:99], a[64:79]
s_mov_b32 s38, 0x2f800
s_mov_b32 s39, 0x37400
s_mul_i32 s46, s5, 0x6000
v_exp_f32 v89, v89
v_add_f32 v226, v226, v86
v_add_f32 v227, v227, v87
v_mfma_f32_32x32x16_bf16 a[96:111], a[248:251], v[96:99], a[96:111]
v_cvt_pk_bf16_f32 v107, v86, v87
v_exp_f32 v90, v90
v_lshrrev_b32 v2, 3, v1
v_lshlrev_b32 v2, 12, v2
v_mfma_f32_32x32x16_bf16 a[0:15], a[228:231], v[100:103], a[0:15]
v_exp_f32 v91, v91
v_add_f32 v226, v226, v88
v_and_b32 v3, 7, v1
v_add_f32 v227, v227, v89
v_mfma_f32_32x32x16_bf16 a[32:47], a[236:239], v[100:103], a[32:47]
v_cvt_pk_bf16_f32 v108, v88, v89
v_exp_f32 v92, v92
v_lshrrev_b32 v4, 4, v1
v_xor_b32 v3, v3, v4
v_mfma_f32_32x32x16_bf16 a[64:79], a[244:247], v[100:103], a[64:79]
v_exp_f32 v93, v93
v_add_f32 v226, v226, v90
v_lshl_add_u32 v23, v3, 4, v2
v_add_f32 v227, v227, v91
v_mfma_f32_32x32x16_bf16 a[96:111], a[252:255], v[100:103], a[96:111]
v_cvt_pk_bf16_f32 v109, v90, v91
v_exp_f32 v94, v94
v_xor_b32 v3, 4, v3
v_exp_f32 v95, v95
v_lshl_add_u32 v24, v3, 4, v2
v_and_b32 v3, 31, v1
v_add_f32 v226, v226, v92
v_bfe_u32 v4, v1, 1, 3
v_add_f32 v227, v227, v93
v_lshlrev_b32 v3, 7, v3
v_cvt_pk_bf16_f32 v110, v92, v93
v_add_u32 v3, s46, v3
v_add_f32 v226, v226, v94
v_lshrrev_b32 v2, 5, v1
v_add_f32 v227, v227, v95
v_cvt_pk_bf16_f32 v111, v94, v95
v_mfma_f32_32x32x16_bf16 v[80:95], a[192:195], v[136:139], v[208:223]
s_add_u32 m0, s90, 0x22000
v_exp_f32 v64, v64
v_xor_b32 v4, v4, v2
v_exp_f32 v65, v65
v_mfma_f32_32x32x16_bf16 v[80:95], a[196:199], v[140:143], v[80:95]
buffer_load_dwordx4 v35, s[24:27], s89 offen lds
v_exp_f32 v66, v66
v_xor_b32 v5, 0, v4
v_exp_f32 v67, v67
v_mfma_f32_32x32x16_bf16 v[80:95], a[200:203], v[152:155], v[80:95]
buffer_load_dwordx4 v35, s[24:27], s89 offen offset:1024 lds
v_add_f32 v224, v224, v64
v_lshl_add_u32 v25, v5, 4, v3
v_add_f32 v225, v225, v65
v_xor_b32 v5, 2, v4
v_cvt_pk_bf16_f32 v96, v64, v65
v_mfma_f32_32x32x16_bf16 v[80:95], a[204:207], v[156:159], v[80:95]
s_add_u32 s89, s89, 0x2000
s_add_u32 m0, s90, 0x20000
v_exp_f32 v68, v68
v_lshl_add_u32 v26, v5, 4, v3
v_xor_b32 v5, 4, v4
v_lshl_add_u32 v27, v5, 4, v3
v_mfma_f32_32x32x16_bf16 v[80:95], a[208:211], v[168:171], v[80:95]
buffer_load_dwordx4 v33, s[20:23], s88 offen lds
v_exp_f32 v69, v69
v_xor_b32 v5, 6, v4
v_add_f32 v224, v224, v66
v_lshl_add_u32 v28, v5, 4, v3
v_mfma_f32_32x32x16_bf16 v[80:95], a[212:215], v[172:175], v[80:95]
v_add_f32 v225, v225, v67
v_cvt_pk_bf16_f32 v97, v66, v67
v_lshlrev_b32 v31, 4, v1
v_exp_f32 v70, v70
s_add_u32 s82, s42, 0
s_lshl_b32 s82, s82, 7
v_mfma_f32_32x32x16_bf16 v[80:95], a[216:219], v[184:187], v[80:95]
s_lshl_b32 s83, s5, 5
buffer_load_dwordx4 v34, s[20:23], s88 offen offset:1024 lds
s_add_u32 s82, s82, s83
v_exp_f32 v71, v71
v_add_f32 v224, v224, v68
v_mfma_f32_32x32x16_bf16 v[80:95], a[220:223], v[188:191], v[80:95]
s_add_u32 s88, s88, 0x2000
s_lshl_b32 s82, s82, 10
s_add_u32 s43, s82, 0x1500000
v_add_f32 v225, v225, v69
v_cvt_pk_bf16_f32 v98, v68, v69
v_exp_f32 v72, v72
v_mfma_f32_32x32x16_bf16 a[16:31], a[224:227], v[104:107], a[16:31]
s_add_u32 s82, s42, 1
s_lshl_b32 s82, s82, 7
ds_read_b128 a[192:195], v10
s_lshl_b32 s83, s5, 5
v_exp_f32 v73, v73
v_add_f32 v224, v224, v70
v_mfma_f32_32x32x16_bf16 a[48:63], a[232:235], v[104:107], a[48:63]
s_add_u32 s82, s82, s83
s_lshl_b32 s82, s82, 10
ds_read_b128 a[196:199], v11
v_add_f32 v225, v225, v71
v_cvt_pk_bf16_f32 v99, v70, v71
v_exp_f32 v74, v74
v_mfma_f32_32x32x16_bf16 a[80:95], a[240:243], v[104:107], a[80:95]
s_add_u32 s44, s82, 0x1500000
s_add_u32 s82, s42, 2
ds_read_b128 a[200:203], v12
s_lshl_b32 s82, s82, 7
v_exp_f32 v75, v75
v_add_f32 v224, v224, v72
v_mfma_f32_32x32x16_bf16 a[112:127], a[248:251], v[104:107], a[112:127]
s_lshl_b32 s83, s5, 5
s_add_u32 s82, s82, s83
ds_read_b128 a[204:207], v13
v_add_f32 v225, v225, v73
v_cvt_pk_bf16_f32 v100, v72, v73
v_exp_f32 v76, v76
v_mfma_f32_32x32x16_bf16 a[16:31], a[228:231], v[108:111], a[16:31]
s_lshl_b32 s82, s82, 10
s_add_u32 s45, s82, 0x1500000
ds_read_b128 a[208:211], v14
v_exp_f32 v77, v77
v_add_f32 v224, v224, v74
v_min_u32 v2, 23, v1
v_mfma_f32_32x32x16_bf16 a[48:63], a[236:239], v[108:111], a[48:63]
ds_read_b128 a[212:215], v15
ds_read_b128 a[216:219], v16
v_add_f32 v225, v225, v75
v_cvt_pk_bf16_f32 v101, v74, v75
v_lshrrev_b32 v3, 3, v2
v_exp_f32 v78, v78
v_mfma_f32_32x32x16_bf16 a[80:95], a[244:247], v[108:111], a[80:95]
ds_read_b128 a[220:223], v17
v_exp_f32 v79, v79
v_and_b32 v2, 7, v2
v_lshlrev_b32 v3, 7, v3
v_add_f32 v224, v224, v76
v_mfma_f32_32x32x16_bf16 a[112:127], a[252:255], v[108:111], a[112:127]
v_add_f32 v225, v225, v77
v_lshl_add_u32 v36, v2, 2, v3
v_cvt_pk_bf16_f32 v102, v76, v77
s_lshl_b32 s82, s42, 7
v_add_f32 v224, v224, v78
s_lshl_b32 s83, s5, 5
v_add_f32 v225, v225, v79
s_add_u32 s82, s82, s83
v_cvt_pk_bf16_f32 v103, v78, v79
s_add_u32 s49, s82, 0x3002000
s_waitcnt vmcnt(8)
s_waitcnt lgkmcnt(0)
s_barrier
v_mfma_f32_32x32x16_bf16 v[64:79], a[192:195], v[128:131], v[192:207]
ds_read_b64_tr_b16 a[224:225], v18 offset:16384
ds_read_b64_tr_b16 a[226:227], v18 offset:18432
s_waitcnt vmcnt(4)
v_exp_f32 v80, v80
v_mfma_f32_32x32x16_bf16 v[64:79], a[196:199], v[132:135], v[64:79]
ds_read_b64_tr_b16 a[232:233], v19 offset:16384
ds_read_b64_tr_b16 a[234:235], v19 offset:18432
s_lshl_b32 s82, s92, 3
v_exp_f32 v81, v81
v_mfma_f32_32x32x16_bf16 v[64:79], a[200:203], v[144:147], v[64:79]
ds_read_b64_tr_b16 a[240:241], v20 offset:16384
ds_read_b64_tr_b16 a[242:243], v20 offset:18432
s_add_u32 s82, s82, s4
v_exp_f32 v82, v82
v_mfma_f32_32x32x16_bf16 v[64:79], a[204:207], v[148:151], v[64:79]
ds_read_b64_tr_b16 a[248:249], v21 offset:16384
ds_read_b64_tr_b16 a[250:251], v21 offset:18432
ds_read_b64_tr_b16 a[228:229], v18 offset:20480
v_exp_f32 v83, v83
v_mfma_f32_32x32x16_bf16 v[64:79], a[208:211], v[160:163], v[64:79]
ds_read_b64_tr_b16 a[230:231], v18 offset:22528
ds_read_b64_tr_b16 a[236:237], v19 offset:20480
v_add_f32 v226, v226, v80
v_add_f32 v227, v227, v81
v_cvt_pk_bf16_f32 v104, v80, v81
v_mfma_f32_32x32x16_bf16 v[64:79], a[212:215], v[164:167], v[64:79]
ds_read_b64_tr_b16 a[238:239], v19 offset:22528
ds_read_b64_tr_b16 a[244:245], v20 offset:20480
v_exp_f32 v84, v84
v_mfma_f32_32x32x16_bf16 v[64:79], a[216:219], v[176:179], v[64:79]
ds_read_b64_tr_b16 a[246:247], v20 offset:22528
ds_read_b64_tr_b16 a[252:253], v21 offset:20480
ds_read_b64_tr_b16 a[254:255], v21 offset:22528
v_mfma_f32_32x32x16_bf16 v[64:79], a[220:223], v[180:183], v[64:79]
v_exp_f32 v85, v85
v_add_f32 v226, v226, v82
v_add_f32 v227, v227, v83
v_cvt_pk_bf16_f32 v105, v82, v83
s_waitcnt lgkmcnt(0)
v_mfma_f32_32x32x16_bf16 a[0:15], a[224:227], v[96:99], a[0:15]
s_lshl_b32 s82, s82, 2
v_exp_f32 v86, v86
v_exp_f32 v87, v87
v_add_f32 v226, v226, v84
v_mfma_f32_32x32x16_bf16 a[32:47], a[232:235], v[96:99], a[32:47]
s_add_u32 s82, s82, s5
s_lshl_b32 s82, s82, 2
v_add_f32 v227, v227, v85
v_cvt_pk_bf16_f32 v106, v84, v85
v_exp_f32 v88, v88
v_mfma_f32_32x32x16_bf16 a[64:79], a[240:243], v[96:99], a[64:79]
v_exp_f32 v89, v89
v_add_f32 v226, v226, v86
v_add_f32 v227, v227, v87
v_cvt_pk_bf16_f32 v107, v86, v87
v_mfma_f32_32x32x16_bf16 a[96:111], a[248:251], v[96:99], a[96:111]
s_add_u32 s82, s82, 0x3002000
v_exp_f32 v90, v90
v_exp_f32 v91, v91
v_mfma_f32_32x32x16_bf16 a[0:15], a[228:231], v[100:103], a[0:15]
v_add_f32 v226, v226, v88
v_add_f32 v227, v227, v89
v_cvt_pk_bf16_f32 v108, v88, v89
v_exp_f32 v92, v92
v_mfma_f32_32x32x16_bf16 a[32:47], a[236:239], v[100:103], a[32:47]
v_exp_f32 v93, v93
v_add_f32 v226, v226, v90
v_add_f32 v227, v227, v91
v_cvt_pk_bf16_f32 v109, v90, v91
v_mfma_f32_32x32x16_bf16 a[64:79], a[244:247], v[100:103], a[64:79]
v_exp_f32 v94, v94
v_exp_f32 v95, v95
v_mfma_f32_32x32x16_bf16 a[96:111], a[252:255], v[100:103], a[96:111]
v_add_f32 v226, v226, v92
v_add_f32 v227, v227, v93
v_cvt_pk_bf16_f32 v110, v92, v93
v_add_f32 v226, v226, v94
v_add_f32 v227, v227, v95
v_cvt_pk_bf16_f32 v111, v94, v95
v_mfma_f32_32x32x16_bf16 v[80:95], a[192:195], v[136:139], v[208:223]
s_add_u32 m0, s90, 0x24000
v_exp_f32 v64, v64
v_exp_f32 v65, v65
v_mfma_f32_32x32x16_bf16 v[80:95], a[196:199], v[140:143], v[80:95]
buffer_load_dwordx4 v35, s[24:27], s89 offen lds
v_exp_f32 v66, v66
v_exp_f32 v67, v67
v_mfma_f32_32x32x16_bf16 v[80:95], a[200:203], v[152:155], v[80:95]
buffer_load_dwordx4 v35, s[24:27], s89 offen offset:1024 lds
s_add_u32 s89, s89, 0x2000
v_add_f32 v224, v224, v64
v_add_f32 v225, v225, v65
v_cvt_pk_bf16_f32 v96, v64, v65
v_mfma_f32_32x32x16_bf16 v[80:95], a[204:207], v[156:159], v[80:95]
s_add_u32 m0, s90, 0x1c000
v_exp_f32 v68, v68
v_exp_f32 v69, v69
v_add_f32 v224, v224, v66
v_mfma_f32_32x32x16_bf16 v[80:95], a[208:211], v[168:171], v[80:95]
buffer_load_dwordx4 v33, s[20:23], s88 offen lds
v_add_f32 v225, v225, v67
v_cvt_pk_bf16_f32 v97, v66, v67
v_exp_f32 v70, v70
v_mfma_f32_32x32x16_bf16 v[80:95], a[212:215], v[172:175], v[80:95]
buffer_load_dwordx4 v34, s[20:23], s88 offen offset:1024 lds
v_exp_f32 v71, v71
v_add_f32 v224, v224, v68
v_mfma_f32_32x32x16_bf16 v[80:95], a[216:219], v[184:187], v[80:95]
s_add_u32 s88, s88, 0x2000
v_add_f32 v225, v225, v69
v_cvt_pk_bf16_f32 v98, v68, v69
v_exp_f32 v72, v72
v_mfma_f32_32x32x16_bf16 v[80:95], a[220:223], v[188:191], v[80:95]
s_cmp_lt_u32 s92, 22
s_cselect_b32 s82, s82, 0x10000000
v_exp_f32 v73, v73
v_add_f32 v224, v224, v70
v_mfma_f32_32x32x16_bf16 a[16:31], a[224:227], v[104:107], a[16:31]
ds_read_b128 a[192:195], v10 offset:8192
v_add_f32 v225, v225, v71
v_cvt_pk_bf16_f32 v99, v70, v71
v_exp_f32 v74, v74
v_mfma_f32_32x32x16_bf16 a[48:63], a[232:235], v[104:107], a[48:63]
ds_read_b128 a[196:199], v11 offset:8192
v_exp_f32 v75, v75
v_add_f32 v224, v224, v72
v_mov_b32 v2, s32
v_mfma_f32_32x32x16_bf16 a[80:95], a[240:243], v[104:107], a[80:95]
ds_read_b128 a[200:203], v12 offset:8192
v_add_f32 v225, v225, v73
v_cvt_pk_bf16_f32 v100, v72, v73
v_exp_f32 v76, v76
v_mfma_f32_32x32x16_bf16 a[112:127], a[248:251], v[104:107], a[112:127]
ds_read_b128 a[204:207], v13 offset:8192
v_exp_f32 v77, v77
v_mov_b32 v3, 0
v_add_f32 v224, v224, v74
v_mfma_f32_32x32x16_bf16 a[16:31], a[228:231], v[108:111], a[16:31]
ds_read_b128 a[208:211], v14 offset:8192
v_add_f32 v225, v225, v75
v_cvt_pk_bf16_f32 v101, v74, v75
v_exp_f32 v78, v78
v_mfma_f32_32x32x16_bf16 a[48:63], a[236:239], v[108:111], a[48:63]
ds_read_b128 a[212:215], v15 offset:8192
ds_read_b128 a[216:219], v16 offset:8192
v_exp_f32 v79, v79
v_add_f32 v224, v224, v76
v_mfma_f32_32x32x16_bf16 a[80:95], a[244:247], v[108:111], a[80:95]
ds_read_b128 a[220:223], v17 offset:8192
v_add_f32 v225, v225, v77
v_cvt_pk_bf16_f32 v102, v76, v77
v_add_f32 v224, v224, v78
v_mfma_f32_32x32x16_bf16 a[112:127], a[252:255], v[108:111], a[112:127]
s_mov_b64 exec, 1
buffer_store_dword v2, v3, s[28:31], s82 offen sc0 sc1
s_mov_b64 exec, -1
v_add_f32 v225, v225, v79
v_cvt_pk_bf16_f32 v103, v78, v79
s_waitcnt vmcnt(5)
s_waitcnt lgkmcnt(0)
s_barrier
v_mfma_f32_32x32x16_bf16 v[64:79], a[192:195], v[128:131], v[192:207]
ds_read_b64_tr_b16 a[224:225], v18 offset:0
ds_read_b64_tr_b16 a[226:227], v18 offset:2048
ds_read_b64_tr_b16 a[232:233], v19 offset:0
v_exp_f32 v80, v80
v_mfma_f32_32x32x16_bf16 v[64:79], a[196:199], v[132:135], v[64:79]
ds_read_b64_tr_b16 a[234:235], v19 offset:2048
ds_read_b64_tr_b16 a[240:241], v20 offset:0
ds_read_b64_tr_b16 a[242:243], v20 offset:2048
v_exp_f32 v81, v81
v_mfma_f32_32x32x16_bf16 v[64:79], a[200:203], v[144:147], v[64:79]
ds_read_b64_tr_b16 a[248:249], v21 offset:0
ds_read_b64_tr_b16 a[250:251], v21 offset:2048
v_exp_f32 v82, v82
v_mfma_f32_32x32x16_bf16 v[64:79], a[204:207], v[148:151], v[64:79]
ds_read_b64_tr_b16 a[228:229], v18 offset:4096
ds_read_b64_tr_b16 a[230:231], v18 offset:6144
v_exp_f32 v83, v83
v_mfma_f32_32x32x16_bf16 v[64:79], a[208:211], v[160:163], v[64:79]
ds_read_b64_tr_b16 a[236:237], v19 offset:4096
ds_read_b64_tr_b16 a[238:239], v19 offset:6144
v_add_f32 v226, v226, v80
v_add_f32 v227, v227, v81
v_mfma_f32_32x32x16_bf16 v[64:79], a[212:215], v[164:167], v[64:79]
ds_read_b64_tr_b16 a[244:245], v20 offset:4096
v_cvt_pk_bf16_f32 v104, v80, v81
v_exp_f32 v84, v84
v_mfma_f32_32x32x16_bf16 v[64:79], a[216:219], v[176:179], v[64:79]
ds_read_b64_tr_b16 a[246:247], v20 offset:6144
ds_read_b64_tr_b16 a[252:253], v21 offset:4096
ds_read_b64_tr_b16 a[254:255], v21 offset:6144
v_mfma_f32_32x32x16_bf16 v[64:79], a[220:223], v[180:183], v[64:79]
v_exp_f32 v85, v85
v_add_f32 v226, v226, v82
v_add_f32 v227, v227, v83
v_cvt_pk_bf16_f32 v105, v82, v83
s_waitcnt lgkmcnt(0)
v_mfma_f32_32x32x16_bf16 a[0:15], a[224:227], v[96:99], a[0:15]
v_exp_f32 v86, v86
v_exp_f32 v87, v87
v_add_f32 v226, v226, v84
v_mfma_f32_32x32x16_bf16 a[32:47], a[232:235], v[96:99], a[32:47]
v_add_f32 v227, v227, v85
v_cvt_pk_bf16_f32 v106, v84, v85
v_exp_f32 v88, v88
v_mfma_f32_32x32x16_bf16 a[64:79], a[240:243], v[96:99], a[64:79]
v_exp_f32 v89, v89
v_add_f32 v226, v226, v86
v_add_f32 v227, v227, v87
v_cvt_pk_bf16_f32 v107, v86, v87
v_mfma_f32_32x32x16_bf16 a[96:111], a[248:251], v[96:99], a[96:111]
v_exp_f32 v90, v90
v_exp_f32 v91, v91
v_add_f32 v226, v226, v88
v_mfma_f32_32x32x16_bf16 a[0:15], a[228:231], v[100:103], a[0:15]
v_add_f32 v227, v227, v89
v_cvt_pk_bf16_f32 v108, v88, v89
v_exp_f32 v92, v92
v_mfma_f32_32x32x16_bf16 a[32:47], a[236:239], v[100:103], a[32:47]
v_exp_f32 v93, v93
v_add_f32 v226, v226, v90
v_add_f32 v227, v227, v91
v_cvt_pk_bf16_f32 v109, v90, v91
v_mfma_f32_32x32x16_bf16 a[64:79], a[244:247], v[100:103], a[64:79]
v_exp_f32 v94, v94
v_exp_f32 v95, v95
v_mfma_f32_32x32x16_bf16 a[96:111], a[252:255], v[100:103], a[96:111]
v_add_f32 v226, v226, v92
v_add_f32 v227, v227, v93
v_cvt_pk_bf16_f32 v110, v92, v93
v_add_f32 v226, v226, v94
v_add_f32 v227, v227, v95
v_cvt_pk_bf16_f32 v111, v94, v95
v_mfma_f32_32x32x16_bf16 v[80:95], a[192:195], v[136:139], v[208:223]
s_add_u32 m0, s90, 0x26000
v_exp_f32 v64, v64
v_exp_f32 v65, v65
v_mfma_f32_32x32x16_bf16 v[80:95], a[196:199], v[140:143], v[80:95]
buffer_load_dwordx4 v35, s[24:27], s89 offen lds
v_exp_f32 v66, v66
v_exp_f32 v67, v67
v_add_f32 v224, v224, v64
v_mfma_f32_32x32x16_bf16 v[80:95], a[200:203], v[152:155], v[80:95]
buffer_load_dwordx4 v35, s[24:27], s89 offen offset:1024 lds
v_add_f32 v225, v225, v65
v_cvt_pk_bf16_f32 v96, v64, v65
v_exp_f32 v68, v68
v_mfma_f32_32x32x16_bf16 v[80:95], a[204:207], v[156:159], v[80:95]
s_add_u32 s89, s89, 0x2000
s_add_u32 m0, s90, 0x1e000
v_exp_f32 v69, v69
v_add_f32 v224, v224, v66
v_add_f32 v225, v225, v67
v_mfma_f32_32x32x16_bf16 v[80:95], a[208:211], v[168:171], v[80:95]
buffer_load_dwordx4 v33, s[20:23], s88 offen lds
v_cvt_pk_bf16_f32 v97, v66, v67
v_exp_f32 v70, v70
v_mfma_f32_32x32x16_bf16 v[80:95], a[212:215], v[172:175], v[80:95]
buffer_load_dwordx4 v34, s[20:23], s88 offen offset:1024 lds
s_add_u32 s88, s88, 0x2000
v_exp_f32 v71, v71
v_add_f32 v224, v224, v68
v_add_f32 v225, v225, v69
v_mfma_f32_32x32x16_bf16 v[80:95], a[216:219], v[184:187], v[80:95]
s_add_u32 m0, s46, 0
s_nop 0
buffer_load_dwordx4 v23, s[8:11], 0 offen lds
v_cvt_pk_bf16_f32 v98, v68, v69
v_exp_f32 v72, v72
v_mfma_f32_32x32x16_bf16 v[80:95], a[220:223], v[188:191], v[80:95]
buffer_load_dwordx4 v24, s[8:11], s33 offen offset:1024 lds
v_exp_f32 v73, v73
v_add_f32 v224, v224, v70
v_add_f32 v225, v225, v71
v_mfma_f32_32x32x16_bf16 a[16:31], a[224:227], v[104:107], a[16:31]
buffer_load_dwordx4 v23, s[8:11], s34 offen offset:2048 lds
ds_read_b128 a[192:195], v10 offset:16384
v_cvt_pk_bf16_f32 v99, v70, v71
v_exp_f32 v74, v74
v_mfma_f32_32x32x16_bf16 a[48:63], a[232:235], v[104:107], a[48:63]
buffer_load_dwordx4 v24, s[8:11], s35 offen offset:3072 lds
ds_read_b128 a[196:199], v11 offset:16384
v_exp_f32 v75, v75
v_add_f32 v224, v224, v72
v_mfma_f32_32x32x16_bf16 a[80:95], a[240:243], v[104:107], a[80:95]
s_add_u32 m0, s46, 0x1000
ds_read_b128 a[200:203], v12 offset:16384
v_add_f32 v225, v225, v73
v_cvt_pk_bf16_f32 v100, v72, v73
v_exp_f32 v76, v76
v_mfma_f32_32x32x16_bf16 a[112:127], a[248:251], v[104:107], a[112:127]
buffer_load_dwordx4 v23, s[8:11], s36 offen lds
ds_read_b128 a[204:207], v13 offset:16384
v_exp_f32 v77, v77
v_add_f32 v224, v224, v74
v_mfma_f32_32x32x16_bf16 a[16:31], a[228:231], v[108:111], a[16:31]
buffer_load_dwordx4 v24, s[8:11], s37 offen offset:1024 lds
ds_read_b128 a[208:211], v14 offset:16384
ds_read_b128 a[212:215], v15 offset:16384
v_add_f32 v225, v225, v75
v_cvt_pk_bf16_f32 v101, v74, v75
v_mfma_f32_32x32x16_bf16 a[48:63], a[236:239], v[108:111], a[48:63]
buffer_load_dwordx4 v23, s[8:11], s38 offen offset:2048 lds
ds_read_b128 a[216:219], v16 offset:16384
ds_read_b128 a[220:223], v17 offset:16384
v_exp_f32 v78, v78
v_mfma_f32_32x32x16_bf16 a[80:95], a[244:247], v[108:111], a[80:95]
buffer_load_dwordx4 v24, s[8:11], s39 offen offset:3072 lds
v_exp_f32 v79, v79
v_add_f32 v224, v224, v76
v_add_f32 v225, v225, v77
v_mfma_f32_32x32x16_bf16 a[112:127], a[252:255], v[108:111], a[112:127]
s_add_u32 s8, s8, 0x80
s_addc_u32 s9, s9, 0
v_cvt_pk_bf16_f32 v102, v76, v77
v_add_f32 v224, v224, v78
v_add_f32 v225, v225, v79
v_cvt_pk_bf16_f32 v103, v78, v79
s_waitcnt vmcnt(13)
s_waitcnt lgkmcnt(0)
s_barrier
v_mfma_f32_32x32x16_bf16 v[64:79], a[192:195], v[128:131], v[192:207]
ds_read_b64_tr_b16 a[224:225], v18 offset:8192
ds_read_b64_tr_b16 a[226:227], v18 offset:10240
ds_read_b64_tr_b16 a[232:233], v19 offset:8192
v_exp_f32 v80, v80
v_mfma_f32_32x32x16_bf16 v[64:79], a[196:199], v[132:135], v[64:79]
ds_read_b64_tr_b16 a[234:235], v19 offset:10240
ds_read_b64_tr_b16 a[240:241], v20 offset:8192
ds_read_b64_tr_b16 a[242:243], v20 offset:10240
v_exp_f32 v81, v81
v_mfma_f32_32x32x16_bf16 v[64:79], a[200:203], v[144:147], v[64:79]
ds_read_b64_tr_b16 a[248:249], v21 offset:8192
ds_read_b64_tr_b16 a[250:251], v21 offset:10240
v_exp_f32 v82, v82
v_mfma_f32_32x32x16_bf16 v[64:79], a[204:207], v[148:151], v[64:79]
ds_read_b64_tr_b16 a[228:229], v18 offset:12288
ds_read_b64_tr_b16 a[230:231], v18 offset:14336
v_exp_f32 v83, v83
v_mfma_f32_32x32x16_bf16 v[64:79], a[208:211], v[160:163], v[64:79]
ds_read_b64_tr_b16 a[236:237], v19 offset:12288
ds_read_b64_tr_b16 a[238:239], v19 offset:14336
v_add_f32 v226, v226, v80
v_add_f32 v227, v227, v81
v_mfma_f32_32x32x16_bf16 v[64:79], a[212:215], v[164:167], v[64:79]
ds_read_b64_tr_b16 a[244:245], v20 offset:12288
v_cvt_pk_bf16_f32 v104, v80, v81
v_exp_f32 v84, v84
v_mfma_f32_32x32x16_bf16 v[64:79], a[216:219], v[176:179], v[64:79]
ds_read_b64_tr_b16 a[246:247], v20 offset:14336
ds_read_b64_tr_b16 a[252:253], v21 offset:12288
ds_read_b64_tr_b16 a[254:255], v21 offset:14336
v_mfma_f32_32x32x16_bf16 v[64:79], a[220:223], v[180:183], v[64:79]
v_exp_f32 v85, v85
v_add_f32 v226, v226, v82
v_add_f32 v227, v227, v83
v_cvt_pk_bf16_f32 v105, v82, v83
s_waitcnt lgkmcnt(0)
v_mfma_f32_32x32x16_bf16 a[0:15], a[224:227], v[96:99], a[0:15]
v_exp_f32 v86, v86
v_exp_f32 v87, v87
v_add_f32 v226, v226, v84
v_mfma_f32_32x32x16_bf16 a[32:47], a[232:235], v[96:99], a[32:47]
v_add_f32 v227, v227, v85
v_cvt_pk_bf16_f32 v106, v84, v85
v_exp_f32 v88, v88
v_mfma_f32_32x32x16_bf16 a[64:79], a[240:243], v[96:99], a[64:79]
v_exp_f32 v89, v89
v_add_f32 v226, v226, v86
v_add_f32 v227, v227, v87
v_cvt_pk_bf16_f32 v107, v86, v87
v_mfma_f32_32x32x16_bf16 a[96:111], a[248:251], v[96:99], a[96:111]
v_exp_f32 v90, v90
v_exp_f32 v91, v91
v_add_f32 v226, v226, v88
v_mfma_f32_32x32x16_bf16 a[0:15], a[228:231], v[100:103], a[0:15]
v_add_f32 v227, v227, v89
v_cvt_pk_bf16_f32 v108, v88, v89
v_exp_f32 v92, v92
v_mfma_f32_32x32x16_bf16 a[32:47], a[236:239], v[100:103], a[32:47]
v_exp_f32 v93, v93
v_add_f32 v226, v226, v90
v_add_f32 v227, v227, v91
v_cvt_pk_bf16_f32 v109, v90, v91
v_mfma_f32_32x32x16_bf16 a[64:79], a[244:247], v[100:103], a[64:79]
v_exp_f32 v94, v94
v_exp_f32 v95, v95
v_mfma_f32_32x32x16_bf16 a[96:111], a[252:255], v[100:103], a[96:111]
v_add_f32 v226, v226, v92
v_add_f32 v227, v227, v93
v_cvt_pk_bf16_f32 v110, v92, v93
v_add_f32 v226, v226, v94
v_add_f32 v227, v227, v95
v_cvt_pk_bf16_f32 v111, v94, v95
v_mfma_f32_32x32x16_bf16 v[80:95], a[192:195], v[136:139], v[208:223]
s_add_u32 m0, s90, 0x22000
v_exp_f32 v64, v64
v_exp_f32 v65, v65
v_mfma_f32_32x32x16_bf16 v[80:95], a[196:199], v[140:143], v[80:95]
buffer_load_dwordx4 v35, s[24:27], s89 offen lds
v_exp_f32 v66, v66
v_exp_f32 v67, v67
v_add_f32 v224, v224, v64
v_mfma_f32_32x32x16_bf16 v[80:95], a[200:203], v[152:155], v[80:95]
buffer_load_dwordx4 v35, s[24:27], s89 offen offset:1024 lds
v_add_f32 v225, v225, v65
v_cvt_pk_bf16_f32 v96, v64, v65
v_exp_f32 v68, v68
v_mfma_f32_32x32x16_bf16 v[80:95], a[204:207], v[156:159], v[80:95]
s_add_u32 s89, s89, 0x2000
s_add_u32 m0, s90, 0x20000
v_exp_f32 v69, v69
v_add_f32 v224, v224, v66
v_add_f32 v225, v225, v67
v_mfma_f32_32x32x16_bf16 v[80:95], a[208:211], v[168:171], v[80:95]
buffer_load_dwordx4 v33, s[20:23], s88 offen lds
v_cvt_pk_bf16_f32 v97, v66, v67
v_exp_f32 v70, v70
v_mfma_f32_32x32x16_bf16 v[80:95], a[212:215], v[172:175], v[80:95]
buffer_load_dwordx4 v34, s[20:23], s88 offen offset:1024 lds
s_add_u32 s88, s88, 0x2000
v_exp_f32 v71, v71
v_add_f32 v224, v224, v68
v_add_f32 v225, v225, v69
v_mfma_f32_32x32x16_bf16 v[80:95], a[216:219], v[184:187], v[80:95]
s_add_u32 m0, s46, 0x2000
s_nop 0
buffer_load_dwordx4 v23, s[8:11], 0 offen lds
v_cvt_pk_bf16_f32 v98, v68, v69
v_exp_f32 v72, v72
v_mfma_f32_32x32x16_bf16 v[80:95], a[220:223], v[188:191], v[80:95]
buffer_load_dwordx4 v24, s[8:11], s33 offen offset:1024 lds
v_exp_f32 v73, v73
v_add_f32 v224, v224, v70
v_add_f32 v225, v225, v71
v_mfma_f32_32x32x16_bf16 a[16:31], a[224:227], v[104:107], a[16:31]
buffer_load_dwordx4 v23, s[8:11], s34 offen offset:2048 lds
ds_read_b128 a[192:195], v10
v_cvt_pk_bf16_f32 v99, v70, v71
v_exp_f32 v74, v74
v_mfma_f32_32x32x16_bf16 a[48:63], a[232:235], v[104:107], a[48:63]
buffer_load_dwordx4 v24, s[8:11], s35 offen offset:3072 lds
ds_read_b128 a[196:199], v11
v_exp_f32 v75, v75
v_add_f32 v224, v224, v72
v_mfma_f32_32x32x16_bf16 a[80:95], a[240:243], v[104:107], a[80:95]
s_add_u32 m0, s46, 0x3000
ds_read_b128 a[200:203], v12
v_add_f32 v225, v225, v73
v_cvt_pk_bf16_f32 v100, v72, v73
v_exp_f32 v76, v76
v_mfma_f32_32x32x16_bf16 a[112:127], a[248:251], v[104:107], a[112:127]
buffer_load_dwordx4 v23, s[8:11], s36 offen lds
ds_read_b128 a[204:207], v13
v_exp_f32 v77, v77
v_add_f32 v224, v224, v74
v_mfma_f32_32x32x16_bf16 a[16:31], a[228:231], v[108:111], a[16:31]
buffer_load_dwordx4 v24, s[8:11], s37 offen offset:1024 lds
ds_read_b128 a[208:211], v14
ds_read_b128 a[212:215], v15
v_add_f32 v225, v225, v75
v_cvt_pk_bf16_f32 v101, v74, v75
v_mfma_f32_32x32x16_bf16 a[48:63], a[236:239], v[108:111], a[48:63]
buffer_load_dwordx4 v23, s[8:11], s38 offen offset:2048 lds
ds_read_b128 a[216:219], v16
ds_read_b128 a[220:223], v17
v_exp_f32 v78, v78
v_mfma_f32_32x32x16_bf16 a[80:95], a[244:247], v[108:111], a[80:95]
buffer_load_dwordx4 v24, s[8:11], s39 offen offset:3072 lds
v_exp_f32 v79, v79
v_add_f32 v224, v224, v76
v_add_f32 v225, v225, v77
v_mfma_f32_32x32x16_bf16 a[112:127], a[252:255], v[108:111], a[112:127]
s_add_u32 s8, s8, 0x80
s_addc_u32 s9, s9, 0
v_cvt_pk_bf16_f32 v102, v76, v77
v_add_f32 v224, v224, v78
v_add_f32 v225, v225, v79
v_cvt_pk_bf16_f32 v103, v78, v79
s_waitcnt vmcnt(20)
s_waitcnt lgkmcnt(0)
s_barrier
v_mfma_f32_32x32x16_bf16 v[64:79], a[192:195], v[128:131], v[192:207]
ds_read_b64_tr_b16 a[224:225], v18 offset:16384
ds_read_b64_tr_b16 a[226:227], v18 offset:18432
ds_read_b64_tr_b16 a[232:233], v19 offset:16384
v_exp_f32 v80, v80
v_mfma_f32_32x32x16_bf16 v[64:79], a[196:199], v[132:135], v[64:79]
ds_read_b64_tr_b16 a[234:235], v19 offset:18432
ds_read_b64_tr_b16 a[240:241], v20 offset:16384
ds_read_b64_tr_b16 a[242:243], v20 offset:18432
v_exp_f32 v81, v81
v_mfma_f32_32x32x16_bf16 v[64:79], a[200:203], v[144:147], v[64:79]
ds_read_b64_tr_b16 a[248:249], v21 offset:16384
ds_read_b64_tr_b16 a[250:251], v21 offset:18432
v_exp_f32 v82, v82
v_mfma_f32_32x32x16_bf16 v[64:79], a[204:207], v[148:151], v[64:79]
ds_read_b64_tr_b16 a[228:229], v18 offset:20480
ds_read_b64_tr_b16 a[230:231], v18 offset:22528
v_exp_f32 v83, v83
v_mfma_f32_32x32x16_bf16 v[64:79], a[208:211], v[160:163], v[64:79]
ds_read_b64_tr_b16 a[236:237], v19 offset:20480
ds_read_b64_tr_b16 a[238:239], v19 offset:22528
v_add_f32 v226, v226, v80
v_add_f32 v227, v227, v81
v_mfma_f32_32x32x16_bf16 v[64:79], a[212:215], v[164:167], v[64:79]
ds_read_b64_tr_b16 a[244:245], v20 offset:20480
v_cvt_pk_bf16_f32 v104, v80, v81
v_exp_f32 v84, v84
v_mfma_f32_32x32x16_bf16 v[64:79], a[216:219], v[176:179], v[64:79]
ds_read_b64_tr_b16 a[246:247], v20 offset:22528
ds_read_b64_tr_b16 a[252:253], v21 offset:20480
ds_read_b64_tr_b16 a[254:255], v21 offset:22528
v_mfma_f32_32x32x16_bf16 v[64:79], a[220:223], v[180:183], v[64:79]
v_exp_f32 v85, v85
v_add_f32 v226, v226, v82
v_add_f32 v227, v227, v83
v_cvt_pk_bf16_f32 v105, v82, v83
s_waitcnt lgkmcnt(0)
v_mfma_f32_32x32x16_bf16 a[0:15], a[224:227], v[96:99], a[0:15]
v_exp_f32 v86, v86
v_exp_f32 v87, v87
v_add_f32 v226, v226, v84
v_mfma_f32_32x32x16_bf16 a[32:47], a[232:235], v[96:99], a[32:47]
v_add_f32 v227, v227, v85
v_cvt_pk_bf16_f32 v106, v84, v85
v_exp_f32 v88, v88
v_mfma_f32_32x32x16_bf16 a[64:79], a[240:243], v[96:99], a[64:79]
v_exp_f32 v89, v89
v_add_f32 v226, v226, v86
v_add_f32 v227, v227, v87
v_cvt_pk_bf16_f32 v107, v86, v87
v_mfma_f32_32x32x16_bf16 a[96:111], a[248:251], v[96:99], a[96:111]
v_exp_f32 v90, v90
v_exp_f32 v91, v91
v_add_f32 v226, v226, v88
v_mfma_f32_32x32x16_bf16 a[0:15], a[228:231], v[100:103], a[0:15]
v_add_f32 v227, v227, v89
v_cvt_pk_bf16_f32 v108, v88, v89
v_exp_f32 v92, v92
v_mfma_f32_32x32x16_bf16 a[32:47], a[236:239], v[100:103], a[32:47]
v_exp_f32 v93, v93
v_add_f32 v226, v226, v90
v_add_f32 v227, v227, v91
v_cvt_pk_bf16_f32 v109, v90, v91
v_mfma_f32_32x32x16_bf16 a[64:79], a[244:247], v[100:103], a[64:79]
v_exp_f32 v94, v94
v_exp_f32 v95, v95
v_mfma_f32_32x32x16_bf16 a[96:111], a[252:255], v[100:103], a[96:111]
v_add_f32 v226, v226, v92
v_add_f32 v227, v227, v93
v_cvt_pk_bf16_f32 v110, v92, v93
v_add_f32 v226, v226, v94
v_add_f32 v227, v227, v95
v_cvt_pk_bf16_f32 v111, v94, v95
v_mfma_f32_32x32x16_bf16 v[80:95], a[192:195], v[136:139], v[208:223]
s_add_u32 m0, s90, 0x24000
s_nop 0
buffer_load_dwordx4 v35, s[24:27], s89 offen lds
v_exp_f32 v64, v64
v_exp_f32 v65, v65
v_mfma_f32_32x32x16_bf16 v[80:95], a[196:199], v[140:143], v[80:95]
buffer_load_dwordx4 v35, s[24:27], s89 offen offset:1024 lds
s_add_u32 s89, s89, 0x2000
v_exp_f32 v66, v66
v_exp_f32 v67, v67
v_mfma_f32_32x32x16_bf16 v[80:95], a[200:203], v[152:155], v[80:95]
s_add_u32 m0, s90, 0x1c000
s_nop 0
buffer_load_dwordx4 v33, s[20:23], s88 offen lds
v_add_f32 v224, v224, v64
v_add_f32 v225, v225, v65
v_cvt_pk_bf16_f32 v96, v64, v65
v_mfma_f32_32x32x16_bf16 v[80:95], a[204:207], v[156:159], v[80:95]
buffer_load_dwordx4 v34, s[20:23], s88 offen offset:1024 lds
v_exp_f32 v68, v68
v_exp_f32 v69, v69
v_mfma_f32_32x32x16_bf16 v[80:95], a[208:211], v[168:171], v[80:95]
s_add_u32 s88, s88, 0x2000
s_add_u32 m0, s46, 0x4000
v_add_f32 v224, v224, v66
v_add_f32 v225, v225, v67
v_cvt_pk_bf16_f32 v97, v66, v67
v_mfma_f32_32x32x16_bf16 v[80:95], a[212:215], v[172:175], v[80:95]
buffer_load_dwordx4 v23, s[8:11], 0 offen lds
v_exp_f32 v70, v70
v_exp_f32 v71, v71
v_add_f32 v224, v224, v68
v_mfma_f32_32x32x16_bf16 v[80:95], a[216:219], v[184:187], v[80:95]
buffer_load_dwordx4 v24, s[8:11], s33 offen offset:1024 lds
v_add_f32 v225, v225, v69
v_cvt_pk_bf16_f32 v98, v68, v69
v_exp_f32 v72, v72
v_mfma_f32_32x32x16_bf16 v[80:95], a[220:223], v[188:191], v[80:95]
buffer_load_dwordx4 v23, s[8:11], s34 offen offset:2048 lds
v_exp_f32 v73, v73
v_add_f32 v224, v224, v70
v_add_f32 v225, v225, v71
v_mfma_f32_32x32x16_bf16 a[16:31], a[224:227], v[104:107], a[16:31]
buffer_load_dwordx4 v24, s[8:11], s35 offen offset:3072 lds
ds_read_b128 a[192:195], v10 offset:8192
v_cvt_pk_bf16_f32 v99, v70, v71
v_exp_f32 v74, v74
v_mfma_f32_32x32x16_bf16 a[48:63], a[232:235], v[104:107], a[48:63]
s_add_u32 m0, s46, 0x5000
ds_read_b128 a[196:199], v11 offset:8192
ds_read_b128 a[200:203], v12 offset:8192
v_exp_f32 v75, v75
v_add_f32 v224, v224, v72
v_mfma_f32_32x32x16_bf16 a[80:95], a[240:243], v[104:107], a[80:95]
buffer_load_dwordx4 v23, s[8:11], s36 offen lds
ds_read_b128 a[204:207], v13 offset:8192
ds_read_b128 a[208:211], v14 offset:8192
v_add_f32 v225, v225, v73
v_cvt_pk_bf16_f32 v100, v72, v73
v_mfma_f32_32x32x16_bf16 a[112:127], a[248:251], v[104:107], a[112:127]
buffer_load_dwordx4 v24, s[8:11], s37 offen offset:1024 lds
v_exp_f32 v76, v76
v_exp_f32 v77, v77
v_mfma_f32_32x32x16_bf16 a[16:31], a[228:231], v[108:111], a[16:31]
buffer_load_dwordx4 v23, s[8:11], s38 offen offset:2048 lds
ds_read_b128 a[212:215], v15 offset:8192
v_add_f32 v224, v224, v74
v_add_f32 v225, v225, v75
v_cvt_pk_bf16_f32 v101, v74, v75
v_mfma_f32_32x32x16_bf16 a[48:63], a[236:239], v[108:111], a[48:63]
buffer_load_dwordx4 v24, s[8:11], s39 offen offset:3072 lds
ds_read_b128 a[216:219], v16 offset:8192
ds_read_b128 a[220:223], v17 offset:8192
v_exp_f32 v78, v78
v_mfma_f32_32x32x16_bf16 a[80:95], a[244:247], v[108:111], a[80:95]
s_add_u32 s8, s8, 0x80
s_addc_u32 s9, s9, 0
v_exp_f32 v79, v79
v_add_f32 v224, v224, v76
v_add_f32 v225, v225, v77
v_mfma_f32_32x32x16_bf16 a[112:127], a[252:255], v[108:111], a[112:127]
buffer_load_dword v32, v36, s[28:31], s49 offen sc0 sc1
v_cvt_pk_bf16_f32 v102, v76, v77
v_add_f32 v224, v224, v78
v_add_f32 v225, v225, v79
v_cvt_pk_bf16_f32 v103, v78, v79
s_waitcnt vmcnt(21)
s_waitcnt lgkmcnt(0)
s_barrier
v_mfma_f32_32x32x16_bf16 v[64:79], a[192:195], v[128:131], v[192:207]
ds_read_b64_tr_b16 a[224:225], v18 offset:0
ds_read_b64_tr_b16 a[226:227], v18 offset:2048
ds_read_b64_tr_b16 a[232:233], v19 offset:0
v_exp_f32 v80, v80
v_mfma_f32_32x32x16_bf16 v[64:79], a[196:199], v[132:135], v[64:79]
ds_read_b64_tr_b16 a[234:235], v19 offset:2048
ds_read_b64_tr_b16 a[240:241], v20 offset:0
ds_read_b64_tr_b16 a[242:243], v20 offset:2048
v_exp_f32 v81, v81
v_mfma_f32_32x32x16_bf16 v[64:79], a[200:203], v[144:147], v[64:79]
ds_read_b64_tr_b16 a[248:249], v21 offset:0
ds_read_b64_tr_b16 a[250:251], v21 offset:2048
v_exp_f32 v82, v82
v_mfma_f32_32x32x16_bf16 v[64:79], a[204:207], v[148:151], v[64:79]
ds_read_b64_tr_b16 a[228:229], v18 offset:4096
ds_read_b64_tr_b16 a[230:231], v18 offset:6144
v_exp_f32 v83, v83
v_mfma_f32_32x32x16_bf16 v[64:79], a[208:211], v[160:163], v[64:79]
ds_read_b64_tr_b16 a[236:237], v19 offset:4096
ds_read_b64_tr_b16 a[238:239], v19 offset:6144
v_add_f32 v226, v226, v80
v_add_f32 v227, v227, v81
v_mfma_f32_32x32x16_bf16 v[64:79], a[212:215], v[164:167], v[64:79]
ds_read_b64_tr_b16 a[244:245], v20 offset:4096
v_cvt_pk_bf16_f32 v104, v80, v81
v_exp_f32 v84, v84
v_mfma_f32_32x32x16_bf16 v[64:79], a[216:219], v[176:179], v[64:79]
ds_read_b64_tr_b16 a[246:247], v20 offset:6144
ds_read_b64_tr_b16 a[252:253], v21 offset:4096
ds_read_b64_tr_b16 a[254:255], v21 offset:6144
v_mfma_f32_32x32x16_bf16 v[64:79], a[220:223], v[180:183], v[64:79]
v_exp_f32 v85, v85
v_add_f32 v226, v226, v82
v_add_f32 v227, v227, v83
v_cvt_pk_bf16_f32 v105, v82, v83
s_waitcnt lgkmcnt(0)
v_mfma_f32_32x32x16_bf16 a[0:15], a[224:227], v[96:99], a[0:15]
v_exp_f32 v86, v86
v_exp_f32 v87, v87
v_add_f32 v226, v226, v84
v_mfma_f32_32x32x16_bf16 a[32:47], a[232:235], v[96:99], a[32:47]
v_add_f32 v227, v227, v85
v_cvt_pk_bf16_f32 v106, v84, v85
v_exp_f32 v88, v88
v_mfma_f32_32x32x16_bf16 a[64:79], a[240:243], v[96:99], a[64:79]
v_exp_f32 v89, v89
v_add_f32 v226, v226, v86
v_add_f32 v227, v227, v87
v_cvt_pk_bf16_f32 v107, v86, v87
v_mfma_f32_32x32x16_bf16 a[96:111], a[248:251], v[96:99], a[96:111]
v_exp_f32 v90, v90
v_exp_f32 v91, v91
v_add_f32 v226, v226, v88
v_mfma_f32_32x32x16_bf16 a[0:15], a[228:231], v[100:103], a[0:15]
v_add_f32 v227, v227, v89
v_cvt_pk_bf16_f32 v108, v88, v89
v_exp_f32 v92, v92
v_mfma_f32_32x32x16_bf16 a[32:47], a[236:239], v[100:103], a[32:47]
s_waitcnt vmcnt(0)
v_cmp_eq_u32 vcc, s32, v32
s_cmp_eq_u64 vcc, exec
s_cbranch_scc0 L_slow_12
L_slow_12_r:
v_exp_f32 v93, v93
v_add_f32 v226, v226, v90
v_mfma_f32_32x32x16_bf16 a[64:79], a[244:247], v[100:103], a[64:79]
v_add_f32 v227, v227, v91
v_cvt_pk_bf16_f32 v109, v90, v91
v_exp_f32 v94, v94
v_mfma_f32_32x32x16_bf16 a[96:111], a[252:255], v[100:103], a[96:111]
v_exp_f32 v95, v95
v_add_f32 v226, v226, v92
v_add_f32 v227, v227, v93
v_cvt_pk_bf16_f32 v110, v92, v93
v_add_f32 v226, v226, v94
v_add_f32 v227, v227, v95
v_cvt_pk_bf16_f32 v111, v94, v95
v_mfma_f32_32x32x16_bf16 v[80:95], a[192:195], v[136:139], v[208:223]
s_add_u32 m0, s90, 0x26000
v_exp_f32 v64, v64
v_exp_f32 v65, v65
v_mfma_f32_32x32x16_bf16 v[80:95], a[196:199], v[140:143], v[80:95]
v_exp_f32 v66, v66
v_exp_f32 v67, v67
v_add_f32 v224, v224, v64
v_mfma_f32_32x32x16_bf16 v[80:95], a[200:203], v[152:155], v[80:95]
v_add_f32 v225, v225, v65
v_cvt_pk_bf16_f32 v96, v64, v65
v_exp_f32 v68, v68
v_mfma_f32_32x32x16_bf16 v[80:95], a[204:207], v[156:159], v[80:95]
buffer_load_dwordx4 v35, s[24:27], s89 offen lds
v_exp_f32 v69, v69
v_add_f32 v224, v224, v66
v_mfma_f32_32x32x16_bf16 v[80:95], a[208:211], v[168:171], v[80:95]
v_add_f32 v225, v225, v67
v_cvt_pk_bf16_f32 v97, v66, v67
v_exp_f32 v70, v70
v_mfma_f32_32x32x16_bf16 v[80:95], a[212:215], v[172:175], v[80:95]
buffer_load_dwordx4 v35, s[24:27], s89 offen offset:1024 lds
v_exp_f32 v71, v71
v_add_f32 v224, v224, v68
v_mfma_f32_32x32x16_bf16 v[80:95], a[216:219], v[184:187], v[80:95]
s_add_u32 s89, s89, 0x2000
v_add_f32 v225, v225, v69
v_cvt_pk_bf16_f32 v98, v68, v69
v_exp_f32 v72, v72
v_mfma_f32_32x32x16_bf16 v[80:95], a[220:223], v[188:191], v[80:95]
v_exp_f32 v73, v73
v_add_f32 v224, v224, v70
v_add_f32 v225, v225, v71
v_mfma_f32_32x32x16_bf16 a[16:31], a[224:227], v[104:107], a[16:31]
ds_read_b128 a[192:195], v10 offset:16384
ds_read_b128 a[196:199], v11 offset:16384
v_cvt_pk_bf16_f32 v99, v70, v71
v_exp_f32 v74, v74
v_mfma_f32_32x32x16_bf16 a[48:63], a[232:235], v[104:107], a[48:63]
ds_read_b128 a[200:203], v12 offset:16384
v_exp_f32 v75, v75
v_add_f32 v224, v224, v72
v_mfma_f32_32x32x16_bf16 a[80:95], a[240:243], v[104:107], a[80:95]
ds_read_b128 a[204:207], v13 offset:16384
ds_read_b128 a[208:211], v14 offset:16384
v_add_f32 v225, v225, v73
v_cvt_pk_bf16_f32 v100, v72, v73
v_mfma_f32_32x32x16_bf16 a[112:127], a[248:251], v[104:107], a[112:127]
v_exp_f32 v76, v76
v_exp_f32 v77, v77
v_mfma_f32_32x32x16_bf16 a[16:31], a[228:231], v[108:111], a[16:31]
ds_read_b128 a[212:215], v15 offset:16384
v_add_f32 v224, v224, v74
v_add_f32 v225, v225, v75
v_cvt_pk_bf16_f32 v101, v74, v75
v_mfma_f32_32x32x16_bf16 a[48:63], a[236:239], v[108:111], a[48:63]
ds_read_b128 a[216:219], v16 offset:16384
ds_read_b128 a[220:223], v17 offset:16384
v_exp_f32 v78, v78
v_mfma_f32_32x32x16_bf16 a[80:95], a[244:247], v[108:111], a[80:95]
v_exp_f32 v79, v79
v_add_f32 v224, v224, v76
v_add_f32 v225, v225, v77
v_mfma_f32_32x32x16_bf16 a[112:127], a[252:255], v[108:111], a[112:127]
v_cvt_pk_bf16_f32 v102, v76, v77
v_add_f32 v224, v224, v78
v_add_f32 v225, v225, v79
v_cvt_pk_bf16_f32 v103, v78, v79
s_waitcnt lgkmcnt(0)
s_barrier
v_mfma_f32_32x32x16_bf16 v[64:79], a[192:195], v[128:131], v[192:207]
ds_read_b64_tr_b16 a[224:225], v18 offset:8192
ds_read_b64_tr_b16 a[226:227], v18 offset:10240
ds_read_b64_tr_b16 a[232:233], v19 offset:8192
v_exp_f32 v80, v80
v_mfma_f32_32x32x16_bf16 v[64:79], a[196:199], v[132:135], v[64:79]
ds_read_b64_tr_b16 a[234:235], v19 offset:10240
ds_read_b64_tr_b16 a[240:241], v20 offset:8192
ds_read_b64_tr_b16 a[242:243], v20 offset:10240
v_exp_f32 v81, v81
v_mfma_f32_32x32x16_bf16 v[64:79], a[200:203], v[144:147], v[64:79]
ds_read_b64_tr_b16 a[248:249], v21 offset:8192
ds_read_b64_tr_b16 a[250:251], v21 offset:10240
v_exp_f32 v82, v82
v_mfma_f32_32x32x16_bf16 v[64:79], a[204:207], v[148:151], v[64:79]
ds_read_b64_tr_b16 a[228:229], v18 offset:12288
ds_read_b64_tr_b16 a[230:231], v18 offset:14336
v_exp_f32 v83, v83
v_mfma_f32_32x32x16_bf16 v[64:79], a[208:211], v[160:163], v[64:79]
ds_read_b64_tr_b16 a[236:237], v19 offset:12288
ds_read_b64_tr_b16 a[238:239], v19 offset:14336
v_add_f32 v226, v226, v80
v_add_f32 v227, v227, v81
v_mfma_f32_32x32x16_bf16 v[64:79], a[212:215], v[164:167], v[64:79]
ds_read_b64_tr_b16 a[244:245], v20 offset:12288
v_cvt_pk_bf16_f32 v104, v80, v81
v_exp_f32 v84, v84
v_mfma_f32_32x32x16_bf16 v[64:79], a[216:219], v[176:179], v[64:79]
ds_read_b64_tr_b16 a[246:247], v20 offset:14336
ds_read_b64_tr_b16 a[252:253], v21 offset:12288
ds_read_b64_tr_b16 a[254:255], v21 offset:14336
v_mfma_f32_32x32x16_bf16 v[64:79], a[220:223], v[180:183], v[64:79]
v_exp_f32 v85, v85
v_add_f32 v226, v226, v82
v_add_f32 v227, v227, v83
v_cvt_pk_bf16_f32 v105, v82, v83
s_waitcnt lgkmcnt(0)
v_mfma_f32_32x32x16_bf16 a[0:15], a[224:227], v[96:99], a[0:15]
v_exp_f32 v86, v86
v_exp_f32 v87, v87
v_add_f32 v226, v226, v84
v_mfma_f32_32x32x16_bf16 a[32:47], a[232:235], v[96:99], a[32:47]
v_add_f32 v227, v227, v85
v_cvt_pk_bf16_f32 v106, v84, v85
v_exp_f32 v88, v88
v_mfma_f32_32x32x16_bf16 a[64:79], a[240:243], v[96:99], a[64:79]
v_exp_f32 v89, v89
v_add_f32 v226, v226, v86
v_add_f32 v227, v227, v87
v_cvt_pk_bf16_f32 v107, v86, v87
v_mfma_f32_32x32x16_bf16 a[96:111], a[248:251], v[96:99], a[96:111]
v_exp_f32 v90, v90
v_exp_f32 v91, v91
v_add_f32 v226, v226, v88
v_mfma_f32_32x32x16_bf16 a[0:15], a[228:231], v[100:103], a[0:15]
v_add_f32 v227, v227, v89
v_cvt_pk_bf16_f32 v108, v88, v89
v_exp_f32 v92, v92
v_mfma_f32_32x32x16_bf16 a[32:47], a[236:239], v[100:103], a[32:47]
v_exp_f32 v93, v93
v_add_f32 v226, v226, v90
v_add_f32 v227, v227, v91
v_cvt_pk_bf16_f32 v109, v90, v91
v_mfma_f32_32x32x16_bf16 a[64:79], a[244:247], v[100:103], a[64:79]
v_exp_f32 v94, v94
v_exp_f32 v95, v95
v_mfma_f32_32x32x16_bf16 a[96:111], a[252:255], v[100:103], a[96:111]
v_add_f32 v226, v226, v92
v_add_f32 v227, v227, v93
v_cvt_pk_bf16_f32 v110, v92, v93
v_add_f32 v226, v226, v94
v_add_f32 v227, v227, v95
v_cvt_pk_bf16_f32 v111, v94, v95
v_mfma_f32_32x32x16_bf16 v[80:95], a[192:195], v[136:139], v[208:223]
s_add_u32 m0, s90, 0x22000
v_exp_f32 v64, v64
v_exp_f32 v65, v65
v_mfma_f32_32x32x16_bf16 v[80:95], a[196:199], v[140:143], v[80:95]
buffer_load_dwordx4 v35, s[24:27], s89 offen lds
v_exp_f32 v66, v66
v_exp_f32 v67, v67
v_mfma_f32_32x32x16_bf16 v[80:95], a[200:203], v[152:155], v[80:95]
buffer_load_dwordx4 v35, s[24:27], s89 offen offset:1024 lds
s_add_u32 s89, s89, 0x2000
v_add_f32 v224, v224, v64
v_add_f32 v225, v225, v65
v_cvt_pk_bf16_f32 v96, v64, v65
v_mfma_f32_32x32x16_bf16 v[80:95], a[204:207], v[156:159], v[80:95]
buffer_load_dwordx4 a[144:147], v31, s[28:31], s43 offen sc1
v_exp_f32 v68, v68
v_exp_f32 v69, v69
v_mfma_f32_32x32x16_bf16 v[80:95], a[208:211], v[168:171], v[80:95]
buffer_load_dwordx4 a[148:151], v31, s[28:31], s44 offen sc1
v_add_f32 v224, v224, v66
v_add_f32 v225, v225, v67
v_cvt_pk_bf16_f32 v97, v66, v67
v_mfma_f32_32x32x16_bf16 v[80:95], a[212:215], v[172:175], v[80:95]
buffer_load_dwordx4 a[152:155], v31, s[28:31], s45 offen sc1
v_exp_f32 v70, v70
v_exp_f32 v71, v71
v_mfma_f32_32x32x16_bf16 v[80:95], a[216:219], v[184:187], v[80:95]
buffer_load_dwordx4 a[156:159], v31, s[28:31], s43 offen offset:1024 sc1
v_add_f32 v224, v224, v68
v_add_f32 v225, v225, v69
v_cvt_pk_bf16_f32 v98, v68, v69
v_mfma_f32_32x32x16_bf16 v[80:95], a[220:223], v[188:191], v[80:95]
buffer_load_dwordx4 a[160:163], v31, s[28:31], s44 offen offset:1024 sc1
v_exp_f32 v72, v72
v_exp_f32 v73, v73
v_mfma_f32_32x32x16_bf16 a[16:31], a[224:227], v[104:107], a[16:31]
buffer_load_dwordx4 a[164:167], v31, s[28:31], s45 offen offset:1024 sc1
ds_read_b128 a[192:195], v10
v_add_f32 v224, v224, v70
v_add_f32 v225, v225, v71
v_cvt_pk_bf16_f32 v99, v70, v71
v_mfma_f32_32x32x16_bf16 a[48:63], a[232:235], v[104:107], a[48:63]
ds_read_b128 a[196:199], v11
ds_read_b128 a[200:203], v12
v_exp_f32 v74, v74
v_exp_f32 v75, v75
v_mfma_f32_32x32x16_bf16 a[80:95], a[240:243], v[104:107], a[80:95]
buffer_load_dwordx4 a[168:171], v31, s[28:31], s43 offen offset:2048 sc1
ds_read_b128 a[204:207], v13
v_add_f32 v224, v224, v72
v_add_f32 v225, v225, v73
v_cvt_pk_bf16_f32 v100, v72, v73
v_mfma_f32_32x32x16_bf16 a[112:127], a[248:251], v[104:107], a[112:127]
buffer_load_dwordx4 a[172:175], v31, s[28:31], s44 offen offset:2048 sc1
v_exp_f32 v76, v76
v_exp_f32 v77, v77
v_mfma_f32_32x32x16_bf16 a[16:31], a[228:231], v[108:111], a[16:31]
ds_read_b128 a[208:211], v14
buffer_load_dwordx4 a[176:179], v31, s[28:31], s45 offen offset:2048 sc1
v_add_f32 v224, v224, v74
v_add_f32 v225, v225, v75
v_cvt_pk_bf16_f32 v101, v74, v75
v_mfma_f32_32x32x16_bf16 a[48:63], a[236:239], v[108:111], a[48:63]
ds_read_b128 a[212:215], v15
buffer_load_dwordx4 a[180:183], v31, s[28:31], s43 offen offset:3072 sc1
v_exp_f32 v78, v78
v_mfma_f32_32x32x16_bf16 a[80:95], a[244:247], v[108:111], a[80:95]
ds_read_b128 a[216:219], v16
ds_read_b128 a[220:223], v17
v_exp_f32 v79, v79
v_add_f32 v224, v224, v76
v_mfma_f32_32x32x16_bf16 a[112:127], a[252:255], v[108:111], a[112:127]
v_add_f32 v225, v225, v77
v_cvt_pk_bf16_f32 v102, v76, v77
v_add_f32 v224, v224, v78
v_add_f32 v225, v225, v79
v_cvt_pk_bf16_f32 v103, v78, v79
s_waitcnt vmcnt(12)
s_waitcnt lgkmcnt(0)
s_barrier
v_mfma_f32_32x32x16_bf16 v[64:79], a[192:195], v[128:131], v[192:207]
ds_read_b64_tr_b16 a[224:225], v18 offset:16384
ds_read_b64_tr_b16 a[226:227], v18 offset:18432
ds_read_b64_tr_b16 a[232:233], v19 offset:16384
v_exp_f32 v80, v80
v_mfma_f32_32x32x16_bf16 v[64:79], a[196:199], v[132:135], v[64:79]
ds_read_b64_tr_b16 a[234:235], v19 offset:18432
ds_read_b64_tr_b16 a[240:241], v20 offset:16384
ds_read_b64_tr_b16 a[242:243], v20 offset:18432
v_exp_f32 v81, v81
v_mfma_f32_32x32x16_bf16 v[64:79], a[200:203], v[144:147], v[64:79]
ds_read_b64_tr_b16 a[248:249], v21 offset:16384
ds_read_b64_tr_b16 a[250:251], v21 offset:18432
v_exp_f32 v82, v82
v_mfma_f32_32x32x16_bf16 v[64:79], a[204:207], v[148:151], v[64:79]
ds_read_b64_tr_b16 a[228:229], v18 offset:20480
ds_read_b64_tr_b16 a[230:231], v18 offset:22528
v_exp_f32 v83, v83
v_mfma_f32_32x32x16_bf16 v[64:79], a[208:211], v[160:163], v[64:79]
ds_read_b64_tr_b16 a[236:237], v19 offset:20480
ds_read_b64_tr_b16 a[238:239], v19 offset:22528
v_add_f32 v226, v226, v80
v_add_f32 v227, v227, v81
v_mfma_f32_32x32x16_bf16 v[64:79], a[212:215], v[164:167], v[64:79]
ds_read_b64_tr_b16 a[244:245], v20 offset:20480
v_cvt_pk_bf16_f32 v104, v80, v81
v_exp_f32 v84, v84
v_mfma_f32_32x32x16_bf16 v[64:79], a[216:219], v[176:179], v[64:79]
ds_read_b64_tr_b16 a[246:247], v20 offset:22528
ds_read_b64_tr_b16 a[252:253], v21 offset:20480
ds_read_b64_tr_b16 a[254:255], v21 offset:22528
v_mfma_f32_32x32x16_bf16 v[64:79], a[220:223], v[180:183], v[64:79]
v_exp_f32 v85, v85
v_add_f32 v226, v226, v82
v_add_f32 v227, v227, v83
v_cvt_pk_bf16_f32 v105, v82, v83
s_waitcnt lgkmcnt(0)
v_mfma_f32_32x32x16_bf16 a[0:15], a[224:227], v[96:99], a[0:15]
v_exp_f32 v86, v86
v_exp_f32 v87, v87
v_add_f32 v226, v226, v84
v_mfma_f32_32x32x16_bf16 a[32:47], a[232:235], v[96:99], a[32:47]
v_add_f32 v227, v227, v85
v_cvt_pk_bf16_f32 v106, v84, v85
v_exp_f32 v88, v88
v_mfma_f32_32x32x16_bf16 a[64:79], a[240:243], v[96:99], a[64:79]
v_exp_f32 v89, v89
v_add_f32 v226, v226, v86
v_add_f32 v227, v227, v87
v_cvt_pk_bf16_f32 v107, v86, v87
v_mfma_f32_32x32x16_bf16 a[96:111], a[248:251], v[96:99], a[96:111]
v_exp_f32 v90, v90
v_exp_f32 v91, v91
v_add_f32 v226, v226, v88
v_mfma_f32_32x32x16_bf16 a[0:15], a[228:231], v[100:103], a[0:15]
v_add_f32 v227, v227, v89
v_cvt_pk_bf16_f32 v108, v88, v89
v_exp_f32 v92, v92
v_mfma_f32_32x32x16_bf16 a[32:47], a[236:239], v[100:103], a[32:47]
v_exp_f32 v93, v93
v_add_f32 v226, v226, v90
v_add_f32 v227, v227, v91
v_cvt_pk_bf16_f32 v109, v90, v91
v_mfma_f32_32x32x16_bf16 a[64:79], a[244:247], v[100:103], a[64:79]
v_exp_f32 v94, v94
v_exp_f32 v95, v95
v_mfma_f32_32x32x16_bf16 a[96:111], a[252:255], v[100:103], a[96:111]
v_add_f32 v226, v226, v92
v_add_f32 v227, v227, v93
v_cvt_pk_bf16_f32 v110, v92, v93
v_add_f32 v226, v226, v94
v_add_f32 v227, v227, v95
v_cvt_pk_bf16_f32 v111, v94, v95
v_mfma_f32_32x32x16_bf16 v[80:95], a[192:195], v[136:139], v[208:223]
v_exp_f32 v64, v64
v_exp_f32 v65, v65
v_mfma_f32_32x32x16_bf16 v[80:95], a[196:199], v[140:143], v[80:95]
v_exp_f32 v66, v66
v_exp_f32 v67, v67
v_add_f32 v224, v224, v64
v_mfma_f32_32x32x16_bf16 v[80:95], a[200:203], v[152:155], v[80:95]
v_add_f32 v225, v225, v65
v_cvt_pk_bf16_f32 v96, v64, v65
v_exp_f32 v68, v68
v_mfma_f32_32x32x16_bf16 v[80:95], a[204:207], v[156:159], v[80:95]
buffer_load_dwordx4 a[184:187], v31, s[28:31], s44 offen offset:3072 sc1
v_exp_f32 v69, v69
v_add_f32 v224, v224, v66
v_mfma_f32_32x32x16_bf16 v[80:95], a[208:211], v[168:171], v[80:95]
buffer_load_dwordx4 a[188:191], v31, s[28:31], s45 offen offset:3072 sc1
s_add_u32 s43, s43, 0x1000
v_add_f32 v225, v225, v67
v_cvt_pk_bf16_f32 v97, v66, v67
v_mfma_f32_32x32x16_bf16 v[80:95], a[212:215], v[172:175], v[80:95]
s_add_u32 s44, s44, 0x1000
v_exp_f32 v70, v70
v_exp_f32 v71, v71
v_mfma_f32_32x32x16_bf16 v[80:95], a[216:219], v[184:187], v[80:95]
s_add_u32 s45, s45, 0x1000
v_add_f32 v224, v224, v68
v_add_f32 v225, v225, v69
v_cvt_pk_bf16_f32 v98, v68, v69
v_mfma_f32_32x32x16_bf16 v[80:95], a[220:223], v[188:191], v[80:95]
v_exp_f32 v72, v72
v_exp_f32 v73, v73
v_mfma_f32_32x32x16_bf16 a[16:31], a[224:227], v[104:107], a[16:31]
buffer_load_dwordx4 v[40:43], v31, s[28:31], s43 offen sc1
v_add_f32 v224, v224, v70
v_add_f32 v225, v225, v71
v_cvt_pk_bf16_f32 v99, v70, v71
v_mfma_f32_32x32x16_bf16 a[48:63], a[232:235], v[104:107], a[48:63]
v_exp_f32 v74, v74
v_exp_f32 v75, v75
v_mfma_f32_32x32x16_bf16 a[80:95], a[240:243], v[104:107], a[80:95]
buffer_load_dwordx4 v[44:47], v31, s[28:31], s44 offen sc1
v_add_f32 v224, v224, v72
v_add_f32 v225, v225, v73
v_cvt_pk_bf16_f32 v100, v72, v73
v_mfma_f32_32x32x16_bf16 a[112:127], a[248:251], v[104:107], a[112:127]
buffer_load_dwordx4 v[48:51], v31, s[28:31], s45 offen sc1
v_exp_f32 v76, v76
v_mfma_f32_32x32x16_bf16 a[16:31], a[228:231], v[108:111], a[16:31]
buffer_load_dwordx4 v[52:55], v31, s[28:31], s43 offen offset:1024 sc1
v_exp_f32 v77, v77
v_add_f32 v224, v224, v74
v_mfma_f32_32x32x16_bf16 a[48:63], a[236:239], v[108:111], a[48:63]
v_add_f32 v225, v225, v75
v_cvt_pk_bf16_f32 v101, v74, v75
v_exp_f32 v78, v78
v_mfma_f32_32x32x16_bf16 a[80:95], a[244:247], v[108:111], a[80:95]
buffer_load_dwordx4 v[56:59], v31, s[28:31], s44 offen offset:1024 sc1
v_exp_f32 v79, v79
v_add_f32 v224, v224, v76
v_mfma_f32_32x32x16_bf16 a[112:127], a[252:255], v[108:111], a[112:127]
v_add_f32 v225, v225, v77
v_cvt_pk_bf16_f32 v102, v76, v77
v_add_f32 v224, v224, v78
v_add_f32 v225, v225, v79
v_cvt_pk_bf16_f32 v103, v78, v79
s_waitcnt vmcnt(17)
s_waitcnt lgkmcnt(0)
s_barrier
ds_read_b64_tr_b16 a[224:225], v18 offset:0
ds_read_b64_tr_b16 a[226:227], v18 offset:2048
ds_read_b64_tr_b16 a[232:233], v19 offset:0
ds_read_b64_tr_b16 a[234:235], v19 offset:2048
ds_read_b64_tr_b16 a[240:241], v20 offset:0
ds_read_b64_tr_b16 a[242:243], v20 offset:2048
ds_read_b64_tr_b16 a[248:249], v21 offset:0
ds_read_b64_tr_b16 a[250:251], v21 offset:2048
ds_read_b64_tr_b16 a[228:229], v18 offset:4096
ds_read_b64_tr_b16 a[230:231], v18 offset:6144
ds_read_b64_tr_b16 a[236:237], v19 offset:4096
ds_read_b64_tr_b16 a[238:239], v19 offset:6144
ds_read_b64_tr_b16 a[244:245], v20 offset:4096
ds_read_b64_tr_b16 a[246:247], v20 offset:6144
ds_read_b64_tr_b16 a[252:253], v21 offset:4096
ds_read_b64_tr_b16 a[254:255], v21 offset:6144
v_exp_f32 v80, v80
v_exp_f32 v81, v81
v_exp_f32 v82, v82
v_exp_f32 v83, v83
v_add_f32 v226, v226, v80
v_add_f32 v227, v227, v81
v_cvt_pk_bf16_f32 v104, v80, v81
v_exp_f32 v84, v84
v_exp_f32 v85, v85
v_add_f32 v226, v226, v82
v_add_f32 v227, v227, v83
v_cvt_pk_bf16_f32 v105, v82, v83
v_exp_f32 v86, v86
v_exp_f32 v87, v87
v_add_f32 v226, v226, v84
v_add_f32 v227, v227, v85
v_cvt_pk_bf16_f32 v106, v84, v85
v_exp_f32 v88, v88
v_exp_f32 v89, v89
v_add_f32 v226, v226, v86
s_waitcnt lgkmcnt(14)
v_mfma_f32_32x32x16_bf16 a[0:15], a[224:227], v[96:99], a[0:15]
v_add_f32 v227, v227, v87
v_cvt_pk_bf16_f32 v107, v86, v87
v_exp_f32 v90, v90
s_waitcnt lgkmcnt(12)
v_mfma_f32_32x32x16_bf16 a[32:47], a[232:235], v[96:99], a[32:47]
v_exp_f32 v91, v91
v_add_f32 v226, v226, v88
v_add_f32 v227, v227, v89
s_waitcnt lgkmcnt(10)
v_mfma_f32_32x32x16_bf16 a[64:79], a[240:243], v[96:99], a[64:79]
v_cvt_pk_bf16_f32 v108, v88, v89
v_exp_f32 v92, v92
s_waitcnt lgkmcnt(8)
v_mfma_f32_32x32x16_bf16 a[96:111], a[248:251], v[96:99], a[96:111]
v_exp_f32 v93, v93
v_add_f32 v226, v226, v90
s_waitcnt lgkmcnt(6)
v_mfma_f32_32x32x16_bf16 a[0:15], a[228:231], v[100:103], a[0:15]
v_add_f32 v227, v227, v91
v_cvt_pk_bf16_f32 v109, v90, v91
s_waitcnt lgkmcnt(4)
v_mfma_f32_32x32x16_bf16 a[32:47], a[236:239], v[100:103], a[32:47]
v_exp_f32 v94, v94
v_exp_f32 v95, v95
s_waitcnt lgkmcnt(2)
v_mfma_f32_32x32x16_bf16 a[64:79], a[244:247], v[100:103], a[64:79]
v_add_f32 v226, v226, v92
v_add_f32 v227, v227, v93
v_cvt_pk_bf16_f32 v110, v92, v93
s_waitcnt lgkmcnt(0)
v_mfma_f32_32x32x16_bf16 a[96:111], a[252:255], v[100:103], a[96:111]
v_add_f32 v226, v226, v94
v_add_f32 v227, v227, v95
v_cvt_pk_bf16_f32 v111, v94, v95
v_mfma_f32_32x32x16_bf16 a[16:31], a[224:227], v[104:107], a[16:31]
buffer_load_dwordx4 v[60:63], v31, s[28:31], s45 offen offset:1024 sc1
v_mfma_f32_32x32x16_bf16 a[48:63], a[232:235], v[104:107], a[48:63]
buffer_load_dwordx4 v[112:115], v31, s[28:31], s43 offen offset:2048 sc1
v_mfma_f32_32x32x16_bf16 a[80:95], a[240:243], v[104:107], a[80:95]
buffer_load_dwordx4 v[116:119], v31, s[28:31], s44 offen offset:2048 sc1
v_mfma_f32_32x32x16_bf16 a[112:127], a[248:251], v[104:107], a[112:127]
buffer_load_dwordx4 v[120:123], v31, s[28:31], s45 offen offset:2048 sc1
v_mfma_f32_32x32x16_bf16 a[16:31], a[228:231], v[108:111], a[16:31]
buffer_load_dwordx4 v[124:127], v31, s[28:31], s43 offen offset:3072 sc1
v_mfma_f32_32x32x16_bf16 a[48:63], a[236:239], v[108:111], a[48:63]
buffer_load_dwordx4 a[128:131], v31, s[28:31], s44 offen offset:3072 sc1
v_mfma_f32_32x32x16_bf16 a[80:95], a[244:247], v[108:111], a[80:95]
buffer_load_dwordx4 a[132:135], v31, s[28:31], s45 offen offset:3072 sc1
s_add_u32 s43, s43, 0x1000
v_mfma_f32_32x32x16_bf16 a[112:127], a[252:255], v[108:111], a[112:127]
s_add_u32 s44, s44, 0x1000
s_add_u32 s45, s45, 0x1000
v_add_f32 v37, v224, v225
v_mov_b32 v2, v37
v_add_f32 v38, v226, v227
v_mov_b32 v3, v38
v_permlane32_swap_b32 v37, v2
s_nop 0
v_permlane32_swap_b32 v38, v3
v_add_f32 v37, v37, v2
v_add_f32 v38, v38, v3
v_max_f32 v2, v37, v38
v_mov_b32 v3, 0x4e800000
v_cmp_nlt_f32 vcc, v2, v3
s_mov_b64 s[98:99], vcc
v_cmp_u_f32 vcc, v37, v38
s_or_b64 s[98:99], s[98:99], vcc
s_cmp_lg_u64 s[98:99], 0
s_cselect_b32 s82, 1, 0
s_lshl_b32 s83, s5, 2
s_add_u32 s83, s83, 0x18000
v_mov_b32 v2, s83
v_mov_b32 v3, s82
ds_write_b32 v2, v3
s_waitcnt lgkmcnt(0)
s_barrier
v_mov_b32 v2, 0x18000
ds_read_b128 v[240:243], v2
s_waitcnt lgkmcnt(0)
v_or_b32 v240, v240, v241
v_or_b32 v242, v242, v243
v_or_b32 v240, v240, v242
s_nop 0
v_readfirstlane_b32 s82, v240
s_cmp_eq_u32 s82, 0
s_cbranch_scc0 L_slow_13
L_slow_13_r:
buffer_load_dwordx4 v[192:195], v31, s[28:31], s43 offen sc1
buffer_load_dwordx4 v[196:199], v31, s[28:31], s44 offen sc1
buffer_load_dwordx4 v[200:203], v31, s[28:31], s45 offen sc1
buffer_load_dwordx4 v[204:207], v31, s[28:31], s43 offen offset:1024 sc1
buffer_load_dwordx4 v[208:211], v31, s[28:31], s44 offen offset:1024 sc1
buffer_load_dwordx4 v[212:215], v31, s[28:31], s45 offen offset:1024 sc1
buffer_load_dwordx4 v[216:219], v31, s[28:31], s43 offen offset:2048 sc1
buffer_load_dwordx4 v[220:223], v31, s[28:31], s44 offen offset:2048 sc1
buffer_load_dwordx4 v[224:227], v31, s[28:31], s45 offen offset:2048 sc1
buffer_load_dwordx4 v[228:231], v31, s[28:31], s43 offen offset:3072 sc1
buffer_load_dwordx4 v[232:235], v31, s[28:31], s44 offen offset:3072 sc1
buffer_load_dwordx4 v[236:239], v31, s[28:31], s45 offen offset:3072 sc1
s_add_u32 s43, s43, 0x1000
s_add_u32 s44, s44, 0x1000
s_add_u32 s45, s45, 0x1000
ds_read_b128 a[192:195], v25 offset:0
ds_read_b128 a[196:199], v25 offset:4096
ds_read_b128 a[200:203], v26 offset:0
ds_read_b128 a[204:207], v26 offset:4096
ds_read_b128 a[208:211], v27 offset:0
ds_read_b128 a[212:215], v27 offset:4096
ds_read_b128 a[216:219], v28 offset:0
ds_read_b128 a[220:223], v28 offset:4096
s_lshl_b32 s82, s4, 3
s_lshl_b32 s83, s5, 1
s_add_u32 s82, s82, s83
s_add_u32 s82, s82, 0
s_lshl_b32 s82, s82, 8
s_lshl_b32 s83, s3, 3
s_add_u32 s82, s82, s83
s_lshl_b32 s53, s82, 10
s_add_u32 s54, s53, 0x1000
s_lshl_b32 s82, s4, 3
s_lshl_b32 s83, s5, 1
s_add_u32 s82, s82, s83
s_add_u32 s82, s82, 1
s_lshl_b32 s82, s82, 8
s_lshl_b32 s83, s3, 3
s_add_u32 s82, s82, s83
s_lshl_b32 s55, s82, 10
s_add_u32 s48, s55, 0x1000
s_and_b32 s6, s2, 7
s_lshr_b32 s82, s2, 3
s_and_b32 s52, s6, 3
s_lshr_b32 s6, s6, 2
s_lshl_b32 s6, s6, 3
s_and_b32 s51, s82, 3
s_lshr_b32 s82, s82, 2
s_add_u32 s50, s6, s82
v_rcp_f32 v2, v37
v_rcp_f32 v4, v38
v_accvgpr_read_b32 v240, a0
v_accvgpr_read_b32 v241, a1
v_accvgpr_read_b32 v242, a2
v_accvgpr_read_b32 v243, a3
v_accvgpr_read_b32 v244, a4
v_accvgpr_read_b32 v245, a5
v_accvgpr_read_b32 v246, a6
v_accvgpr_read_b32 v247, a7
v_pk_mul_f32 v[240:241], v[240:241], v[2:3] op_sel_hi:[1,0]
v_pk_mul_f32 v[242:243], v[242:243], v[2:3] op_sel_hi:[1,0]
v_pk_mul_f32 v[244:245], v[244:245], v[2:3] op_sel_hi:[1,0]
v_pk_mul_f32 v[246:247], v[246:247], v[2:3] op_sel_hi:[1,0]
v_cvt_pk_bf16_f32 v128, v240, v241
v_cvt_pk_bf16_f32 v129, v242, v243
v_cvt_pk_bf16_f32 v130, v244, v245
v_cvt_pk_bf16_f32 v131, v246, v247
buffer_store_dwordx4 v[128:131], v31, s[28:31], s53 offen sc0 sc1
v_accvgpr_read_b32 v240, a16
v_accvgpr_read_b32 v241, a17
v_accvgpr_read_b32 v242, a18
v_accvgpr_read_b32 v243, a19
v_accvgpr_read_b32 v244, a20
v_accvgpr_read_b32 v245, a21
v_accvgpr_read_b32 v246, a22
v_accvgpr_read_b32 v247, a23
v_pk_mul_f32 v[240:241], v[240:241], v[4:5] op_sel_hi:[1,0]
v_pk_mul_f32 v[242:243], v[242:243], v[4:5] op_sel_hi:[1,0]
v_pk_mul_f32 v[244:245], v[244:245], v[4:5] op_sel_hi:[1,0]
v_pk_mul_f32 v[246:247], v[246:247], v[4:5] op_sel_hi:[1,0]
v_cvt_pk_bf16_f32 v160, v240, v241
v_cvt_pk_bf16_f32 v161, v242, v243
v_cvt_pk_bf16_f32 v162, v244, v245
v_cvt_pk_bf16_f32 v163, v246, v247
buffer_store_dwordx4 v[160:163], v31, s[28:31], s55 offen sc0 sc1
v_accvgpr_read_b32 v248, a8
v_accvgpr_read_b32 v249, a9
v_accvgpr_read_b32 v250, a10
v_accvgpr_read_b32 v251, a11
v_accvgpr_read_b32 v252, a12
v_accvgpr_read_b32 v253, a13
v_accvgpr_read_b32 v254, a14
v_accvgpr_read_b32 v255, a15
v_pk_mul_f32 v[248:249], v[248:249], v[2:3] op_sel_hi:[1,0]
v_pk_mul_f32 v[250:251], v[250:251], v[2:3] op_sel_hi:[1,0]
v_pk_mul_f32 v[252:253], v[252:253], v[2:3] op_sel_hi:[1,0]
v_pk_mul_f32 v[254:255], v[254:255], v[2:3] op_sel_hi:[1,0]
v_cvt_pk_bf16_f32 v132, v248, v249
v_cvt_pk_bf16_f32 v133, v250, v251
v_cvt_pk_bf16_f32 v134, v252, v253
v_cvt_pk_bf16_f32 v135, v254, v255
buffer_store_dwordx4 v[132:135], v31, s[28:31], s53 offen offset:1024 sc0 sc1
v_accvgpr_read_b32 v248, a24
v_accvgpr_read_b32 v249, a25
v_accvgpr_read_b32 v250, a26
v_accvgpr_read_b32 v251, a27
v_accvgpr_read_b32 v252, a28
v_accvgpr_read_b32 v253, a29
v_accvgpr_read_b32 v254, a30
v_accvgpr_read_b32 v255, a31
v_pk_mul_f32 v[248:249], v[248:249], v[4:5] op_sel_hi:[1,0]
v_pk_mul_f32 v[250:251], v[250:251], v[4:5] op_sel_hi:[1,0]
v_pk_mul_f32 v[252:253], v[252:253], v[4:5] op_sel_hi:[1,0]
v_pk_mul_f32 v[254:255], v[254:255], v[4:5] op_sel_hi:[1,0]
v_cvt_pk_bf16_f32 v164, v248, v249
v_cvt_pk_bf16_f32 v165, v250, v251
v_cvt_pk_bf16_f32 v166, v252, v253
v_cvt_pk_bf16_f32 v167, v254, v255
buffer_store_dwordx4 v[164:167], v31, s[28:31], s55 offen offset:1024 sc0 sc1
v_accvgpr_read_b32 v240, a32
v_accvgpr_read_b32 v241, a33
v_accvgpr_read_b32 v242, a34
v_accvgpr_read_b32 v243, a35
v_accvgpr_read_b32 v244, a36
v_accvgpr_read_b32 v245, a37
v_accvgpr_read_b32 v246, a38
v_accvgpr_read_b32 v247, a39
v_pk_mul_f32 v[240:241], v[240:241], v[2:3] op_sel_hi:[1,0]
v_pk_mul_f32 v[242:243], v[242:243], v[2:3] op_sel_hi:[1,0]
v_pk_mul_f32 v[244:245], v[244:245], v[2:3] op_sel_hi:[1,0]
v_pk_mul_f32 v[246:247], v[246:247], v[2:3] op_sel_hi:[1,0]
v_cvt_pk_bf16_f32 v136, v240, v241
v_cvt_pk_bf16_f32 v137, v242, v243
v_cvt_pk_bf16_f32 v138, v244, v245
v_cvt_pk_bf16_f32 v139, v246, v247
buffer_store_dwordx4 v[136:139], v31, s[28:31], s53 offen offset:2048 sc0 sc1
v_accvgpr_read_b32 v240, a48
v_accvgpr_read_b32 v241, a49
v_accvgpr_read_b32 v242, a50
v_accvgpr_read_b32 v243, a51
v_accvgpr_read_b32 v244, a52
v_accvgpr_read_b32 v245, a53
v_accvgpr_read_b32 v246, a54
v_accvgpr_read_b32 v247, a55
v_pk_mul_f32 v[240:241], v[240:241], v[4:5] op_sel_hi:[1,0]
v_pk_mul_f32 v[242:243], v[242:243], v[4:5] op_sel_hi:[1,0]
v_pk_mul_f32 v[244:245], v[244:245], v[4:5] op_sel_hi:[1,0]
v_pk_mul_f32 v[246:247], v[246:247], v[4:5] op_sel_hi:[1,0]
v_cvt_pk_bf16_f32 v168, v240, v241
v_cvt_pk_bf16_f32 v169, v242, v243
v_cvt_pk_bf16_f32 v170, v244, v245
v_cvt_pk_bf16_f32 v171, v246, v247
buffer_store_dwordx4 v[168:171], v31, s[28:31], s55 offen offset:2048 sc0 sc1
v_accvgpr_read_b32 v248, a40
v_accvgpr_read_b32 v249, a41
v_accvgpr_read_b32 v250, a42
v_accvgpr_read_b32 v251, a43
v_accvgpr_read_b32 v252, a44
v_accvgpr_read_b32 v253, a45
v_accvgpr_read_b32 v254, a46
v_accvgpr_read_b32 v255, a47
v_pk_mul_f32 v[248:249], v[248:249], v[2:3] op_sel_hi:[1,0]
v_pk_mul_f32 v[250:251], v[250:251], v[2:3] op_sel_hi:[1,0]
v_pk_mul_f32 v[252:253], v[252:253], v[2:3] op_sel_hi:[1,0]
v_pk_mul_f32 v[254:255], v[254:255], v[2:3] op_sel_hi:[1,0]
v_cvt_pk_bf16_f32 v140, v248, v249
v_cvt_pk_bf16_f32 v141, v250, v251
v_cvt_pk_bf16_f32 v142, v252, v253
v_cvt_pk_bf16_f32 v143, v254, v255
buffer_store_dwordx4 v[140:143], v31, s[28:31], s53 offen offset:3072 sc0 sc1
v_accvgpr_read_b32 v248, a56
v_accvgpr_read_b32 v249, a57
v_accvgpr_read_b32 v250, a58
v_accvgpr_read_b32 v251, a59
v_accvgpr_read_b32 v252, a60
v_accvgpr_read_b32 v253, a61
v_accvgpr_read_b32 v254, a62
v_accvgpr_read_b32 v255, a63
v_pk_mul_f32 v[248:249], v[248:249], v[4:5] op_sel_hi:[1,0]
v_pk_mul_f32 v[250:251], v[250:251], v[4:5] op_sel_hi:[1,0]
v_pk_mul_f32 v[252:253], v[252:253], v[4:5] op_sel_hi:[1,0]
v_pk_mul_f32 v[254:255], v[254:255], v[4:5] op_sel_hi:[1,0]
v_cvt_pk_bf16_f32 v172, v248, v249
v_cvt_pk_bf16_f32 v173, v250, v251
v_cvt_pk_bf16_f32 v174, v252, v253
v_cvt_pk_bf16_f32 v175, v254, v255
buffer_store_dwordx4 v[172:175], v31, s[28:31], s55 offen offset:3072 sc0 sc1
v_accvgpr_read_b32 v240, a64
v_accvgpr_read_b32 v241, a65
v_accvgpr_read_b32 v242, a66
v_accvgpr_read_b32 v243, a67
v_accvgpr_read_b32 v244, a68
v_accvgpr_read_b32 v245, a69
v_accvgpr_read_b32 v246, a70
v_accvgpr_read_b32 v247, a71
v_pk_mul_f32 v[240:241], v[240:241], v[2:3] op_sel_hi:[1,0]
v_pk_mul_f32 v[242:243], v[242:243], v[2:3] op_sel_hi:[1,0]
v_pk_mul_f32 v[244:245], v[244:245], v[2:3] op_sel_hi:[1,0]
v_pk_mul_f32 v[246:247], v[246:247], v[2:3] op_sel_hi:[1,0]
v_cvt_pk_bf16_f32 v144, v240, v241
v_cvt_pk_bf16_f32 v145, v242, v243
v_cvt_pk_bf16_f32 v146, v244, v245
v_cvt_pk_bf16_f32 v147, v246, v247
buffer_store_dwordx4 v[144:147], v31, s[28:31], s54 offen sc0 sc1
v_accvgpr_read_b32 v240, a80
v_accvgpr_read_b32 v241, a81
v_accvgpr_read_b32 v242, a82
v_accvgpr_read_b32 v243, a83
v_accvgpr_read_b32 v244, a84
v_accvgpr_read_b32 v245, a85
v_accvgpr_read_b32 v246, a86
v_accvgpr_read_b32 v247, a87
v_pk_mul_f32 v[240:241], v[240:241], v[4:5] op_sel_hi:[1,0]
v_pk_mul_f32 v[242:243], v[242:243], v[4:5] op_sel_hi:[1,0]
v_pk_mul_f32 v[244:245], v[244:245], v[4:5] op_sel_hi:[1,0]
v_pk_mul_f32 v[246:247], v[246:247], v[4:5] op_sel_hi:[1,0]
v_cvt_pk_bf16_f32 v176, v240, v241
v_cvt_pk_bf16_f32 v177, v242, v243
v_cvt_pk_bf16_f32 v178, v244, v245
v_cvt_pk_bf16_f32 v179, v246, v247
buffer_store_dwordx4 v[176:179], v31, s[28:31], s48 offen sc0 sc1
v_accvgpr_read_b32 v248, a72
v_accvgpr_read_b32 v249, a73
v_accvgpr_read_b32 v250, a74
v_accvgpr_read_b32 v251, a75
v_accvgpr_read_b32 v252, a76
v_accvgpr_read_b32 v253, a77
v_accvgpr_read_b32 v254, a78
v_accvgpr_read_b32 v255, a79
v_pk_mul_f32 v[248:249], v[248:249], v[2:3] op_sel_hi:[1,0]
v_pk_mul_f32 v[250:251], v[250:251], v[2:3] op_sel_hi:[1,0]
v_pk_mul_f32 v[252:253], v[252:253], v[2:3] op_sel_hi:[1,0]
v_pk_mul_f32 v[254:255], v[254:255], v[2:3] op_sel_hi:[1,0]
v_cvt_pk_bf16_f32 v148, v248, v249
v_cvt_pk_bf16_f32 v149, v250, v251
v_cvt_pk_bf16_f32 v150, v252, v253
v_cvt_pk_bf16_f32 v151, v254, v255
buffer_store_dwordx4 v[148:151], v31, s[28:31], s54 offen offset:1024 sc0 sc1
v_accvgpr_read_b32 v248, a88
v_accvgpr_read_b32 v249, a89
v_accvgpr_read_b32 v250, a90
v_accvgpr_read_b32 v251, a91
v_accvgpr_read_b32 v252, a92
v_accvgpr_read_b32 v253, a93
v_accvgpr_read_b32 v254, a94
v_accvgpr_read_b32 v255, a95
v_pk_mul_f32 v[248:249], v[248:249], v[4:5] op_sel_hi:[1,0]
v_pk_mul_f32 v[250:251], v[250:251], v[4:5] op_sel_hi:[1,0]
v_pk_mul_f32 v[252:253], v[252:253], v[4:5] op_sel_hi:[1,0]
v_pk_mul_f32 v[254:255], v[254:255], v[4:5] op_sel_hi:[1,0]
v_cvt_pk_bf16_f32 v180, v248, v249
v_cvt_pk_bf16_f32 v181, v250, v251
v_cvt_pk_bf16_f32 v182, v252, v253
v_cvt_pk_bf16_f32 v183, v254, v255
buffer_store_dwordx4 v[180:183], v31, s[28:31], s48 offen offset:1024 sc0 sc1
v_accvgpr_read_b32 v240, a96
v_accvgpr_read_b32 v241, a97
v_accvgpr_read_b32 v242, a98
v_accvgpr_read_b32 v243, a99
v_accvgpr_read_b32 v244, a100
v_accvgpr_read_b32 v245, a101
v_accvgpr_read_b32 v246, a102
v_accvgpr_read_b32 v247, a103
v_pk_mul_f32 v[240:241], v[240:241], v[2:3] op_sel_hi:[1,0]
v_pk_mul_f32 v[242:243], v[242:243], v[2:3] op_sel_hi:[1,0]
v_pk_mul_f32 v[244:245], v[244:245], v[2:3] op_sel_hi:[1,0]
v_pk_mul_f32 v[246:247], v[246:247], v[2:3] op_sel_hi:[1,0]
v_cvt_pk_bf16_f32 v152, v240, v241
v_cvt_pk_bf16_f32 v153, v242, v243
v_cvt_pk_bf16_f32 v154, v244, v245
v_cvt_pk_bf16_f32 v155, v246, v247
buffer_store_dwordx4 v[152:155], v31, s[28:31], s54 offen offset:2048 sc0 sc1
v_accvgpr_read_b32 v240, a112
v_accvgpr_read_b32 v241, a113
v_accvgpr_read_b32 v242, a114
v_accvgpr_read_b32 v243, a115
v_accvgpr_read_b32 v244, a116
v_accvgpr_read_b32 v245, a117
v_accvgpr_read_b32 v246, a118
v_accvgpr_read_b32 v247, a119
v_pk_mul_f32 v[240:241], v[240:241], v[4:5] op_sel_hi:[1,0]
v_pk_mul_f32 v[242:243], v[242:243], v[4:5] op_sel_hi:[1,0]
v_pk_mul_f32 v[244:245], v[244:245], v[4:5] op_sel_hi:[1,0]
v_pk_mul_f32 v[246:247], v[246:247], v[4:5] op_sel_hi:[1,0]
v_cvt_pk_bf16_f32 v184, v240, v241
v_cvt_pk_bf16_f32 v185, v242, v243
v_cvt_pk_bf16_f32 v186, v244, v245
v_cvt_pk_bf16_f32 v187, v246, v247
buffer_store_dwordx4 v[184:187], v31, s[28:31], s48 offen offset:2048 sc0 sc1
v_accvgpr_read_b32 v248, a104
v_accvgpr_read_b32 v249, a105
v_accvgpr_read_b32 v250, a106
v_accvgpr_read_b32 v251, a107
v_accvgpr_read_b32 v252, a108
v_accvgpr_read_b32 v253, a109
v_accvgpr_read_b32 v254, a110
v_accvgpr_read_b32 v255, a111
v_pk_mul_f32 v[248:249], v[248:249], v[2:3] op_sel_hi:[1,0]
v_pk_mul_f32 v[250:251], v[250:251], v[2:3] op_sel_hi:[1,0]
v_pk_mul_f32 v[252:253], v[252:253], v[2:3] op_sel_hi:[1,0]
v_pk_mul_f32 v[254:255], v[254:255], v[2:3] op_sel_hi:[1,0]
v_cvt_pk_bf16_f32 v156, v248, v249
v_cvt_pk_bf16_f32 v157, v250, v251
v_cvt_pk_bf16_f32 v158, v252, v253
v_cvt_pk_bf16_f32 v159, v254, v255
buffer_store_dwordx4 v[156:159], v31, s[28:31], s54 offen offset:3072 sc0 sc1
v_accvgpr_read_b32 v248, a120
v_accvgpr_read_b32 v249, a121
v_accvgpr_read_b32 v250, a122
v_accvgpr_read_b32 v251, a123
v_accvgpr_read_b32 v252, a124
v_accvgpr_read_b32 v253, a125
v_accvgpr_read_b32 v254, a126
v_accvgpr_read_b32 v255, a127
v_pk_mul_f32 v[248:249], v[248:249], v[4:5] op_sel_hi:[1,0]
v_pk_mul_f32 v[250:251], v[250:251], v[4:5] op_sel_hi:[1,0]
v_pk_mul_f32 v[252:253], v[252:253], v[4:5] op_sel_hi:[1,0]
v_pk_mul_f32 v[254:255], v[254:255], v[4:5] op_sel_hi:[1,0]
v_cvt_pk_bf16_f32 v188, v248, v249
v_cvt_pk_bf16_f32 v189, v250, v251
v_cvt_pk_bf16_f32 v190, v252, v253
v_cvt_pk_bf16_f32 v191, v254, v255
buffer_store_dwordx4 v[188:191], v31, s[28:31], s48 offen offset:3072 sc0 sc1
s_lshl_b32 s82, s52, 20
s_and_b32 s83, s50, 7
s_lshl_b32 s83, s83, 17
s_add_u32 s82, s82, s83
s_lshl_b32 s83, s5, 15
s_add_u32 s82, s82, s83
s_lshl_b32 s83, s51, 8
s_add_u32 s82, s82, s83
s_add_u32 s98, s64, s82
s_addc_u32 s99, s65, 0
v_lshrrev_b32 v4, 1, v1
v_lshlrev_b32 v4, 10, v4
v_and_b32 v5, 1, v1
v_lshl_add_u32 v4, v5, 7, v4
global_load_dword v30, v4, s[98:99]
s_waitcnt lgkmcnt(0)
s_waitcnt vmcnt(52)
v_mfma_f32_32x32x16_bf16 a[0:15], a[144:147], a[192:195], 0
s_add_u32 m0, s46, 0
s_nop 0
buffer_load_dwordx4 v23, s[8:11], 0 offen lds
v_mfma_f32_32x32x16_bf16 a[16:31], a[144:147], a[196:199], 0
buffer_load_dwordx4 v24, s[8:11], s33 offen offset:1024 lds
buffer_load_dwordx4 v23, s[8:11], s34 offen offset:2048 lds
s_waitcnt vmcnt(54)
v_mfma_f32_32x32x16_bf16 a[32:47], a[148:151], a[192:195], 0
buffer_load_dwordx4 v24, s[8:11], s35 offen offset:3072 lds
s_add_u32 m0, s46, 0x1000
v_mfma_f32_32x32x16_bf16 a[48:63], a[148:151], a[196:199], 0
buffer_load_dwordx4 v23, s[8:11], s36 offen lds
buffer_load_dwordx4 v24, s[8:11], s37 offen offset:1024 lds
s_waitcnt vmcnt(56)
v_mfma_f32_32x32x16_bf16 a[64:79], a[152:155], a[192:195], 0
buffer_load_dwordx4 v23, s[8:11], s38 offen offset:2048 lds
v_mfma_f32_32x32x16_bf16 a[80:95], a[152:155], a[196:199], 0
buffer_load_dwordx4 v24, s[8:11], s39 offen offset:3072 lds
s_add_u32 s8, s8, 0x80
s_addc_u32 s9, s9, 0
s_waitcnt vmcnt(57)
v_mfma_f32_32x32x16_bf16 a[0:15], a[156:159], a[200:203], a[0:15]
v_mfma_f32_32x32x16_bf16 a[16:31], a[156:159], a[204:207], a[16:31]
buffer_load_dwordx4 a[144:147], v31, s[28:31], s43 offen sc1
s_waitcnt vmcnt(57)
v_mfma_f32_32x32x16_bf16 a[32:47], a[160:163], a[200:203], a[32:47]
v_mfma_f32_32x32x16_bf16 a[48:63], a[160:163], a[204:207], a[48:63]
buffer_load_dwordx4 a[148:151], v31, s[28:31], s44 offen sc1
s_waitcnt vmcnt(57)
v_mfma_f32_32x32x16_bf16 a[64:79], a[164:167], a[200:203], a[64:79]
v_mfma_f32_32x32x16_bf16 a[80:95], a[164:167], a[204:207], a[80:95]
buffer_load_dwordx4 a[152:155], v31, s[28:31], s45 offen sc1
s_waitcnt vmcnt(57)
v_mfma_f32_32x32x16_bf16 a[0:15], a[168:171], a[208:211], a[0:15]
ds_read_b128 a[224:227], v25 offset:8192
buffer_load_dwordx4 a[156:159], v31, s[28:31], s43 offen offset:1024 sc1
v_mfma_f32_32x32x16_bf16 a[16:31], a[168:171], a[212:215], a[16:31]
ds_read_b128 a[228:231], v25 offset:12288
buffer_load_dwordx4 a[160:163], v31, s[28:31], s44 offen offset:1024 sc1
s_waitcnt vmcnt(58)
v_mfma_f32_32x32x16_bf16 a[32:47], a[172:175], a[208:211], a[32:47]
ds_read_b128 a[232:235], v26 offset:8192
ds_read_b128 a[236:239], v26 offset:12288
v_mfma_f32_32x32x16_bf16 a[48:63], a[172:175], a[212:215], a[48:63]
ds_read_b128 a[240:243], v27 offset:8192
ds_read_b128 a[244:247], v27 offset:12288
s_waitcnt vmcnt(57)
v_mfma_f32_32x32x16_bf16 a[64:79], a[176:179], a[208:211], a[64:79]
buffer_load_dwordx4 a[164:167], v31, s[28:31], s45 offen offset:1024 sc1
v_mfma_f32_32x32x16_bf16 a[80:95], a[176:179], a[212:215], a[80:95]
ds_read_b128 a[248:251], v28 offset:8192
ds_read_b128 a[252:255], v28 offset:12288
s_waitcnt vmcnt(57)
v_mfma_f32_32x32x16_bf16 a[0:15], a[180:183], a[216:219], a[0:15]
v_mfma_f32_32x32x16_bf16 a[16:31], a[180:183], a[220:223], a[16:31]
buffer_load_dwordx4 a[168:171], v31, s[28:31], s43 offen offset:2048 sc1
s_waitcnt vmcnt(57)
v_mfma_f32_32x32x16_bf16 a[32:47], a[184:187], a[216:219], a[32:47]
v_mfma_f32_32x32x16_bf16 a[48:63], a[184:187], a[220:223], a[48:63]
buffer_load_dwordx4 a[172:175], v31, s[28:31], s44 offen offset:2048 sc1
s_waitcnt vmcnt(57)
v_mfma_f32_32x32x16_bf16 a[64:79], a[188:191], a[216:219], a[64:79]
v_mfma_f32_32x32x16_bf16 a[80:95], a[188:191], a[220:223], a[80:95]
buffer_load_dwordx4 a[176:179], v31, s[28:31], s45 offen offset:2048 sc1
buffer_load_dwordx4 a[180:183], v31, s[28:31], s43 offen offset:3072 sc1
buffer_load_dwordx4 a[184:187], v31, s[28:31], s44 offen offset:3072 sc1
buffer_load_dwordx4 a[188:191], v31, s[28:31], s45 offen offset:3072 sc1
s_add_u32 s43, s43, 0x1000
s_add_u32 s44, s44, 0x1000
s_add_u32 s45, s45, 0x1000
s_waitcnt lgkmcnt(0)
s_waitcnt vmcnt(60)
v_mfma_f32_32x32x16_bf16 a[0:15], v[40:43], a[224:227], a[0:15]
s_add_u32 m0, s46, 0x2000
s_nop 0
buffer_load_dwordx4 v23, s[8:11], 0 offen lds
v_mfma_f32_32x32x16_bf16 a[16:31], v[40:43], a[228:231], a[16:31]
buffer_load_dwordx4 v24, s[8:11], s33 offen offset:1024 lds
buffer_load_dwordx4 v23, s[8:11], s34 offen offset:2048 lds
s_waitcnt vmcnt(62)
v_mfma_f32_32x32x16_bf16 a[32:47], v[44:47], a[224:227], a[32:47]
buffer_load_dwordx4 v24, s[8:11], s35 offen offset:3072 lds
s_add_u32 m0, s46, 0x3000
v_mfma_f32_32x32x16_bf16 a[48:63], v[44:47], a[228:231], a[48:63]
buffer_load_dwordx4 v23, s[8:11], s36 offen lds
buffer_load_dwordx4 v24, s[8:11], s37 offen offset:1024 lds
s_waitcnt vmcnt(63)
v_mfma_f32_32x32x16_bf16 a[64:79], v[48:51], a[224:227], a[64:79]
buffer_load_dwordx4 v23, s[8:11], s38 offen offset:2048 lds
v_mfma_f32_32x32x16_bf16 a[80:95], v[48:51], a[228:231], a[80:95]
buffer_load_dwordx4 v24, s[8:11], s39 offen offset:3072 lds
s_add_u32 s8, s8, 0x80
s_addc_u32 s9, s9, 0
v_mfma_f32_32x32x16_bf16 a[0:15], v[52:55], a[232:235], a[0:15]
v_mfma_f32_32x32x16_bf16 a[16:31], v[52:55], a[236:239], a[16:31]
buffer_load_dwordx4 v[64:67], v31, s[28:31], s43 offen sc1
s_waitcnt vmcnt(63)
v_mfma_f32_32x32x16_bf16 a[32:47], v[56:59], a[232:235], a[32:47]
v_mfma_f32_32x32x16_bf16 a[48:63], v[56:59], a[236:239], a[48:63]
buffer_load_dwordx4 v[68:71], v31, s[28:31], s44 offen sc1
v_mfma_f32_32x32x16_bf16 a[64:79], v[60:63], a[232:235], a[64:79]
v_mfma_f32_32x32x16_bf16 a[80:95], v[60:63], a[236:239], a[80:95]
buffer_load_dwordx4 v[72:75], v31, s[28:31], s45 offen sc1
v_mfma_f32_32x32x16_bf16 a[0:15], v[112:115], a[240:243], a[0:15]
ds_read_b128 a[192:195], v25 offset:16384
buffer_load_dwordx4 v[76:79], v31, s[28:31], s43 offen offset:1024 sc1
v_mfma_f32_32x32x16_bf16 a[16:31], v[112:115], a[244:247], a[16:31]
ds_read_b128 a[196:199], v25 offset:20480
buffer_load_dwordx4 v[80:83], v31, s[28:31], s44 offen offset:1024 sc1
s_waitcnt vmcnt(63)
v_mfma_f32_32x32x16_bf16 a[32:47], v[116:119], a[240:243], a[32:47]
ds_read_b128 a[200:203], v26 offset:16384
ds_read_b128 a[204:207], v26 offset:20480
v_mfma_f32_32x32x16_bf16 a[48:63], v[116:119], a[244:247], a[48:63]
ds_read_b128 a[208:211], v27 offset:16384
ds_read_b128 a[212:215], v27 offset:20480
v_mfma_f32_32x32x16_bf16 a[64:79], v[120:123], a[240:243], a[64:79]
buffer_load_dwordx4 v[84:87], v31, s[28:31], s45 offen offset:1024 sc1
v_mfma_f32_32x32x16_bf16 a[80:95], v[120:123], a[244:247], a[80:95]
ds_read_b128 a[216:219], v28 offset:16384
ds_read_b128 a[220:223], v28 offset:20480
v_mfma_f32_32x32x16_bf16 a[0:15], v[124:127], a[248:251], a[0:15]
v_mfma_f32_32x32x16_bf16 a[16:31], v[124:127], a[252:255], a[16:31]
buffer_load_dwordx4 v[88:91], v31, s[28:31], s43 offen offset:2048 sc1
v_mfma_f32_32x32x16_bf16 a[32:47], a[128:131], a[248:251], a[32:47]
v_mfma_f32_32x32x16_bf16 a[48:63], a[128:131], a[252:255], a[48:63]
buffer_load_dwordx4 v[92:95], v31, s[28:31], s44 offen offset:2048 sc1
s_waitcnt vmcnt(63)
v_mfma_f32_32x32x16_bf16 a[64:79], a[132:135], a[248:251], a[64:79]
v_mfma_f32_32x32x16_bf16 a[80:95], a[132:135], a[252:255], a[80:95]
buffer_load_dwordx4 v[96:99], v31, s[28:31], s45 offen offset:2048 sc1
buffer_load_dwordx4 v[100:103], v31, s[28:31], s43 offen offset:3072 sc1
buffer_load_dwordx4 v[104:107], v31, s[28:31], s44 offen offset:3072 sc1
buffer_load_dwordx4 v[108:111], v31, s[28:31], s45 offen offset:3072 sc1
s_add_u32 s43, s43, 0x1000
s_add_u32 s44, s44, 0x1000
s_add_u32 s45, s45, 0x1000
s_waitcnt lgkmcnt(0)
v_mfma_f32_32x32x16_bf16 a[0:15], v[192:195], a[192:195], a[0:15]
s_add_u32 m0, s46, 0x4000
s_nop 0
buffer_load_dwordx4 v23, s[8:11], 0 offen lds
v_mfma_f32_32x32x16_bf16 a[16:31], v[192:195], a[196:199], a[16:31]
buffer_load_dwordx4 v24, s[8:11], s33 offen offset:1024 lds
buffer_load_dwordx4 v23, s[8:11], s34 offen offset:2048 lds
v_mfma_f32_32x32x16_bf16 a[32:47], v[196:199], a[192:195], a[32:47]
buffer_load_dwordx4 v24, s[8:11], s35 offen offset:3072 lds
s_add_u32 m0, s46, 0x5000
v_mfma_f32_32x32x16_bf16 a[48:63], v[196:199], a[196:199], a[48:63]
buffer_load_dwordx4 v23, s[8:11], s36 offen lds
buffer_load_dwordx4 v24, s[8:11], s37 offen offset:1024 lds
s_waitcnt vmcnt(63)
v_mfma_f32_32x32x16_bf16 a[64:79], v[200:203], a[192:195], a[64:79]
buffer_load_dwordx4 v23, s[8:11], s38 offen offset:2048 lds
v_mfma_f32_32x32x16_bf16 a[80:95], v[200:203], a[196:199], a[80:95]
buffer_load_dwordx4 v24, s[8:11], s39 offen offset:3072 lds
s_add_u32 s8, s8, 0x80
s_addc_u32 s9, s9, 0
s_waitcnt vmcnt(49)
s_lshl_b32 s82, s4, 2
s_add_u32 s82, s82, s5
s_lshl_b32 s82, s82, 5
s_add_u32 s82, s82, s3
s_lshl_b32 s82, s82, 2
s_add_u32 s82, s82, 0x3004000
v_mov_b32 v2, s32
v_mov_b32 v3, 0
s_mov_b64 exec, 1
buffer_store_dword v2, v3, s[28:31], s82 offen sc0 sc1
s_mov_b64 exec, -1
v_mfma_f32_32x32x16_bf16 a[0:15], v[204:207], a[200:203], a[0:15]
v_mfma_f32_32x32x16_bf16 a[16:31], v[204:207], a[204:207], a[16:31]
buffer_load_dwordx4 v[192:195], v31, s[28:31], s43 offen sc1
v_mfma_f32_32x32x16_bf16 a[32:47], v[208:211], a[200:203], a[32:47]
v_mfma_f32_32x32x16_bf16 a[48:63], v[208:211], a[204:207], a[48:63]
buffer_load_dwordx4 v[196:199], v31, s[28:31], s44 offen sc1
v_mfma_f32_32x32x16_bf16 a[64:79], v[212:215], a[200:203], a[64:79]
v_mfma_f32_32x32x16_bf16 a[80:95], v[212:215], a[204:207], a[80:95]
buffer_load_dwordx4 v[200:203], v31, s[28:31], s45 offen sc1
s_waitcnt vmcnt(44)
v_mfma_f32_32x32x16_bf16 a[0:15], v[216:219], a[208:211], a[0:15]
ds_read_b128 a[224:227], v25 offset:0
buffer_load_dwordx4 v[204:207], v31, s[28:31], s43 offen offset:1024 sc1
v_mfma_f32_32x32x16_bf16 a[16:31], v[216:219], a[212:215], a[16:31]
ds_read_b128 a[228:231], v25 offset:4096
buffer_load_dwordx4 v[208:211], v31, s[28:31], s44 offen offset:1024 sc1
v_mfma_f32_32x32x16_bf16 a[32:47], v[220:223], a[208:211], a[32:47]
ds_read_b128 a[232:235], v26 offset:0
ds_read_b128 a[236:239], v26 offset:4096
v_mfma_f32_32x32x16_bf16 a[48:63], v[220:223], a[212:215], a[48:63]
ds_read_b128 a[240:243], v27 offset:0
ds_read_b128 a[244:247], v27 offset:4096
v_mfma_f32_32x32x16_bf16 a[64:79], v[224:227], a[208:211], a[64:79]
buffer_load_dwordx4 v[212:215], v31, s[28:31], s45 offen offset:1024 sc1
v_mfma_f32_32x32x16_bf16 a[80:95], v[224:227], a[212:215], a[80:95]
ds_read_b128 a[248:251], v28 offset:0
ds_read_b128 a[252:255], v28 offset:4096
v_mfma_f32_32x32x16_bf16 a[0:15], v[228:231], a[216:219], a[0:15]
v_mfma_f32_32x32x16_bf16 a[16:31], v[228:231], a[220:223], a[16:31]
buffer_load_dwordx4 v[216:219], v31, s[28:31], s43 offen offset:2048 sc1
v_mfma_f32_32x32x16_bf16 a[32:47], v[232:235], a[216:219], a[32:47]
v_mfma_f32_32x32x16_bf16 a[48:63], v[232:235], a[220:223], a[48:63]
buffer_load_dwordx4 v[220:223], v31, s[28:31], s44 offen offset:2048 sc1
v_mfma_f32_32x32x16_bf16 a[64:79], v[236:239], a[216:219], a[64:79]
v_mfma_f32_32x32x16_bf16 a[80:95], v[236:239], a[220:223], a[80:95]
buffer_load_dwordx4 v[224:227], v31, s[28:31], s45 offen offset:2048 sc1
buffer_load_dwordx4 v[228:231], v31, s[28:31], s43 offen offset:3072 sc1
buffer_load_dwordx4 v[232:235], v31, s[28:31], s44 offen offset:3072 sc1
buffer_load_dwordx4 v[236:239], v31, s[28:31], s45 offen offset:3072 sc1
s_add_u32 s43, s43, 0x1000
s_add_u32 s44, s44, 0x1000
s_add_u32 s45, s45, 0x1000
s_waitcnt lgkmcnt(0)
s_waitcnt vmcnt(52)
v_mfma_f32_32x32x16_bf16 a[0:15], a[144:147], a[224:227], a[0:15]
s_add_u32 m0, s46, 0
s_nop 0
buffer_load_dwordx4 v23, s[8:11], 0 offen lds
v_min_u32 v56, 2, v1
v_lshlrev_b32 v56, 4, v56
s_lshr_b32 s83, s40, 2
v_mfma_f32_32x32x16_bf16 a[16:31], a[144:147], a[228:231], a[16:31]
buffer_load_dwordx4 v24, s[8:11], s33 offen offset:1024 lds
s_lshl_b32 s83, s83, 5
buffer_load_dwordx4 v23, s[8:11], s34 offen offset:2048 lds
s_add_u32 s83, s83, s42
s_waitcnt vmcnt(54)
v_mfma_f32_32x32x16_bf16 a[32:47], a[148:151], a[224:227], a[32:47]
buffer_load_dwordx4 v24, s[8:11], s35 offen offset:3072 lds
s_lshl_b32 s83, s83, 2
s_add_u32 m0, s46, 0x1000
s_and_b32 s84, s40, 3
v_mfma_f32_32x32x16_bf16 a[48:63], a[148:151], a[228:231], a[48:63]
buffer_load_dwordx4 v23, s[8:11], s36 offen lds
s_add_u32 s83, s83, s84
buffer_load_dwordx4 v24, s[8:11], s37 offen offset:1024 lds
s_waitcnt vmcnt(56)
v_mfma_f32_32x32x16_bf16 a[64:79], a[152:155], a[224:227], a[64:79]
buffer_load_dwordx4 v23, s[8:11], s38 offen offset:2048 lds
s_lshl_b32 s83, s83, 2
s_add_u32 s55, s83, 0x3000000
v_mfma_f32_32x32x16_bf16 a[80:95], a[152:155], a[228:231], a[80:95]
buffer_load_dwordx4 v24, s[8:11], s39 offen offset:3072 lds
buffer_load_dword v55, v56, s[28:31], s55 offen sc0 sc1
s_add_u32 s8, s8, 0x80
s_addc_u32 s9, s9, 0
s_waitcnt vmcnt(58)
v_mfma_f32_32x32x16_bf16 a[0:15], a[156:159], a[232:235], a[0:15]
v_mfma_f32_32x32x16_bf16 a[16:31], a[156:159], a[236:239], a[16:31]
buffer_load_dwordx4 a[144:147], v31, s[28:31], s43 offen sc1
s_waitcnt vmcnt(58)
v_mfma_f32_32x32x16_bf16 a[32:47], a[160:163], a[232:235], a[32:47]
v_mfma_f32_32x32x16_bf16 a[48:63], a[160:163], a[236:239], a[48:63]
buffer_load_dwordx4 a[148:151], v31, s[28:31], s44 offen sc1
s_waitcnt vmcnt(58)
v_mfma_f32_32x32x16_bf16 a[64:79], a[164:167], a[232:235], a[64:79]
v_mfma_f32_32x32x16_bf16 a[80:95], a[164:167], a[236:239], a[80:95]
buffer_load_dwordx4 a[152:155], v31, s[28:31], s45 offen sc1
s_waitcnt vmcnt(45)
v_mfma_f32_32x32x16_bf16 a[0:15], a[168:171], a[240:243], a[0:15]
ds_read_b128 a[192:195], v25 offset:8192
buffer_load_dwordx4 a[156:159], v31, s[28:31], s43 offen offset:1024 sc1
v_mfma_f32_32x32x16_bf16 a[16:31], a[168:171], a[244:247], a[16:31]
ds_read_b128 a[196:199], v25 offset:12288
buffer_load_dwordx4 a[160:163], v31, s[28:31], s44 offen offset:1024 sc1
v_mfma_f32_32x32x16_bf16 a[32:47], a[172:175], a[240:243], a[32:47]
ds_read_b128 a[200:203], v26 offset:8192
ds_read_b128 a[204:207], v26 offset:12288
v_mfma_f32_32x32x16_bf16 a[48:63], a[172:175], a[244:247], a[48:63]
ds_read_b128 a[208:211], v27 offset:8192
ds_read_b128 a[212:215], v27 offset:12288
v_mfma_f32_32x32x16_bf16 a[64:79], a[176:179], a[240:243], a[64:79]
buffer_load_dwordx4 a[164:167], v31, s[28:31], s45 offen offset:1024 sc1
v_mfma_f32_32x32x16_bf16 a[80:95], a[176:179], a[244:247], a[80:95]
ds_read_b128 a[216:219], v28 offset:8192
ds_read_b128 a[220:223], v28 offset:12288
v_mfma_f32_32x32x16_bf16 a[0:15], a[180:183], a[248:251], a[0:15]
v_mfma_f32_32x32x16_bf16 a[16:31], a[180:183], a[252:255], a[16:31]
buffer_load_dwordx4 a[168:171], v31, s[28:31], s43 offen offset:2048 sc1
v_mfma_f32_32x32x16_bf16 a[32:47], a[184:187], a[248:251], a[32:47]
v_mfma_f32_32x32x16_bf16 a[48:63], a[184:187], a[252:255], a[48:63]
buffer_load_dwordx4 a[172:175], v31, s[28:31], s44 offen offset:2048 sc1
v_mfma_f32_32x32x16_bf16 a[64:79], a[188:191], a[248:251], a[64:79]
v_mfma_f32_32x32x16_bf16 a[80:95], a[188:191], a[252:255], a[80:95]
buffer_load_dwordx4 a[176:179], v31, s[28:31], s45 offen offset:2048 sc1
buffer_load_dwordx4 a[180:183], v31, s[28:31], s43 offen offset:3072 sc1
buffer_load_dwordx4 a[184:187], v31, s[28:31], s44 offen offset:3072 sc1
buffer_load_dwordx4 a[188:191], v31, s[28:31], s45 offen offset:3072 sc1
s_add_u32 s43, s43, 0x1000
s_add_u32 s44, s44, 0x1000
s_add_u32 s45, s45, 0x1000
s_waitcnt lgkmcnt(0)
s_waitcnt vmcnt(53)
v_mfma_f32_32x32x16_bf16 a[0:15], v[64:67], a[192:195], a[0:15]
s_add_u32 m0, s46, 0x2000
s_nop 0
buffer_load_dwordx4 v23, s[8:11], 0 offen lds
v_mfma_f32_32x32x16_bf16 a[16:31], v[64:67], a[196:199], a[16:31]
buffer_load_dwordx4 v24, s[8:11], s33 offen offset:1024 lds
buffer_load_dwordx4 v23, s[8:11], s34 offen offset:2048 lds
s_waitcnt vmcnt(55)
v_mfma_f32_32x32x16_bf16 a[32:47], v[68:71], a[192:195], a[32:47]
buffer_load_dwordx4 v24, s[8:11], s35 offen offset:3072 lds
s_add_u32 m0, s46, 0x3000
v_mfma_f32_32x32x16_bf16 a[48:63], v[68:71], a[196:199], a[48:63]
buffer_load_dwordx4 v23, s[8:11], s36 offen lds
buffer_load_dwordx4 v24, s[8:11], s37 offen offset:1024 lds
s_waitcnt vmcnt(57)
v_mfma_f32_32x32x16_bf16 a[64:79], v[72:75], a[192:195], a[64:79]
buffer_load_dwordx4 v23, s[8:11], s38 offen offset:2048 lds
v_mfma_f32_32x32x16_bf16 a[80:95], v[72:75], a[196:199], a[80:95]
buffer_load_dwordx4 v24, s[8:11], s39 offen offset:3072 lds
s_add_u32 s8, s8, 0x80
s_addc_u32 s9, s9, 0
s_waitcnt vmcnt(58)
v_mfma_f32_32x32x16_bf16 a[0:15], v[76:79], a[200:203], a[0:15]
s_and_b32 s83, s50, 7
s_mul_i32 s83, s83, 0x56
buffer_load_dwordx4 v[64:67], v31, s[28:31], s43 offen sc1
v_mfma_f32_32x32x16_bf16 a[16:31], v[76:79], a[204:207], a[16:31]
s_mul_i32 s84, s5, 22
s_add_u32 s83, s83, s84
buffer_load_dwordx4 v[68:71], v31, s[28:31], s44 offen sc1
s_waitcnt vmcnt(59)
v_mfma_f32_32x32x16_bf16 a[32:47], v[80:83], a[200:203], a[32:47]
s_lshl_b32 s84, s51, 8
s_and_b32 s85, s52, 1
buffer_load_dwordx4 v[72:75], v31, s[28:31], s45 offen sc1
v_mfma_f32_32x32x16_bf16 a[48:63], v[80:83], a[204:207], a[48:63]
s_lshl_b32 s85, s85, 7
s_add_u32 s84, s84, s85
s_add_u32 s98, s74, s84
s_addc_u32 s99, s75, 0
s_waitcnt vmcnt(59)
v_mfma_f32_32x32x16_bf16 a[64:79], v[84:87], a[200:203], a[64:79]
v_min_u32 v4, 21, v1
v_add_u32 v4, s83, v4
v_min_u32 v4, 0x2af, v4
v_mfma_f32_32x32x16_bf16 a[80:95], v[84:87], a[204:207], a[80:95]
v_lshlrev_b32 v4, 10, v4
global_load_dword v29, v4, s[98:99]
s_waitcnt vmcnt(46)
v_mfma_f32_32x32x16_bf16 a[0:15], v[88:91], a[208:211], a[0:15]
ds_read_b128 a[224:227], v25 offset:16384
buffer_load_dwordx4 v[76:79], v31, s[28:31], s43 offen offset:1024 sc1
v_mfma_f32_32x32x16_bf16 a[16:31], v[88:91], a[212:215], a[16:31]
ds_read_b128 a[228:231], v25 offset:20480
buffer_load_dwordx4 v[80:83], v31, s[28:31], s44 offen offset:1024 sc1
v_mfma_f32_32x32x16_bf16 a[32:47], v[92:95], a[208:211], a[32:47]
ds_read_b128 a[232:235], v26 offset:16384
ds_read_b128 a[236:239], v26 offset:20480
v_mfma_f32_32x32x16_bf16 a[48:63], v[92:95], a[212:215], a[48:63]
ds_read_b128 a[240:243], v27 offset:16384
ds_read_b128 a[244:247], v27 offset:20480
v_mfma_f32_32x32x16_bf16 a[64:79], v[96:99], a[208:211], a[64:79]
buffer_load_dwordx4 v[84:87], v31, s[28:31], s45 offen offset:1024 sc1
v_mfma_f32_32x32x16_bf16 a[80:95], v[96:99], a[212:215], a[80:95]
ds_read_b128 a[248:251], v28 offset:16384
ds_read_b128 a[252:255], v28 offset:20480
v_mfma_f32_32x32x16_bf16 a[0:15], v[100:103], a[216:219], a[0:15]
v_mfma_f32_32x32x16_bf16 a[16:31], v[100:103], a[220:223], a[16:31]
buffer_load_dwordx4 v[88:91], v31, s[28:31], s43 offen offset:2048 sc1
v_mfma_f32_32x32x16_bf16 a[32:47], v[104:107], a[216:219], a[32:47]
v_mfma_f32_32x32x16_bf16 a[48:63], v[104:107], a[220:223], a[48:63]
buffer_load_dwordx4 v[92:95], v31, s[28:31], s44 offen offset:2048 sc1
v_mfma_f32_32x32x16_bf16 a[64:79], v[108:111], a[216:219], a[64:79]
v_mfma_f32_32x32x16_bf16 a[80:95], v[108:111], a[220:223], a[80:95]
buffer_load_dwordx4 v[96:99], v31, s[28:31], s45 offen offset:2048 sc1
buffer_load_dwordx4 v[100:103], v31, s[28:31], s43 offen offset:3072 sc1
buffer_load_dwordx4 v[104:107], v31, s[28:31], s44 offen offset:3072 sc1
buffer_load_dwordx4 v[108:111], v31, s[28:31], s45 offen offset:3072 sc1
s_add_u32 s43, s43, 0x1000
s_add_u32 s44, s44, 0x1000
s_add_u32 s45, s45, 0x1000
s_waitcnt lgkmcnt(0)
s_waitcnt vmcnt(53)
v_mfma_f32_32x32x16_bf16 a[0:15], v[192:195], a[224:227], a[0:15]
s_waitcnt vmcnt(33)
v_cmp_eq_u32 vcc, s32, v55
s_cmp_eq_u64 vcc, exec
s_cbranch_scc0 L_slow_14
L_slow_14_r:
s_mov_b32 s20, s72
s_and_b32 s21, s73, 0xffff
s_mov_b32 s22, 0x1000
s_mov_b32 s23, 0x20000
v_and_b32 v4, 31, v1
v_mfma_f32_32x32x16_bf16 a[16:31], v[192:195], a[228:231], a[16:31]
v_lshlrev_b32 v4, 1, v4
s_mul_i32 s83, s5, 3
s_add_u32 s83, s83, 0
s_lshr_b32 s84, s83, 2
s_add_u32 s84, s84, s42
s_bfe_u32 s85, s83, 0x10001
s_and_b32 s86, s83, 1
s_lshl_b32 s87, s40, 1
s_add_u32 s87, s87, s85
v_mfma_f32_32x32x16_bf16 a[32:47], v[196:199], a[224:227], a[32:47]
s_mul_i32 s88, s87, 44
s_lshl_b32 s84, s84, 1
s_add_u32 s88, s88, s84
s_add_u32 s88, s88, s86
s_lshl_b32 s46, s88, 10
s_add_u32 s89, s46, 0x1100000
buffer_load_dwordx4 v[40:43], v31, s[28:31], s89 offen sc1
s_lshl_b32 s87, s87, 6
v_mfma_f32_32x32x16_bf16 a[48:63], v[196:199], a[228:231], a[48:63]
buffer_load_ushort v52, v4, s[20:23], s87 offen
s_mul_i32 s83, s5, 3
s_add_u32 s83, s83, 1
s_lshr_b32 s84, s83, 2
s_add_u32 s84, s84, s42
s_bfe_u32 s85, s83, 0x10001
s_and_b32 s86, s83, 1
s_lshl_b32 s87, s40, 1
v_mfma_f32_32x32x16_bf16 a[64:79], v[200:203], a[224:227], a[64:79]
s_add_u32 s87, s87, s85
s_mul_i32 s88, s87, 44
s_lshl_b32 s84, s84, 1
s_add_u32 s88, s88, s84
s_add_u32 s88, s88, s86
s_lshl_b32 s47, s88, 10
s_add_u32 s89, s47, 0x1100000
buffer_load_dwordx4 v[44:47], v31, s[28:31], s89 offen sc1
v_mfma_f32_32x32x16_bf16 a[80:95], v[200:203], a[228:231], a[80:95]
s_lshl_b32 s87, s87, 6
buffer_load_ushort v53, v4, s[20:23], s87 offen
s_mul_i32 s83, s5, 3
s_add_u32 s83, s83, 2
s_lshr_b32 s84, s83, 2
s_add_u32 s84, s84, s42
s_bfe_u32 s85, s83, 0x10001
s_and_b32 s86, s83, 1
s_lshl_b32 s87, s40, 1
s_add_u32 s87, s87, s85
s_mul_i32 s88, s87, 44
s_lshl_b32 s84, s84, 1
s_add_u32 s88, s88, s84
s_add_u32 s88, s88, s86
s_lshl_b32 s48, s88, 10
s_add_u32 s89, s48, 0x1100000
buffer_load_dwordx4 v[48:51], v31, s[28:31], s89 offen sc1
s_lshl_b32 s87, s87, 6
buffer_load_ushort v54, v4, s[20:23], s87 offen
v_mfma_f32_32x32x16_bf16 a[0:15], v[204:207], a[232:235], a[0:15]
s_lshl_b32 s82, s52, 20
s_lshl_b32 s83, s51, 8
s_add_u32 s82, s82, s83
s_add_u32 s12, s64, s82
s_addc_u32 s13, s65, 0
s_and_b32 s13, s13, 0xffff
s_mov_b32 s14, 0x100000
s_mov_b32 s15, 0x20000
s_lshl_b32 s82, s5, 14
v_mfma_f32_32x32x16_bf16 a[16:31], v[204:207], a[236:239], a[16:31]
s_add_u32 s33, s82, 0
s_add_u32 s34, s82, 0xc00
s_add_u32 s35, s82, 0x1800
s_add_u32 s36, s82, 0x2400
v_lshrrev_b32 v2, 4, v1
v_lshlrev_b32 v3, 2, v2
v_and_b32 v4, 15, v1
v_xor_b32 v4, v4, v3
v_lshlrev_b32 v2, 10, v2
v_mfma_f32_32x32x16_bf16 a[32:47], v[208:211], a[232:235], a[32:47]
v_lshl_add_u32 v10, v4, 4, v2
v_lshrrev_b32 v2, 5, v1
v_bfe_u32 v3, v1, 4, 1
v_bfe_u32 v4, v1, 2, 2
v_and_b32 v5, 3, v1
v_mfma_f32_32x32x16_bf16 a[48:63], v[208:211], a[236:239], a[48:63]
v_and_b32 v6, 1, v5
v_lshl_add_u32 v6, v3, 1, v6
v_lshrrev_b32 v7, 1, v5
v_lshlrev_b32 v7, 3, v7
v_lshl_add_u32 v8, v2, 3, v4
v_mfma_f32_32x32x16_bf16 a[64:79], v[212:215], a[232:235], a[64:79]
v_lshlrev_b32 v8, 8, v8
v_add_u32 v8, v8, v7
v_lshl_add_u32 v8, v6, 4, v8
v_add_u32 v8, 0x18000, v8
v_xor_b32 v9, 0, v4
v_mfma_f32_32x32x16_bf16 a[80:95], v[212:215], a[236:239], a[80:95]
v_lshl_add_u32 v11, v9, 6, v8
v_xor_b32 v9, 1, v4
v_lshl_add_u32 v12, v9, 6, v8
v_xor_b32 v9, 2, v4
v_lshl_add_u32 v13, v9, 6, v8
v_xor_b32 v9, 3, v4
v_lshl_add_u32 v14, v9, 6, v8
v_lshlrev_b32 v15, 4, v1
s_lshl_b32 s82, s50, 2
s_add_u32 s82, s82, s5
s_lshl_b32 s82, s82, 8
s_lshl_b32 s83, s52, 6
s_add_u32 s82, s82, s83
s_lshl_b32 s37, s82, 10
s_lshl_b32 s38, s5, 12
s_add_u32 s38, s38, 0x18000
s_lshl_b32 s82, s50, 2
s_add_u32 s82, s82, s5
s_lshr_b32 s82, s82, 1
s_lshl_b32 s82, s82, 5
s_lshl_b32 s83, s52, 3
s_add_u32 s82, s82, s83
s_lshl_b32 s82, s82, 2
s_add_u32 s39, s82, 0x3004000
v_and_b32 v17, 7, v1
v_lshlrev_b32 v17, 2, v17
buffer_load_dword v16, v17, s[28:31], s39 offen sc0 sc1
v_mfma_f32_32x32x16_bf16 a[0:15], v[216:219], a[240:243], a[0:15]
s_add_u32 m0, s38, 0
ds_read_b128 a[192:195], v25 offset:0
buffer_load_dwordx4 v10, s[12:15], s33 offen lds
v_mfma_f32_32x32x16_bf16 a[16:31], v[216:219], a[244:247], a[16:31]
buffer_load_dwordx4 v10, s[12:15], s34 offen offset:1024 lds
ds_read_b128 a[196:199], v25 offset:4096
v_mfma_f32_32x32x16_bf16 a[32:47], v[220:223], a[240:243], a[32:47]
ds_read_b128 a[200:203], v26 offset:0
buffer_load_dwordx4 v10, s[12:15], s35 offen offset:2048 lds
v_mfma_f32_32x32x16_bf16 a[48:63], v[220:223], a[244:247], a[48:63]
ds_read_b128 a[204:207], v26 offset:4096
buffer_load_dwordx4 v10, s[12:15], s36 offen offset:3072 lds
v_mfma_f32_32x32x16_bf16 a[64:79], v[224:227], a[240:243], a[64:79]
ds_read_b128 a[208:211], v27 offset:0
s_add_u32 s12, s12, 0x10000
s_addc_u32 s13, s13, 0
v_mfma_f32_32x32x16_bf16 a[80:95], v[224:227], a[244:247], a[80:95]
ds_read_b128 a[212:215], v27 offset:4096
ds_read_b128 a[216:219], v28 offset:0
ds_read_b128 a[220:223], v28 offset:4096
v_mfma_f32_32x32x16_bf16 a[0:15], v[228:231], a[248:251], a[0:15]
s_add_u32 m0, s38, 0x4000
v_mfma_f32_32x32x16_bf16 a[16:31], v[228:231], a[252:255], a[16:31]
buffer_load_dwordx4 v10, s[12:15], s33 offen lds
v_mfma_f32_32x32x16_bf16 a[32:47], v[232:235], a[248:251], a[32:47]
buffer_load_dwordx4 v10, s[12:15], s34 offen offset:1024 lds
v_mfma_f32_32x32x16_bf16 a[48:63], v[232:235], a[252:255], a[48:63]
buffer_load_dwordx4 v10, s[12:15], s35 offen offset:2048 lds
v_mfma_f32_32x32x16_bf16 a[64:79], v[236:239], a[248:251], a[64:79]
buffer_load_dwordx4 v10, s[12:15], s36 offen offset:3072 lds
v_mfma_f32_32x32x16_bf16 a[80:95], v[236:239], a[252:255], a[80:95]
s_add_u32 s12, s12, 0x10000
s_addc_u32 s13, s13, 0
s_waitcnt lgkmcnt(0)
s_waitcnt vmcnt(47)
v_mfma_f32_32x32x16_bf16 a[0:15], a[144:147], a[192:195], a[0:15]
s_add_u32 m0, s38, 0x8000
v_mfma_f32_32x32x16_bf16 a[16:31], a[144:147], a[196:199], a[16:31]
buffer_load_dwordx4 v10, s[12:15], s33 offen lds
s_waitcnt vmcnt(47)
v_mfma_f32_32x32x16_bf16 a[32:47], a[148:151], a[192:195], a[32:47]
buffer_load_dwordx4 v10, s[12:15], s34 offen offset:1024 lds
v_mfma_f32_32x32x16_bf16 a[48:63], a[148:151], a[196:199], a[48:63]
buffer_load_dwordx4 v10, s[12:15], s35 offen offset:2048 lds
s_waitcnt vmcnt(48)
v_mfma_f32_32x32x16_bf16 a[64:79], a[152:155], a[192:195], a[64:79]
buffer_load_dwordx4 v10, s[12:15], s36 offen offset:3072 lds
v_mfma_f32_32x32x16_bf16 a[80:95], a[152:155], a[196:199], a[80:95]
s_add_u32 s12, s12, 0x10000
s_addc_u32 s13, s13, 0
s_waitcnt vmcnt(48)
v_mfma_f32_32x32x16_bf16 a[0:15], a[156:159], a[200:203], a[0:15]
v_mfma_f32_32x32x16_bf16 a[16:31], a[156:159], a[204:207], a[16:31]
s_waitcnt vmcnt(47)
v_mfma_f32_32x32x16_bf16 a[32:47], a[160:163], a[200:203], a[32:47]
v_mfma_f32_32x32x16_bf16 a[48:63], a[160:163], a[204:207], a[48:63]
s_waitcnt vmcnt(46)
v_mfma_f32_32x32x16_bf16 a[64:79], a[164:167], a[200:203], a[64:79]
v_mfma_f32_32x32x16_bf16 a[80:95], a[164:167], a[204:207], a[80:95]
s_waitcnt vmcnt(32)
s_waitcnt vmcnt(12)
v_cmp_eq_u32 vcc, s32, v16
s_cmp_eq_u64 vcc, exec
s_cbranch_scc0 L_slow_15
L_slow_15_r:
v_mfma_f32_32x32x16_bf16 a[0:15], a[168:171], a[208:211], a[0:15]
buffer_load_dwordx4 v[128:131], v15, s[28:31], s37 offen sc1
ds_read_b128 a[224:227], v25 offset:8192
v_mfma_f32_32x32x16_bf16 a[16:31], a[168:171], a[212:215], a[16:31]
ds_read_b128 a[228:231], v25 offset:12288
buffer_load_dwordx4 v[132:135], v15, s[28:31], s37 offen offset:1024 sc1
v_mfma_f32_32x32x16_bf16 a[32:47], a[172:175], a[208:211], a[32:47]
ds_read_b128 a[232:235], v26 offset:8192
buffer_load_dwordx4 v[136:139], v15, s[28:31], s37 offen offset:2048 sc1
v_mfma_f32_32x32x16_bf16 a[48:63], a[172:175], a[212:215], a[48:63]
ds_read_b128 a[236:239], v26 offset:12288
buffer_load_dwordx4 v[140:143], v15, s[28:31], s37 offen offset:3072 sc1
v_mfma_f32_32x32x16_bf16 a[64:79], a[176:179], a[208:211], a[64:79]
ds_read_b128 a[240:243], v27 offset:8192
ds_read_b128 a[244:247], v27 offset:12288
s_add_u32 s37, s37, 0x1000
v_mfma_f32_32x32x16_bf16 a[80:95], a[176:179], a[212:215], a[80:95]
ds_read_b128 a[248:251], v28 offset:8192
ds_read_b128 a[252:255], v28 offset:12288
v_mfma_f32_32x32x16_bf16 a[0:15], a[180:183], a[216:219], a[0:15]
buffer_load_dwordx4 v[144:147], v15, s[28:31], s37 offen sc1
v_mfma_f32_32x32x16_bf16 a[16:31], a[180:183], a[220:223], a[16:31]
buffer_load_dwordx4 v[148:151], v15, s[28:31], s37 offen offset:1024 sc1
v_mfma_f32_32x32x16_bf16 a[32:47], a[184:187], a[216:219], a[32:47]
buffer_load_dwordx4 v[152:155], v15, s[28:31], s37 offen offset:2048 sc1
v_mfma_f32_32x32x16_bf16 a[48:63], a[184:187], a[220:223], a[48:63]
v_mfma_f32_32x32x16_bf16 a[64:79], a[188:191], a[216:219], a[64:79]
buffer_load_dwordx4 v[156:159], v15, s[28:31], s37 offen offset:3072 sc1
v_mfma_f32_32x32x16_bf16 a[80:95], a[188:191], a[220:223], a[80:95]
s_add_u32 s37, s37, 0x1000
s_waitcnt lgkmcnt(0)
v_mfma_f32_32x32x16_bf16 a[0:15], v[64:67], a[224:227], a[0:15]
buffer_load_dwordx4 v[160:163], v15, s[28:31], s37 offen sc1
v_mfma_f32_32x32x16_bf16 a[16:31], v[64:67], a[228:231], a[16:31]
buffer_load_dwordx4 v[164:167], v15, s[28:31], s37 offen offset:1024 sc1
v_mfma_f32_32x32x16_bf16 a[32:47], v[68:71], a[224:227], a[32:47]
buffer_load_dwordx4 v[168:171], v15, s[28:31], s37 offen offset:2048 sc1
v_mfma_f32_32x32x16_bf16 a[48:63], v[68:71], a[228:231], a[48:63]
v_mfma_f32_32x32x16_bf16 a[64:79], v[72:75], a[224:227], a[64:79]
buffer_load_dwordx4 v[172:175], v15, s[28:31], s37 offen offset:3072 sc1
v_mfma_f32_32x32x16_bf16 a[80:95], v[72:75], a[228:231], a[80:95]
s_add_u32 s37, s37, 0x1000
v_mfma_f32_32x32x16_bf16 a[0:15], v[76:79], a[232:235], a[0:15]
buffer_load_dwordx4 v[176:179], v15, s[28:31], s37 offen sc1
v_mfma_f32_32x32x16_bf16 a[16:31], v[76:79], a[236:239], a[16:31]
buffer_load_dwordx4 v[180:183], v15, s[28:31], s37 offen offset:1024 sc1
v_mfma_f32_32x32x16_bf16 a[32:47], v[80:83], a[232:235], a[32:47]
buffer_load_dwordx4 v[184:187], v15, s[28:31], s37 offen offset:2048 sc1
v_mfma_f32_32x32x16_bf16 a[48:63], v[80:83], a[236:239], a[48:63]
v_mfma_f32_32x32x16_bf16 a[64:79], v[84:87], a[232:235], a[64:79]
buffer_load_dwordx4 v[188:191], v15, s[28:31], s37 offen offset:3072 sc1
v_mfma_f32_32x32x16_bf16 a[80:95], v[84:87], a[236:239], a[80:95]
s_add_u32 s37, s37, 0x1000
v_mfma_f32_32x32x16_bf16 a[0:15], v[88:91], a[240:243], a[0:15]
v_mfma_f32_32x32x16_bf16 a[16:31], v[88:91], a[244:247], a[16:31]
v_mfma_f32_32x32x16_bf16 a[32:47], v[92:95], a[240:243], a[32:47]
v_mfma_f32_32x32x16_bf16 a[48:63], v[92:95], a[244:247], a[48:63]
v_mfma_f32_32x32x16_bf16 a[64:79], v[96:99], a[240:243], a[64:79]
v_mfma_f32_32x32x16_bf16 a[80:95], v[96:99], a[244:247], a[80:95]
v_mfma_f32_32x32x16_bf16 a[0:15], v[100:103], a[248:251], a[0:15]
v_mfma_f32_32x32x16_bf16 a[16:31], v[100:103], a[252:255], a[16:31]
v_mfma_f32_32x32x16_bf16 a[32:47], v[104:107], a[248:251], a[32:47]
v_mfma_f32_32x32x16_bf16 a[48:63], v[104:107], a[252:255], a[48:63]
v_mfma_f32_32x32x16_bf16 a[64:79], v[108:111], a[248:251], a[64:79]
v_mfma_f32_32x32x16_bf16 a[80:95], v[108:111], a[252:255], a[80:95]
buffer_load_dwordx4 v[64:67], v15, s[28:31], s37 offen sc1
buffer_load_dwordx4 v[68:71], v15, s[28:31], s37 offen offset:1024 sc1
buffer_load_dwordx4 v[72:75], v15, s[28:31], s37 offen offset:2048 sc1
buffer_load_dwordx4 v[76:79], v15, s[28:31], s37 offen offset:3072 sc1
s_add_u32 s37, s37, 0x1000
buffer_load_dwordx4 v[80:83], v15, s[28:31], s37 offen sc1
buffer_load_dwordx4 v[84:87], v15, s[28:31], s37 offen offset:1024 sc1
buffer_load_dwordx4 v[88:91], v15, s[28:31], s37 offen offset:2048 sc1
buffer_load_dwordx4 v[92:95], v15, s[28:31], s37 offen offset:3072 sc1
s_add_u32 s37, s37, 0x1000
buffer_load_dwordx4 v[96:99], v15, s[28:31], s37 offen sc1
buffer_load_dwordx4 v[100:103], v15, s[28:31], s37 offen offset:1024 sc1
buffer_load_dwordx4 v[104:107], v15, s[28:31], s37 offen offset:2048 sc1
buffer_load_dwordx4 v[108:111], v15, s[28:31], s37 offen offset:3072 sc1
s_add_u32 s37, s37, 0x1000
buffer_load_dwordx4 v[112:115], v15, s[28:31], s37 offen sc1
buffer_load_dwordx4 v[116:119], v15, s[28:31], s37 offen offset:1024 sc1
buffer_load_dwordx4 v[120:123], v15, s[28:31], s37 offen offset:2048 sc1
buffer_load_dwordx4 v[124:127], v15, s[28:31], s37 offen offset:3072 sc1
s_add_u32 s37, s37, 0x1000
s_waitcnt lgkmcnt(0)
s_barrier
s_mul_i32 s82, s5, 0x6000
v_lshlrev_b32 v2, 4, v1
v_add_u32 v3, s82, v2
ds_write_b128 v3, a[0:3] offset:0
ds_write_b128 v3, a[4:7] offset:1024
ds_write_b128 v3, a[8:11] offset:2048
ds_write_b128 v3, a[12:15] offset:3072
ds_write_b128 v3, a[16:19] offset:4096
ds_write_b128 v3, a[20:23] offset:5120
ds_write_b128 v3, a[24:27] offset:6144
ds_write_b128 v3, a[28:31] offset:7168
ds_write_b128 v3, a[32:35] offset:8192
ds_write_b128 v3, a[36:39] offset:9216
ds_write_b128 v3, a[40:43] offset:10240
ds_write_b128 v3, a[44:47] offset:11264
ds_write_b128 v3, a[48:51] offset:12288
ds_write_b128 v3, a[52:55] offset:13312
ds_write_b128 v3, a[56:59] offset:14336
ds_write_b128 v3, a[60:63] offset:15360
ds_write_b128 v3, a[64:67] offset:16384
ds_write_b128 v3, a[68:71] offset:17408
ds_write_b128 v3, a[72:75] offset:18432
ds_write_b128 v3, a[76:79] offset:19456
ds_write_b128 v3, a[80:83] offset:20480
ds_write_b128 v3, a[84:87] offset:21504
ds_write_b128 v3, a[88:91] offset:22528
ds_write_b128 v3, a[92:95] offset:23552
s_waitcnt vmcnt(40)
s_waitcnt lgkmcnt(0)
s_barrier
ds_read_b64_tr_b16 a[64:65], v11 offset:0
ds_read_b64_tr_b16 a[66:67], v11 offset:1024
ds_read_b64_tr_b16 a[68:69], v12 offset:0
ds_read_b64_tr_b16 a[70:71], v12 offset:1024
ds_read_b64_tr_b16 a[72:73], v13 offset:0
ds_read_b64_tr_b16 a[74:75], v13 offset:1024
ds_read_b64_tr_b16 a[76:77], v14 offset:0
ds_read_b64_tr_b16 a[78:79], v14 offset:1024
ds_read_b64_tr_b16 a[80:81], v11 offset:4096
ds_read_b64_tr_b16 a[82:83], v11 offset:5120
ds_read_b64_tr_b16 a[84:85], v12 offset:4096
ds_read_b64_tr_b16 a[86:87], v12 offset:5120
ds_read_b64_tr_b16 a[88:89], v13 offset:4096
ds_read_b64_tr_b16 a[90:91], v13 offset:5120
ds_read_b64_tr_b16 a[92:93], v14 offset:4096
ds_read_b64_tr_b16 a[94:95], v14 offset:5120
s_waitcnt vmcnt(31) lgkmcnt(14)
v_mfma_f32_32x32x16_bf16 a[0:15], a[64:67], v[128:131], 0
ds_read_b64_tr_b16 a[96:97], v11 offset:8192
ds_read_b64_tr_b16 a[98:99], v11 offset:9216
ds_read_b64_tr_b16 a[100:101], v12 offset:8192
v_lshlrev_b32 v2, 4, v1
s_mul_i32 s83, s5, 3
s_add_u32 s83, s83, 0
s_lshl_b32 s83, s83, 11
v_add_u32 v4, s83, v2
s_waitcnt lgkmcnt(15)
v_mfma_f32_32x32x16_bf16 a[16:31], a[68:71], v[128:131], 0
ds_read_b64_tr_b16 a[102:103], v12 offset:9216
ds_read_b64_tr_b16 a[104:105], v13 offset:8192
v_add_u32 v60, 0, v4
ds_read_b128 v[192:195], v60
ds_read_b128 v[196:199], v60 offset:1024
v_add_u32 v61, 0x6000, v4
ds_read_b128 v[200:203], v61
s_waitcnt lgkmcnt(15)
v_mfma_f32_32x32x16_bf16 a[32:47], a[72:75], v[128:131], 0
ds_read_b128 v[204:207], v61 offset:1024
ds_read_b64_tr_b16 a[106:107], v13 offset:9216
ds_read_b64_tr_b16 a[108:109], v14 offset:8192
v_add_u32 v62, 0xc000, v4
ds_read_b128 v[208:211], v62
ds_read_b128 v[212:215], v62 offset:1024
v_add_u32 v63, 0x12000, v4
v_mfma_f32_32x32x16_bf16 a[48:63], a[76:79], v[128:131], 0
ds_read_b128 v[216:219], v63
ds_read_b128 v[220:223], v63 offset:1024
ds_read_b64_tr_b16 a[110:111], v14 offset:9216
v_lshlrev_b32 v52, 16, v52
s_waitcnt lgkmcnt(8)
v_add_f32 v192, v192, v200
v_add_f32 v193, v193, v201
v_add_f32 v194, v194, v202
v_add_f32 v195, v195, v203
s_waitcnt vmcnt(30)
v_mfma_f32_32x32x16_bf16 a[0:15], a[80:83], v[132:135], a[0:15]
ds_read_b64_tr_b16 a[64:65], v11 offset:12288
ds_read_b64_tr_b16 a[66:67], v11 offset:13312
ds_read_b64_tr_b16 a[68:69], v12 offset:12288
s_waitcnt lgkmcnt(10)
v_add_f32 v196, v196, v204
v_add_f32 v197, v197, v205
v_add_f32 v198, v198, v206
v_add_f32 v199, v199, v207
s_waitcnt lgkmcnt(5)
v_add_f32 v208, v208, v216
v_mfma_f32_32x32x16_bf16 a[16:31], a[84:87], v[132:135], a[16:31]
ds_read_b64_tr_b16 a[70:71], v12 offset:13312
ds_read_b64_tr_b16 a[72:73], v13 offset:12288
v_add_f32 v209, v209, v217
v_add_f32 v210, v210, v218
v_add_f32 v211, v211, v219
s_waitcnt lgkmcnt(6)
v_add_f32 v212, v212, v220
v_add_f32 v213, v213, v221
v_mfma_f32_32x32x16_bf16 a[32:47], a[88:91], v[132:135], a[32:47]
ds_read_b64_tr_b16 a[74:75], v13 offset:13312
ds_read_b64_tr_b16 a[76:77], v14 offset:12288
v_add_f32 v214, v214, v222
v_add_f32 v215, v215, v223
v_add_f32 v192, v192, v52
v_add_f32 v193, v193, v52
v_add_f32 v194, v194, v52
v_mfma_f32_32x32x16_bf16 a[48:63], a[92:95], v[132:135], a[48:63]
ds_read_b64_tr_b16 a[78:79], v14 offset:13312
v_add_f32 v195, v195, v52
v_add_f32 v196, v196, v52
v_add_f32 v197, v197, v52
v_add_f32 v198, v198, v52
v_add_f32 v199, v199, v52
v_add_f32 v192, v192, v208
v_add_f32 v193, v193, v209
s_barrier
s_waitcnt vmcnt(29)
v_mfma_f32_32x32x16_bf16 a[0:15], a[96:99], v[136:139], a[0:15]
s_add_u32 m0, s38, 0xc000
ds_read_b64_tr_b16 a[80:81], v11 offset:16384
buffer_load_dwordx4 v10, s[12:15], s33 offen lds
ds_read_b64_tr_b16 a[82:83], v11 offset:17408
v_add_f32 v194, v194, v210
v_add_f32 v195, v195, v211
v_add_f32 v196, v196, v212
v_add_f32 v197, v197, v213
v_mfma_f32_32x32x16_bf16 a[16:31], a[100:103], v[136:139], a[16:31]
buffer_load_dwordx4 v10, s[12:15], s34 offen offset:1024 lds
ds_read_b64_tr_b16 a[84:85], v12 offset:16384
ds_read_b64_tr_b16 a[86:87], v12 offset:17408
v_add_f32 v198, v198, v214
v_add_f32 v199, v199, v215
v_lshlrev_b32 v200, 16, v40
v_and_b32 v201, 0xffff0000, v40
v_mul_f32 v200, v200, v192
v_mfma_f32_32x32x16_bf16 a[32:47], a[104:107], v[136:139], a[32:47]
buffer_load_dwordx4 v10, s[12:15], s35 offen offset:2048 lds
ds_read_b64_tr_b16 a[88:89], v13 offset:16384
ds_read_b64_tr_b16 a[90:91], v13 offset:17408
v_mul_f32 v201, v201, v193
v_cvt_pk_bf16_f32 v40, v200, v201
v_lshlrev_b32 v200, 16, v41
v_and_b32 v201, 0xffff0000, v41
v_mul_f32 v200, v200, v194
s_waitcnt lgkmcnt(14)
v_mfma_f32_32x32x16_bf16 a[48:63], a[108:111], v[136:139], a[48:63]
buffer_load_dwordx4 v10, s[12:15], s36 offen offset:3072 lds
ds_read_b64_tr_b16 a[92:93], v14 offset:16384
s_add_u32 s12, s12, 0x10000
s_addc_u32 s13, s13, 0
ds_read_b64_tr_b16 a[94:95], v14 offset:17408
v_mul_f32 v201, v201, v195
v_cvt_pk_bf16_f32 v41, v200, v201
v_lshlrev_b32 v200, 16, v42
v_and_b32 v201, 0xffff0000, v42
v_mul_f32 v200, v200, v196
v_mul_f32 v201, v201, v197
v_cvt_pk_bf16_f32 v42, v200, v201
v_lshlrev_b32 v200, 16, v43
s_waitcnt vmcnt(32) lgkmcnt(14)
v_mfma_f32_32x32x16_bf16 a[0:15], a[64:67], v[140:143], a[0:15]
ds_read_b64_tr_b16 a[96:97], v11 offset:20480
ds_read_b64_tr_b16 a[98:99], v11 offset:21504
ds_read_b64_tr_b16 a[100:101], v12 offset:20480
v_and_b32 v201, 0xffff0000, v43
v_mul_f32 v200, v200, v198
v_mul_f32 v201, v201, v199
v_cvt_pk_bf16_f32 v43, v200, v201
s_add_u32 s89, s46, 0x1800000
s_waitcnt lgkmcnt(15)
v_mfma_f32_32x32x16_bf16 a[16:31], a[68:71], v[140:143], a[16:31]
buffer_store_dwordx4 v[40:43], v2, s[28:31], s89 offen sc0 sc1
s_mul_i32 s83, s5, 3
s_add_u32 s83, s83, 1
ds_read_b64_tr_b16 a[102:103], v12 offset:21504
s_lshl_b32 s83, s83, 11
ds_read_b64_tr_b16 a[104:105], v13 offset:20480
v_add_u32 v4, s83, v2
s_waitcnt lgkmcnt(15)
v_mfma_f32_32x32x16_bf16 a[32:47], a[72:75], v[140:143], a[32:47]
ds_read_b64_tr_b16 a[106:107], v13 offset:21504
ds_read_b64_tr_b16 a[108:109], v14 offset:20480
v_add_u32 v60, 0, v4
ds_read_b128 v[224:227], v60
ds_read_b128 v[228:231], v60 offset:1024
v_add_u32 v61, 0x6000, v4
ds_read_b128 v[232:235], v61
s_waitcnt lgkmcnt(15)
v_mfma_f32_32x32x16_bf16 a[48:63], a[76:79], v[140:143], a[48:63]
ds_read_b128 v[236:239], v61 offset:1024
ds_read_b64_tr_b16 a[110:111], v14 offset:21504
v_add_u32 v62, 0xc000, v4
ds_read_b128 v[240:243], v62
ds_read_b128 v[244:247], v62 offset:1024
v_add_u32 v63, 0x12000, v4
ds_read_b128 v[248:251], v63
ds_read_b128 v[252:255], v63 offset:1024
buffer_load_dwordx4 v[128:131], v15, s[28:31], s37 offen sc1
buffer_load_dwordx4 v[132:135], v15, s[28:31], s37 offen offset:1024 sc1
buffer_load_dwordx4 v[136:139], v15, s[28:31], s37 offen offset:2048 sc1
buffer_load_dwordx4 v[140:143], v15, s[28:31], s37 offen offset:3072 sc1
s_add_u32 s37, s37, 0x1000
s_waitcnt vmcnt(36)
v_mfma_f32_32x32x16_bf16 a[0:15], a[80:83], v[144:147], a[0:15]
ds_read_b64_tr_b16 a[64:65], v11 offset:24576
ds_read_b64_tr_b16 a[66:67], v11 offset:25600
ds_read_b64_tr_b16 a[68:69], v12 offset:24576
v_lshlrev_b32 v53, 16, v53
s_waitcnt lgkmcnt(9)
v_add_f32 v224, v224, v232
v_add_f32 v225, v225, v233
v_add_f32 v226, v226, v234
v_add_f32 v227, v227, v235
v_mfma_f32_32x32x16_bf16 a[16:31], a[84:87], v[144:147], a[16:31]
ds_read_b64_tr_b16 a[70:71], v12 offset:25600
ds_read_b64_tr_b16 a[72:73], v13 offset:24576
s_waitcnt lgkmcnt(10)
v_add_f32 v228, v228, v236
v_add_f32 v229, v229, v237
v_add_f32 v230, v230, v238
v_add_f32 v231, v231, v239
s_waitcnt lgkmcnt(6)
v_add_f32 v240, v240, v248
v_mfma_f32_32x32x16_bf16 a[32:47], a[88:91], v[144:147], a[32:47]
ds_read_b64_tr_b16 a[74:75], v13 offset:25600
ds_read_b64_tr_b16 a[76:77], v14 offset:24576
v_add_f32 v241, v241, v249
v_add_f32 v242, v242, v250
v_add_f32 v243, v243, v251
s_waitcnt lgkmcnt(7)
v_add_f32 v244, v244, v252
v_add_f32 v245, v245, v253
v_mfma_f32_32x32x16_bf16 a[48:63], a[92:95], v[144:147], a[48:63]
ds_read_b64_tr_b16 a[78:79], v14 offset:25600
v_add_f32 v246, v246, v254
v_add_f32 v247, v247, v255
v_add_f32 v224, v224, v53
v_add_f32 v225, v225, v53
v_add_f32 v226, v226, v53
v_add_f32 v227, v227, v53
v_add_f32 v228, v228, v53
s_waitcnt vmcnt(35)
v_mfma_f32_32x32x16_bf16 a[0:15], a[96:99], v[148:151], a[0:15]
ds_read_b64_tr_b16 a[80:81], v11 offset:28672
ds_read_b64_tr_b16 a[82:83], v11 offset:29696
ds_read_b64_tr_b16 a[84:85], v12 offset:28672
v_add_f32 v229, v229, v53
v_add_f32 v230, v230, v53
v_add_f32 v231, v231, v53
v_add_f32 v224, v224, v240
v_add_f32 v225, v225, v241
v_mfma_f32_32x32x16_bf16 a[16:31], a[100:103], v[148:151], a[16:31]
ds_read_b64_tr_b16 a[86:87], v12 offset:29696
ds_read_b64_tr_b16 a[88:89], v13 offset:28672
v_add_f32 v226, v226, v242
v_add_f32 v227, v227, v243
v_add_f32 v228, v228, v244
v_add_f32 v229, v229, v245
v_add_f32 v230, v230, v246
v_mfma_f32_32x32x16_bf16 a[32:47], a[104:107], v[148:151], a[32:47]
ds_read_b64_tr_b16 a[90:91], v13 offset:29696
ds_read_b64_tr_b16 a[92:93], v14 offset:28672
v_add_f32 v231, v231, v247
v_lshlrev_b32 v232, 16, v44
v_and_b32 v233, 0xffff0000, v44
v_mul_f32 v232, v232, v224
v_mul_f32 v233, v233, v225
v_mfma_f32_32x32x16_bf16 a[48:63], a[108:111], v[148:151], a[48:63]
ds_read_b64_tr_b16 a[94:95], v14 offset:29696
v_cvt_pk_bf16_f32 v44, v232, v233
v_lshlrev_b32 v232, 16, v45
v_and_b32 v233, 0xffff0000, v45
v_mul_f32 v232, v232, v226
v_mul_f32 v233, v233, v227
v_cvt_pk_bf16_f32 v45, v232, v233
v_lshlrev_b32 v232, 16, v46
s_barrier
s_waitcnt vmcnt(34) lgkmcnt(14)
v_mfma_f32_32x32x16_bf16 a[0:15], a[64:67], v[152:155], a[0:15]
s_add_u32 m0, s38, 0
ds_read_b64_tr_b16 a[96:97], v11 offset:32768
buffer_load_dwordx4 v10, s[12:15], s33 offen lds
ds_read_b64_tr_b16 a[98:99], v11 offset:33792
v_and_b32 v233, 0xffff0000, v46
v_mul_f32 v232, v232, v228
v_mul_f32 v233, v233, v229
v_cvt_pk_bf16_f32 v46, v232, v233
s_waitcnt lgkmcnt(14)
v_mfma_f32_32x32x16_bf16 a[16:31], a[68:71], v[152:155], a[16:31]
buffer_load_dwordx4 v10, s[12:15], s34 offen offset:1024 lds
ds_read_b64_tr_b16 a[100:101], v12 offset:32768
ds_read_b64_tr_b16 a[102:103], v12 offset:33792
v_lshlrev_b32 v232, 16, v47
v_and_b32 v233, 0xffff0000, v47
v_mul_f32 v232, v232, v230
v_mul_f32 v233, v233, v231
v_cvt_pk_bf16_f32 v47, v232, v233
s_waitcnt lgkmcnt(14)
v_mfma_f32_32x32x16_bf16 a[32:47], a[72:75], v[152:155], a[32:47]
s_add_u32 s89, s47, 0x1800000
buffer_store_dwordx4 v[44:47], v2, s[28:31], s89 offen sc0 sc1
buffer_load_dwordx4 v10, s[12:15], s35 offen offset:2048 lds
s_mul_i32 s83, s5, 3
ds_read_b64_tr_b16 a[104:105], v13 offset:32768
s_add_u32 s83, s83, 2
ds_read_b64_tr_b16 a[106:107], v13 offset:33792
s_waitcnt lgkmcnt(14)
v_mfma_f32_32x32x16_bf16 a[48:63], a[76:79], v[152:155], a[48:63]
s_lshl_b32 s83, s83, 11
buffer_load_dwordx4 v10, s[12:15], s36 offen offset:3072 lds
ds_read_b64_tr_b16 a[108:109], v14 offset:32768
s_add_u32 s12, s12, 0x10000
s_addc_u32 s13, s13, 0
ds_read_b64_tr_b16 a[110:111], v14 offset:33792
v_add_u32 v4, s83, v2
v_add_u32 v60, 0, v4
ds_read_b128 v[192:195], v60
ds_read_b128 v[196:199], v60 offset:1024
v_add_u32 v61, 0x6000, v4
ds_read_b128 v[200:203], v61
ds_read_b128 v[204:207], v61 offset:1024
v_add_u32 v62, 0xc000, v4
s_waitcnt vmcnt(38) lgkmcnt(15)
v_mfma_f32_32x32x16_bf16 a[0:15], a[80:83], v[156:159], a[0:15]
ds_read_b128 v[208:211], v62
ds_read_b128 v[212:215], v62 offset:1024
ds_read_b64_tr_b16 a[64:65], v11 offset:36864
ds_read_b64_tr_b16 a[66:67], v11 offset:37888
ds_read_b64_tr_b16 a[68:69], v12 offset:36864
v_add_u32 v63, 0x12000, v4
ds_read_b128 v[216:219], v63
ds_read_b128 v[220:223], v63 offset:1024
v_mfma_f32_32x32x16_bf16 a[16:31], a[84:87], v[156:159], a[16:31]
ds_read_b64_tr_b16 a[70:71], v12 offset:37888
ds_read_b64_tr_b16 a[72:73], v13 offset:36864
v_lshlrev_b32 v54, 16, v54
s_waitcnt lgkmcnt(10)
v_add_f32 v192, v192, v200
v_add_f32 v193, v193, v201
v_add_f32 v194, v194, v202
v_add_f32 v195, v195, v203
v_mfma_f32_32x32x16_bf16 a[32:47], a[88:91], v[156:159], a[32:47]
ds_read_b64_tr_b16 a[74:75], v13 offset:37888
ds_read_b64_tr_b16 a[76:77], v14 offset:36864
s_waitcnt lgkmcnt(11)
v_add_f32 v196, v196, v204
v_add_f32 v197, v197, v205
v_add_f32 v198, v198, v206
v_add_f32 v199, v199, v207
s_waitcnt lgkmcnt(5)
v_add_f32 v208, v208, v216
v_mfma_f32_32x32x16_bf16 a[48:63], a[92:95], v[156:159], a[48:63]
ds_read_b64_tr_b16 a[78:79], v14 offset:37888
v_add_f32 v209, v209, v217
v_add_f32 v210, v210, v218
v_add_f32 v211, v211, v219
s_waitcnt lgkmcnt(5)
v_add_f32 v212, v212, v220
v_add_f32 v213, v213, v221
v_add_f32 v214, v214, v222
v_add_f32 v215, v215, v223
buffer_load_dwordx4 v[144:147], v15, s[28:31], s37 offen sc1
buffer_load_dwordx4 v[148:151], v15, s[28:31], s37 offen offset:1024 sc1
buffer_load_dwordx4 v[152:155], v15, s[28:31], s37 offen offset:2048 sc1
buffer_load_dwordx4 v[156:159], v15, s[28:31], s37 offen offset:3072 sc1
s_add_u32 s37, s37, 0x1000
s_waitcnt vmcnt(41)
v_mfma_f32_32x32x16_bf16 a[0:15], a[96:99], v[160:163], a[0:15]
ds_read_b64_tr_b16 a[80:81], v11 offset:40960
ds_read_b64_tr_b16 a[82:83], v11 offset:41984
ds_read_b64_tr_b16 a[84:85], v12 offset:40960
v_add_f32 v192, v192, v54
v_add_f32 v193, v193, v54
v_add_f32 v194, v194, v54
v_add_f32 v195, v195, v54
v_add_f32 v196, v196, v54
v_mfma_f32_32x32x16_bf16 a[16:31], a[100:103], v[160:163], a[16:31]
ds_read_b64_tr_b16 a[86:87], v12 offset:41984
ds_read_b64_tr_b16 a[88:89], v13 offset:40960
v_add_f32 v197, v197, v54
v_add_f32 v198, v198, v54
v_add_f32 v199, v199, v54
v_add_f32 v192, v192, v208
v_add_f32 v193, v193, v209
v_mfma_f32_32x32x16_bf16 a[32:47], a[104:107], v[160:163], a[32:47]
ds_read_b64_tr_b16 a[90:91], v13 offset:41984
ds_read_b64_tr_b16 a[92:93], v14 offset:40960
v_add_f32 v194, v194, v210
v_add_f32 v195, v195, v211
v_add_f32 v196, v196, v212
v_add_f32 v197, v197, v213
v_add_f32 v198, v198, v214
v_mfma_f32_32x32x16_bf16 a[48:63], a[108:111], v[160:163], a[48:63]
ds_read_b64_tr_b16 a[94:95], v14 offset:41984
v_add_f32 v199, v199, v215
v_lshlrev_b32 v200, 16, v48
v_and_b32 v201, 0xffff0000, v48
v_mul_f32 v200, v200, v192
v_mul_f32 v201, v201, v193
v_cvt_pk_bf16_f32 v48, v200, v201
v_lshlrev_b32 v200, 16, v49
s_waitcnt vmcnt(40)
v_mfma_f32_32x32x16_bf16 a[0:15], a[64:67], v[164:167], a[0:15]
ds_read_b64_tr_b16 a[96:97], v11 offset:45056
ds_read_b64_tr_b16 a[98:99], v11 offset:46080
ds_read_b64_tr_b16 a[100:101], v12 offset:45056
v_and_b32 v201, 0xffff0000, v49
v_mul_f32 v200, v200, v194
v_mul_f32 v201, v201, v195
v_cvt_pk_bf16_f32 v49, v200, v201
v_lshlrev_b32 v200, 16, v50
s_waitcnt lgkmcnt(15)
v_mfma_f32_32x32x16_bf16 a[16:31], a[68:71], v[164:167], a[16:31]
ds_read_b64_tr_b16 a[102:103], v12 offset:46080
ds_read_b64_tr_b16 a[104:105], v13 offset:45056
v_and_b32 v201, 0xffff0000, v50
v_mul_f32 v200, v200, v196
v_mul_f32 v201, v201, v197
v_cvt_pk_bf16_f32 v50, v200, v201
v_lshlrev_b32 v200, 16, v51
s_waitcnt lgkmcnt(15)
v_mfma_f32_32x32x16_bf16 a[32:47], a[72:75], v[164:167], a[32:47]
ds_read_b64_tr_b16 a[106:107], v13 offset:46080
ds_read_b64_tr_b16 a[108:109], v14 offset:45056
v_and_b32 v201, 0xffff0000, v51
v_mul_f32 v200, v200, v198
v_mul_f32 v201, v201, v199
v_cvt_pk_bf16_f32 v51, v200, v201
s_add_u32 s89, s48, 0x1800000
s_waitcnt lgkmcnt(15)
v_mfma_f32_32x32x16_bf16 a[48:63], a[76:79], v[164:167], a[48:63]
buffer_store_dwordx4 v[48:51], v2, s[28:31], s89 offen sc0 sc1
s_lshl_b32 s82, s40, 3
s_add_u32 s82, s82, s41
ds_read_b64_tr_b16 a[110:111], v14 offset:46080
s_lshl_b32 s82, s82, 2
s_add_u32 s82, s82, s5
s_lshl_b32 s82, s82, 2
s_add_u32 s49, s82, 0x3006000
s_waitcnt vmcnt(15)
s_barrier
s_waitcnt lgkmcnt(14)
v_mfma_f32_32x32x16_bf16 a[0:15], a[80:83], v[168:171], a[0:15]
s_add_u32 m0, s38, 0x4000
ds_read_b64_tr_b16 a[64:65], v11 offset:49152
s_and_b32 s40, s52, 1
buffer_load_dwordx4 v10, s[12:15], s33 offen lds
ds_read_b64_tr_b16 a[66:67], v11 offset:50176
s_lshl_b32 s41, s40, 1
s_waitcnt lgkmcnt(14)
v_mfma_f32_32x32x16_bf16 a[16:31], a[84:87], v[168:171], a[16:31]
buffer_load_dwordx4 v10, s[12:15], s34 offen offset:1024 lds
ds_read_b64_tr_b16 a[68:69], v12 offset:49152
s_and_b32 s6, s5, 1
ds_read_b64_tr_b16 a[70:71], v12 offset:50176
s_add_u32 s41, s41, s6
ds_read_b64_tr_b16 a[72:73], v13 offset:49152
s_waitcnt lgkmcnt(15)
v_mfma_f32_32x32x16_bf16 a[32:47], a[88:91], v[168:171], a[32:47]
buffer_load_dwordx4 v10, s[12:15], s35 offen offset:2048 lds
s_lshr_b32 s42, s52, 1
ds_read_b64_tr_b16 a[74:75], v13 offset:50176
s_lshl_b32 s42, s42, 1
buffer_load_dwordx4 v10, s[12:15], s36 offen offset:3072 lds
s_waitcnt lgkmcnt(14)
v_mfma_f32_32x32x16_bf16 a[48:63], a[92:95], v[168:171], a[48:63]
s_add_u32 s12, s12, 0x10000
s_addc_u32 s13, s13, 0
ds_read_b64_tr_b16 a[76:77], v14 offset:49152
s_lshr_b32 s6, s5, 1
ds_read_b64_tr_b16 a[78:79], v14 offset:50176
s_add_u32 s42, s42, s6
s_waitcnt lgkmcnt(14)
v_mfma_f32_32x32x16_bf16 a[0:15], a[96:99], v[172:175], a[0:15]
s_lshl_b32 s43, s50, 2
ds_read_b64_tr_b16 a[80:81], v11 offset:53248
s_add_u32 s43, s43, s42
ds_read_b64_tr_b16 a[82:83], v11 offset:54272
s_lshl_b32 s82, s51, 8
s_waitcnt lgkmcnt(14)
v_mfma_f32_32x32x16_bf16 a[16:31], a[100:103], v[172:175], a[16:31]
ds_read_b64_tr_b16 a[84:85], v12 offset:53248
s_lshl_b32 s83, s40, 7
ds_read_b64_tr_b16 a[86:87], v12 offset:54272
s_add_u32 s82, s82, s83
s_waitcnt lgkmcnt(14)
v_mfma_f32_32x32x16_bf16 a[32:47], a[104:107], v[172:175], a[32:47]
ds_read_b64_tr_b16 a[88:89], v13 offset:53248
s_add_u32 s24, s74, s82
s_addc_u32 s25, s75, 0
ds_read_b64_tr_b16 a[90:91], v13 offset:54272
s_waitcnt lgkmcnt(14)
v_mfma_f32_32x32x16_bf16 a[48:63], a[108:111], v[172:175], a[48:63]
ds_read_b64_tr_b16 a[92:93], v14 offset:53248
s_and_b32 s25, s25, 0xffff
ds_read_b64_tr_b16 a[94:95], v14 offset:54272
s_mov_b32 s26, 0
buffer_load_dwordx4 v[160:163], v15, s[28:31], s37 offen sc1
buffer_load_dwordx4 v[164:167], v15, s[28:31], s37 offen offset:1024 sc1
buffer_load_dwordx4 v[168:171], v15, s[28:31], s37 offen offset:2048 sc1
buffer_load_dwordx4 v[172:175], v15, s[28:31], s37 offen offset:3072 sc1
s_add_u32 s37, s37, 0x1000
s_waitcnt lgkmcnt(14)
v_mfma_f32_32x32x16_bf16 a[0:15], a[64:67], v[176:179], a[0:15]
ds_read_b64_tr_b16 a[96:97], v11 offset:57344
s_mov_b32 s27, 0x20000
ds_read_b64_tr_b16 a[98:99], v11 offset:58368
s_sub_u32 s26, 0xac000, s82
s_waitcnt lgkmcnt(14)
v_mfma_f32_32x32x16_bf16 a[16:31], a[68:71], v[176:179], a[16:31]
ds_read_b64_tr_b16 a[100:101], v12 offset:57344
ds_read_b64_tr_b16 a[102:103], v12 offset:58368
v_lshrrev_b32 v2, 3, v1
v_and_b32 v3, 7, v1
s_waitcnt lgkmcnt(14)
v_mfma_f32_32x32x16_bf16 a[32:47], a[72:75], v[176:179], a[32:47]
ds_read_b64_tr_b16 a[104:105], v13 offset:57344
ds_read_b64_tr_b16 a[106:107], v13 offset:58368
v_bfe_u32 v4, v1, 4, 1
v_lshlrev_b32 v4, 2, v4
s_waitcnt lgkmcnt(14)
v_mfma_f32_32x32x16_bf16 a[48:63], a[76:79], v[176:179], a[48:63]
ds_read_b64_tr_b16 a[108:109], v14 offset:57344
ds_read_b64_tr_b16 a[110:111], v14 offset:58368
v_xor_b32 v3, v3, v4
v_lshlrev_b32 v2, 10, v2
s_waitcnt lgkmcnt(14)
v_mfma_f32_32x32x16_bf16 a[0:15], a[80:83], v[180:183], a[0:15]
ds_read_b64_tr_b16 a[64:65], v11 offset:61440
ds_read_b64_tr_b16 a[66:67], v11 offset:62464
v_lshl_add_u32 v18, v3, 4, v2
s_mul_i32 s82, s43, 0xb000
s_waitcnt lgkmcnt(14)
v_mfma_f32_32x32x16_bf16 a[16:31], a[84:87], v[180:183], a[16:31]
ds_read_b64_tr_b16 a[68:69], v12 offset:61440
s_and_b32 s83, s5, 1
ds_read_b64_tr_b16 a[70:71], v12 offset:62464
s_mul_i32 s83, s83, 0x5800
s_waitcnt lgkmcnt(14)
v_mfma_f32_32x32x16_bf16 a[32:47], a[88:91], v[180:183], a[32:47]
ds_read_b64_tr_b16 a[72:73], v13 offset:61440
s_add_u32 s82, s82, s83
ds_read_b64_tr_b16 a[74:75], v13 offset:62464
s_add_u32 s45, s82, 0x1800000
s_waitcnt lgkmcnt(14)
v_mfma_f32_32x32x16_bf16 a[48:63], a[92:95], v[180:183], a[48:63]
ds_read_b64_tr_b16 a[76:77], v14 offset:61440
s_lshr_b32 s82, s43, 1
ds_read_b64_tr_b16 a[78:79], v14 offset:62464
s_lshl_b32 s82, s82, 7
s_waitcnt vmcnt(13)
s_barrier
s_waitcnt lgkmcnt(14)
v_mfma_f32_32x32x16_bf16 a[0:15], a[96:99], v[184:187], a[0:15]
s_add_u32 m0, s38, 0x8000
ds_read_b64_tr_b16 a[80:81], v11 offset:0
s_add_u32 s46, s82, 0x3006000
buffer_load_dwordx4 v10, s[12:15], s33 offen lds
ds_read_b64_tr_b16 a[82:83], v11 offset:1024
v_and_b32 v23, 31, v1
s_waitcnt lgkmcnt(14)
v_mfma_f32_32x32x16_bf16 a[16:31], a[100:103], v[184:187], a[16:31]
buffer_load_dwordx4 v10, s[12:15], s34 offen offset:1024 lds
ds_read_b64_tr_b16 a[84:85], v12 offset:0
ds_read_b64_tr_b16 a[86:87], v12 offset:1024
ds_read_b64_tr_b16 a[88:89], v13 offset:0
v_lshlrev_b32 v23, 2, v23
s_mov_b32 s8, s56
s_waitcnt lgkmcnt(15)
v_mfma_f32_32x32x16_bf16 a[32:47], a[104:107], v[184:187], a[32:47]
buffer_load_dwordx4 v10, s[12:15], s35 offen offset:2048 lds
s_and_b32 s9, s57, 0xffff
ds_read_b64_tr_b16 a[90:91], v13 offset:1024
s_mov_b32 s10, 0x200000
buffer_load_dwordx4 v10, s[12:15], s36 offen offset:3072 lds
s_waitcnt lgkmcnt(14)
v_mfma_f32_32x32x16_bf16 a[48:63], a[108:111], v[184:187], a[48:63]
s_add_u32 s12, s12, 0x10000
s_addc_u32 s13, s13, 0
ds_read_b64_tr_b16 a[92:93], v14 offset:0
s_mov_b32 s11, 0x20000
ds_read_b64_tr_b16 a[94:95], v14 offset:1024
s_mov_b32 s20, s76
s_waitcnt lgkmcnt(14)
v_mfma_f32_32x32x16_bf16 a[0:15], a[64:67], v[188:191], a[0:15]
ds_read_b64_tr_b16 a[96:97], v11 offset:4096
s_and_b32 s21, s77, 0xffff
ds_read_b64_tr_b16 a[98:99], v11 offset:5120
s_mov_b32 s22, 0x200000
s_waitcnt lgkmcnt(14)
v_mfma_f32_32x32x16_bf16 a[16:31], a[68:71], v[188:191], a[16:31]
ds_read_b64_tr_b16 a[100:101], v12 offset:4096
s_mov_b32 s23, 0x20000
ds_read_b64_tr_b16 a[102:103], v12 offset:5120
s_lshl_b32 s82, s43, 15
s_waitcnt lgkmcnt(14)
v_mfma_f32_32x32x16_bf16 a[32:47], a[72:75], v[188:191], a[32:47]
ds_read_b64_tr_b16 a[104:105], v13 offset:4096
s_lshl_b32 s83, s51, 8
ds_read_b64_tr_b16 a[106:107], v13 offset:5120
s_add_u32 s82, s82, s83
s_waitcnt lgkmcnt(14)
v_mfma_f32_32x32x16_bf16 a[48:63], a[76:79], v[188:191], a[48:63]
ds_read_b64_tr_b16 a[108:109], v14 offset:4096
s_lshl_b32 s83, s41, 6
ds_read_b64_tr_b16 a[110:111], v14 offset:5120
s_add_u32 s44, s82, s83
buffer_load_dwordx4 v[176:179], v15, s[28:31], s37 offen sc1
buffer_load_dwordx4 v[180:183], v15, s[28:31], s37 offen offset:1024 sc1
buffer_load_dwordx4 v[184:187], v15, s[28:31], s37 offen offset:2048 sc1
buffer_load_dwordx4 v[188:191], v15, s[28:31], s37 offen offset:3072 sc1
s_add_u32 s37, s37, 0x1000
s_waitcnt vmcnt(16)
v_mov_b32 v26, s32
v_mov_b32 v27, 0
s_mov_b64 exec, 1
buffer_store_dword v26, v27, s[28:31], s49 offen sc0 sc1
s_mov_b64 exec, -1
s_waitcnt lgkmcnt(14)
v_mfma_f32_32x32x16_bf16 a[0:15], a[80:83], v[64:67], a[0:15]
ds_read_b64_tr_b16 a[64:65], v11 offset:8192
ds_read_b64_tr_b16 a[66:67], v11 offset:9216
v_and_b32 v2, 31, v1
v_lshlrev_b32 v2, 10, v2
s_waitcnt lgkmcnt(14)
v_mfma_f32_32x32x16_bf16 a[16:31], a[84:87], v[64:67], a[16:31]
ds_read_b64_tr_b16 a[68:69], v12 offset:8192
ds_read_b64_tr_b16 a[70:71], v12 offset:9216
v_lshrrev_b32 v3, 5, v1
v_lshl_add_u32 v19, v3, 4, v2
s_waitcnt lgkmcnt(14)
v_mfma_f32_32x32x16_bf16 a[32:47], a[88:91], v[64:67], a[32:47]
ds_read_b64_tr_b16 a[72:73], v13 offset:8192
ds_read_b64_tr_b16 a[74:75], v13 offset:9216
v_lshrrev_b32 v2, 5, v1
v_bfe_u32 v3, v1, 4, 1
s_waitcnt lgkmcnt(14)
v_mfma_f32_32x32x16_bf16 a[48:63], a[92:95], v[64:67], a[48:63]
ds_read_b64_tr_b16 a[76:77], v14 offset:8192
ds_read_b64_tr_b16 a[78:79], v14 offset:9216
v_bfe_u32 v4, v1, 2, 2
v_and_b32 v5, 3, v1
s_waitcnt lgkmcnt(14)
v_mfma_f32_32x32x16_bf16 a[0:15], a[96:99], v[68:71], a[0:15]
ds_read_b64_tr_b16 a[80:81], v11 offset:12288
ds_read_b64_tr_b16 a[82:83], v11 offset:13312
v_and_b32 v6, 1, v5
v_lshl_add_u32 v6, v3, 1, v6
s_waitcnt lgkmcnt(14)
v_mfma_f32_32x32x16_bf16 a[16:31], a[100:103], v[68:71], a[16:31]
ds_read_b64_tr_b16 a[84:85], v12 offset:12288
ds_read_b64_tr_b16 a[86:87], v12 offset:13312
v_lshrrev_b32 v7, 1, v4
v_lshlrev_b32 v7, 2, v7
s_waitcnt lgkmcnt(14)
v_mfma_f32_32x32x16_bf16 a[32:47], a[104:107], v[68:71], a[32:47]
ds_read_b64_tr_b16 a[88:89], v13 offset:12288
ds_read_b64_tr_b16 a[90:91], v13 offset:13312
v_lshl_add_u32 v8, v2, 3, v4
v_lshlrev_b32 v8, 7, v8
s_waitcnt lgkmcnt(14)
v_mfma_f32_32x32x16_bf16 a[48:63], a[108:111], v[68:71], a[48:63]
ds_read_b64_tr_b16 a[92:93], v14 offset:12288
ds_read_b64_tr_b16 a[94:95], v14 offset:13312
v_lshrrev_b32 v9, 1, v5
v_lshl_add_u32 v8, v9, 3, v8
s_waitcnt vmcnt(13)
s_barrier
s_waitcnt lgkmcnt(14)
v_mfma_f32_32x32x16_bf16 a[0:15], a[64:67], v[72:75], a[0:15]
s_add_u32 m0, s38, 0xc000
ds_read_b64_tr_b16 a[96:97], v11 offset:16384
s_and_b32 s82, s5, 1
buffer_load_dwordx4 v10, s[12:15], s33 offen lds
ds_read_b64_tr_b16 a[98:99], v11 offset:17408
s_mul_i32 s82, s82, 0xb000
s_waitcnt lgkmcnt(14)
v_mfma_f32_32x32x16_bf16 a[16:31], a[68:71], v[72:75], a[16:31]
buffer_load_dwordx4 v10, s[12:15], s34 offen offset:1024 lds
ds_read_b64_tr_b16 a[100:101], v12 offset:16384
s_add_u32 s82, s82, 0
ds_read_b64_tr_b16 a[102:103], v12 offset:17408
ds_read_b64_tr_b16 a[104:105], v13 offset:16384
v_add_u32 v8, s82, v8
s_waitcnt lgkmcnt(15)
v_mfma_f32_32x32x16_bf16 a[32:47], a[72:75], v[72:75], a[32:47]
buffer_load_dwordx4 v10, s[12:15], s35 offen offset:2048 lds
ds_read_b64_tr_b16 a[106:107], v13 offset:17408
buffer_load_dwordx4 v10, s[12:15], s36 offen offset:3072 lds
v_add_u32 v9, 0, v6
v_xor_b32 v9, v9, v7
s_waitcnt lgkmcnt(14)
v_mfma_f32_32x32x16_bf16 a[48:63], a[76:79], v[72:75], a[48:63]
s_add_u32 s12, s12, 0x10000
s_addc_u32 s13, s13, 0
ds_read_b64_tr_b16 a[108:109], v14 offset:16384
ds_read_b64_tr_b16 a[110:111], v14 offset:17408
v_lshl_add_u32 v20, v9, 4, v8
v_add_u32 v9, 4, v6
s_waitcnt lgkmcnt(14)
v_mfma_f32_32x32x16_bf16 a[0:15], a[80:83], v[76:79], a[0:15]
ds_read_b64_tr_b16 a[64:65], v11 offset:20480
ds_read_b64_tr_b16 a[66:67], v11 offset:21504
v_xor_b32 v9, v9, v7
v_lshl_add_u32 v21, v9, 4, v8
s_waitcnt lgkmcnt(14)
v_mfma_f32_32x32x16_bf16 a[16:31], a[84:87], v[76:79], a[16:31]
ds_read_b64_tr_b16 a[68:69], v12 offset:20480
s_lshl_b32 s82, s50, 2
ds_read_b64_tr_b16 a[70:71], v12 offset:21504
s_add_u32 s82, s82, s51
s_waitcnt lgkmcnt(14)
v_mfma_f32_32x32x16_bf16 a[32:47], a[88:91], v[76:79], a[32:47]
ds_read_b64_tr_b16 a[72:73], v13 offset:20480
s_lshl_b32 s82, s82, 2
ds_read_b64_tr_b16 a[74:75], v13 offset:21504
s_add_u32 s82, s82, s42
s_waitcnt lgkmcnt(14)
v_mfma_f32_32x32x16_bf16 a[48:63], a[92:95], v[76:79], a[48:63]
ds_read_b64_tr_b16 a[76:77], v14 offset:20480
s_lshl_b32 s82, s82, 4
ds_read_b64_tr_b16 a[78:79], v14 offset:21504
s_add_u32 s47, s82, 0x3008000
buffer_load_dwordx4 v[64:67], v15, s[28:31], s37 offen sc1
buffer_load_dwordx4 v[68:71], v15, s[28:31], s37 offen offset:1024 sc1
buffer_load_dwordx4 v[72:75], v15, s[28:31], s37 offen offset:2048 sc1
buffer_load_dwordx4 v[76:79], v15, s[28:31], s37 offen offset:3072 sc1
s_add_u32 s37, s37, 0x1000
s_waitcnt lgkmcnt(14)
v_mfma_f32_32x32x16_bf16 a[0:15], a[96:99], v[80:83], a[0:15]
ds_read_b64_tr_b16 a[80:81], v11 offset:24576
ds_read_b64_tr_b16 a[82:83], v11 offset:25600
v_and_b32 v25, 3, v1
s_waitcnt lgkmcnt(14)
v_mfma_f32_32x32x16_bf16 a[16:31], a[100:103], v[80:83], a[16:31]
ds_read_b64_tr_b16 a[84:85], v12 offset:24576
ds_read_b64_tr_b16 a[86:87], v12 offset:25600
v_lshlrev_b32 v25, 2, v25
s_waitcnt lgkmcnt(14)
v_mfma_f32_32x32x16_bf16 a[32:47], a[104:107], v[80:83], a[32:47]
ds_read_b64_tr_b16 a[88:89], v13 offset:24576
ds_read_b64_tr_b16 a[90:91], v13 offset:25600
s_waitcnt lgkmcnt(14)
v_mfma_f32_32x32x16_bf16 a[48:63], a[108:111], v[80:83], a[48:63]
ds_read_b64_tr_b16 a[92:93], v14 offset:24576
ds_read_b64_tr_b16 a[94:95], v14 offset:25600
s_waitcnt lgkmcnt(14)
v_mfma_f32_32x32x16_bf16 a[0:15], a[64:67], v[84:87], a[0:15]
ds_read_b64_tr_b16 a[96:97], v11 offset:28672
ds_read_b64_tr_b16 a[98:99], v11 offset:29696
s_waitcnt lgkmcnt(14)
v_mfma_f32_32x32x16_bf16 a[16:31], a[68:71], v[84:87], a[16:31]
ds_read_b64_tr_b16 a[100:101], v12 offset:28672
ds_read_b64_tr_b16 a[102:103], v12 offset:29696
s_waitcnt lgkmcnt(14)
v_mfma_f32_32x32x16_bf16 a[32:47], a[72:75], v[84:87], a[32:47]
ds_read_b64_tr_b16 a[104:105], v13 offset:28672
ds_read_b64_tr_b16 a[106:107], v13 offset:29696
s_waitcnt lgkmcnt(14)
v_mfma_f32_32x32x16_bf16 a[48:63], a[76:79], v[84:87], a[48:63]
ds_read_b64_tr_b16 a[108:109], v14 offset:28672
ds_read_b64_tr_b16 a[110:111], v14 offset:29696
s_waitcnt vmcnt(13)
s_barrier
s_waitcnt lgkmcnt(14)
v_mfma_f32_32x32x16_bf16 a[0:15], a[80:83], v[88:91], a[0:15]
s_add_u32 m0, s38, 0
ds_read_b64_tr_b16 a[64:65], v11 offset:32768
buffer_load_dwordx4 v10, s[12:15], s33 offen lds
ds_read_b64_tr_b16 a[66:67], v11 offset:33792
s_waitcnt lgkmcnt(14)
v_mfma_f32_32x32x16_bf16 a[16:31], a[84:87], v[88:91], a[16:31]
buffer_load_dwordx4 v10, s[12:15], s34 offen offset:1024 lds
ds_read_b64_tr_b16 a[68:69], v12 offset:32768
ds_read_b64_tr_b16 a[70:71], v12 offset:33792
ds_read_b64_tr_b16 a[72:73], v13 offset:32768
s_waitcnt lgkmcnt(15)
v_mfma_f32_32x32x16_bf16 a[32:47], a[88:91], v[88:91], a[32:47]
buffer_load_dwordx4 v10, s[12:15], s35 offen offset:2048 lds
ds_read_b64_tr_b16 a[74:75], v13 offset:33792
buffer_load_dwordx4 v10, s[12:15], s36 offen offset:3072 lds
s_waitcnt lgkmcnt(14)
v_mfma_f32_32x32x16_bf16 a[48:63], a[92:95], v[88:91], a[48:63]
s_add_u32 s12, s12, 0x10000
s_addc_u32 s13, s13, 0
ds_read_b64_tr_b16 a[76:77], v14 offset:32768
ds_read_b64_tr_b16 a[78:79], v14 offset:33792
s_waitcnt lgkmcnt(14)
v_mfma_f32_32x32x16_bf16 a[0:15], a[96:99], v[92:95], a[0:15]
ds_read_b64_tr_b16 a[80:81], v11 offset:36864
ds_read_b64_tr_b16 a[82:83], v11 offset:37888
s_waitcnt lgkmcnt(14)
v_mfma_f32_32x32x16_bf16 a[16:31], a[100:103], v[92:95], a[16:31]
ds_read_b64_tr_b16 a[84:85], v12 offset:36864
ds_read_b64_tr_b16 a[86:87], v12 offset:37888
s_waitcnt lgkmcnt(14)
v_mfma_f32_32x32x16_bf16 a[32:47], a[104:107], v[92:95], a[32:47]
ds_read_b64_tr_b16 a[88:89], v13 offset:36864
ds_read_b64_tr_b16 a[90:91], v13 offset:37888
s_waitcnt lgkmcnt(14)
v_mfma_f32_32x32x16_bf16 a[48:63], a[108:111], v[92:95], a[48:63]
ds_read_b64_tr_b16 a[92:93], v14 offset:36864
ds_read_b64_tr_b16 a[94:95], v14 offset:37888
buffer_load_dwordx4 v[80:83], v15, s[28:31], s37 offen sc1
buffer_load_dwordx4 v[84:87], v15, s[28:31], s37 offen offset:1024 sc1
buffer_load_dwordx4 v[88:91], v15, s[28:31], s37 offen offset:2048 sc1
buffer_load_dwordx4 v[92:95], v15, s[28:31], s37 offen offset:3072 sc1
s_add_u32 s37, s37, 0x1000
s_waitcnt lgkmcnt(14)
v_mfma_f32_32x32x16_bf16 a[0:15], a[64:67], v[96:99], a[0:15]
ds_read_b64_tr_b16 a[96:97], v11 offset:40960
s_lshl_b32 s53, s5, 13
s_lshl_b32 s54, s5, 10
ds_read_b64_tr_b16 a[98:99], v11 offset:41984
s_waitcnt lgkmcnt(14)
v_mfma_f32_32x32x16_bf16 a[16:31], a[68:71], v[96:99], a[16:31]
ds_read_b64_tr_b16 a[100:101], v12 offset:40960
s_add_u32 m0, s54, 0
ds_read_b64_tr_b16 a[102:103], v12 offset:41984
ds_read_b64_tr_b16 a[104:105], v13 offset:40960
s_waitcnt lgkmcnt(15)
v_mfma_f32_32x32x16_bf16 a[32:47], a[72:75], v[96:99], a[32:47]
ds_read_b64_tr_b16 a[106:107], v13 offset:41984
buffer_load_dwordx4 v18, s[24:27], s53 offen lds
s_waitcnt lgkmcnt(14)
v_mfma_f32_32x32x16_bf16 a[48:63], a[76:79], v[96:99], a[48:63]
ds_read_b64_tr_b16 a[108:109], v14 offset:40960
s_add_u32 s53, s53, 0x8000
ds_read_b64_tr_b16 a[110:111], v14 offset:41984
s_waitcnt lgkmcnt(14)
v_mfma_f32_32x32x16_bf16 a[0:15], a[80:83], v[100:103], a[0:15]
ds_read_b64_tr_b16 a[64:65], v11 offset:45056
s_add_u32 m0, s54, 0x1000
ds_read_b64_tr_b16 a[66:67], v11 offset:46080
s_waitcnt lgkmcnt(14)
v_mfma_f32_32x32x16_bf16 a[16:31], a[84:87], v[100:103], a[16:31]
ds_read_b64_tr_b16 a[68:69], v12 offset:45056
buffer_load_dwordx4 v18, s[24:27], s53 offen lds
s_waitcnt lgkmcnt(13)
v_mfma_f32_32x32x16_bf16 a[32:47], a[88:91], v[100:103], a[32:47]
ds_read_b64_tr_b16 a[70:71], v12 offset:46080
ds_read_b64_tr_b16 a[72:73], v13 offset:45056
s_add_u32 s53, s53, 0x8000
s_waitcnt lgkmcnt(13)
v_mfma_f32_32x32x16_bf16 a[48:63], a[92:95], v[100:103], a[48:63]
ds_read_b64_tr_b16 a[74:75], v13 offset:46080
ds_read_b64_tr_b16 a[76:77], v14 offset:45056
ds_read_b64_tr_b16 a[78:79], v14 offset:46080
s_waitcnt vmcnt(14)
s_barrier
s_waitcnt lgkmcnt(14)
v_mfma_f32_32x32x16_bf16 a[0:15], a[96:99], v[104:107], a[0:15]
s_add_u32 m0, s38, 0x4000
ds_read_b64_tr_b16 a[80:81], v11 offset:49152
buffer_load_dwordx4 v10, s[12:15], s33 offen lds
ds_read_b64_tr_b16 a[82:83], v11 offset:50176
s_waitcnt lgkmcnt(14)
v_mfma_f32_32x32x16_bf16 a[16:31], a[100:103], v[104:107], a[16:31]
buffer_load_dwordx4 v10, s[12:15], s34 offen offset:1024 lds
ds_read_b64_tr_b16 a[84:85], v12 offset:49152
ds_read_b64_tr_b16 a[86:87], v12 offset:50176
ds_read_b64_tr_b16 a[88:89], v13 offset:49152
s_waitcnt lgkmcnt(15)
v_mfma_f32_32x32x16_bf16 a[32:47], a[104:107], v[104:107], a[32:47]
buffer_load_dwordx4 v10, s[12:15], s35 offen offset:2048 lds
ds_read_b64_tr_b16 a[90:91], v13 offset:50176
buffer_load_dwordx4 v10, s[12:15], s36 offen offset:3072 lds
s_waitcnt lgkmcnt(14)
v_mfma_f32_32x32x16_bf16 a[48:63], a[108:111], v[104:107], a[48:63]
s_add_u32 s12, s12, 0x10000
s_addc_u32 s13, s13, 0
ds_read_b64_tr_b16 a[92:93], v14 offset:49152
ds_read_b64_tr_b16 a[94:95], v14 offset:50176
s_waitcnt lgkmcnt(14)
v_mfma_f32_32x32x16_bf16 a[0:15], a[64:67], v[108:111], a[0:15]
ds_read_b64_tr_b16 a[96:97], v11 offset:53248
s_add_u32 m0, s54, 0x2000
ds_read_b64_tr_b16 a[98:99], v11 offset:54272
s_waitcnt lgkmcnt(14)
v_mfma_f32_32x32x16_bf16 a[16:31], a[68:71], v[108:111], a[16:31]
ds_read_b64_tr_b16 a[100:101], v12 offset:53248
buffer_load_dwordx4 v18, s[24:27], s53 offen lds
s_waitcnt lgkmcnt(13)
v_mfma_f32_32x32x16_bf16 a[32:47], a[72:75], v[108:111], a[32:47]
ds_read_b64_tr_b16 a[102:103], v12 offset:54272
ds_read_b64_tr_b16 a[104:105], v13 offset:53248
s_add_u32 s53, s53, 0x8000
s_waitcnt lgkmcnt(13)
v_mfma_f32_32x32x16_bf16 a[48:63], a[76:79], v[108:111], a[48:63]
ds_read_b64_tr_b16 a[106:107], v13 offset:54272
ds_read_b64_tr_b16 a[108:109], v14 offset:53248
ds_read_b64_tr_b16 a[110:111], v14 offset:54272
buffer_load_dwordx4 v[96:99], v15, s[28:31], s37 offen sc1
buffer_load_dwordx4 v[100:103], v15, s[28:31], s37 offen offset:1024 sc1
buffer_load_dwordx4 v[104:107], v15, s[28:31], s37 offen offset:2048 sc1
buffer_load_dwordx4 v[108:111], v15, s[28:31], s37 offen offset:3072 sc1
s_add_u32 s37, s37, 0x1000
s_waitcnt lgkmcnt(14)
v_mfma_f32_32x32x16_bf16 a[0:15], a[80:83], v[112:115], a[0:15]
ds_read_b64_tr_b16 a[64:65], v11 offset:57344
s_add_u32 m0, s54, 0x3000
ds_read_b64_tr_b16 a[66:67], v11 offset:58368
s_waitcnt lgkmcnt(14)
v_mfma_f32_32x32x16_bf16 a[16:31], a[84:87], v[112:115], a[16:31]
ds_read_b64_tr_b16 a[68:69], v12 offset:57344
buffer_load_dwordx4 v18, s[24:27], s53 offen lds
s_waitcnt lgkmcnt(13)
v_mfma_f32_32x32x16_bf16 a[32:47], a[88:91], v[112:115], a[32:47]
ds_read_b64_tr_b16 a[70:71], v12 offset:58368
ds_read_b64_tr_b16 a[72:73], v13 offset:57344
s_add_u32 s53, s53, 0x8000
s_waitcnt lgkmcnt(13)
v_mfma_f32_32x32x16_bf16 a[48:63], a[92:95], v[112:115], a[48:63]
ds_read_b64_tr_b16 a[74:75], v13 offset:58368
ds_read_b64_tr_b16 a[76:77], v14 offset:57344
ds_read_b64_tr_b16 a[78:79], v14 offset:58368
s_waitcnt lgkmcnt(14)
v_mfma_f32_32x32x16_bf16 a[0:15], a[96:99], v[116:119], a[0:15]
ds_read_b64_tr_b16 a[80:81], v11 offset:61440
s_add_u32 m0, s54, 0x4000
ds_read_b64_tr_b16 a[82:83], v11 offset:62464
s_waitcnt lgkmcnt(14)
v_mfma_f32_32x32x16_bf16 a[16:31], a[100:103], v[116:119], a[16:31]
ds_read_b64_tr_b16 a[84:85], v12 offset:61440
buffer_load_dwordx4 v18, s[24:27], s53 offen lds
s_waitcnt lgkmcnt(13)
v_mfma_f32_32x32x16_bf16 a[32:47], a[104:107], v[116:119], a[32:47]
ds_read_b64_tr_b16 a[86:87], v12 offset:62464
ds_read_b64_tr_b16 a[88:89], v13 offset:61440
s_add_u32 s53, s53, 0x8000
s_waitcnt lgkmcnt(13)
v_mfma_f32_32x32x16_bf16 a[48:63], a[108:111], v[116:119], a[48:63]
ds_read_b64_tr_b16 a[90:91], v13 offset:62464
ds_read_b64_tr_b16 a[92:93], v14 offset:61440
ds_read_b64_tr_b16 a[94:95], v14 offset:62464
s_waitcnt vmcnt(17)
s_barrier
s_waitcnt lgkmcnt(14)
v_mfma_f32_32x32x16_bf16 a[0:15], a[64:67], v[120:123], a[0:15]
s_add_u32 m0, s38, 0x8000
ds_read_b64_tr_b16 a[96:97], v11 offset:0
buffer_load_dwordx4 v10, s[12:15], s33 offen lds
ds_read_b64_tr_b16 a[98:99], v11 offset:1024
s_waitcnt lgkmcnt(14)
v_mfma_f32_32x32x16_bf16 a[16:31], a[68:71], v[120:123], a[16:31]
buffer_load_dwordx4 v10, s[12:15], s34 offen offset:1024 lds
ds_read_b64_tr_b16 a[100:101], v12 offset:0
ds_read_b64_tr_b16 a[102:103], v12 offset:1024
ds_read_b64_tr_b16 a[104:105], v13 offset:0
s_waitcnt lgkmcnt(15)
v_mfma_f32_32x32x16_bf16 a[32:47], a[72:75], v[120:123], a[32:47]
buffer_load_dwordx4 v10, s[12:15], s35 offen offset:2048 lds
ds_read_b64_tr_b16 a[106:107], v13 offset:1024
buffer_load_dwordx4 v10, s[12:15], s36 offen offset:3072 lds
s_waitcnt lgkmcnt(14)
v_mfma_f32_32x32x16_bf16 a[48:63], a[76:79], v[120:123], a[48:63]
s_add_u32 s12, s12, 0x10000
s_addc_u32 s13, s13, 0
ds_read_b64_tr_b16 a[108:109], v14 offset:0
ds_read_b64_tr_b16 a[110:111], v14 offset:1024
s_waitcnt lgkmcnt(14)
v_mfma_f32_32x32x16_bf16 a[0:15], a[80:83], v[124:127], a[0:15]
ds_read_b64_tr_b16 a[64:65], v11 offset:4096
s_add_u32 m0, s54, 0x5000
ds_read_b64_tr_b16 a[66:67], v11 offset:5120
s_waitcnt lgkmcnt(14)
v_mfma_f32_32x32x16_bf16 a[16:31], a[84:87], v[124:127], a[16:31]
ds_read_b64_tr_b16 a[68:69], v12 offset:4096
buffer_load_dwordx4 v18, s[24:27], s53 offen lds
s_waitcnt lgkmcnt(13)
v_mfma_f32_32x32x16_bf16 a[32:47], a[88:91], v[124:127], a[32:47]
ds_read_b64_tr_b16 a[70:71], v12 offset:5120
ds_read_b64_tr_b16 a[72:73], v13 offset:4096
s_add_u32 s53, s53, 0x8000
s_waitcnt lgkmcnt(13)
v_mfma_f32_32x32x16_bf16 a[48:63], a[92:95], v[124:127], a[48:63]
ds_read_b64_tr_b16 a[74:75], v13 offset:5120
ds_read_b64_tr_b16 a[76:77], v14 offset:4096
ds_read_b64_tr_b16 a[78:79], v14 offset:5120
buffer_load_dwordx4 v[112:115], v15, s[28:31], s37 offen sc1
buffer_load_dwordx4 v[116:119], v15, s[28:31], s37 offen offset:1024 sc1
buffer_load_dwordx4 v[120:123], v15, s[28:31], s37 offen offset:2048 sc1
buffer_load_dwordx4 v[124:127], v15, s[28:31], s37 offen offset:3072 sc1
s_add_u32 s37, s37, 0x1000
s_waitcnt lgkmcnt(14)
v_mfma_f32_32x32x16_bf16 a[0:15], a[96:99], v[128:131], a[0:15]
ds_read_b64_tr_b16 a[80:81], v11 offset:8192
s_add_u32 m0, s54, 0x6000
ds_read_b64_tr_b16 a[82:83], v11 offset:9216
s_waitcnt lgkmcnt(14)
v_mfma_f32_32x32x16_bf16 a[16:31], a[100:103], v[128:131], a[16:31]
ds_read_b64_tr_b16 a[84:85], v12 offset:8192
buffer_load_dwordx4 v18, s[24:27], s53 offen lds
s_waitcnt lgkmcnt(13)
v_mfma_f32_32x32x16_bf16 a[32:47], a[104:107], v[128:131], a[32:47]
ds_read_b64_tr_b16 a[86:87], v12 offset:9216
ds_read_b64_tr_b16 a[88:89], v13 offset:8192
s_add_u32 s53, s53, 0x8000
s_waitcnt lgkmcnt(13)
v_mfma_f32_32x32x16_bf16 a[48:63], a[108:111], v[128:131], a[48:63]
ds_read_b64_tr_b16 a[90:91], v13 offset:9216
ds_read_b64_tr_b16 a[92:93], v14 offset:8192
ds_read_b64_tr_b16 a[94:95], v14 offset:9216
s_waitcnt lgkmcnt(14)
v_mfma_f32_32x32x16_bf16 a[0:15], a[64:67], v[132:135], a[0:15]
ds_read_b64_tr_b16 a[96:97], v11 offset:12288
s_add_u32 m0, s54, 0x7000
ds_read_b64_tr_b16 a[98:99], v11 offset:13312
s_waitcnt lgkmcnt(14)
v_mfma_f32_32x32x16_bf16 a[16:31], a[68:71], v[132:135], a[16:31]
ds_read_b64_tr_b16 a[100:101], v12 offset:12288
buffer_load_dwordx4 v18, s[24:27], s53 offen lds
s_waitcnt lgkmcnt(13)
v_mfma_f32_32x32x16_bf16 a[32:47], a[72:75], v[132:135], a[32:47]
ds_read_b64_tr_b16 a[102:103], v12 offset:13312
ds_read_b64_tr_b16 a[104:105], v13 offset:12288
s_add_u32 s53, s53, 0x8000
s_waitcnt lgkmcnt(13)
v_mfma_f32_32x32x16_bf16 a[48:63], a[76:79], v[132:135], a[48:63]
ds_read_b64_tr_b16 a[106:107], v13 offset:13312
ds_read_b64_tr_b16 a[108:109], v14 offset:12288
ds_read_b64_tr_b16 a[110:111], v14 offset:13312
s_waitcnt vmcnt(18)
s_barrier
s_waitcnt lgkmcnt(14)
v_mfma_f32_32x32x16_bf16 a[0:15], a[80:83], v[136:139], a[0:15]
s_add_u32 m0, s38, 0xc000
ds_read_b64_tr_b16 a[64:65], v11 offset:16384
buffer_load_dwordx4 v10, s[12:15], s33 offen lds
ds_read_b64_tr_b16 a[66:67], v11 offset:17408
s_waitcnt lgkmcnt(14)
v_mfma_f32_32x32x16_bf16 a[16:31], a[84:87], v[136:139], a[16:31]
buffer_load_dwordx4 v10, s[12:15], s34 offen offset:1024 lds
ds_read_b64_tr_b16 a[68:69], v12 offset:16384
ds_read_b64_tr_b16 a[70:71], v12 offset:17408
ds_read_b64_tr_b16 a[72:73], v13 offset:16384
s_waitcnt lgkmcnt(15)
v_mfma_f32_32x32x16_bf16 a[32:47], a[88:91], v[136:139], a[32:47]
buffer_load_dwordx4 v10, s[12:15], s35 offen offset:2048 lds
ds_read_b64_tr_b16 a[74:75], v13 offset:17408
buffer_load_dwordx4 v10, s[12:15], s36 offen offset:3072 lds
s_waitcnt lgkmcnt(14)
v_mfma_f32_32x32x16_bf16 a[48:63], a[92:95], v[136:139], a[48:63]
s_add_u32 s12, s12, 0x10000
s_addc_u32 s13, s13, 0
ds_read_b64_tr_b16 a[76:77], v14 offset:16384
ds_read_b64_tr_b16 a[78:79], v14 offset:17408
s_waitcnt lgkmcnt(14)
v_mfma_f32_32x32x16_bf16 a[0:15], a[96:99], v[140:143], a[0:15]
ds_read_b64_tr_b16 a[80:81], v11 offset:20480
s_add_u32 m0, s54, 0x8000
ds_read_b64_tr_b16 a[82:83], v11 offset:21504
s_waitcnt lgkmcnt(14)
v_mfma_f32_32x32x16_bf16 a[16:31], a[100:103], v[140:143], a[16:31]
ds_read_b64_tr_b16 a[84:85], v12 offset:20480
buffer_load_dwordx4 v18, s[24:27], s53 offen lds
s_waitcnt lgkmcnt(13)
v_mfma_f32_32x32x16_bf16 a[32:47], a[104:107], v[140:143], a[32:47]
ds_read_b64_tr_b16 a[86:87], v12 offset:21504
ds_read_b64_tr_b16 a[88:89], v13 offset:20480
s_add_u32 s53, s53, 0x8000
s_waitcnt lgkmcnt(13)
v_mfma_f32_32x32x16_bf16 a[48:63], a[108:111], v[140:143], a[48:63]
ds_read_b64_tr_b16 a[90:91], v13 offset:21504
ds_read_b64_tr_b16 a[92:93], v14 offset:20480
ds_read_b64_tr_b16 a[94:95], v14 offset:21504
s_waitcnt lgkmcnt(14)
v_mfma_f32_32x32x16_bf16 a[0:15], a[64:67], v[144:147], a[0:15]
ds_read_b64_tr_b16 a[96:97], v11 offset:24576
s_add_u32 m0, s54, 0x9000
ds_read_b64_tr_b16 a[98:99], v11 offset:25600
s_waitcnt lgkmcnt(14)
v_mfma_f32_32x32x16_bf16 a[16:31], a[68:71], v[144:147], a[16:31]
ds_read_b64_tr_b16 a[100:101], v12 offset:24576
buffer_load_dwordx4 v18, s[24:27], s53 offen lds
s_waitcnt lgkmcnt(13)
v_mfma_f32_32x32x16_bf16 a[32:47], a[72:75], v[144:147], a[32:47]
ds_read_b64_tr_b16 a[102:103], v12 offset:25600
ds_read_b64_tr_b16 a[104:105], v13 offset:24576
s_add_u32 s53, s53, 0x8000
s_waitcnt lgkmcnt(13)
v_mfma_f32_32x32x16_bf16 a[48:63], a[76:79], v[144:147], a[48:63]
ds_read_b64_tr_b16 a[106:107], v13 offset:25600
ds_read_b64_tr_b16 a[108:109], v14 offset:24576
ds_read_b64_tr_b16 a[110:111], v14 offset:25600
s_waitcnt lgkmcnt(14)
v_mfma_f32_32x32x16_bf16 a[0:15], a[80:83], v[148:151], a[0:15]
ds_read_b64_tr_b16 a[64:65], v11 offset:28672
s_add_u32 m0, s54, 0xa000
ds_read_b64_tr_b16 a[66:67], v11 offset:29696
s_waitcnt lgkmcnt(14)
v_mfma_f32_32x32x16_bf16 a[16:31], a[84:87], v[148:151], a[16:31]
ds_read_b64_tr_b16 a[68:69], v12 offset:28672
buffer_load_dwordx4 v18, s[24:27], s53 offen lds
s_waitcnt lgkmcnt(13)
v_mfma_f32_32x32x16_bf16 a[32:47], a[88:91], v[148:151], a[32:47]
ds_read_b64_tr_b16 a[70:71], v12 offset:29696
ds_read_b64_tr_b16 a[72:73], v13 offset:28672
s_add_u32 s53, s53, 0x8000
s_waitcnt lgkmcnt(13)
v_mfma_f32_32x32x16_bf16 a[48:63], a[92:95], v[148:151], a[48:63]
ds_read_b64_tr_b16 a[74:75], v13 offset:29696
ds_read_b64_tr_b16 a[76:77], v14 offset:28672
ds_read_b64_tr_b16 a[78:79], v14 offset:29696
s_waitcnt vmcnt(14)
s_barrier
s_waitcnt lgkmcnt(14)
v_mfma_f32_32x32x16_bf16 a[0:15], a[96:99], v[152:155], a[0:15]
s_add_u32 m0, s38, 0
ds_read_b64_tr_b16 a[80:81], v11 offset:32768
buffer_load_dwordx4 v10, s[12:15], s33 offen lds
ds_read_b64_tr_b16 a[82:83], v11 offset:33792
s_waitcnt lgkmcnt(14)
v_mfma_f32_32x32x16_bf16 a[16:31], a[100:103], v[152:155], a[16:31]
buffer_load_dwordx4 v10, s[12:15], s34 offen offset:1024 lds
ds_read_b64_tr_b16 a[84:85], v12 offset:32768
ds_read_b64_tr_b16 a[86:87], v12 offset:33792
ds_read_b64_tr_b16 a[88:89], v13 offset:32768
s_waitcnt lgkmcnt(15)
v_mfma_f32_32x32x16_bf16 a[32:47], a[104:107], v[152:155], a[32:47]
buffer_load_dwordx4 v10, s[12:15], s35 offen offset:2048 lds
ds_read_b64_tr_b16 a[90:91], v13 offset:33792
buffer_load_dwordx4 v10, s[12:15], s36 offen offset:3072 lds
s_waitcnt lgkmcnt(14)
v_mfma_f32_32x32x16_bf16 a[48:63], a[108:111], v[152:155], a[48:63]
s_add_u32 s12, s12, 0x10000
s_addc_u32 s13, s13, 0
ds_read_b64_tr_b16 a[92:93], v14 offset:32768
ds_read_b64_tr_b16 a[94:95], v14 offset:33792
s_waitcnt lgkmcnt(14)
v_mfma_f32_32x32x16_bf16 a[0:15], a[64:67], v[156:159], a[0:15]
ds_read_b64_tr_b16 a[96:97], v11 offset:36864
s_add_u32 m0, s54, 0xb000
ds_read_b64_tr_b16 a[98:99], v11 offset:37888
s_waitcnt lgkmcnt(14)
v_mfma_f32_32x32x16_bf16 a[16:31], a[68:71], v[156:159], a[16:31]
ds_read_b64_tr_b16 a[100:101], v12 offset:36864
buffer_load_dwordx4 v18, s[24:27], s53 offen lds
s_waitcnt lgkmcnt(13)
v_mfma_f32_32x32x16_bf16 a[32:47], a[72:75], v[156:159], a[32:47]
ds_read_b64_tr_b16 a[102:103], v12 offset:37888
ds_read_b64_tr_b16 a[104:105], v13 offset:36864
s_add_u32 s53, s53, 0x8000
s_waitcnt lgkmcnt(13)
v_mfma_f32_32x32x16_bf16 a[48:63], a[76:79], v[156:159], a[48:63]
ds_read_b64_tr_b16 a[106:107], v13 offset:37888
ds_read_b64_tr_b16 a[108:109], v14 offset:36864
ds_read_b64_tr_b16 a[110:111], v14 offset:37888
s_waitcnt lgkmcnt(14)
v_mfma_f32_32x32x16_bf16 a[0:15], a[80:83], v[160:163], a[0:15]
ds_read_b64_tr_b16 a[64:65], v11 offset:40960
s_add_u32 m0, s54, 0xc000
ds_read_b64_tr_b16 a[66:67], v11 offset:41984
ds_read_b64_tr_b16 a[68:69], v12 offset:40960
s_waitcnt lgkmcnt(15)
v_mfma_f32_32x32x16_bf16 a[16:31], a[84:87], v[160:163], a[16:31]
ds_read_b64_tr_b16 a[70:71], v12 offset:41984
buffer_load_dwordx4 v18, s[24:27], s53 offen lds
ds_read_b64_tr_b16 a[72:73], v13 offset:40960
s_waitcnt lgkmcnt(15)
v_mfma_f32_32x32x16_bf16 a[32:47], a[88:91], v[160:163], a[32:47]
ds_read_b64_tr_b16 a[74:75], v13 offset:41984
buffer_load_dword v22, v23, s[28:31], s46 offen sc0 sc1
s_waitcnt lgkmcnt(14)
v_mfma_f32_32x32x16_bf16 a[48:63], a[92:95], v[160:163], a[48:63]
ds_read_b64_tr_b16 a[76:77], v14 offset:40960
s_add_u32 s53, s53, 0x8000
ds_read_b64_tr_b16 a[78:79], v14 offset:41984
s_waitcnt lgkmcnt(14)
v_mfma_f32_32x32x16_bf16 a[0:15], a[96:99], v[164:167], a[0:15]
ds_read_b64_tr_b16 a[80:81], v11 offset:45056
s_add_u32 m0, s54, 0xd000
ds_read_b64_tr_b16 a[82:83], v11 offset:46080
s_waitcnt lgkmcnt(14)
v_mfma_f32_32x32x16_bf16 a[16:31], a[100:103], v[164:167], a[16:31]
ds_read_b64_tr_b16 a[84:85], v12 offset:45056
buffer_load_dwordx4 v18, s[24:27], s53 offen lds
s_waitcnt lgkmcnt(13)
v_mfma_f32_32x32x16_bf16 a[32:47], a[104:107], v[164:167], a[32:47]
ds_read_b64_tr_b16 a[86:87], v12 offset:46080
ds_read_b64_tr_b16 a[88:89], v13 offset:45056
s_add_u32 s53, s53, 0x8000
s_waitcnt lgkmcnt(13)
v_mfma_f32_32x32x16_bf16 a[48:63], a[108:111], v[164:167], a[48:63]
ds_read_b64_tr_b16 a[90:91], v13 offset:46080
ds_read_b64_tr_b16 a[92:93], v14 offset:45056
ds_read_b64_tr_b16 a[94:95], v14 offset:46080
s_waitcnt vmcnt(11)
s_barrier
s_waitcnt lgkmcnt(14)
v_mfma_f32_32x32x16_bf16 a[0:15], a[64:67], v[168:171], a[0:15]
s_add_u32 m0, s38, 0x4000
ds_read_b64_tr_b16 a[96:97], v11 offset:49152
buffer_load_dwordx4 v10, s[12:15], s33 offen lds
ds_read_b64_tr_b16 a[98:99], v11 offset:50176
s_waitcnt lgkmcnt(14)
v_mfma_f32_32x32x16_bf16 a[16:31], a[68:71], v[168:171], a[16:31]
buffer_load_dwordx4 v10, s[12:15], s34 offen offset:1024 lds
ds_read_b64_tr_b16 a[100:101], v12 offset:49152
ds_read_b64_tr_b16 a[102:103], v12 offset:50176
ds_read_b64_tr_b16 a[104:105], v13 offset:49152
s_waitcnt lgkmcnt(15)
v_mfma_f32_32x32x16_bf16 a[32:47], a[72:75], v[168:171], a[32:47]
buffer_load_dwordx4 v10, s[12:15], s35 offen offset:2048 lds
ds_read_b64_tr_b16 a[106:107], v13 offset:50176
buffer_load_dwordx4 v10, s[12:15], s36 offen offset:3072 lds
s_waitcnt lgkmcnt(14)
v_mfma_f32_32x32x16_bf16 a[48:63], a[76:79], v[168:171], a[48:63]
s_add_u32 s12, s12, 0x10000
s_addc_u32 s13, s13, 0
ds_read_b64_tr_b16 a[108:109], v14 offset:49152
ds_read_b64_tr_b16 a[110:111], v14 offset:50176
s_waitcnt lgkmcnt(14)
v_mfma_f32_32x32x16_bf16 a[0:15], a[80:83], v[172:175], a[0:15]
ds_read_b64_tr_b16 a[64:65], v11 offset:53248
s_add_u32 m0, s54, 0xe000
ds_read_b64_tr_b16 a[66:67], v11 offset:54272
s_waitcnt lgkmcnt(14)
v_mfma_f32_32x32x16_bf16 a[16:31], a[84:87], v[172:175], a[16:31]
ds_read_b64_tr_b16 a[68:69], v12 offset:53248
buffer_load_dwordx4 v18, s[24:27], s53 offen lds
s_waitcnt lgkmcnt(13)
v_mfma_f32_32x32x16_bf16 a[32:47], a[88:91], v[172:175], a[32:47]
ds_read_b64_tr_b16 a[70:71], v12 offset:54272
ds_read_b64_tr_b16 a[72:73], v13 offset:53248
s_add_u32 s53, s53, 0x8000
s_waitcnt lgkmcnt(13)
v_mfma_f32_32x32x16_bf16 a[48:63], a[92:95], v[172:175], a[48:63]
ds_read_b64_tr_b16 a[74:75], v13 offset:54272
ds_read_b64_tr_b16 a[76:77], v14 offset:53248
ds_read_b64_tr_b16 a[78:79], v14 offset:54272
s_waitcnt lgkmcnt(14)
v_mfma_f32_32x32x16_bf16 a[0:15], a[96:99], v[176:179], a[0:15]
ds_read_b64_tr_b16 a[80:81], v11 offset:57344
s_add_u32 m0, s54, 0xf000
ds_read_b64_tr_b16 a[82:83], v11 offset:58368
s_waitcnt lgkmcnt(14)
v_mfma_f32_32x32x16_bf16 a[16:31], a[100:103], v[176:179], a[16:31]
ds_read_b64_tr_b16 a[84:85], v12 offset:57344
buffer_load_dwordx4 v18, s[24:27], s53 offen lds
s_waitcnt lgkmcnt(13)
v_mfma_f32_32x32x16_bf16 a[32:47], a[104:107], v[176:179], a[32:47]
ds_read_b64_tr_b16 a[86:87], v12 offset:58368
ds_read_b64_tr_b16 a[88:89], v13 offset:57344
s_add_u32 s53, s53, 0x8000
s_waitcnt lgkmcnt(13)
v_mfma_f32_32x32x16_bf16 a[48:63], a[108:111], v[176:179], a[48:63]
ds_read_b64_tr_b16 a[90:91], v13 offset:58368
ds_read_b64_tr_b16 a[92:93], v14 offset:57344
ds_read_b64_tr_b16 a[94:95], v14 offset:58368
s_waitcnt lgkmcnt(14)
v_mfma_f32_32x32x16_bf16 a[0:15], a[64:67], v[180:183], a[0:15]
ds_read_b64_tr_b16 a[96:97], v11 offset:61440
s_add_u32 m0, s54, 0x10000
ds_read_b64_tr_b16 a[98:99], v11 offset:62464
s_waitcnt lgkmcnt(14)
v_mfma_f32_32x32x16_bf16 a[16:31], a[68:71], v[180:183], a[16:31]
ds_read_b64_tr_b16 a[100:101], v12 offset:61440
buffer_load_dwordx4 v18, s[24:27], s53 offen lds
s_waitcnt lgkmcnt(13)
v_mfma_f32_32x32x16_bf16 a[32:47], a[72:75], v[180:183], a[32:47]
ds_read_b64_tr_b16 a[102:103], v12 offset:62464
ds_read_b64_tr_b16 a[104:105], v13 offset:61440
s_add_u32 s53, s53, 0x8000
s_waitcnt lgkmcnt(13)
v_mfma_f32_32x32x16_bf16 a[48:63], a[76:79], v[180:183], a[48:63]
ds_read_b64_tr_b16 a[106:107], v13 offset:62464
ds_read_b64_tr_b16 a[108:109], v14 offset:61440
ds_read_b64_tr_b16 a[110:111], v14 offset:62464
s_waitcnt vmcnt(11)
s_barrier
s_waitcnt lgkmcnt(14)
v_mfma_f32_32x32x16_bf16 a[0:15], a[80:83], v[184:187], a[0:15]
s_add_u32 m0, s38, 0x8000
ds_read_b64_tr_b16 a[64:65], v11 offset:0
buffer_load_dwordx4 v10, s[12:15], s33 offen lds
ds_read_b64_tr_b16 a[66:67], v11 offset:1024
s_waitcnt lgkmcnt(14)
v_mfma_f32_32x32x16_bf16 a[16:31], a[84:87], v[184:187], a[16:31]
buffer_load_dwordx4 v10, s[12:15], s34 offen offset:1024 lds
ds_read_b64_tr_b16 a[68:69], v12 offset:0
ds_read_b64_tr_b16 a[70:71], v12 offset:1024
ds_read_b64_tr_b16 a[72:73], v13 offset:0
s_waitcnt lgkmcnt(15)
v_mfma_f32_32x32x16_bf16 a[32:47], a[88:91], v[184:187], a[32:47]
buffer_load_dwordx4 v10, s[12:15], s35 offen offset:2048 lds
ds_read_b64_tr_b16 a[74:75], v13 offset:1024
buffer_load_dwordx4 v10, s[12:15], s36 offen offset:3072 lds
s_waitcnt lgkmcnt(14)
v_mfma_f32_32x32x16_bf16 a[48:63], a[92:95], v[184:187], a[48:63]
s_add_u32 s12, s12, 0x10000
s_addc_u32 s13, s13, 0
ds_read_b64_tr_b16 a[76:77], v14 offset:0
ds_read_b64_tr_b16 a[78:79], v14 offset:1024
s_waitcnt lgkmcnt(14)
v_mfma_f32_32x32x16_bf16 a[0:15], a[96:99], v[188:191], a[0:15]
ds_read_b64_tr_b16 a[80:81], v11 offset:4096
s_add_u32 m0, s54, 0x11000
ds_read_b64_tr_b16 a[82:83], v11 offset:5120
s_waitcnt lgkmcnt(14)
v_mfma_f32_32x32x16_bf16 a[16:31], a[100:103], v[188:191], a[16:31]
ds_read_b64_tr_b16 a[84:85], v12 offset:4096
buffer_load_dwordx4 v18, s[24:27], s53 offen lds
s_waitcnt lgkmcnt(13)
v_mfma_f32_32x32x16_bf16 a[32:47], a[104:107], v[188:191], a[32:47]
ds_read_b64_tr_b16 a[86:87], v12 offset:5120
ds_read_b64_tr_b16 a[88:89], v13 offset:4096
s_add_u32 s53, s53, 0x8000
s_waitcnt lgkmcnt(13)
v_mfma_f32_32x32x16_bf16 a[48:63], a[108:111], v[188:191], a[48:63]
ds_read_b64_tr_b16 a[90:91], v13 offset:5120
ds_read_b64_tr_b16 a[92:93], v14 offset:4096
ds_read_b64_tr_b16 a[94:95], v14 offset:5120
s_waitcnt vmcnt(13)
v_cmp_eq_u32 vcc, s32, v22
s_cmp_eq_u64 vcc, exec
s_cbranch_scc0 L_slow_16
L_slow_16_r:
s_waitcnt lgkmcnt(14)
v_mfma_f32_32x32x16_bf16 a[0:15], a[64:67], v[64:67], a[0:15]
ds_read_b64_tr_b16 a[96:97], v11 offset:8192
s_add_u32 m0, s54, 0x12000
ds_read_b64_tr_b16 a[98:99], v11 offset:9216
s_waitcnt lgkmcnt(14)
v_mfma_f32_32x32x16_bf16 a[16:31], a[68:71], v[64:67], a[16:31]
ds_read_b64_tr_b16 a[100:101], v12 offset:8192
buffer_load_dwordx4 v18, s[24:27], s53 offen lds
s_waitcnt lgkmcnt(13)
v_mfma_f32_32x32x16_bf16 a[32:47], a[72:75], v[64:67], a[32:47]
ds_read_b64_tr_b16 a[102:103], v12 offset:9216
ds_read_b64_tr_b16 a[104:105], v13 offset:8192
s_add_u32 s53, s53, 0x8000
s_waitcnt lgkmcnt(13)
v_mfma_f32_32x32x16_bf16 a[48:63], a[76:79], v[64:67], a[48:63]
ds_read_b64_tr_b16 a[106:107], v13 offset:9216
ds_read_b64_tr_b16 a[108:109], v14 offset:8192
ds_read_b64_tr_b16 a[110:111], v14 offset:9216
s_waitcnt lgkmcnt(14)
v_mfma_f32_32x32x16_bf16 a[0:15], a[80:83], v[68:71], a[0:15]
ds_read_b64_tr_b16 a[64:65], v11 offset:12288
s_add_u32 m0, s54, 0x13000
ds_read_b64_tr_b16 a[66:67], v11 offset:13312
s_waitcnt lgkmcnt(14)
v_mfma_f32_32x32x16_bf16 a[16:31], a[84:87], v[68:71], a[16:31]
ds_read_b64_tr_b16 a[68:69], v12 offset:12288
buffer_load_dwordx4 v18, s[24:27], s53 offen lds
s_waitcnt lgkmcnt(13)
v_mfma_f32_32x32x16_bf16 a[32:47], a[88:91], v[68:71], a[32:47]
ds_read_b64_tr_b16 a[70:71], v12 offset:13312
ds_read_b64_tr_b16 a[72:73], v13 offset:12288
s_add_u32 s53, s53, 0x8000
s_waitcnt lgkmcnt(13)
v_mfma_f32_32x32x16_bf16 a[48:63], a[92:95], v[68:71], a[48:63]
ds_read_b64_tr_b16 a[74:75], v13 offset:13312
ds_read_b64_tr_b16 a[76:77], v14 offset:12288
ds_read_b64_tr_b16 a[78:79], v14 offset:13312
s_waitcnt vmcnt(10)
s_barrier
s_waitcnt lgkmcnt(14)
v_mfma_f32_32x32x16_bf16 a[0:15], a[96:99], v[72:75], a[0:15]
s_add_u32 m0, s38, 0xc000
ds_read_b64_tr_b16 a[80:81], v11 offset:16384
buffer_load_dwordx4 v10, s[12:15], s33 offen lds
ds_read_b64_tr_b16 a[82:83], v11 offset:17408
s_waitcnt lgkmcnt(14)
v_mfma_f32_32x32x16_bf16 a[16:31], a[100:103], v[72:75], a[16:31]
buffer_load_dwordx4 v10, s[12:15], s34 offen offset:1024 lds
ds_read_b64_tr_b16 a[84:85], v12 offset:16384
ds_read_b64_tr_b16 a[86:87], v12 offset:17408
ds_read_b64_tr_b16 a[88:89], v13 offset:16384
s_waitcnt lgkmcnt(15)
v_mfma_f32_32x32x16_bf16 a[32:47], a[104:107], v[72:75], a[32:47]
buffer_load_dwordx4 v10, s[12:15], s35 offen offset:2048 lds
ds_read_b64_tr_b16 a[90:91], v13 offset:17408
buffer_load_dwordx4 v10, s[12:15], s36 offen offset:3072 lds
s_waitcnt lgkmcnt(14)
v_mfma_f32_32x32x16_bf16 a[48:63], a[108:111], v[72:75], a[48:63]
s_add_u32 s12, s12, 0x10000
s_addc_u32 s13, s13, 0
ds_read_b64_tr_b16 a[92:93], v14 offset:16384
ds_read_b64_tr_b16 a[94:95], v14 offset:17408
s_waitcnt lgkmcnt(14)
v_mfma_f32_32x32x16_bf16 a[0:15], a[64:67], v[76:79], a[0:15]
ds_read_b64_tr_b16 a[96:97], v11 offset:20480
s_add_u32 m0, s54, 0x14000
ds_read_b64_tr_b16 a[98:99], v11 offset:21504
s_waitcnt lgkmcnt(14)
v_mfma_f32_32x32x16_bf16 a[16:31], a[68:71], v[76:79], a[16:31]
ds_read_b64_tr_b16 a[100:101], v12 offset:20480
buffer_load_dwordx4 v18, s[24:27], s53 offen lds
s_waitcnt lgkmcnt(13)
v_mfma_f32_32x32x16_bf16 a[32:47], a[72:75], v[76:79], a[32:47]
ds_read_b64_tr_b16 a[102:103], v12 offset:21504
ds_read_b64_tr_b16 a[104:105], v13 offset:20480
s_add_u32 s53, s53, 0x8000
s_waitcnt lgkmcnt(13)
v_mfma_f32_32x32x16_bf16 a[48:63], a[76:79], v[76:79], a[48:63]
ds_read_b64_tr_b16 a[106:107], v13 offset:21504
ds_read_b64_tr_b16 a[108:109], v14 offset:20480
ds_read_b64_tr_b16 a[110:111], v14 offset:21504
s_waitcnt lgkmcnt(14)
v_mfma_f32_32x32x16_bf16 a[0:15], a[80:83], v[80:83], a[0:15]
ds_read_b64_tr_b16 a[64:65], v11 offset:24576
buffer_load_dwordx4 a[112:115], v15, s[28:31], s45 offen sc1
s_add_u32 m0, s54, 0x15000
ds_read_b64_tr_b16 a[66:67], v11 offset:25600
s_waitcnt lgkmcnt(14)
v_mfma_f32_32x32x16_bf16 a[16:31], a[84:87], v[80:83], a[16:31]
ds_read_b64_tr_b16 a[68:69], v12 offset:24576
buffer_load_dwordx4 a[116:119], v15, s[28:31], s45 offen offset:1024 sc1
buffer_load_dwordx4 v18, s[24:27], s53 offen lds
s_waitcnt lgkmcnt(13)
v_mfma_f32_32x32x16_bf16 a[32:47], a[88:91], v[80:83], a[32:47]
ds_read_b64_tr_b16 a[70:71], v12 offset:25600
ds_read_b64_tr_b16 a[72:73], v13 offset:24576
buffer_load_dwordx4 a[120:123], v15, s[28:31], s45 offen offset:2048 sc1
s_waitcnt lgkmcnt(13)
v_mfma_f32_32x32x16_bf16 a[48:63], a[92:95], v[80:83], a[48:63]
ds_read_b64_tr_b16 a[74:75], v13 offset:25600
ds_read_b64_tr_b16 a[76:77], v14 offset:24576
s_add_u32 s53, s53, 0x8000
ds_read_b64_tr_b16 a[78:79], v14 offset:25600
s_waitcnt lgkmcnt(14)
v_mfma_f32_32x32x16_bf16 a[0:15], a[96:99], v[84:87], a[0:15]
ds_read_b64_tr_b16 a[80:81], v11 offset:28672
buffer_load_dwordx4 a[124:127], v15, s[28:31], s45 offen offset:3072 sc1
ds_read_b64_tr_b16 a[82:83], v11 offset:29696
s_waitcnt lgkmcnt(14)
v_mfma_f32_32x32x16_bf16 a[16:31], a[100:103], v[84:87], a[16:31]
ds_read_b64_tr_b16 a[84:85], v12 offset:28672
s_add_u32 s45, s45, 0x1000
ds_read_b64_tr_b16 a[86:87], v12 offset:29696
s_waitcnt lgkmcnt(14)
v_mfma_f32_32x32x16_bf16 a[32:47], a[104:107], v[84:87], a[32:47]
ds_read_b64_tr_b16 a[88:89], v13 offset:28672
buffer_load_dwordx4 a[128:131], v15, s[28:31], s45 offen sc1
s_waitcnt lgkmcnt(13)
v_mfma_f32_32x32x16_bf16 a[48:63], a[108:111], v[84:87], a[48:63]
ds_read_b64_tr_b16 a[90:91], v13 offset:29696
ds_read_b64_tr_b16 a[92:93], v14 offset:28672
ds_read_b64_tr_b16 a[94:95], v14 offset:29696
s_waitcnt vmcnt(14)
s_barrier
s_waitcnt lgkmcnt(14)
v_mfma_f32_32x32x16_bf16 a[0:15], a[64:67], v[88:91], a[0:15]
ds_read_b64_tr_b16 a[96:97], v11 offset:32768
buffer_load_dwordx4 a[132:135], v15, s[28:31], s45 offen offset:1024 sc1
ds_read_b64_tr_b16 a[98:99], v11 offset:33792
s_waitcnt lgkmcnt(14)
v_mfma_f32_32x32x16_bf16 a[16:31], a[68:71], v[88:91], a[16:31]
ds_read_b64_tr_b16 a[100:101], v12 offset:32768
buffer_load_dwordx4 a[136:139], v15, s[28:31], s45 offen offset:2048 sc1
ds_read_b64_tr_b16 a[102:103], v12 offset:33792
s_waitcnt lgkmcnt(14)
v_mfma_f32_32x32x16_bf16 a[32:47], a[72:75], v[88:91], a[32:47]
ds_read_b64_tr_b16 a[104:105], v13 offset:32768
buffer_load_dwordx4 a[140:143], v15, s[28:31], s45 offen offset:3072 sc1
s_waitcnt lgkmcnt(13)
v_mfma_f32_32x32x16_bf16 a[48:63], a[76:79], v[88:91], a[48:63]
ds_read_b64_tr_b16 a[106:107], v13 offset:33792
ds_read_b64_tr_b16 a[108:109], v14 offset:32768
ds_read_b64_tr_b16 a[110:111], v14 offset:33792
s_waitcnt lgkmcnt(14)
v_mfma_f32_32x32x16_bf16 a[0:15], a[80:83], v[92:95], a[0:15]
ds_read_b64_tr_b16 a[64:65], v11 offset:36864
s_add_u32 s45, s45, 0x1000
ds_read_b64_tr_b16 a[66:67], v11 offset:37888
ds_read_b64_tr_b16 a[68:69], v12 offset:36864
s_waitcnt lgkmcnt(15)
v_mfma_f32_32x32x16_bf16 a[16:31], a[84:87], v[92:95], a[16:31]
ds_read_b64_tr_b16 a[70:71], v12 offset:37888
buffer_load_dwordx4 a[144:147], v15, s[28:31], s45 offen sc1
s_waitcnt lgkmcnt(14)
v_mfma_f32_32x32x16_bf16 a[32:47], a[88:91], v[92:95], a[32:47]
ds_read_b64_tr_b16 a[72:73], v13 offset:36864
buffer_load_dwordx4 a[148:151], v15, s[28:31], s45 offen offset:1024 sc1
s_waitcnt lgkmcnt(13)
v_mfma_f32_32x32x16_bf16 a[48:63], a[92:95], v[92:95], a[48:63]
ds_read_b64_tr_b16 a[74:75], v13 offset:37888
ds_read_b64_tr_b16 a[76:77], v14 offset:36864
ds_read_b64_tr_b16 a[78:79], v14 offset:37888
s_waitcnt lgkmcnt(14)
v_mfma_f32_32x32x16_bf16 a[0:15], a[96:99], v[96:99], a[0:15]
ds_read_b64_tr_b16 a[80:81], v11 offset:40960
buffer_load_dwordx4 a[152:155], v15, s[28:31], s45 offen offset:2048 sc1
ds_read_b64_tr_b16 a[82:83], v11 offset:41984
s_waitcnt lgkmcnt(14)
v_mfma_f32_32x32x16_bf16 a[16:31], a[100:103], v[96:99], a[16:31]
ds_read_b64_tr_b16 a[84:85], v12 offset:40960
buffer_load_dwordx4 a[156:159], v15, s[28:31], s45 offen offset:3072 sc1
s_waitcnt lgkmcnt(13)
v_mfma_f32_32x32x16_bf16 a[32:47], a[104:107], v[96:99], a[32:47]
ds_read_b64_tr_b16 a[86:87], v12 offset:41984
ds_read_b64_tr_b16 a[88:89], v13 offset:40960
s_add_u32 s45, s45, 0x1000
s_waitcnt lgkmcnt(13)
v_mfma_f32_32x32x16_bf16 a[48:63], a[108:111], v[96:99], a[48:63]
ds_read_b64_tr_b16 a[90:91], v13 offset:41984
ds_read_b64_tr_b16 a[92:93], v14 offset:40960
ds_read_b64_tr_b16 a[94:95], v14 offset:41984
s_waitcnt lgkmcnt(14)
v_mfma_f32_32x32x16_bf16 a[0:15], a[64:67], v[100:103], a[0:15]
ds_read_b64_tr_b16 a[96:97], v11 offset:45056
buffer_load_dwordx4 a[160:163], v15, s[28:31], s45 offen sc1
ds_read_b64_tr_b16 a[98:99], v11 offset:46080
s_waitcnt lgkmcnt(14)
v_mfma_f32_32x32x16_bf16 a[16:31], a[68:71], v[100:103], a[16:31]
ds_read_b64_tr_b16 a[100:101], v12 offset:45056
buffer_load_dwordx4 a[164:167], v15, s[28:31], s45 offen offset:1024 sc1
ds_read_b64_tr_b16 a[102:103], v12 offset:46080
s_waitcnt lgkmcnt(14)
v_mfma_f32_32x32x16_bf16 a[32:47], a[72:75], v[100:103], a[32:47]
ds_read_b64_tr_b16 a[104:105], v13 offset:45056
buffer_load_dwordx4 a[168:171], v15, s[28:31], s45 offen offset:2048 sc1
s_waitcnt lgkmcnt(13)
v_mfma_f32_32x32x16_bf16 a[48:63], a[76:79], v[100:103], a[48:63]
ds_read_b64_tr_b16 a[106:107], v13 offset:46080
ds_read_b64_tr_b16 a[108:109], v14 offset:45056
ds_read_b64_tr_b16 a[110:111], v14 offset:46080
s_waitcnt vmcnt(17)
s_barrier
s_waitcnt lgkmcnt(14)
v_mfma_f32_32x32x16_bf16 a[0:15], a[80:83], v[104:107], a[0:15]
ds_read_b64_tr_b16 a[64:65], v11 offset:49152
buffer_load_dwordx4 a[172:175], v15, s[28:31], s45 offen offset:3072 sc1
ds_read_b64_tr_b16 a[66:67], v11 offset:50176
s_waitcnt lgkmcnt(14)
v_mfma_f32_32x32x16_bf16 a[16:31], a[84:87], v[104:107], a[16:31]
ds_read_b64_tr_b16 a[68:69], v12 offset:49152
s_add_u32 s45, s45, 0x1000
ds_read_b64_tr_b16 a[70:71], v12 offset:50176
s_waitcnt lgkmcnt(14)
v_mfma_f32_32x32x16_bf16 a[32:47], a[88:91], v[104:107], a[32:47]
ds_read_b64_tr_b16 a[72:73], v13 offset:49152
buffer_load_dwordx4 a[176:179], v15, s[28:31], s45 offen sc1
s_waitcnt lgkmcnt(13)
v_mfma_f32_32x32x16_bf16 a[48:63], a[92:95], v[104:107], a[48:63]
ds_read_b64_tr_b16 a[74:75], v13 offset:50176
ds_read_b64_tr_b16 a[76:77], v14 offset:49152
ds_read_b64_tr_b16 a[78:79], v14 offset:50176
s_waitcnt lgkmcnt(14)
v_mfma_f32_32x32x16_bf16 a[0:15], a[96:99], v[108:111], a[0:15]
ds_read_b64_tr_b16 a[80:81], v11 offset:53248
buffer_load_dwordx4 a[180:183], v15, s[28:31], s45 offen offset:1024 sc1
ds_read_b64_tr_b16 a[82:83], v11 offset:54272
s_waitcnt lgkmcnt(14)
v_mfma_f32_32x32x16_bf16 a[16:31], a[100:103], v[108:111], a[16:31]
ds_read_b64_tr_b16 a[84:85], v12 offset:53248
buffer_load_dwordx4 a[184:187], v15, s[28:31], s45 offen offset:2048 sc1
ds_read_b64_tr_b16 a[86:87], v12 offset:54272
s_waitcnt lgkmcnt(14)
v_mfma_f32_32x32x16_bf16 a[32:47], a[104:107], v[108:111], a[32:47]
ds_read_b64_tr_b16 a[88:89], v13 offset:53248
buffer_load_dwordx4 a[188:191], v15, s[28:31], s45 offen offset:3072 sc1
s_waitcnt lgkmcnt(13)
v_mfma_f32_32x32x16_bf16 a[48:63], a[108:111], v[108:111], a[48:63]
ds_read_b64_tr_b16 a[90:91], v13 offset:54272
ds_read_b64_tr_b16 a[92:93], v14 offset:53248
ds_read_b64_tr_b16 a[94:95], v14 offset:54272
s_waitcnt lgkmcnt(14)
v_mfma_f32_32x32x16_bf16 a[0:15], a[64:67], v[112:115], a[0:15]
ds_read_b64_tr_b16 a[96:97], v11 offset:57344
s_add_u32 s45, s45, 0x1000
ds_read_b64_tr_b16 a[98:99], v11 offset:58368
ds_read_b64_tr_b16 a[100:101], v12 offset:57344
s_waitcnt lgkmcnt(15)
v_mfma_f32_32x32x16_bf16 a[16:31], a[68:71], v[112:115], a[16:31]
ds_read_b64_tr_b16 a[102:103], v12 offset:58368
buffer_load_dwordx4 a[192:195], v15, s[28:31], s45 offen sc1
s_waitcnt lgkmcnt(14)
v_mfma_f32_32x32x16_bf16 a[32:47], a[72:75], v[112:115], a[32:47]
ds_read_b64_tr_b16 a[104:105], v13 offset:57344
buffer_load_dwordx4 a[196:199], v15, s[28:31], s45 offen offset:1024 sc1
s_waitcnt lgkmcnt(13)
v_mfma_f32_32x32x16_bf16 a[48:63], a[76:79], v[112:115], a[48:63]
ds_read_b64_tr_b16 a[106:107], v13 offset:58368
ds_read_b64_tr_b16 a[108:109], v14 offset:57344
ds_read_b64_tr_b16 a[110:111], v14 offset:58368
s_waitcnt lgkmcnt(14)
v_mfma_f32_32x32x16_bf16 a[0:15], a[80:83], v[116:119], a[0:15]
ds_read_b64_tr_b16 a[64:65], v11 offset:61440
buffer_load_dwordx4 v[40:43], v19, s[8:11], s44 offen
s_waitcnt lgkmcnt(13)
v_mfma_f32_32x32x16_bf16 a[16:31], a[84:87], v[116:119], a[16:31]
ds_read_b64_tr_b16 a[66:67], v11 offset:62464
ds_read_b64_tr_b16 a[68:69], v12 offset:61440
ds_read_b64_tr_b16 a[70:71], v12 offset:62464
s_waitcnt lgkmcnt(14)
v_mfma_f32_32x32x16_bf16 a[32:47], a[88:91], v[116:119], a[32:47]
ds_read_b64_tr_b16 a[72:73], v13 offset:61440
buffer_load_dwordx4 v[44:47], v19, s[8:11], s44 offen offset:32
s_waitcnt lgkmcnt(13)
v_mfma_f32_32x32x16_bf16 a[48:63], a[92:95], v[116:119], a[48:63]
ds_read_b64_tr_b16 a[74:75], v13 offset:62464
ds_read_b64_tr_b16 a[76:77], v14 offset:61440
ds_read_b64_tr_b16 a[78:79], v14 offset:62464
s_waitcnt lgkmcnt(14)
v_mfma_f32_32x32x16_bf16 a[0:15], a[96:99], v[120:123], a[0:15]
s_waitcnt lgkmcnt(12)
v_mfma_f32_32x32x16_bf16 a[16:31], a[100:103], v[120:123], a[16:31]
s_waitcnt lgkmcnt(10)
v_mfma_f32_32x32x16_bf16 a[32:47], a[104:107], v[120:123], a[32:47]
s_waitcnt lgkmcnt(8)
v_mfma_f32_32x32x16_bf16 a[48:63], a[108:111], v[120:123], a[48:63]
s_waitcnt lgkmcnt(6)
v_mfma_f32_32x32x16_bf16 a[0:15], a[64:67], v[124:127], a[0:15]
s_waitcnt lgkmcnt(4)
v_mfma_f32_32x32x16_bf16 a[16:31], a[68:71], v[124:127], a[16:31]
s_waitcnt lgkmcnt(2)
v_mfma_f32_32x32x16_bf16 a[32:47], a[72:75], v[124:127], a[32:47]
s_waitcnt lgkmcnt(0)
v_mfma_f32_32x32x16_bf16 a[48:63], a[76:79], v[124:127], a[48:63]
s_waitcnt vmcnt(22)
s_barrier
s_lshl_b32 s82, s50, 2
s_add_u32 s82, s82, s51
s_lshl_b32 s82, s82, 2
s_add_u32 s82, s82, s52
s_lshl_b32 s82, s82, 2
s_add_u32 s82, s82, s5
s_lshl_b32 s82, s82, 13
s_add_u32 s82, s82, 0x2000000
s_add_u32 s83, s82, 0x1000
ds_read_b64_tr_b16 v[64:65], v20 offset:0
ds_read_b64_tr_b16 v[66:67], v20 offset:512
ds_read_b64_tr_b16 v[96:97], v21 offset:0
ds_read_b64_tr_b16 v[98:99], v21 offset:512
ds_read_b64_tr_b16 v[68:69], v20 offset:2048
ds_read_b64_tr_b16 v[70:71], v20 offset:2560
ds_read_b64_tr_b16 v[100:101], v21 offset:2048
ds_read_b64_tr_b16 v[102:103], v21 offset:2560
ds_read_b64_tr_b16 v[72:73], v20 offset:4096
ds_read_b64_tr_b16 v[74:75], v20 offset:4608
ds_read_b64_tr_b16 v[104:105], v21 offset:4096
ds_read_b64_tr_b16 v[106:107], v21 offset:4608
s_waitcnt lgkmcnt(10)
v_mfma_f32_32x32x16_bf16 v[208:223], v[64:67], a[112:115], 0
ds_read_b64_tr_b16 v[76:77], v20 offset:6144
ds_read_b64_tr_b16 v[78:79], v20 offset:6656
v_accvgpr_read_b32 v128, a0
v_accvgpr_read_b32 v129, a1
v_accvgpr_read_b32 v130, a2
s_waitcnt lgkmcnt(10)
v_mfma_f32_32x32x16_bf16 v[224:239], v[96:99], a[112:115], 0
ds_read_b64_tr_b16 v[108:109], v21 offset:6144
ds_read_b64_tr_b16 v[110:111], v21 offset:6656
v_accvgpr_read_b32 v131, a3
v_accvgpr_read_b32 v132, a4
v_accvgpr_read_b32 v133, a5
v_accvgpr_read_b32 v134, a6
s_waitcnt lgkmcnt(10)
v_mfma_f32_32x32x16_bf16 v[208:223], v[68:71], a[116:119], v[208:223]
ds_read_b64_tr_b16 v[80:81], v20 offset:8192
ds_read_b64_tr_b16 v[82:83], v20 offset:8704
v_accvgpr_read_b32 v135, a7
v_accvgpr_read_b32 v136, a8
v_accvgpr_read_b32 v137, a9
s_waitcnt lgkmcnt(10)
v_mfma_f32_32x32x16_bf16 v[224:239], v[100:103], a[116:119], v[224:239]
ds_read_b64_tr_b16 v[112:113], v21 offset:8192
ds_read_b64_tr_b16 v[114:115], v21 offset:8704
v_accvgpr_read_b32 v138, a10
v_accvgpr_read_b32 v139, a11
v_accvgpr_read_b32 v140, a12
v_accvgpr_read_b32 v141, a13
s_waitcnt vmcnt(21) lgkmcnt(10)
v_mfma_f32_32x32x16_bf16 v[208:223], v[72:75], a[120:123], v[208:223]
ds_read_b64_tr_b16 v[84:85], v20 offset:10240
ds_read_b64_tr_b16 v[86:87], v20 offset:10752
v_accvgpr_read_b32 v142, a14
v_accvgpr_read_b32 v143, a15
v_cvt_pk_bf16_f32 v128, v128, v129
s_waitcnt lgkmcnt(10)
v_mfma_f32_32x32x16_bf16 v[224:239], v[104:107], a[120:123], v[224:239]
ds_read_b64_tr_b16 v[116:117], v21 offset:10240
ds_read_b64_tr_b16 v[118:119], v21 offset:10752
v_cvt_pk_bf16_f32 v129, v130, v131
v_cvt_pk_bf16_f32 v130, v132, v133
v_cvt_pk_bf16_f32 v131, v134, v135
v_cvt_pk_bf16_f32 v132, v136, v137
s_waitcnt vmcnt(20) lgkmcnt(10)
v_mfma_f32_32x32x16_bf16 v[208:223], v[76:79], a[124:127], v[208:223]
ds_read_b64_tr_b16 v[88:89], v20 offset:12288
ds_read_b64_tr_b16 v[90:91], v20 offset:12800
v_cvt_pk_bf16_f32 v133, v138, v139
v_cvt_pk_bf16_f32 v134, v140, v141
v_cvt_pk_bf16_f32 v135, v142, v143
buffer_store_dwordx4 v[128:131], v15, s[28:31], s82 offen sc0 sc1
s_waitcnt lgkmcnt(10)
v_mfma_f32_32x32x16_bf16 v[224:239], v[108:111], a[124:127], v[224:239]
buffer_store_dwordx4 v[132:135], v15, s[28:31], s82 offen offset:1024 sc0 sc1
ds_read_b64_tr_b16 v[120:121], v21 offset:12288
ds_read_b64_tr_b16 v[122:123], v21 offset:12800
v_accvgpr_read_b32 v144, a16
v_accvgpr_read_b32 v145, a17
s_waitcnt vmcnt(21) lgkmcnt(10)
v_mfma_f32_32x32x16_bf16 v[208:223], v[80:83], a[128:131], v[208:223]
ds_read_b64_tr_b16 v[92:93], v20 offset:14336
ds_read_b64_tr_b16 v[94:95], v20 offset:14848
v_accvgpr_read_b32 v146, a18
v_accvgpr_read_b32 v147, a19
v_accvgpr_read_b32 v148, a20
s_waitcnt lgkmcnt(10)
v_mfma_f32_32x32x16_bf16 v[224:239], v[112:115], a[128:131], v[224:239]
ds_read_b64_tr_b16 v[124:125], v21 offset:14336
ds_read_b64_tr_b16 v[126:127], v21 offset:14848
v_accvgpr_read_b32 v149, a21
v_accvgpr_read_b32 v150, a22
v_accvgpr_read_b32 v151, a23
v_accvgpr_read_b32 v152, a24
s_waitcnt vmcnt(20) lgkmcnt(10)
v_mfma_f32_32x32x16_bf16 v[208:223], v[84:87], a[132:135], v[208:223]
ds_read_b64_tr_b16 v[64:65], v20 offset:16384
ds_read_b64_tr_b16 v[66:67], v20 offset:16896
v_accvgpr_read_b32 v153, a25
v_accvgpr_read_b32 v154, a26
v_accvgpr_read_b32 v155, a27
s_waitcnt lgkmcnt(10)
v_mfma_f32_32x32x16_bf16 v[224:239], v[116:119], a[132:135], v[224:239]
ds_read_b64_tr_b16 v[96:97], v21 offset:16384
ds_read_b64_tr_b16 v[98:99], v21 offset:16896
v_accvgpr_read_b32 v156, a28
v_accvgpr_read_b32 v157, a29
v_accvgpr_read_b32 v158, a30
v_accvgpr_read_b32 v159, a31
s_waitcnt vmcnt(19) lgkmcnt(10)
v_mfma_f32_32x32x16_bf16 v[208:223], v[88:91], a[136:139], v[208:223]
ds_read_b64_tr_b16 v[68:69], v20 offset:18432
ds_read_b64_tr_b16 v[70:71], v20 offset:18944
v_cvt_pk_bf16_f32 v144, v144, v145
v_cvt_pk_bf16_f32 v145, v146, v147
v_cvt_pk_bf16_f32 v146, v148, v149
s_waitcnt lgkmcnt(10)
v_mfma_f32_32x32x16_bf16 v[224:239], v[120:123], a[136:139], v[224:239]
ds_read_b64_tr_b16 v[100:101], v21 offset:18432
ds_read_b64_tr_b16 v[102:103], v21 offset:18944
v_cvt_pk_bf16_f32 v147, v150, v151
v_cvt_pk_bf16_f32 v148, v152, v153
v_cvt_pk_bf16_f32 v149, v154, v155
v_cvt_pk_bf16_f32 v150, v156, v157
s_waitcnt vmcnt(18) lgkmcnt(10)
v_mfma_f32_32x32x16_bf16 v[208:223], v[92:95], a[140:143], v[208:223]
ds_read_b64_tr_b16 v[72:73], v20 offset:20480
ds_read_b64_tr_b16 v[74:75], v20 offset:20992
v_cvt_pk_bf16_f32 v151, v158, v159
buffer_store_dwordx4 v[144:147], v15, s[28:31], s82 offen offset:2048 sc0 sc1
buffer_store_dwordx4 v[148:151], v15, s[28:31], s82 offen offset:3072 sc0 sc1
s_waitcnt lgkmcnt(10)
v_mfma_f32_32x32x16_bf16 v[224:239], v[124:127], a[140:143], v[224:239]
ds_read_b64_tr_b16 v[104:105], v21 offset:20480
ds_read_b64_tr_b16 v[106:107], v21 offset:20992
v_accvgpr_read_b32 v160, a32
v_accvgpr_read_b32 v161, a33
v_accvgpr_read_b32 v162, a34
v_accvgpr_read_b32 v163, a35
s_waitcnt vmcnt(19) lgkmcnt(10)
v_mfma_f32_32x32x16_bf16 v[208:223], v[64:67], a[144:147], v[208:223]
ds_read_b64_tr_b16 v[76:77], v20 offset:22528
ds_read_b64_tr_b16 v[78:79], v20 offset:23040
v_accvgpr_read_b32 v164, a36
v_accvgpr_read_b32 v165, a37
v_accvgpr_read_b32 v166, a38
s_waitcnt lgkmcnt(10)
v_mfma_f32_32x32x16_bf16 v[224:239], v[96:99], a[144:147], v[224:239]
ds_read_b64_tr_b16 v[108:109], v21 offset:22528
ds_read_b64_tr_b16 v[110:111], v21 offset:23040
v_accvgpr_read_b32 v167, a39
v_accvgpr_read_b32 v168, a40
v_accvgpr_read_b32 v169, a41
v_accvgpr_read_b32 v170, a42
s_waitcnt vmcnt(18) lgkmcnt(10)
v_mfma_f32_32x32x16_bf16 v[208:223], v[68:71], a[148:151], v[208:223]
ds_read_b64_tr_b16 v[80:81], v20 offset:24576
ds_read_b64_tr_b16 v[82:83], v20 offset:25088
v_accvgpr_read_b32 v171, a43
v_accvgpr_read_b32 v172, a44
v_accvgpr_read_b32 v173, a45
s_waitcnt lgkmcnt(10)
v_mfma_f32_32x32x16_bf16 v[224:239], v[100:103], a[148:151], v[224:239]
ds_read_b64_tr_b16 v[112:113], v21 offset:24576
ds_read_b64_tr_b16 v[114:115], v21 offset:25088
v_accvgpr_read_b32 v174, a46
v_accvgpr_read_b32 v175, a47
v_cvt_pk_bf16_f32 v160, v160, v161
v_cvt_pk_bf16_f32 v161, v162, v163
s_waitcnt vmcnt(17) lgkmcnt(10)
v_mfma_f32_32x32x16_bf16 v[208:223], v[72:75], a[152:155], v[208:223]
ds_read_b64_tr_b16 v[84:85], v20 offset:26624
ds_read_b64_tr_b16 v[86:87], v20 offset:27136
v_cvt_pk_bf16_f32 v162, v164, v165
v_cvt_pk_bf16_f32 v163, v166, v167
v_cvt_pk_bf16_f32 v164, v168, v169
v_cvt_pk_bf16_f32 v165, v170, v171
s_waitcnt lgkmcnt(10)
v_mfma_f32_32x32x16_bf16 v[224:239], v[104:107], a[152:155], v[224:239]
ds_read_b64_tr_b16 v[116:117], v21 offset:26624
ds_read_b64_tr_b16 v[118:119], v21 offset:27136
v_cvt_pk_bf16_f32 v166, v172, v173
v_cvt_pk_bf16_f32 v167, v174, v175
buffer_store_dwordx4 v[160:163], v15, s[28:31], s83 offen sc0 sc1
s_waitcnt vmcnt(17) lgkmcnt(10)
v_mfma_f32_32x32x16_bf16 v[208:223], v[76:79], a[156:159], v[208:223]
buffer_store_dwordx4 v[164:167], v15, s[28:31], s83 offen offset:1024 sc0 sc1
ds_read_b64_tr_b16 v[88:89], v20 offset:28672
ds_read_b64_tr_b16 v[90:91], v20 offset:29184
v_accvgpr_read_b32 v176, a48
v_accvgpr_read_b32 v177, a49
s_waitcnt lgkmcnt(10)
v_mfma_f32_32x32x16_bf16 v[224:239], v[108:111], a[156:159], v[224:239]
ds_read_b64_tr_b16 v[120:121], v21 offset:28672
ds_read_b64_tr_b16 v[122:123], v21 offset:29184
v_accvgpr_read_b32 v178, a50
v_accvgpr_read_b32 v179, a51
v_accvgpr_read_b32 v180, a52
v_accvgpr_read_b32 v181, a53
s_waitcnt vmcnt(17) lgkmcnt(10)
v_mfma_f32_32x32x16_bf16 v[208:223], v[80:83], a[160:163], v[208:223]
ds_read_b64_tr_b16 v[92:93], v20 offset:30720
ds_read_b64_tr_b16 v[94:95], v20 offset:31232
v_accvgpr_read_b32 v182, a54
v_accvgpr_read_b32 v183, a55
v_accvgpr_read_b32 v184, a56
s_waitcnt lgkmcnt(10)
v_mfma_f32_32x32x16_bf16 v[224:239], v[112:115], a[160:163], v[224:239]
ds_read_b64_tr_b16 v[124:125], v21 offset:30720
ds_read_b64_tr_b16 v[126:127], v21 offset:31232
v_accvgpr_read_b32 v185, a57
v_accvgpr_read_b32 v186, a58
v_accvgpr_read_b32 v187, a59
v_accvgpr_read_b32 v188, a60
s_waitcnt vmcnt(16) lgkmcnt(10)
v_mfma_f32_32x32x16_bf16 v[208:223], v[84:87], a[164:167], v[208:223]
ds_read_b64_tr_b16 v[64:65], v20 offset:32768
ds_read_b64_tr_b16 v[66:67], v20 offset:33280
v_accvgpr_read_b32 v189, a61
v_accvgpr_read_b32 v190, a62
v_accvgpr_read_b32 v191, a63
s_waitcnt lgkmcnt(10)
v_mfma_f32_32x32x16_bf16 v[224:239], v[116:119], a[164:167], v[224:239]
ds_read_b64_tr_b16 v[96:97], v21 offset:32768
ds_read_b64_tr_b16 v[98:99], v21 offset:33280
v_cvt_pk_bf16_f32 v176, v176, v177
v_cvt_pk_bf16_f32 v177, v178, v179
v_cvt_pk_bf16_f32 v178, v180, v181
v_cvt_pk_bf16_f32 v179, v182, v183
s_waitcnt vmcnt(15) lgkmcnt(10)
v_mfma_f32_32x32x16_bf16 v[208:223], v[88:91], a[168:171], v[208:223]
ds_read_b64_tr_b16 v[68:69], v20 offset:34816
ds_read_b64_tr_b16 v[70:71], v20 offset:35328
v_cvt_pk_bf16_f32 v180, v184, v185
v_cvt_pk_bf16_f32 v181, v186, v187
v_cvt_pk_bf16_f32 v182, v188, v189
v_cvt_pk_bf16_f32 v183, v190, v191
s_waitcnt lgkmcnt(10)
v_mfma_f32_32x32x16_bf16 v[224:239], v[120:123], a[168:171], v[224:239]
buffer_store_dwordx4 v[176:179], v15, s[28:31], s83 offen offset:2048 sc0 sc1
ds_read_b64_tr_b16 v[100:101], v21 offset:34816
ds_read_b64_tr_b16 v[102:103], v21 offset:35328
buffer_store_dwordx4 v[180:183], v15, s[28:31], s83 offen offset:3072 sc0 sc1
s_waitcnt vmcnt(16) lgkmcnt(10)
v_mfma_f32_32x32x16_bf16 v[208:223], v[92:95], a[172:175], v[208:223]
ds_read_b64_tr_b16 v[72:73], v20 offset:36864
ds_read_b64_tr_b16 v[74:75], v20 offset:37376
s_waitcnt lgkmcnt(10)
v_mfma_f32_32x32x16_bf16 v[224:239], v[124:127], a[172:175], v[224:239]
ds_read_b64_tr_b16 v[104:105], v21 offset:36864
ds_read_b64_tr_b16 v[106:107], v21 offset:37376
s_waitcnt vmcnt(15) lgkmcnt(10)
v_mfma_f32_32x32x16_bf16 v[208:223], v[64:67], a[176:179], v[208:223]
ds_read_b64_tr_b16 v[76:77], v20 offset:38912
ds_read_b64_tr_b16 v[78:79], v20 offset:39424
s_waitcnt lgkmcnt(10)
v_mfma_f32_32x32x16_bf16 v[224:239], v[96:99], a[176:179], v[224:239]
ds_read_b64_tr_b16 v[108:109], v21 offset:38912
ds_read_b64_tr_b16 v[110:111], v21 offset:39424
s_waitcnt vmcnt(14) lgkmcnt(10)
v_mfma_f32_32x32x16_bf16 v[208:223], v[68:71], a[180:183], v[208:223]
ds_read_b64_tr_b16 v[80:81], v20 offset:40960
ds_read_b64_tr_b16 v[82:83], v20 offset:41472
s_waitcnt lgkmcnt(10)
v_mfma_f32_32x32x16_bf16 v[224:239], v[100:103], a[180:183], v[224:239]
ds_read_b64_tr_b16 v[112:113], v21 offset:40960
ds_read_b64_tr_b16 v[114:115], v21 offset:41472
s_waitcnt vmcnt(13) lgkmcnt(10)
v_mfma_f32_32x32x16_bf16 v[208:223], v[72:75], a[184:187], v[208:223]
ds_read_b64_tr_b16 v[84:85], v20 offset:43008
ds_read_b64_tr_b16 v[86:87], v20 offset:43520
s_waitcnt lgkmcnt(10)
v_mfma_f32_32x32x16_bf16 v[224:239], v[104:107], a[184:187], v[224:239]
ds_read_b64_tr_b16 v[116:117], v21 offset:43008
ds_read_b64_tr_b16 v[118:119], v21 offset:43520
s_waitcnt vmcnt(12) lgkmcnt(10)
v_mfma_f32_32x32x16_bf16 v[208:223], v[76:79], a[188:191], v[208:223]
s_waitcnt lgkmcnt(8)
v_mfma_f32_32x32x16_bf16 v[224:239], v[108:111], a[188:191], v[224:239]
s_waitcnt vmcnt(11) lgkmcnt(6)
v_mfma_f32_32x32x16_bf16 v[208:223], v[80:83], a[192:195], v[208:223]
s_waitcnt lgkmcnt(4)
v_mfma_f32_32x32x16_bf16 v[224:239], v[112:115], a[192:195], v[224:239]
s_waitcnt vmcnt(10) lgkmcnt(2)
v_mfma_f32_32x32x16_bf16 v[208:223], v[84:87], a[196:199], v[208:223]
s_waitcnt lgkmcnt(0)
v_mfma_f32_32x32x16_bf16 v[224:239], v[116:119], a[196:199], v[224:239]
s_waitcnt vmcnt(0)
s_lshl_b32 s82, s50, 2
s_add_u32 s82, s82, s51
s_lshl_b32 s82, s82, 2
s_add_u32 s82, s82, s5
s_lshl_b32 s82, s82, 2
s_add_u32 s82, s82, s52
s_lshl_b32 s82, s82, 2
s_add_u32 s82, s82, 0x3008000
v_mov_b32 v2, s32
v_mov_b32 v3, 0
s_mov_b64 exec, 1
buffer_store_dword v2, v3, s[28:31], s82 offen sc0 sc1
s_mov_b64 exec, -1
s_lshl_b32 s82, s5, 13
s_add_u32 s82, s82, 0x18000
v_lshlrev_b32 v2, 4, v1
v_add_u32 v3, s82, v2
ds_write_b128 v3, v[208:211] offset:0
ds_write_b128 v3, v[212:215] offset:1024
ds_write_b128 v3, v[216:219] offset:2048
ds_write_b128 v3, v[220:223] offset:3072
ds_write_b128 v3, v[224:227] offset:4096
ds_write_b128 v3, v[228:231] offset:5120
ds_write_b128 v3, v[232:235] offset:6144
ds_write_b128 v3, v[236:239] offset:7168
s_waitcnt lgkmcnt(0)
s_barrier
s_and_b32 s83, s5, 1
s_lshl_b32 s83, s83, 12
s_lshl_b32 s82, s5, 13
s_add_u32 s82, s82, s83
s_add_u32 s82, s82, 0x18000
v_add_u32 v3, s82, v2
s_xor_b32 s84, s5, 1
s_lshl_b32 s84, s84, 13
s_add_u32 s84, s84, s83
s_add_u32 s84, s84, 0x18000
v_add_u32 v4, s84, v2
ds_read_b128 v[64:67], v3
ds_read_b128 v[80:83], v4
ds_read_b128 v[68:71], v3 offset:1024
ds_read_b128 v[84:87], v4 offset:1024
ds_read_b128 v[72:75], v3 offset:2048
ds_read_b128 v[88:91], v4 offset:2048
ds_read_b128 v[76:79], v3 offset:3072
ds_read_b128 v[92:95], v4 offset:3072
s_waitcnt lgkmcnt(6)
v_pk_add_f32 v[64:65], v[64:65], v[80:81]
v_pk_add_f32 v[66:67], v[66:67], v[82:83]
s_waitcnt lgkmcnt(4)
v_pk_add_f32 v[68:69], v[68:69], v[84:85]
v_pk_add_f32 v[70:71], v[70:71], v[86:87]
s_waitcnt lgkmcnt(2)
v_pk_add_f32 v[72:73], v[72:73], v[88:89]
v_pk_add_f32 v[74:75], v[74:75], v[90:91]
s_waitcnt lgkmcnt(0)
v_pk_add_f32 v[76:77], v[76:77], v[92:93]
v_pk_add_f32 v[78:79], v[78:79], v[94:95]
s_mov_b32 s98, 0xbfb8aa3b
s_mov_b32 s100, 1.0
v_pk_mul_f32 v[80:81], v[64:65], s[98:99] op_sel_hi:[1,0]
v_pk_mul_f32 v[82:83], v[66:67], s[98:99] op_sel_hi:[1,0]
v_pk_mul_f32 v[84:85], v[68:69], s[98:99] op_sel_hi:[1,0]
v_pk_mul_f32 v[86:87], v[70:71], s[98:99] op_sel_hi:[1,0]
v_pk_mul_f32 v[88:89], v[72:73], s[98:99] op_sel_hi:[1,0]
v_pk_mul_f32 v[90:91], v[74:75], s[98:99] op_sel_hi:[1,0]
v_pk_mul_f32 v[92:93], v[76:77], s[98:99] op_sel_hi:[1,0]
v_pk_mul_f32 v[94:95], v[78:79], s[98:99] op_sel_hi:[1,0]
v_exp_f32 v80, v80
v_exp_f32 v81, v81
v_exp_f32 v82, v82
v_exp_f32 v83, v83
v_exp_f32 v84, v84
v_exp_f32 v85, v85
v_exp_f32 v86, v86
v_exp_f32 v87, v87
v_exp_f32 v88, v88
v_exp_f32 v89, v89
v_exp_f32 v90, v90
v_exp_f32 v91, v91
v_exp_f32 v92, v92
v_exp_f32 v93, v93
v_exp_f32 v94, v94
v_exp_f32 v95, v95
v_pk_add_f32 v[80:81], v[80:81], s[100:101] op_sel_hi:[1,0]
v_pk_add_f32 v[82:83], v[82:83], s[100:101] op_sel_hi:[1,0]
v_pk_add_f32 v[84:85], v[84:85], s[100:101] op_sel_hi:[1,0]
v_pk_add_f32 v[86:87], v[86:87], s[100:101] op_sel_hi:[1,0]
v_pk_add_f32 v[88:89], v[88:89], s[100:101] op_sel_hi:[1,0]
v_pk_add_f32 v[90:91], v[90:91], s[100:101] op_sel_hi:[1,0]
v_pk_add_f32 v[92:93], v[92:93], s[100:101] op_sel_hi:[1,0]
v_pk_add_f32 v[94:95], v[94:95], s[100:101] op_sel_hi:[1,0]
v_rcp_f32 v80, v80
v_rcp_f32 v81, v81
v_rcp_f32 v82, v82
v_rcp_f32 v83, v83
v_rcp_f32 v84, v84
v_rcp_f32 v85, v85
v_rcp_f32 v86, v86
v_rcp_f32 v87, v87
v_rcp_f32 v88, v88
v_rcp_f32 v89, v89
v_rcp_f32 v90, v90
v_rcp_f32 v91, v91
v_rcp_f32 v92, v92
v_rcp_f32 v93, v93
v_rcp_f32 v94, v94
v_rcp_f32 v95, v95
v_pk_mul_f32 v[80:81], v[80:81], v[64:65]
v_pk_mul_f32 v[82:83], v[82:83], v[66:67]
v_pk_mul_f32 v[84:85], v[84:85], v[68:69]
v_pk_mul_f32 v[86:87], v[86:87], v[70:71]
v_pk_mul_f32 v[88:89], v[88:89], v[72:73]
v_pk_mul_f32 v[90:91], v[90:91], v[74:75]
v_pk_mul_f32 v[92:93], v[92:93], v[76:77]
v_pk_mul_f32 v[94:95], v[94:95], v[78:79]
s_mov_b32 s91, 0
L_poll_17:
buffer_load_dword v24, v25, s[28:31], s47 offen sc0 sc1
s_waitcnt vmcnt(0)
v_xor_b32 v6, s32, v24
v_cmp_eq_u32 vcc, 0, v6
s_cmp_eq_u64 vcc, exec
s_cbranch_scc1 L_polld_18
s_add_u32 s91, s91, 1
s_cmp_lt_u32 s91, 0x4e20
s_cbranch_scc0 L_polld_18_to
s_sleep 2
s_branch L_poll_17
L_polld_18_to:
s_or_b32 s67, s67, 0x80
L_polld_18:
s_lshl_b32 s82, s50, 2
s_add_u32 s82, s82, s51
s_lshl_b32 s82, s82, 2
s_add_u32 s82, s82, 0
s_lshl_b32 s82, s82, 2
s_add_u32 s82, s82, s42
s_lshl_b32 s82, s82, 2
s_add_u32 s82, s82, s41
s_lshl_b32 s82, s82, 11
s_add_u32 s82, s82, 0x2000000
buffer_load_dwordx4 v[128:131], v15, s[28:31], s82 offen sc1
buffer_load_dwordx4 v[132:135], v15, s[28:31], s82 offen offset:1024 sc1
s_lshl_b32 s82, s50, 2
s_add_u32 s82, s82, s51
s_lshl_b32 s82, s82, 2
s_add_u32 s82, s82, 1
s_lshl_b32 s82, s82, 2
s_add_u32 s82, s82, s42
s_lshl_b32 s82, s82, 2
s_add_u32 s82, s82, s41
s_lshl_b32 s82, s82, 11
s_add_u32 s82, s82, 0x2000000
buffer_load_dwordx4 v[136:139], v15, s[28:31], s82 offen sc1
buffer_load_dwordx4 v[140:143], v15, s[28:31], s82 offen offset:1024 sc1
s_lshl_b32 s82, s50, 2
s_add_u32 s82, s82, s51
s_lshl_b32 s82, s82, 2
s_add_u32 s82, s82, 2
s_lshl_b32 s82, s82, 2
s_add_u32 s82, s82, s42
s_lshl_b32 s82, s82, 2
s_add_u32 s82, s82, s41
s_lshl_b32 s82, s82, 11
s_add_u32 s82, s82, 0x2000000
buffer_load_dwordx4 v[144:147], v15, s[28:31], s82 offen sc1
buffer_load_dwordx4 v[148:151], v15, s[28:31], s82 offen offset:1024 sc1
s_lshl_b32 s82, s50, 2
s_add_u32 s82, s82, s51
s_lshl_b32 s82, s82, 2
s_add_u32 s82, s82, 3
s_lshl_b32 s82, s82, 2
s_add_u32 s82, s82, s42
s_lshl_b32 s82, s82, 2
s_add_u32 s82, s82, s41
s_lshl_b32 s82, s82, 11
s_add_u32 s82, s82, 0x2000000
buffer_load_dwordx4 v[152:155], v15, s[28:31], s82 offen sc1
buffer_load_dwordx4 v[156:159], v15, s[28:31], s82 offen offset:1024 sc1
v_mov_b32 v160, 0xffff0000
s_waitcnt vmcnt(7)
v_lshlrev_b32 v96, 16, v128
v_and_b32 v97, v160, v128
v_lshlrev_b32 v98, 16, v129
v_and_b32 v99, v160, v129
v_lshlrev_b32 v100, 16, v130
v_and_b32 v101, v160, v130
v_lshlrev_b32 v102, 16, v131
v_and_b32 v103, v160, v131
s_waitcnt vmcnt(6)
v_lshlrev_b32 v104, 16, v132
v_and_b32 v105, v160, v132
v_lshlrev_b32 v106, 16, v133
v_and_b32 v107, v160, v133
v_lshlrev_b32 v108, 16, v134
v_and_b32 v109, v160, v134
v_lshlrev_b32 v110, 16, v135
v_and_b32 v111, v160, v135
s_waitcnt vmcnt(5)
v_lshlrev_b32 v162, 16, v136
v_and_b32 v163, v160, v136
v_pk_add_f32 v[96:97], v[96:97], v[162:163]
v_lshlrev_b32 v164, 16, v137
v_and_b32 v165, v160, v137
v_pk_add_f32 v[98:99], v[98:99], v[164:165]
v_lshlrev_b32 v166, 16, v138
v_and_b32 v167, v160, v138
v_pk_add_f32 v[100:101], v[100:101], v[166:167]
v_lshlrev_b32 v168, 16, v139
v_and_b32 v169, v160, v139
v_pk_add_f32 v[102:103], v[102:103], v[168:169]
s_waitcnt vmcnt(4)
v_lshlrev_b32 v162, 16, v140
v_and_b32 v163, v160, v140
v_pk_add_f32 v[104:105], v[104:105], v[162:163]
v_lshlrev_b32 v164, 16, v141
v_and_b32 v165, v160, v141
v_pk_add_f32 v[106:107], v[106:107], v[164:165]
v_lshlrev_b32 v166, 16, v142
v_and_b32 v167, v160, v142
v_pk_add_f32 v[108:109], v[108:109], v[166:167]
v_lshlrev_b32 v168, 16, v143
v_and_b32 v169, v160, v143
v_pk_add_f32 v[110:111], v[110:111], v[168:169]
s_waitcnt vmcnt(3)
v_lshlrev_b32 v162, 16, v144
v_and_b32 v163, v160, v144
v_pk_add_f32 v[96:97], v[96:97], v[162:163]
v_lshlrev_b32 v164, 16, v145
v_and_b32 v165, v160, v145
v_pk_add_f32 v[98:99], v[98:99], v[164:165]
v_lshlrev_b32 v166, 16, v146
v_and_b32 v167, v160, v146
v_pk_add_f32 v[100:101], v[100:101], v[166:167]
v_lshlrev_b32 v168, 16, v147
v_and_b32 v169, v160, v147
v_pk_add_f32 v[102:103], v[102:103], v[168:169]
s_waitcnt vmcnt(2)
v_lshlrev_b32 v162, 16, v148
v_and_b32 v163, v160, v148
v_pk_add_f32 v[104:105], v[104:105], v[162:163]
v_lshlrev_b32 v164, 16, v149
v_and_b32 v165, v160, v149
v_pk_add_f32 v[106:107], v[106:107], v[164:165]
v_lshlrev_b32 v166, 16, v150
v_and_b32 v167, v160, v150
v_pk_add_f32 v[108:109], v[108:109], v[166:167]
v_lshlrev_b32 v168, 16, v151
v_and_b32 v169, v160, v151
v_pk_add_f32 v[110:111], v[110:111], v[168:169]
s_waitcnt vmcnt(1)
v_lshlrev_b32 v162, 16, v152
v_and_b32 v163, v160, v152
v_pk_add_f32 v[96:97], v[96:97], v[162:163]
v_lshlrev_b32 v164, 16, v153
v_and_b32 v165, v160, v153
v_pk_add_f32 v[98:99], v[98:99], v[164:165]
v_lshlrev_b32 v166, 16, v154
v_and_b32 v167, v160, v154
v_pk_add_f32 v[100:101], v[100:101], v[166:167]
v_lshlrev_b32 v168, 16, v155
v_and_b32 v169, v160, v155
v_pk_add_f32 v[102:103], v[102:103], v[168:169]
s_waitcnt vmcnt(0)
v_lshlrev_b32 v162, 16, v156
v_and_b32 v163, v160, v156
v_pk_add_f32 v[104:105], v[104:105], v[162:163]
v_lshlrev_b32 v164, 16, v157
v_and_b32 v165, v160, v157
v_pk_add_f32 v[106:107], v[106:107], v[164:165]
v_lshlrev_b32 v166, 16, v158
v_and_b32 v167, v160, v158
v_pk_add_f32 v[108:109], v[108:109], v[166:167]
v_lshlrev_b32 v168, 16, v159
v_and_b32 v169, v160, v159
v_pk_add_f32 v[110:111], v[110:111], v[168:169]
v_lshlrev_b32 v2, 16, v40
v_and_b32 v3, 0xffff0000, v40
v_fmac_f32 v2, v96, v80
v_fmac_f32 v3, v97, v81
v_cvt_pk_bf16_f32 v40, v2, v3
v_lshlrev_b32 v2, 16, v41
v_and_b32 v3, 0xffff0000, v41
v_fmac_f32 v2, v98, v82
v_fmac_f32 v3, v99, v83
v_cvt_pk_bf16_f32 v41, v2, v3
v_lshlrev_b32 v2, 16, v42
v_and_b32 v3, 0xffff0000, v42
v_fmac_f32 v2, v100, v84
v_fmac_f32 v3, v101, v85
v_cvt_pk_bf16_f32 v42, v2, v3
v_lshlrev_b32 v2, 16, v43
v_and_b32 v3, 0xffff0000, v43
v_fmac_f32 v2, v102, v86
v_fmac_f32 v3, v103, v87
v_cvt_pk_bf16_f32 v43, v2, v3
buffer_store_dwordx4 v[40:43], v19, s[20:23], s44 offen
v_lshlrev_b32 v2, 16, v44
v_and_b32 v3, 0xffff0000, v44
v_fmac_f32 v2, v104, v88
v_fmac_f32 v3, v105, v89
v_cvt_pk_bf16_f32 v44, v2, v3
v_lshlrev_b32 v2, 16, v45
v_and_b32 v3, 0xffff0000, v45
v_fmac_f32 v2, v106, v90
v_fmac_f32 v3, v107, v91
v_cvt_pk_bf16_f32 v45, v2, v3
v_lshlrev_b32 v2, 16, v46
v_and_b32 v3, 0xffff0000, v46
v_fmac_f32 v2, v108, v92
v_fmac_f32 v3, v109, v93
v_cvt_pk_bf16_f32 v46, v2, v3
v_lshlrev_b32 v2, 16, v47
v_and_b32 v3, 0xffff0000, v47
v_fmac_f32 v2, v110, v94
v_fmac_f32 v3, v111, v95
v_cvt_pk_bf16_f32 v47, v2, v3
buffer_store_dwordx4 v[44:47], v19, s[20:23], s44 offen offset:32
s_cmp_eq_u32 s67, 0
s_cbranch_scc1 L_end
v_mov_b32 v2, s67
v_mov_b32 v3, 4
global_atomic_or v3, v2, s[78:79]
L_end:
L_done:
s_endpgm
L_slow_3:
s_mov_b32 s91, 0
v_mov_b32 v3, 0
L_nw_19:
global_load_dword v2, v3, s[78:79] sc0 sc1
s_waitcnt vmcnt(0)
v_readfirstlane_b32 s32, v2
s_cmp_lg_u32 s32, 0
s_cbranch_scc1 L_nw_19_d
s_add_u32 s91, s91, 1
s_cmp_lt_u32 s91, 0x4e20
s_cbranch_scc0 L_nw_19_to
s_sleep 2
s_branch L_nw_19
L_nw_19_to:
s_or_b32 s67, s67, 1
s_mov_b32 s32, 1
L_nw_19_d:
s_waitcnt lgkmcnt(0)
s_branch L_slow_3_r
L_slow_7:
s_mov_b32 s91, 0
v_mov_b32 v3, 0
L_nw_20:
global_load_dword v2, v3, s[78:79] sc0 sc1
s_waitcnt vmcnt(0)
v_readfirstlane_b32 s32, v2
s_cmp_lg_u32 s32, 0
s_cbranch_scc1 L_nw_20_d
s_add_u32 s91, s91, 1
s_cmp_lt_u32 s91, 0x4e20
s_cbranch_scc0 L_nw_20_to
s_sleep 2
s_branch L_nw_20
L_nw_20_to:
s_or_b32 s67, s67, 1
s_mov_b32 s32, 1
L_nw_20_d:
s_waitcnt lgkmcnt(0)
s_branch L_slow_7_r
L_slow_11:
s_mov_b32 s91, 0
L_poll_21:
buffer_load_dword v22, v37, s[28:31], s55 offen sc0 sc1
s_waitcnt vmcnt(0)
v_xor_b32 v4, s32, v22
v_cmp_eq_u32 vcc, 0, v4
s_cmp_eq_u64 vcc, exec
s_cbranch_scc1 L_polld_22
s_add_u32 s91, s91, 1
s_cmp_lt_u32 s91, 0x4e20
s_cbranch_scc0 L_polld_22_to
s_sleep 2
s_branch L_poll_21
L_polld_22_to:
s_or_b32 s67, s67, 4
L_polld_22:
s_waitcnt lgkmcnt(0)
s_branch L_slow_11_r
L_slow_12:
s_mov_b32 s91, 0
L_poll_23:
buffer_load_dword v32, v36, s[28:31], s49 offen sc0 sc1
s_waitcnt vmcnt(0)
v_xor_b32 v5, s32, v32
v_cmp_eq_u32 vcc, 0, v5
s_cmp_eq_u64 vcc, exec
s_cbranch_scc1 L_polld_24
s_add_u32 s91, s91, 1
s_cmp_lt_u32 s91, 0x4e20
s_cbranch_scc0 L_polld_24_to
s_sleep 2
s_branch L_poll_23
L_polld_24_to:
s_or_b32 s67, s67, 8
L_polld_24:
s_waitcnt lgkmcnt(0)
s_branch L_slow_12_r
L_slow_13:
s_waitcnt vmcnt(0) lgkmcnt(0)
s_barrier
v_mov_b32 v2, 0xff61b1e6
v_mov_b32 v3, 0xff61b1e6
s_mov_b32 s88, 0
s_mov_b32 s94, 0
L_redoA_25:
s_add_u32 m0, s90, 0x1c000
s_nop 0
buffer_load_dwordx4 v33, s[20:23], s88 offen lds
buffer_load_dwordx4 v34, s[20:23], s88 offen offset:1024 lds
s_add_u32 s88, s88, 0x2000
s_waitcnt vmcnt(0)
s_barrier
ds_read_b128 a[192:195], v10
ds_read_b128 a[196:199], v11
ds_read_b128 a[200:203], v12
ds_read_b128 a[204:207], v13
ds_read_b128 a[208:211], v14
ds_read_b128 a[212:215], v15
ds_read_b128 a[216:219], v16
ds_read_b128 a[220:223], v17
s_waitcnt lgkmcnt(0)
v_mfma_f32_32x32x16_bf16 v[64:79], a[192:195], v[128:131], 0
v_mfma_f32_32x32x16_bf16 v[64:79], a[196:199], v[132:135], v[64:79]
v_mfma_f32_32x32x16_bf16 v[64:79], a[200:203], v[144:147], v[64:79]
v_mfma_f32_32x32x16_bf16 v[64:79], a[204:207], v[148:151], v[64:79]
v_mfma_f32_32x32x16_bf16 v[64:79], a[208:211], v[160:163], v[64:79]
v_mfma_f32_32x32x16_bf16 v[64:79], a[212:215], v[164:167], v[64:79]
v_mfma_f32_32x32x16_bf16 v[64:79], a[216:219], v[176:179], v[64:79]
v_mfma_f32_32x32x16_bf16 v[64:79], a[220:223], v[180:183], v[64:79]
v_mfma_f32_32x32x16_bf16 v[80:95], a[192:195], v[136:139], 0
v_mfma_f32_32x32x16_bf16 v[80:95], a[196:199], v[140:143], v[80:95]
v_mfma_f32_32x32x16_bf16 v[80:95], a[200:203], v[152:155], v[80:95]
v_mfma_f32_32x32x16_bf16 v[80:95], a[204:207], v[156:159], v[80:95]
v_mfma_f32_32x32x16_bf16 v[80:95], a[208:211], v[168:171], v[80:95]
v_mfma_f32_32x32x16_bf16 v[80:95], a[212:215], v[172:175], v[80:95]
v_mfma_f32_32x32x16_bf16 v[80:95], a[216:219], v[184:187], v[80:95]
v_mfma_f32_32x32x16_bf16 v[80:95], a[220:223], v[188:191], v[80:95]
s_nop 3
v_max3_f32 v2, v2, v64, v65
v_max3_f32 v2, v2, v66, v67
v_max3_f32 v2, v2, v68, v69
v_max3_f32 v2, v2, v70, v71
v_max3_f32 v2, v2, v72, v73
v_max3_f32 v2, v2, v74, v75
v_max3_f32 v2, v2, v76, v77
v_max3_f32 v2, v2, v78, v79
v_max3_f32 v3, v3, v80, v81
v_max3_f32 v3, v3, v82, v83
v_max3_f32 v3, v3, v84, v85
v_max3_f32 v3, v3, v86, v87
v_max3_f32 v3, v3, v88, v89
v_max3_f32 v3, v3, v90, v91
v_max3_f32 v3, v3, v92, v93
v_max3_f32 v3, v3, v94, v95
s_barrier
s_add_u32 s94, s94, 1
s_cmp_lt_u32 s94, 16
s_cbranch_scc1 L_redoA_25
v_mov_b32 v4, v2
v_mov_b32 v5, v3
s_nop 0
v_permlane32_swap_b32 v2, v4
v_permlane32_swap_b32 v3, v5
v_max_f32 v2, v2, v4
v_sub_f32 v2, 0, v2
v_max_f32 v3, v3, v5
v_sub_f32 v3, 0, v3
v_mov_b32 v192, v2
v_mov_b32 v193, v2
v_mov_b32 v194, v2
v_mov_b32 v195, v2
v_mov_b32 v196, v2
v_mov_b32 v197, v2
v_mov_b32 v198, v2
v_mov_b32 v199, v2
v_mov_b32 v200, v2
v_mov_b32 v201, v2
v_mov_b32 v202, v2
v_mov_b32 v203, v2
v_mov_b32 v204, v2
v_mov_b32 v205, v2
v_mov_b32 v206, v2
v_mov_b32 v207, v2
v_mov_b32 v224, 0
v_mov_b32 v225, 0
v_mov_b32 v208, v3
v_mov_b32 v209, v3
v_mov_b32 v210, v3
v_mov_b32 v211, v3
v_mov_b32 v212, v3
v_mov_b32 v213, v3
v_mov_b32 v214, v3
v_mov_b32 v215, v3
v_mov_b32 v216, v3
v_mov_b32 v217, v3
v_mov_b32 v218, v3
v_mov_b32 v219, v3
v_mov_b32 v220, v3
v_mov_b32 v221, v3
v_mov_b32 v222, v3
v_mov_b32 v223, v3
v_mov_b32 v226, 0
v_mov_b32 v227, 0
v_accvgpr_write_b32 a0, 0
v_accvgpr_write_b32 a1, 0
v_accvgpr_write_b32 a2, 0
v_accvgpr_write_b32 a3, 0
v_accvgpr_write_b32 a4, 0
v_accvgpr_write_b32 a5, 0
v_accvgpr_write_b32 a6, 0
v_accvgpr_write_b32 a7, 0
v_accvgpr_write_b32 a8, 0
v_accvgpr_write_b32 a9, 0
v_accvgpr_write_b32 a10, 0
v_accvgpr_write_b32 a11, 0
v_accvgpr_write_b32 a12, 0
v_accvgpr_write_b32 a13, 0
v_accvgpr_write_b32 a14, 0
v_accvgpr_write_b32 a15, 0
v_accvgpr_write_b32 a16, 0
v_accvgpr_write_b32 a17, 0
v_accvgpr_write_b32 a18, 0
v_accvgpr_write_b32 a19, 0
v_accvgpr_write_b32 a20, 0
v_accvgpr_write_b32 a21, 0
v_accvgpr_write_b32 a22, 0
v_accvgpr_write_b32 a23, 0
v_accvgpr_write_b32 a24, 0
v_accvgpr_write_b32 a25, 0
v_accvgpr_write_b32 a26, 0
v_accvgpr_write_b32 a27, 0
v_accvgpr_write_b32 a28, 0
v_accvgpr_write_b32 a29, 0
v_accvgpr_write_b32 a30, 0
v_accvgpr_write_b32 a31, 0
v_accvgpr_write_b32 a32, 0
v_accvgpr_write_b32 a33, 0
v_accvgpr_write_b32 a34, 0
v_accvgpr_write_b32 a35, 0
v_accvgpr_write_b32 a36, 0
v_accvgpr_write_b32 a37, 0
v_accvgpr_write_b32 a38, 0
v_accvgpr_write_b32 a39, 0
v_accvgpr_write_b32 a40, 0
v_accvgpr_write_b32 a41, 0
v_accvgpr_write_b32 a42, 0
v_accvgpr_write_b32 a43, 0
v_accvgpr_write_b32 a44, 0
v_accvgpr_write_b32 a45, 0
v_accvgpr_write_b32 a46, 0
v_accvgpr_write_b32 a47, 0
v_accvgpr_write_b32 a48, 0
v_accvgpr_write_b32 a49, 0
v_accvgpr_write_b32 a50, 0
v_accvgpr_write_b32 a51, 0
v_accvgpr_write_b32 a52, 0
v_accvgpr_write_b32 a53, 0
v_accvgpr_write_b32 a54, 0
v_accvgpr_write_b32 a55, 0
v_accvgpr_write_b32 a56, 0
v_accvgpr_write_b32 a57, 0
v_accvgpr_write_b32 a58, 0
v_accvgpr_write_b32 a59, 0
v_accvgpr_write_b32 a60, 0
v_accvgpr_write_b32 a61, 0
v_accvgpr_write_b32 a62, 0
v_accvgpr_write_b32 a63, 0
v_accvgpr_write_b32 a64, 0
v_accvgpr_write_b32 a65, 0
v_accvgpr_write_b32 a66, 0
v_accvgpr_write_b32 a67, 0
v_accvgpr_write_b32 a68, 0
v_accvgpr_write_b32 a69, 0
v_accvgpr_write_b32 a70, 0
v_accvgpr_write_b32 a71, 0
v_accvgpr_write_b32 a72, 0
v_accvgpr_write_b32 a73, 0
v_accvgpr_write_b32 a74, 0
v_accvgpr_write_b32 a75, 0
v_accvgpr_write_b32 a76, 0
v_accvgpr_write_b32 a77, 0
v_accvgpr_write_b32 a78, 0
v_accvgpr_write_b32 a79, 0
v_accvgpr_write_b32 a80, 0
v_accvgpr_write_b32 a81, 0
v_accvgpr_write_b32 a82, 0
v_accvgpr_write_b32 a83, 0
v_accvgpr_write_b32 a84, 0
v_accvgpr_write_b32 a85, 0
v_accvgpr_write_b32 a86, 0
v_accvgpr_write_b32 a87, 0
v_accvgpr_write_b32 a88, 0
v_accvgpr_write_b32 a89, 0
v_accvgpr_write_b32 a90, 0
v_accvgpr_write_b32 a91, 0
v_accvgpr_write_b32 a92, 0
v_accvgpr_write_b32 a93, 0
v_accvgpr_write_b32 a94, 0
v_accvgpr_write_b32 a95, 0
v_accvgpr_write_b32 a96, 0
v_accvgpr_write_b32 a97, 0
v_accvgpr_write_b32 a98, 0
v_accvgpr_write_b32 a99, 0
v_accvgpr_write_b32 a100, 0
v_accvgpr_write_b32 a101, 0
v_accvgpr_write_b32 a102, 0
v_accvgpr_write_b32 a103, 0
v_accvgpr_write_b32 a104, 0
v_accvgpr_write_b32 a105, 0
v_accvgpr_write_b32 a106, 0
v_accvgpr_write_b32 a107, 0
v_accvgpr_write_b32 a108, 0
v_accvgpr_write_b32 a109, 0
v_accvgpr_write_b32 a110, 0
v_accvgpr_write_b32 a111, 0
v_accvgpr_write_b32 a112, 0
v_accvgpr_write_b32 a113, 0
v_accvgpr_write_b32 a114, 0
v_accvgpr_write_b32 a115, 0
v_accvgpr_write_b32 a116, 0
v_accvgpr_write_b32 a117, 0
v_accvgpr_write_b32 a118, 0
v_accvgpr_write_b32 a119, 0
v_accvgpr_write_b32 a120, 0
v_accvgpr_write_b32 a121, 0
v_accvgpr_write_b32 a122, 0
v_accvgpr_write_b32 a123, 0
v_accvgpr_write_b32 a124, 0
v_accvgpr_write_b32 a125, 0
v_accvgpr_write_b32 a126, 0
v_accvgpr_write_b32 a127, 0
s_mov_b32 s88, 0
s_mov_b32 s89, 0
s_mov_b32 s94, 0
L_redoB_26:
s_add_u32 m0, s90, 0x1c000
s_nop 0
buffer_load_dwordx4 v33, s[20:23], s88 offen lds
buffer_load_dwordx4 v34, s[20:23], s88 offen offset:1024 lds
s_add_u32 s88, s88, 0x2000
s_add_u32 m0, s90, 0x22000
s_nop 0
buffer_load_dwordx4 v35, s[24:27], s89 offen lds
buffer_load_dwordx4 v35, s[24:27], s89 offen offset:1024 lds
s_add_u32 s89, s89, 0x2000
s_waitcnt vmcnt(0)
s_barrier
ds_read_b128 a[192:195], v10
ds_read_b128 a[196:199], v11
ds_read_b128 a[200:203], v12
ds_read_b128 a[204:207], v13
ds_read_b128 a[208:211], v14
ds_read_b128 a[212:215], v15
ds_read_b128 a[216:219], v16
ds_read_b128 a[220:223], v17
ds_read_b64_tr_b16 a[224:225], v18 offset:0
ds_read_b64_tr_b16 a[226:227], v18 offset:2048
ds_read_b64_tr_b16 a[232:233], v19 offset:0
ds_read_b64_tr_b16 a[234:235], v19 offset:2048
ds_read_b64_tr_b16 a[240:241], v20 offset:0
ds_read_b64_tr_b16 a[242:243], v20 offset:2048
ds_read_b64_tr_b16 a[248:249], v21 offset:0
ds_read_b64_tr_b16 a[250:251], v21 offset:2048
ds_read_b64_tr_b16 a[228:229], v18 offset:4096
ds_read_b64_tr_b16 a[230:231], v18 offset:6144
ds_read_b64_tr_b16 a[236:237], v19 offset:4096
ds_read_b64_tr_b16 a[238:239], v19 offset:6144
ds_read_b64_tr_b16 a[244:245], v20 offset:4096
ds_read_b64_tr_b16 a[246:247], v20 offset:6144
ds_read_b64_tr_b16 a[252:253], v21 offset:4096
ds_read_b64_tr_b16 a[254:255], v21 offset:6144
s_waitcnt lgkmcnt(0)
v_mfma_f32_32x32x16_bf16 v[64:79], a[192:195], v[128:131], v[192:207]
v_mfma_f32_32x32x16_bf16 v[64:79], a[196:199], v[132:135], v[64:79]
v_mfma_f32_32x32x16_bf16 v[64:79], a[200:203], v[144:147], v[64:79]
v_mfma_f32_32x32x16_bf16 v[64:79], a[204:207], v[148:151], v[64:79]
v_mfma_f32_32x32x16_bf16 v[64:79], a[208:211], v[160:163], v[64:79]
v_mfma_f32_32x32x16_bf16 v[64:79], a[212:215], v[164:167], v[64:79]
v_mfma_f32_32x32x16_bf16 v[64:79], a[216:219], v[176:179], v[64:79]
v_mfma_f32_32x32x16_bf16 v[64:79], a[220:223], v[180:183], v[64:79]
v_mfma_f32_32x32x16_bf16 v[80:95], a[192:195], v[136:139], v[208:223]
v_mfma_f32_32x32x16_bf16 v[80:95], a[196:199], v[140:143], v[80:95]
v_mfma_f32_32x32x16_bf16 v[80:95], a[200:203], v[152:155], v[80:95]
v_mfma_f32_32x32x16_bf16 v[80:95], a[204:207], v[156:159], v[80:95]
v_mfma_f32_32x32x16_bf16 v[80:95], a[208:211], v[168:171], v[80:95]
v_mfma_f32_32x32x16_bf16 v[80:95], a[212:215], v[172:175], v[80:95]
v_mfma_f32_32x32x16_bf16 v[80:95], a[216:219], v[184:187], v[80:95]
v_mfma_f32_32x32x16_bf16 v[80:95], a[220:223], v[188:191], v[80:95]
s_nop 3
v_exp_f32 v64, v64
v_exp_f32 v65, v65
v_exp_f32 v66, v66
v_exp_f32 v67, v67
v_add_f32 v224, v224, v64
v_add_f32 v225, v225, v65
v_cvt_pk_bf16_f32 v96, v64, v65
v_exp_f32 v68, v68
v_exp_f32 v69, v69
v_add_f32 v224, v224, v66
v_add_f32 v225, v225, v67
v_cvt_pk_bf16_f32 v97, v66, v67
v_exp_f32 v70, v70
v_exp_f32 v71, v71
v_add_f32 v224, v224, v68
v_add_f32 v225, v225, v69
v_cvt_pk_bf16_f32 v98, v68, v69
v_exp_f32 v72, v72
v_exp_f32 v73, v73
v_add_f32 v224, v224, v70
v_add_f32 v225, v225, v71
v_cvt_pk_bf16_f32 v99, v70, v71
v_exp_f32 v74, v74
v_exp_f32 v75, v75
v_add_f32 v224, v224, v72
v_add_f32 v225, v225, v73
v_cvt_pk_bf16_f32 v100, v72, v73
v_exp_f32 v76, v76
v_exp_f32 v77, v77
v_add_f32 v224, v224, v74
v_add_f32 v225, v225, v75
v_cvt_pk_bf16_f32 v101, v74, v75
v_exp_f32 v78, v78
v_exp_f32 v79, v79
v_add_f32 v224, v224, v76
v_add_f32 v225, v225, v77
v_cvt_pk_bf16_f32 v102, v76, v77
v_add_f32 v224, v224, v78
v_add_f32 v225, v225, v79
v_cvt_pk_bf16_f32 v103, v78, v79
v_exp_f32 v80, v80
v_exp_f32 v81, v81
v_exp_f32 v82, v82
v_exp_f32 v83, v83
v_add_f32 v226, v226, v80
v_add_f32 v227, v227, v81
v_cvt_pk_bf16_f32 v104, v80, v81
v_exp_f32 v84, v84
v_exp_f32 v85, v85
v_add_f32 v226, v226, v82
v_add_f32 v227, v227, v83
v_cvt_pk_bf16_f32 v105, v82, v83
v_exp_f32 v86, v86
v_exp_f32 v87, v87
v_add_f32 v226, v226, v84
v_add_f32 v227, v227, v85
v_cvt_pk_bf16_f32 v106, v84, v85
v_exp_f32 v88, v88
v_exp_f32 v89, v89
v_add_f32 v226, v226, v86
v_add_f32 v227, v227, v87
v_cvt_pk_bf16_f32 v107, v86, v87
v_exp_f32 v90, v90
v_exp_f32 v91, v91
v_add_f32 v226, v226, v88
v_add_f32 v227, v227, v89
v_cvt_pk_bf16_f32 v108, v88, v89
v_exp_f32 v92, v92
v_exp_f32 v93, v93
v_add_f32 v226, v226, v90
v_add_f32 v227, v227, v91
v_cvt_pk_bf16_f32 v109, v90, v91
v_exp_f32 v94, v94
v_exp_f32 v95, v95
v_add_f32 v226, v226, v92
v_add_f32 v227, v227, v93
v_cvt_pk_bf16_f32 v110, v92, v93
v_add_f32 v226, v226, v94
v_add_f32 v227, v227, v95
v_cvt_pk_bf16_f32 v111, v94, v95
v_mfma_f32_32x32x16_bf16 a[0:15], a[224:227], v[96:99], a[0:15]
v_mfma_f32_32x32x16_bf16 a[32:47], a[232:235], v[96:99], a[32:47]
v_mfma_f32_32x32x16_bf16 a[64:79], a[240:243], v[96:99], a[64:79]
v_mfma_f32_32x32x16_bf16 a[96:111], a[248:251], v[96:99], a[96:111]
v_mfma_f32_32x32x16_bf16 a[0:15], a[228:231], v[100:103], a[0:15]
v_mfma_f32_32x32x16_bf16 a[32:47], a[236:239], v[100:103], a[32:47]
v_mfma_f32_32x32x16_bf16 a[64:79], a[244:247], v[100:103], a[64:79]
v_mfma_f32_32x32x16_bf16 a[96:111], a[252:255], v[100:103], a[96:111]
v_mfma_f32_32x32x16_bf16 a[16:31], a[224:227], v[104:107], a[16:31]
v_mfma_f32_32x32x16_bf16 a[48:63], a[232:235], v[104:107], a[48:63]
v_mfma_f32_32x32x16_bf16 a[80:95], a[240:243], v[104:107], a[80:95]
v_mfma_f32_32x32x16_bf16 a[112:127], a[248:251], v[104:107], a[112:127]
v_mfma_f32_32x32x16_bf16 a[16:31], a[228:231], v[108:111], a[16:31]
v_mfma_f32_32x32x16_bf16 a[48:63], a[236:239], v[108:111], a[48:63]
v_mfma_f32_32x32x16_bf16 a[80:95], a[244:247], v[108:111], a[80:95]
v_mfma_f32_32x32x16_bf16 a[112:127], a[252:255], v[108:111], a[112:127]
s_barrier
s_add_u32 s94, s94, 1
s_cmp_lt_u32 s94, 16
s_cbranch_scc1 L_redoB_26
v_add_f32 v37, v224, v225
v_mov_b32 v2, v37
v_add_f32 v38, v226, v227
v_mov_b32 v3, v38
v_permlane32_swap_b32 v37, v2
s_nop 0
v_permlane32_swap_b32 v38, v3
v_add_f32 v37, v37, v2
v_add_f32 v38, v38, v3
s_nop 7
s_waitcnt lgkmcnt(0)
s_branch L_slow_13_r
L_slow_14:
s_mov_b32 s91, 0
L_poll_27:
buffer_load_dword v55, v56, s[28:31], s55 offen sc0 sc1
s_waitcnt vmcnt(0)
v_xor_b32 v6, s32, v55
v_cmp_eq_u32 vcc, 0, v6
s_cmp_eq_u64 vcc, exec
s_cbranch_scc1 L_polld_28
s_add_u32 s91, s91, 1
s_cmp_lt_u32 s91, 0x4e20
s_cbranch_scc0 L_polld_28_to
s_sleep 2
s_branch L_poll_27
L_polld_28_to:
s_or_b32 s67, s67, 16
L_polld_28:
s_waitcnt lgkmcnt(0)
s_branch L_slow_14_r
L_slow_15:
s_mov_b32 s91, 0
L_poll_29:
buffer_load_dword v16, v17, s[28:31], s39 offen sc0 sc1
s_waitcnt vmcnt(0)
v_xor_b32 v6, s32, v16
v_cmp_eq_u32 vcc, 0, v6
s_cmp_eq_u64 vcc, exec
s_cbranch_scc1 L_polld_30
s_add_u32 s91, s91, 1
s_cmp_lt_u32 s91, 0x4e20
s_cbranch_scc0 L_polld_30_to
s_sleep 2
s_branch L_poll_29
L_polld_30_to:
s_or_b32 s67, s67, 32
L_polld_30:
s_waitcnt lgkmcnt(0)
s_branch L_slow_15_r
L_slow_16:
s_mov_b32 s91, 0
L_poll_31:
buffer_load_dword v22, v23, s[28:31], s46 offen sc0 sc1
s_waitcnt vmcnt(0)
v_xor_b32 v6, s32, v22
v_cmp_eq_u32 vcc, 0, v6
s_cmp_eq_u64 vcc, exec
s_cbranch_scc1 L_polld_32
s_add_u32 s91, s91, 1
s_cmp_lt_u32 s91, 0x4e20
s_cbranch_scc0 L_polld_32_to
s_sleep 2
s_branch L_poll_31
L_polld_32_to:
s_or_b32 s67, s67, 64
L_polld_32:
s_waitcnt lgkmcnt(0)
s_branch L_slow_16_r
.section .rodata,"a"
.p2align 6
.amdhsa_kernel recurrent_scan__sliding_block_cached__mixer_gmlp__prompt_kernel
  .amdhsa_next_free_vgpr 512
  .amdhsa_next_free_sgpr 102
  .amdhsa_accum_offset 256
  .amdhsa_group_segment_fixed_size 0
  .amdhsa_kernarg_size 104
  .amdhsa_user_sgpr_count 2
  .amdhsa_user_sgpr_kernarg_segment_ptr 1
  .amdhsa_system_sgpr_workgroup_id_x 1
.end_amdhsa_kernel
.text
```
